```python
import torch

def _softmax(x, axis=-1):
    return torch.softmax(x, dim=axis)

def _gelu(x):
    return torch.nn.functional.gelu(x, approximate='tanh')

def _silu(x):
    return torch.nn.functional.silu(x)

def _sigmoid(x):
    return torch.sigmoid(x)

def _layernorm(x, axis=-1, eps=1e-05):
    m = x.mean(dim=axis, keepdim=True)
    v = x.var(dim=axis, keepdim=True, unbiased=False)
    return (x - m) / torch.sqrt(v + eps)

def _scatter_add(tgt, idx, src, axis=0):
    return tgt.clone().index_add_(axis, idx, src)

def _segment_sum(src, seg, n):
    out = torch.zeros((n,) + src.shape[1:], dtype=src.dtype)
    return out.index_add_(0, seg, src)

def _pad(x, pw):
    flat = tuple((v for pair in reversed(pw) for v in pair))
    return torch.nn.functional.pad(x, flat)
kernel_name = 'adaLN_cond__compressed_kv_cla__glu_gated_geglu__prompt'

def setup_inputs():

    _w = lambda a: (lambda t: t.to(torch.bfloat16) if t.is_floating_point() else t)(torch.as_tensor(a))

    def _A_setup():
        B, H, Sq, Sk, D, M = (1, 32, 2048, 2048, 128, 640)
        Dc = 4 * D
        return {'x': _w((lambda *s: torch.randn(*s, dtype=torch.bfloat16) * 0.1)(B, Sq, M)), 'c_kv': _w((lambda *s: torch.randn(*s, dtype=torch.bfloat16) * 3.2)(B, Sk, Dc)), 'w_q': _w((lambda *s: torch.randn(*s, dtype=torch.bfloat16) * 0.4)(M, H, D) * M ** (-0.5)), 'w_uk': _w((lambda *s: torch.randn(*s, dtype=torch.bfloat16) * 0.4)(Dc, H, D) * Dc ** (-0.5)), 'w_uv': _w((lambda *s: torch.randn(*s, dtype=torch.bfloat16) * 3.2)(Dc, H, D) * Dc ** (-0.5)), 'w_o': _w((lambda *s: torch.randn(*s, dtype=torch.bfloat16) * 3.2)(H, D, M) * (H * D) ** (-0.5))}
    _A_in = _A_setup()

    def _B_setup():
        B, S, Dm, Df = (1, 2048, 640, 1728)
        return {'x': _w((lambda *s: torch.randn(*s, dtype=torch.bfloat16) * 0.1)(B, S, Dm)), 'w_gate': _w((lambda *s: torch.randn(*s, dtype=torch.bfloat16) * 3.2)(Dm, Df) * Dm ** (-0.5)), 'w_up': _w((lambda *s: torch.randn(*s, dtype=torch.bfloat16) * 3.2)(Dm, Df) * Dm ** (-0.5)), 'w_down': _w((lambda *s: torch.randn(*s, dtype=torch.bfloat16) * 3.2)(Df, Dm) * Df ** (-0.5))}
    _B_in = _B_setup()
    return {'A_x': _A_in['x'], 'A_c_kv': _A_in['c_kv'], 'A_w_q': _A_in['w_q'], 'A_w_uk': _A_in['w_uk'], 'A_w_uv': _A_in['w_uv'], 'A_w_o': _A_in['w_o'], 'B_x': _B_in['x'], 'B_w_gate': _B_in['w_gate'], 'B_w_up': _B_in['w_up'], 'B_w_down': _B_in['w_down'], 'c': _w((lambda *s: torch.randn(*s, dtype=torch.bfloat16) * 0.4)(1, 640) * 8.0), 'w_mod': _w((lambda *s: torch.randn(*s, dtype=torch.bfloat16) * 0.4)(640, 6 * 640) * 640 ** (-0.5) * 8.0)}

def reference(A_x, A_c_kv, A_w_q, A_w_uk, A_w_uv, A_w_o, B_x, B_w_gate, B_w_up, B_w_down, c, w_mod):

    def _A_ref(x, c_kv, w_q, w_uk, w_uv, w_o):
        B, Sq, M = (x.shape[0], x.shape[1], x.shape[2])
        Sk = c_kv.shape[1]
        H, D = (w_q.shape[1], w_q.shape[2])
        q = torch.einsum('bqm,mhd->bhqd', x, w_q)
        k = torch.einsum('bkc,chd->bhkd', c_kv, w_uk)
        v = torch.einsum('bkc,chd->bhkd', c_kv, w_uv)
        scores = torch.einsum('bhqd,bhkd->bhqk', q, k) * D ** (-0.5)
        off = Sk - Sq
        qi = torch.arange(Sq)[:, None]
        kj = torch.arange(Sk)[None, :]
        cmask = kj <= qi + off
        scores = torch.where(cmask[None, None], scores, -1000000000.0)
        p = _softmax(scores, axis=-1)
        ctx = torch.einsum('bhqk,bhkd->bhqd', p, v)
        return torch.einsum('bhqd,hdm->bqm', ctx, w_o)

    def _B_ref(x, w_gate, w_up, w_down):
        g = torch.einsum('bsd,df->bsf', x, w_gate)
        u = torch.einsum('bsd,df->bsf', x, w_up)
        h = _gelu(g) * u
        return torch.einsum('bsf,fd->bsd', h, w_down)
    x = A_x
    mod = (_silu(c) @ w_mod).reshape(c.shape[0], 6, 1, -1)
    sa, ca, ga, sb, cb, gb = (mod[:, 0].clone(), mod[:, 1].clone(), mod[:, 2].clone(), mod[:, 3].clone(), mod[:, 4].clone(), mod[:, 5].clone())
    h = _layernorm(x, axis=-1) * (1 + ca) + sa
    x = x + ga * _A_ref(h, A_c_kv, A_w_q, A_w_uk, A_w_uv, A_w_o)
    h = _layernorm(x, axis=-1) * (1 + cb) + sb
    x = x + gb * _B_ref(h, B_w_gate, B_w_up, B_w_down)
    return x
```

```asm
; @launch kernel=adaLN_cond__compressed_kv_cla__glu_gated_geglu__prompt_kernel grid=(256,1,1) block=(256,1,1) lds=163840
.amdgcn_target "amdgcn-amd-amdhsa--gfx950"
.text
.macro mf a, b, c, d
v_mfma_f32_16x16x32_bf16 \a, \b, \c, \d
.endm
.macro ard a, b
v_accvgpr_read_b32 \a, \b
.endm
.macro awr a, b
v_accvgpr_write_b32 \a, \b
.endm
.macro cvt a, b, c
v_cvt_pk_bf16_f32 \a, \b, \c
.endm
.globl adaLN_cond__compressed_kv_cla__glu_gated_geglu__prompt_kernel
.p2align 8
.type adaLN_cond__compressed_kv_cla__glu_gated_geglu__prompt_kernel,@function
adaLN_cond__compressed_kv_cla__glu_gated_geglu__prompt_kernel:
s_cmp_ge_u32 s2,256
s_cbranch_scc0 Lgo
s_endpgm
Lgo:
s_load_dwordx2 s[4:5],s[0:1],112
s_load_dwordx2 s[6:7],s[0:1],8
s_load_dwordx2 s[8:9],s[0:1],24
s_load_dwordx2 s[10:11],s[0:1],32
s_load_dwordx2 s[12:13],s[0:1],0
s_load_dwordx2 s[24:25],s[0:1],80
s_load_dwordx2 s[26:27],s[0:1],88
s_load_dwordx2 s[32:33],s[0:1],104
s_load_dwordx2 s[70:71],s[0:1],16
v_lshrrev_b32 v33,6,v0
v_and_b32 v1,63,v0
v_readfirstlane_b32 s3,v33
s_getpc_b64 s[60:61]
ct1:
s_sub_u32 s60,s60,ct1-adaLN_cond__compressed_kv_cla__glu_gated_geglu__prompt_kernel
s_subb_u32 s61,s61,0
s_mov_b32 s62,code_end-adaLN_cond__compressed_kv_cla__glu_gated_geglu__prompt_kernel
s_mov_b32 s63,0x20000
s_bfe_u32 s64,s2,0x50003
s_lshl_b32 s64,s64,2
s_add_u32 s64,s64,s3
s_lshl_b32 s64,s64,7
v_lshlrev_b32 v206,14,v1
buffer_load_dword v206,v206,s[60:63],s64 offen
s_and_b32 s14,s2,7
s_lshl_b32 s14,s14,2
s_bfe_u32 s15,s2,0x20003
s_add_u32 s14,s14,s15
s_bfe_u32 s48,s2,0x10005
s_lshr_b32 s15,s2,6
v_lshrrev_b32 v34,4,v1
v_and_b32 v33,15,v1
v_lshlrev_b32 v35,1,v34
v_xor_b32 v35,v33,v35
v_lshlrev_b32 v36,13,v34
v_lshl_add_u32 v26,v35,4,v36
v_add_u32 v27,31744,v26
v_xor_b32 v28,128,v26
v_add_u32 v28,63488,v28
v_add_u32 v29,31744,v28
s_lshl_b32 s42,s3,17
s_lshl_b32 s43,s14,8
s_add_u32 s42,s42,s43
s_lshl_b32 s44,s3,12
s_and_b32 s55,s14,3
s_xor_b32 s55,s55,s15
s_lshl_b32 s55,s55,1
s_bfe_u32 s46,s2,0x30003
s_lshl_b32 s46,s46,2
s_add_u32 s46,s46,s3
s_lshl_b32 s46,s46,11
s_lshl_b32 s47,s15,19
s_add_u32 s46,s46,s47
s_mov_b32 s56,s46
v_lshlrev_b32 v30,7,v1
v_add_u32 v30,s46,v30
v_mov_b32 v31,0x4000000
v_cmp_gt_u32 vcc,16,v1
s_nop 1
v_cndmask_b32 v30,v31,v30,vcc
s_waitcnt lgkmcnt(0)
s_cmp_eq_u32 s48,0
s_cselect_b32 s8,s8,s10
s_cselect_b32 s9,s9,s11
s_mov_b32 s16,s6
s_mov_b32 s17,s7
s_mov_b32 s18,2097152
s_mov_b32 s19,0x20000
s_mov_b32 s20,s8
s_mov_b32 s21,s9
s_mov_b32 s22,4194304
s_mov_b32 s23,0x20000
s_xor_b32 s43,s55,0
s_lshl_b32 s43,s43,19
s_add_u32 m0,s44,0
s_add_u32 s43,s43,s42
buffer_load_dwordx4 v26,s[20:23],s43 offen lds
buffer_load_dwordx4 v27,s[20:23],s43 offen offset:1024 lds
buffer_load_dwordx4 v28,s[20:23],s43 offen offset:2048 lds
buffer_load_dwordx4 v29,s[20:23],s43 offen offset:3072 lds
v_xor_b32 v36,v33,v34
v_lshlrev_b32 v36,4,v36
v_lshl_add_u32 v36,v34,10,v36
v_xor_b32 v18,0,v36
v_xor_b32 v19,64,v36
v_add_u32 v19,3072,v19
v_xor_b32 v20,128,v36
v_add_u32 v20,6144,v20
v_xor_b32 v21,192,v36
v_add_u32 v21,9216,v21
s_lshl_b32 s40,s15,19
s_lshl_b32 s41,s3,14
s_add_u32 s40,s40,s41
s_lshl_b32 s41,s55,7
s_add_u32 s40,s40,s41
s_add_u32 m0,s44,16384
s_xor_b32 s43,s40,0
buffer_load_dwordx4 v18,s[16:19],s43 offen  lds
buffer_load_dwordx4 v19,s[16:19],s43 offen offset:1024  lds
buffer_load_dwordx4 v20,s[16:19],s43 offen offset:2048  lds
buffer_load_dwordx4 v21,s[16:19],s43 offen offset:3072  lds
s_lshl_b32 s47,s2,2
s_add_u32 s47,s47,s3
s_lshl_b32 s47,s47,11
s_sub_u32 s47,s47,s56
v_add_u32 v207,s47,v30
buffer_load_dword v207,v207,s[16:19],0 offen
s_and_b32 s45,s3,1
s_lshr_b32 s46,s3,1
v_xor_b32 v35,v33,v34
v_lshlrev_b32 v35,4,v35
v_lshl_add_u32 v35,v33,8,v35
s_lshl_b32 s47,s46,13
v_add_u32 v35,s47,v35
v_xor_b32 v2,0,v35
v_add_u32 v6,0x10000,v2
v_xor_b32 v3,64,v35
v_add_u32 v7,0x10000,v3
v_xor_b32 v4,128,v35
v_add_u32 v8,0x10000,v4
v_xor_b32 v5,192,v35
v_add_u32 v9,0x10000,v5
v_bfe_u32 v35,v1,2,2
v_lshl_add_u32 v36,v34,3,v35
v_lshlrev_b32 v36,8,v36
v_and_b32 v37,3,v1
v_lshl_add_u32 v36,v37,3,v36
v_and_b32 v37,1,v34
v_lshl_add_u32 v35,v37,2,v35
v_lshl_add_u32 v36,v35,5,v36
s_lshl_b32 s47,s45,7
v_xor_b32 v36,s47,v36
v_xor_b32 v10,0,v36
v_add_u32 v14,0x10000,v10
v_xor_b32 v11,32,v36
v_add_u32 v15,0x10000,v11
v_xor_b32 v12,64,v36
v_add_u32 v16,0x10000,v12
v_xor_b32 v13,96,v36
v_add_u32 v17,0x10000,v13
s_add_u32 m0,s44,32768
s_xor_b32 s43,s40,65536
buffer_load_dwordx4 v18,s[16:19],s43 offen  lds
buffer_load_dwordx4 v19,s[16:19],s43 offen offset:1024  lds
buffer_load_dwordx4 v20,s[16:19],s43 offen offset:2048  lds
buffer_load_dwordx4 v21,s[16:19],s43 offen offset:3072  lds
s_add_u32 s28,s4,2752512
s_addc_u32 s29,s5,0
s_mov_b32 s30,33554432
s_mov_b32 s31,0x20000
s_lshl_b32 s49,s14,20
s_lshl_b32 s47,s15,18
s_add_u32 s49,s49,s47
s_lshl_b32 s47,s46,13
s_add_u32 s49,s49,s47
s_add_u32 s47,s48,11
s_lshl_b32 s47,s45,s47
s_add_u32 s49,s49,s47
s_lshl_b32 s47,s48,14
s_add_u32 s49,s49,s47
v_lshlrev_b32 v32,4,v1
v_add_u32 v38,4096,v32
s_xor_b32 s43,s55,1
s_lshl_b32 s43,s43,19
s_add_u32 m0,s44,49152
s_add_u32 s43,s43,s42
buffer_load_dwordx4 v26,s[20:23],s43 offen lds
buffer_load_dwordx4 v27,s[20:23],s43 offen offset:1024 lds
buffer_load_dwordx4 v28,s[20:23],s43 offen offset:2048 lds
buffer_load_dwordx4 v29,s[20:23],s43 offen offset:3072 lds
s_cmp_eq_u32 s48,0
s_cbranch_scc0 LV
LK:
s_mov_b32 s72,s24
s_mov_b32 s73,s25
s_mov_b32 s74,1280
s_mov_b32 s75,0x20000
s_mov_b32 s76,s26
s_mov_b32 s77,s27
s_cmp_lt_u32 s2,240
s_cselect_b32 s78,4915200,0
s_mov_b32 s79,0x20000
s_mov_b32 s36,s32
s_mov_b32 s37,s33
s_mov_b32 s38,256
s_mov_b32 s39,0x20000
s_add_u32 s32,s4,0
s_addc_u32 s33,s5,0
s_mov_b32 s34,61440
s_mov_b32 s35,0x20000
s_lshr_b32 s64,s2,2
s_and_b32 s65,s2,3
v_lshrrev_b32 v250,3,v0
s_mul_i32 s50,s65,160
v_add_u32 v250,s50,v250
v_mul_u32_u24 v251,7680,v250
v_and_b32 v252,7,v0
v_lshl_add_u32 v251,v252,4,v251
v_lshlrev_b32 v250,1,v250
s_lshl_b32 s66,s64,7
v_lshlrev_b32 v252,5,v252
v_lshrrev_b32 v253,5,v1
v_lshl_add_u32 v252,v253,4,v252
v_bfe_u32 v253,v1,4,1
v_lshl_add_u32 v252,v253,3,v252
s_lshl_b32 s50,s3,8
s_add_u32 s50,s50,137216
v_add_u32 v252,s50,v252
v_lshlrev_b32 v253,2,v1
v_add_u32 v254,137216,v253
s_mul_i32 s67,s65,15360
s_lshl_b32 s50,s64,8
s_add_u32 s67,s67,s50
s_cmp_lt_u32 s2,240
s_cselect_b32 s67,s67,0x1000000
s_cmp_eq_u32 s3,0
s_cselect_b32 s67,s67,0x1000000
s_lshl_b32 s68,s65,6
s_cmp_lt_u32 s2,80
s_cselect_b32 s68,s68,4096
s_cmp_eq_u32 s3,0
s_cselect_b32 s68,s68,4096
v_lshlrev_b32 v255,12,v1
v_and_b32 v37,3,v1
v_lshlrev_b32 v37,6,v37
v_mov_b32 v35,1
v_lshlrev_b32 v40,4,v0
s_cmp_eq_u32 s3,0
s_cselect_b32 s50,0,0x1000000
s_cselect_b32 s51,0,1024
v_add_u32 v39,4096,v32
v_add_u32 v39,s50,v39
s_add_u32 s51,s51,135168
v_add_u32 v42,s51,v32
v_cmp_gt_u32 vcc,160,v0
s_nop 1
v_cndmask_b32 v36,1.0,0,vcc
v_add_u32 v41,131072,v40
s_add_u32 s8,s4,87883776
s_addc_u32 s9,s5,0
s_mov_b32 s10,212992
s_mov_b32 s11,0x20000
s_mul_i32 s50,s2,2688
s_cmp_lt_u32 s68,4096
s_cselect_b32 s50,s50,0x100000
v_lshlrev_b32 v22,7,v1
v_mov_b32 v23,0x100000
v_cmp_gt_u32 vcc,21,v1
s_nop 1
v_cndmask_b32 v22,v23,v22,vcc
v_mov_b32 v48,0
v_mov_b32 v49,0
v_mov_b32 v50,0
v_mov_b32 v51,0
buffer_store_dwordx4 v[48:51],v22,s[8:11],s50 offen sc1
buffer_store_dwordx4 v[48:51],v22,s[8:11],s50 offen offset:16 sc1
s_mov_b32 s52,15360
s_mov_b32 s53,30720
s_mov_b32 s54,46080
s_mov_b32 s56,s12
s_mov_b32 s57,s13
s_mov_b32 s58,2621440
s_mov_b32 s59,0x20000
s_mov_b32 s63,0x20000
s_add_u32 s60,s4,131072
s_addc_u32 s61,s5,0
s_mov_b32 s62,2621440
v_and_b32 v44,7,v1
v_lshrrev_b32 v47,3,v1
s_mul_i32 s50,s3,20
v_add_u32 v47,s50,v47
s_lshl_b32 s51,s2,3
v_add_u32 v45,s51,v44
v_mul_u32_u24 v45,1280,v45
v_lshl_add_u32 v45,v47,4,v45
v_lshrrev_b32 v43,5,v1
v_lshl_add_u32 v24,v43,26,v45
v_lshlrev_b32 v31,5,v47
v_add_u32 v31,131072,v31
s_lshr_b32 s50,s2,4
s_lshl_b32 s50,s50,1
s_bfe_u32 s51,s2,0x10002
s_add_u32 s50,s50,s51
s_mul_i32 s50,s50,81920
s_bfe_u32 s51,s2,0x10001
s_lshl_b32 s51,s51,11
s_add_u32 s50,s50,s51
s_bfe_u32 s51,s2,0x10003
s_lshl_b32 s51,s51,10
s_add_u32 s50,s50,s51
s_and_b32 s51,s2,1
s_lshl_b32 s51,s51,7
s_add_u32 s50,s50,s51
v_lshrrev_b32 v46,2,v47
v_lshlrev_b32 v46,12,v46
v_and_b32 v47,3,v47
v_lshl_add_u32 v46,v47,8,v46
v_lshl_add_u32 v46,v44,4,v46
v_add_u32 v46,s50,v46
v_lshl_add_u32 v25,v43,26,v46
v_sub_u32 v43,1,v43
v_cvt_f32_u32 v30,v43
v_lshlrev_b32 v44,4,v44
v_add_u32 v44,138240,v44
s_lshl_b32 s50,s3,2
v_add_u32 v47,s50,v44
s_mov_b32 s24,s70
s_mov_b32 s25,s71
s_mov_b32 s26,5242880
s_mov_b32 s27,0x20000
s_lshr_b32 s50,s2,5
s_lshl_b32 s50,s50,2
s_add_u32 s50,s50,s3
s_lshl_b32 s50,s50,13
s_lshl_b32 s6,s14,8
s_add_u32 s6,s6,s50
v_lshrrev_b32 v22,1,v1
v_lshlrev_b32 v22,18,v22
v_and_b32 v23,1,v1
v_lshl_add_u32 v22,v23,7,v22
s_waitcnt vmcnt(6)
s_barrier
ds_read_b128 v[132:135],v2 offset:20480
ds_read_b128 v[128:131],v2 offset:16384
ds_read_b64_tr_b16 a[0:1],v10 offset:0
s_xor_b32 s43,s55,2
s_lshl_b32 s43,s43,19
s_add_u32 m0,s44,65536
s_add_u32 s43,s43,s42
ds_read_b64_tr_b16 a[2:3],v10 offset:1024
ds_read_b64_tr_b16 a[4:5],v11 offset:0
buffer_load_dwordx4 v26,s[20:23],s43 offen lds
ds_read_b64_tr_b16 a[6:7],v11 offset:1024
ds_read_b64_tr_b16 a[8:9],v12 offset:0
ds_read_b64_tr_b16 a[10:11],v12 offset:1024
buffer_load_dwordx4 v27,s[20:23],s43 offen offset:1024 lds
ds_read_b64_tr_b16 a[12:13],v13 offset:0
ds_read_b64_tr_b16 a[14:15],v13 offset:1024
buffer_load_dwordx4 v28,s[20:23],s43 offen offset:2048 lds
ds_read_b128 v[140:143],v3 offset:20480
ds_read_b128 v[136:139],v3 offset:16384
buffer_load_dwordx4 v29,s[20:23],s43 offen offset:3072 lds
ds_read_b64_tr_b16 a[16:17],v10 offset:8192
ds_read_b64_tr_b16 a[18:19],v10 offset:9216
ds_read_b64_tr_b16 a[20:21],v11 offset:8192
s_add_u32 m0,s44,81920
s_xor_b32 s43,s40,256
ds_read_b64_tr_b16 a[22:23],v11 offset:9216
ds_read_b64_tr_b16 a[24:25],v12 offset:8192
buffer_load_dwordx4 v18,s[16:19],s43 offen  lds
ds_read_b64_tr_b16 a[26:27],v12 offset:9216
ds_read_b64_tr_b16 a[28:29],v13 offset:8192
ds_read_b64_tr_b16 a[30:31],v13 offset:9216
buffer_load_dwordx4 v19,s[16:19],s43 offen offset:1024  lds
ds_read_b128 v[164:167],v2 offset:36864
ds_read_b128 v[160:163],v2 offset:32768
buffer_load_dwordx4 v20,s[16:19],s43 offen offset:2048  lds
ds_read_b128 v[172:175],v3 offset:36864
ds_read_b128 v[168:171],v3 offset:32768
buffer_load_dwordx4 v21,s[16:19],s43 offen offset:3072  lds
s_waitcnt lgkmcnt(0)
s_waitcnt vmcnt(10)
s_barrier
mf v[64:67],a[0:3],v[128:131],0
ds_read_b128 v[148:151],v4 offset:20480
ds_read_b128 v[144:147],v4 offset:16384
mf v[64:67],a[16:19],v[136:139],v[64:67]
s_add_u32 m0,s44,98304
s_xor_b32 s43,s40,65792
mf v[68:71],a[20:23],v[136:139],0
ds_read_b64_tr_b16 a[32:33],v10 offset:49152
ds_read_b64_tr_b16 a[34:35],v10 offset:50176
mf v[68:71],a[4:7],v[128:131],v[68:71]
buffer_load_dwordx4 v18,s[16:19],s43 offen  lds
mf v[72:75],a[8:11],v[128:131],0
ds_read_b64_tr_b16 a[36:37],v11 offset:49152
ds_read_b64_tr_b16 a[38:39],v11 offset:50176
mf v[72:75],a[24:27],v[136:139],v[72:75]
buffer_load_dwordx4 v19,s[16:19],s43 offen offset:1024  lds
mf v[76:79],a[28:31],v[136:139],0
ds_read_b64_tr_b16 a[40:41],v12 offset:49152
ds_read_b64_tr_b16 a[42:43],v12 offset:50176
mf v[76:79],a[12:15],v[128:131],v[76:79]
buffer_load_dwordx4 v20,s[16:19],s43 offen offset:2048  lds
mf v[92:95],a[12:15],v[132:135],0
ds_read_b64_tr_b16 a[44:45],v13 offset:49152
ds_read_b64_tr_b16 a[46:47],v13 offset:50176
mf v[92:95],a[28:31],v[140:143],v[92:95]
buffer_load_dwordx4 v21,s[16:19],s43 offen offset:3072  lds
mf v[88:91],a[24:27],v[140:143],0
ds_read_b128 v[156:159],v5 offset:20480
ds_read_b128 v[152:155],v5 offset:16384
mf v[88:91],a[8:11],v[132:135],v[88:91]
s_xor_b32 s43,s55,3
s_lshl_b32 s43,s43,19
s_add_u32 m0,s44,114688
s_add_u32 s43,s43,s42
mf v[84:87],a[4:7],v[132:135],0
buffer_load_dwordx4 v26,s[20:23],s43 offen lds
mf v[84:87],a[20:23],v[140:143],v[84:87]
ds_read_b64_tr_b16 a[48:49],v10 offset:57344
ds_read_b64_tr_b16 a[50:51],v10 offset:58368
mf v[80:83],a[16:19],v[140:143],0
buffer_load_dwordx4 v27,s[20:23],s43 offen offset:1024 lds
mf v[80:83],a[0:3],v[132:135],v[80:83]
ds_read_b64_tr_b16 a[52:53],v11 offset:57344
ds_read_b64_tr_b16 a[54:55],v11 offset:58368
mf v[96:99],a[0:3],v[160:163],0
mf v[96:99],a[16:19],v[168:171],v[96:99]
ds_read_b64_tr_b16 a[56:57],v12 offset:57344
ds_read_b64_tr_b16 a[58:59],v12 offset:58368
mf v[100:103],a[20:23],v[168:171],0
buffer_load_dwordx4 v28,s[20:23],s43 offen offset:2048 lds
mf v[100:103],a[4:7],v[160:163],v[100:103]
ds_read_b64_tr_b16 a[60:61],v13 offset:57344
ds_read_b64_tr_b16 a[62:63],v13 offset:58368
mf v[104:107],a[8:11],v[160:163],0
buffer_load_dwordx4 v29,s[20:23],s43 offen offset:3072 lds
mf v[104:107],a[24:27],v[168:171],v[104:107]
ds_read_b128 v[180:183],v4 offset:36864
ds_read_b128 v[176:179],v4 offset:32768
mf v[108:111],a[28:31],v[168:171],0
s_xor_b32 s43,s55,4
s_lshl_b32 s43,s43,19
s_add_u32 m0,s44,0
s_add_u32 s43,s43,s42
mf v[108:111],a[12:15],v[160:163],v[108:111]
ds_read_b128 v[188:191],v5 offset:36864
ds_read_b128 v[184:187],v5 offset:32768
mf v[124:127],a[12:15],v[164:167],0
buffer_load_dwordx4 v26,s[20:23],s43 offen lds
mf v[124:127],a[28:31],v[172:175],v[124:127]
buffer_load_dwordx4 v27,s[20:23],s43 offen offset:1024 lds
mf v[120:123],a[24:27],v[172:175],0
mf v[120:123],a[8:11],v[164:167],v[120:123]
buffer_load_dwordx4 v28,s[20:23],s43 offen offset:2048 lds
mf v[116:119],a[4:7],v[164:167],0
mf v[116:119],a[20:23],v[172:175],v[116:119]
buffer_load_dwordx4 v29,s[20:23],s43 offen offset:3072 lds
mf v[112:115],a[16:19],v[172:175],0
mf v[112:115],a[0:3],v[164:167],v[112:115]
s_waitcnt lgkmcnt(0)
s_waitcnt vmcnt(8)
s_barrier
mf v[64:67],a[32:35],v[144:147],v[64:67]
ds_read_b128 v[132:135],v6 offset:20480
ds_read_b128 v[128:131],v6 offset:16384
mf v[64:67],a[48:51],v[152:155],v[64:67]
s_add_u32 m0,s44,16384
s_xor_b32 s43,s40,512
mf v[68:71],a[52:55],v[152:155],v[68:71]
ds_read_b64_tr_b16 a[64:65],v14 offset:0
ds_read_b64_tr_b16 a[66:67],v14 offset:1024
mf v[68:71],a[36:39],v[144:147],v[68:71]
mf v[72:75],a[40:43],v[144:147],v[72:75]
ds_read_b64_tr_b16 a[68:69],v15 offset:0
ds_read_b64_tr_b16 a[70:71],v15 offset:1024
mf v[72:75],a[56:59],v[152:155],v[72:75]
mf v[76:79],a[60:63],v[152:155],v[76:79]
ds_read_b64_tr_b16 a[72:73],v16 offset:0
ds_read_b64_tr_b16 a[74:75],v16 offset:1024
mf v[76:79],a[44:47],v[144:147],v[76:79]
buffer_load_dwordx4 v18,s[16:19],s43 offen  lds
mf v[92:95],a[44:47],v[148:151],v[92:95]
ds_read_b64_tr_b16 a[76:77],v17 offset:0
ds_read_b64_tr_b16 a[78:79],v17 offset:1024
mf v[92:95],a[60:63],v[156:159],v[92:95]
buffer_load_dwordx4 v[212:215],v251,s[76:79],s66 offen
s_add_u32 s66,s66,245760
mf v[88:91],a[56:59],v[156:159],v[88:91]
ds_read_b128 v[140:143],v7 offset:20480
ds_read_b128 v[136:139],v7 offset:16384
mf v[88:91],a[40:43],v[148:151],v[88:91]
buffer_load_ushort v232,v250,s[72:75],0 offen offset:0
mf v[84:87],a[36:39],v[148:151],v[84:87]
buffer_load_dwordx4 v19,s[16:19],s43 offen offset:1024  lds
mf v[84:87],a[52:55],v[156:159],v[84:87]
ds_read_b64_tr_b16 a[80:81],v14 offset:8192
ds_read_b64_tr_b16 a[82:83],v14 offset:9216
mf v[80:83],a[48:51],v[156:159],v[80:83]
buffer_load_dwordx4 v[216:219],v251,s[76:79],s66 offen
s_add_u32 s66,s66,245760
mf v[80:83],a[32:35],v[148:151],v[80:83]
ds_read_b64_tr_b16 a[84:85],v15 offset:8192
ds_read_b64_tr_b16 a[86:87],v15 offset:9216
mf v[96:99],a[32:35],v[176:179],v[96:99]
buffer_load_ushort v233,v250,s[72:75],0 offen offset:64
mf v[96:99],a[48:51],v[184:187],v[96:99]
ds_read_b64_tr_b16 a[88:89],v16 offset:8192
ds_read_b64_tr_b16 a[90:91],v16 offset:9216
mf v[100:103],a[52:55],v[184:187],v[100:103]
buffer_load_dwordx4 v[220:223],v251,s[76:79],s66 offen
s_add_u32 s66,s66,245760
mf v[100:103],a[36:39],v[176:179],v[100:103]
ds_read_b64_tr_b16 a[92:93],v17 offset:8192
ds_read_b64_tr_b16 a[94:95],v17 offset:9216
mf v[104:107],a[40:43],v[176:179],v[104:107]
buffer_load_dwordx4 v20,s[16:19],s43 offen offset:2048  lds
buffer_load_ushort v234,v250,s[72:75],0 offen offset:128
mf v[104:107],a[56:59],v[184:187],v[104:107]
ds_read_b128 v[164:167],v6 offset:36864
ds_read_b128 v[160:163],v6 offset:32768
mf v[108:111],a[60:63],v[184:187],v[108:111]
buffer_load_dwordx4 v[224:227],v251,s[76:79],s66 offen
s_add_u32 s66,s66,245760
mf v[108:111],a[44:47],v[176:179],v[108:111]
ds_read_b128 v[172:175],v7 offset:36864
ds_read_b128 v[168:171],v7 offset:32768
mf v[124:127],a[44:47],v[180:183],v[124:127]
buffer_load_ushort v235,v250,s[72:75],0 offen offset:192
buffer_load_dwordx4 v[192:195],v45,s[56:59],0 offen offset:0
mf v[124:127],a[60:63],v[188:191],v[124:127]
buffer_load_dwordx4 v21,s[16:19],s43 offen offset:3072  lds
buffer_load_dwordx4 v[196:199],v45,s[56:59],0 offen offset:128
mf v[120:123],a[56:59],v[188:191],v[120:123]
mf v[120:123],a[40:43],v[180:183],v[120:123]
buffer_load_dwordx4 v[228:231],v251,s[76:79],s66 offen
s_add_u32 s66,s66,245760
mf v[116:119],a[36:39],v[180:183],v[116:119]
buffer_load_dwordx4 v[200:203],v24,s[56:59],0 offen offset:256
mf v[116:119],a[52:55],v[188:191],v[116:119]
buffer_load_ushort v236,v250,s[72:75],0 offen offset:256
mf v[112:115],a[48:51],v[188:191],v[112:115]
mf v[112:115],a[32:35],v[180:183],v[112:115]
s_waitcnt lgkmcnt(0)
s_waitcnt vmcnt(21)
s_barrier
mf v[64:67],a[64:67],v[128:131],v[64:67]
ds_read_b128 v[148:151],v8 offset:20480
ds_read_b128 v[144:147],v8 offset:16384
mf v[64:67],a[80:83],v[136:139],v[64:67]
s_add_u32 m0,s44,32768
s_xor_b32 s43,s40,66048
mf v[68:71],a[84:87],v[136:139],v[68:71]
ds_read_b64_tr_b16 a[96:97],v14 offset:49152
ds_read_b64_tr_b16 a[98:99],v14 offset:50176
mf v[68:71],a[68:71],v[128:131],v[68:71]
buffer_load_dwordx4 v18,s[16:19],s43 offen  lds
mf v[72:75],a[72:75],v[128:131],v[72:75]
ds_read_b64_tr_b16 a[100:101],v15 offset:49152
ds_read_b64_tr_b16 a[102:103],v15 offset:50176
mf v[72:75],a[88:91],v[136:139],v[72:75]
buffer_load_dwordx4 v19,s[16:19],s43 offen offset:1024  lds
mf v[76:79],a[92:95],v[136:139],v[76:79]
ds_read_b64_tr_b16 a[104:105],v16 offset:49152
ds_read_b64_tr_b16 a[106:107],v16 offset:50176
mf v[76:79],a[76:79],v[128:131],v[76:79]
buffer_load_dwordx4 v20,s[16:19],s43 offen offset:2048  lds
mf v[92:95],a[76:79],v[132:135],v[92:95]
ds_read_b64_tr_b16 a[108:109],v17 offset:49152
ds_read_b64_tr_b16 a[110:111],v17 offset:50176
mf v[92:95],a[92:95],v[140:143],v[92:95]
buffer_load_dwordx4 v21,s[16:19],s43 offen offset:3072  lds
mf v[88:91],a[88:91],v[140:143],v[88:91]
ds_read_b128 v[156:159],v9 offset:20480
ds_read_b128 v[152:155],v9 offset:16384
mf v[88:91],a[72:75],v[132:135],v[88:91]
s_xor_b32 s43,s55,5
s_lshl_b32 s43,s43,19
s_add_u32 m0,s44,49152
s_add_u32 s43,s43,s42
mf v[84:87],a[68:71],v[132:135],v[84:87]
buffer_load_dwordx4 v26,s[20:23],s43 offen lds
mf v[84:87],a[84:87],v[140:143],v[84:87]
ds_read_b64_tr_b16 a[112:113],v14 offset:57344
ds_read_b64_tr_b16 a[114:115],v14 offset:58368
mf v[80:83],a[80:83],v[140:143],v[80:83]
buffer_load_dwordx4 v27,s[20:23],s43 offen offset:1024 lds
mf v[80:83],a[64:67],v[132:135],v[80:83]
ds_read_b64_tr_b16 a[116:117],v15 offset:57344
ds_read_b64_tr_b16 a[118:119],v15 offset:58368
mf v[96:99],a[64:67],v[160:163],v[96:99]
mf v[96:99],a[80:83],v[168:171],v[96:99]
ds_read_b64_tr_b16 a[120:121],v16 offset:57344
ds_read_b64_tr_b16 a[122:123],v16 offset:58368
mf v[100:103],a[84:87],v[168:171],v[100:103]
buffer_load_dwordx4 v28,s[20:23],s43 offen offset:2048 lds
mf v[100:103],a[68:71],v[160:163],v[100:103]
ds_read_b64_tr_b16 a[124:125],v17 offset:57344
ds_read_b64_tr_b16 a[126:127],v17 offset:58368
mf v[104:107],a[72:75],v[160:163],v[104:107]
buffer_load_dwordx4 v29,s[20:23],s43 offen offset:3072 lds
mf v[104:107],a[88:91],v[168:171],v[104:107]
ds_read_b128 v[180:183],v8 offset:36864
ds_read_b128 v[176:179],v8 offset:32768
mf v[108:111],a[92:95],v[168:171],v[108:111]
s_xor_b32 s43,s55,6
s_lshl_b32 s43,s43,19
s_add_u32 m0,s44,65536
s_add_u32 s43,s43,s42
mf v[108:111],a[76:79],v[160:163],v[108:111]
ds_read_b128 v[188:191],v9 offset:36864
ds_read_b128 v[184:187],v9 offset:32768
mf v[124:127],a[76:79],v[164:167],v[124:127]
buffer_load_dwordx4 v26,s[20:23],s43 offen lds
mf v[124:127],a[92:95],v[172:175],v[124:127]
buffer_load_dwordx4 v27,s[20:23],s43 offen offset:1024 lds
mf v[120:123],a[88:91],v[172:175],v[120:123]
mf v[120:123],a[72:75],v[164:167],v[120:123]
buffer_load_dwordx4 v28,s[20:23],s43 offen offset:2048 lds
mf v[116:119],a[68:71],v[164:167],v[116:119]
mf v[116:119],a[84:87],v[172:175],v[116:119]
buffer_load_dwordx4 v29,s[20:23],s43 offen offset:3072 lds
mf v[112:115],a[80:83],v[172:175],v[112:115]
mf v[112:115],a[64:67],v[164:167],v[112:115]
s_waitcnt lgkmcnt(0)
s_waitcnt vmcnt(8)
s_barrier
mf v[64:67],a[96:99],v[144:147],v[64:67]
ds_read_b128 v[132:135],v2 offset:20480
ds_read_b128 v[128:131],v2 offset:16384
mf v[64:67],a[112:115],v[152:155],v[64:67]
s_add_u32 m0,s44,81920
s_xor_b32 s43,s40,768
mf v[68:71],a[116:119],v[152:155],v[68:71]
ds_read_b64_tr_b16 a[128:129],v10 offset:0
ds_read_b64_tr_b16 a[130:131],v10 offset:1024
mf v[68:71],a[100:103],v[144:147],v[68:71]
v_lshlrev_b32 v232,16,v232
v_mul_f32 v240,0xbfb8aa3b,v232
mf v[72:75],a[104:107],v[144:147],v[72:75]
ds_read_b64_tr_b16 a[132:133],v11 offset:0
ds_read_b64_tr_b16 a[134:135],v11 offset:1024
mf v[72:75],a[120:123],v[152:155],v[72:75]
v_lshlrev_b32 v233,16,v233
v_mul_f32 v241,0xbfb8aa3b,v233
mf v[76:79],a[124:127],v[152:155],v[76:79]
ds_read_b64_tr_b16 a[136:137],v12 offset:0
ds_read_b64_tr_b16 a[138:139],v12 offset:1024
mf v[76:79],a[108:111],v[144:147],v[76:79]
buffer_load_dwordx4 v18,s[16:19],s43 offen  lds
mf v[92:95],a[108:111],v[148:151],v[92:95]
ds_read_b64_tr_b16 a[140:141],v13 offset:0
ds_read_b64_tr_b16 a[142:143],v13 offset:1024
mf v[92:95],a[124:127],v[156:159],v[92:95]
v_lshlrev_b32 v234,16,v234
v_mul_f32 v242,0xbfb8aa3b,v234
mf v[88:91],a[120:123],v[156:159],v[88:91]
ds_read_b128 v[140:143],v3 offset:20480
ds_read_b128 v[136:139],v3 offset:16384
mf v[88:91],a[104:107],v[148:151],v[88:91]
v_lshlrev_b32 v235,16,v235
v_mul_f32 v243,0xbfb8aa3b,v235
mf v[84:87],a[100:103],v[148:151],v[84:87]
buffer_load_dwordx4 v19,s[16:19],s43 offen offset:1024  lds
mf v[84:87],a[116:119],v[156:159],v[84:87]
ds_read_b64_tr_b16 a[144:145],v10 offset:8192
ds_read_b64_tr_b16 a[146:147],v10 offset:9216
mf v[80:83],a[112:115],v[156:159],v[80:83]
v_lshlrev_b32 v236,16,v236
v_mul_f32 v244,0xbfb8aa3b,v236
mf v[80:83],a[96:99],v[148:151],v[80:83]
ds_read_b64_tr_b16 a[148:149],v11 offset:8192
ds_read_b64_tr_b16 a[150:151],v11 offset:9216
mf v[96:99],a[96:99],v[176:179],v[96:99]
v_exp_f32 v240,v240
mf v[96:99],a[112:115],v[184:187],v[96:99]
ds_read_b64_tr_b16 a[152:153],v12 offset:8192
ds_read_b64_tr_b16 a[154:155],v12 offset:9216
mf v[100:103],a[116:119],v[184:187],v[100:103]
v_exp_f32 v241,v241
mf v[100:103],a[100:103],v[176:179],v[100:103]
ds_read_b64_tr_b16 a[156:157],v13 offset:8192
ds_read_b64_tr_b16 a[158:159],v13 offset:9216
mf v[104:107],a[104:107],v[176:179],v[104:107]
buffer_load_dwordx4 v20,s[16:19],s43 offen offset:2048  lds
mf v[104:107],a[120:123],v[184:187],v[104:107]
ds_read_b128 v[164:167],v2 offset:36864
ds_read_b128 v[160:163],v2 offset:32768
mf v[108:111],a[124:127],v[184:187],v[108:111]
v_exp_f32 v242,v242
mf v[108:111],a[108:111],v[176:179],v[108:111]
ds_read_b128 v[172:175],v3 offset:36864
ds_read_b128 v[168:171],v3 offset:32768
mf v[124:127],a[108:111],v[180:183],v[124:127]
v_exp_f32 v243,v243
mf v[124:127],a[124:127],v[188:191],v[124:127]
buffer_load_dwordx4 v21,s[16:19],s43 offen offset:3072  lds
mf v[120:123],a[120:123],v[188:191],v[120:123]
v_exp_f32 v244,v244
mf v[120:123],a[104:107],v[180:183],v[120:123]
v_add_f32 v240,1.0,v240
v_add_f32 v241,1.0,v241
mf v[116:119],a[100:103],v[180:183],v[116:119]
v_add_f32 v242,1.0,v242
v_add_f32 v243,1.0,v243
mf v[116:119],a[116:119],v[188:191],v[116:119]
v_add_f32 v244,1.0,v244
v_rcp_f32 v240,v240
v_rcp_f32 v241,v241
v_rcp_f32 v242,v242
v_rcp_f32 v243,v243
v_rcp_f32 v244,v244
v_mul_f32 v232,v232,v240
v_mul_f32 v233,v233,v241
v_mul_f32 v234,v234,v242
v_mul_f32 v235,v235,v243
v_mul_f32 v236,v236,v244
cvt v232,v232,v232
v_lshlrev_b32 v232,16,v232
cvt v233,v233,v233
v_lshlrev_b32 v233,16,v233
mf v[112:115],a[112:115],v[188:191],v[112:115]
mf v[112:115],a[96:99],v[180:183],v[112:115]
s_waitcnt lgkmcnt(0)
s_waitcnt vmcnt(8)
s_barrier
mf v[64:67],a[128:131],v[128:131],v[64:67]
ds_read_b128 v[148:151],v4 offset:20480
ds_read_b128 v[144:147],v4 offset:16384
mf v[64:67],a[144:147],v[136:139],v[64:67]
s_add_u32 m0,s44,98304
s_xor_b32 s43,s40,66304
mf v[68:71],a[148:151],v[136:139],v[68:71]
ds_read_b64_tr_b16 a[160:161],v10 offset:49152
ds_read_b64_tr_b16 a[162:163],v10 offset:50176
mf v[68:71],a[132:135],v[128:131],v[68:71]
buffer_load_dwordx4 v18,s[16:19],s43 offen  lds
cvt v234,v234,v234
v_lshlrev_b32 v234,16,v234
mf v[72:75],a[136:139],v[128:131],v[72:75]
ds_read_b64_tr_b16 a[164:165],v11 offset:49152
ds_read_b64_tr_b16 a[166:167],v11 offset:50176
mf v[72:75],a[152:155],v[136:139],v[72:75]
buffer_load_dwordx4 v19,s[16:19],s43 offen offset:1024  lds
cvt v235,v235,v235
v_lshlrev_b32 v235,16,v235
mf v[76:79],a[156:159],v[136:139],v[76:79]
ds_read_b64_tr_b16 a[168:169],v12 offset:49152
ds_read_b64_tr_b16 a[170:171],v12 offset:50176
mf v[76:79],a[140:143],v[128:131],v[76:79]
buffer_load_dwordx4 v20,s[16:19],s43 offen offset:2048  lds
cvt v236,v236,v236
v_lshlrev_b32 v236,16,v236
mf v[92:95],a[140:143],v[132:135],v[92:95]
ds_read_b64_tr_b16 a[172:173],v13 offset:49152
ds_read_b64_tr_b16 a[174:175],v13 offset:50176
mf v[92:95],a[156:159],v[140:143],v[92:95]
buffer_load_dwordx4 v21,s[16:19],s43 offen offset:3072  lds
v_lshlrev_b32 v248,16,v212
v_and_b32 v249,0xffff0000,v212
mf v[88:91],a[152:155],v[140:143],v[88:91]
ds_read_b128 v[156:159],v5 offset:20480
ds_read_b128 v[152:155],v5 offset:16384
mf v[88:91],a[136:139],v[132:135],v[88:91]
s_xor_b32 s43,s55,7
s_lshl_b32 s43,s43,19
s_add_u32 m0,s44,114688
s_add_u32 s43,s43,s42
mf v[84:87],a[132:135],v[132:135],v[84:87]
buffer_load_dwordx4 v26,s[20:23],s43 offen lds
v_mul_f32 v240,v248,v232
v_mul_f32 v241,v249,v232
mf v[84:87],a[148:151],v[140:143],v[84:87]
ds_read_b64_tr_b16 a[176:177],v10 offset:57344
ds_read_b64_tr_b16 a[178:179],v10 offset:58368
mf v[80:83],a[144:147],v[140:143],v[80:83]
buffer_load_dwordx4 v27,s[20:23],s43 offen offset:1024 lds
mf v[80:83],a[128:131],v[132:135],v[80:83]
ds_read_b64_tr_b16 a[180:181],v11 offset:57344
ds_read_b64_tr_b16 a[182:183],v11 offset:58368
mf v[96:99],a[128:131],v[160:163],v[96:99]
v_lshlrev_b32 v248,16,v213
v_and_b32 v249,0xffff0000,v213
mf v[96:99],a[144:147],v[168:171],v[96:99]
ds_read_b64_tr_b16 a[184:185],v12 offset:57344
ds_read_b64_tr_b16 a[186:187],v12 offset:58368
mf v[100:103],a[148:151],v[168:171],v[100:103]
buffer_load_dwordx4 v28,s[20:23],s43 offen offset:2048 lds
v_mul_f32 v242,v248,v232
v_mul_f32 v243,v249,v232
mf v[100:103],a[132:135],v[160:163],v[100:103]
ds_read_b64_tr_b16 a[188:189],v13 offset:57344
ds_read_b64_tr_b16 a[190:191],v13 offset:58368
mf v[104:107],a[136:139],v[160:163],v[104:107]
buffer_load_dwordx4 v29,s[20:23],s43 offen offset:3072 lds
v_lshlrev_b32 v248,16,v214
v_and_b32 v249,0xffff0000,v214
mf v[104:107],a[152:155],v[168:171],v[104:107]
ds_read_b128 v[180:183],v4 offset:36864
ds_read_b128 v[176:179],v4 offset:32768
mf v[108:111],a[156:159],v[168:171],v[108:111]
s_add_u32 m0,s44,0
s_xor_b32 s43,s40,131072
mf v[108:111],a[140:143],v[160:163],v[108:111]
ds_read_b128 v[188:191],v5 offset:36864
ds_read_b128 v[184:187],v5 offset:32768
mf v[124:127],a[140:143],v[164:167],v[124:127]
buffer_load_dwordx4 v18,s[16:19],s43 offen  lds
mf v[124:127],a[156:159],v[172:175],v[124:127]
buffer_load_dwordx4 v19,s[16:19],s43 offen offset:1024  lds
mf v[120:123],a[152:155],v[172:175],v[120:123]
v_mul_f32 v244,v248,v232
v_mul_f32 v245,v249,v232
mf v[120:123],a[136:139],v[164:167],v[120:123]
buffer_load_dwordx4 v20,s[16:19],s43 offen offset:2048  lds
mf v[116:119],a[132:135],v[164:167],v[116:119]
v_lshlrev_b32 v248,16,v215
v_and_b32 v249,0xffff0000,v215
mf v[116:119],a[148:151],v[172:175],v[116:119]
buffer_load_dwordx4 v21,s[16:19],s43 offen offset:3072  lds
v_mul_f32 v246,v248,v232
v_mul_f32 v247,v249,v232
v_lshlrev_b32 v248,16,v216
v_and_b32 v249,0xffff0000,v216
v_fmac_f32 v240,v248,v233
v_fmac_f32 v241,v249,v233
v_lshlrev_b32 v248,16,v217
v_and_b32 v249,0xffff0000,v217
v_fmac_f32 v242,v248,v233
v_fmac_f32 v243,v249,v233
v_lshlrev_b32 v248,16,v218
v_and_b32 v249,0xffff0000,v218
v_fmac_f32 v244,v248,v233
v_fmac_f32 v245,v249,v233
v_lshlrev_b32 v248,16,v219
mf v[112:115],a[144:147],v[172:175],v[112:115]
mf v[112:115],a[128:131],v[164:167],v[112:115]
s_waitcnt lgkmcnt(0)
s_waitcnt vmcnt(8)
s_barrier
mf v[64:67],a[160:163],v[144:147],v[64:67]
ds_read_b128 v[132:135],v6 offset:20480
ds_read_b128 v[128:131],v6 offset:16384
mf v[64:67],a[176:179],v[152:155],v[64:67]
s_add_u32 m0,s44,16384
s_xor_b32 s43,s40,131328
mf v[68:71],a[180:183],v[152:155],v[68:71]
ds_read_b64_tr_b16 a[192:193],v14 offset:0
ds_read_b64_tr_b16 a[194:195],v14 offset:1024
mf v[68:71],a[164:167],v[144:147],v[68:71]
v_and_b32 v249,0xffff0000,v219
v_fmac_f32 v246,v248,v233
mf v[72:75],a[168:171],v[144:147],v[72:75]
ds_read_b64_tr_b16 a[196:197],v15 offset:0
ds_read_b64_tr_b16 a[198:199],v15 offset:1024
mf v[72:75],a[184:187],v[152:155],v[72:75]
v_fmac_f32 v247,v249,v233
v_lshlrev_b32 v248,16,v220
mf v[76:79],a[188:191],v[152:155],v[76:79]
ds_read_b64_tr_b16 a[200:201],v16 offset:0
ds_read_b64_tr_b16 a[202:203],v16 offset:1024
mf v[76:79],a[172:175],v[144:147],v[76:79]
buffer_load_dwordx4 v18,s[16:19],s43 offen  lds
mf v[92:95],a[172:175],v[148:151],v[92:95]
ds_read_b64_tr_b16 a[204:205],v17 offset:0
ds_read_b64_tr_b16 a[206:207],v17 offset:1024
mf v[92:95],a[188:191],v[156:159],v[92:95]
v_and_b32 v249,0xffff0000,v220
v_fmac_f32 v240,v248,v234
mf v[88:91],a[184:187],v[156:159],v[88:91]
ds_read_b128 v[140:143],v7 offset:20480
ds_read_b128 v[136:139],v7 offset:16384
mf v[88:91],a[168:171],v[148:151],v[88:91]
v_fmac_f32 v241,v249,v234
v_lshlrev_b32 v248,16,v221
mf v[84:87],a[164:167],v[148:151],v[84:87]
buffer_load_dwordx4 v19,s[16:19],s43 offen offset:1024  lds
mf v[84:87],a[180:183],v[156:159],v[84:87]
ds_read_b64_tr_b16 a[208:209],v14 offset:8192
ds_read_b64_tr_b16 a[210:211],v14 offset:9216
mf v[80:83],a[176:179],v[156:159],v[80:83]
v_and_b32 v249,0xffff0000,v221
v_fmac_f32 v242,v248,v234
mf v[80:83],a[160:163],v[148:151],v[80:83]
ds_read_b64_tr_b16 a[212:213],v15 offset:8192
ds_read_b64_tr_b16 a[214:215],v15 offset:9216
mf v[96:99],a[160:163],v[176:179],v[96:99]
v_fmac_f32 v243,v249,v234
v_lshlrev_b32 v248,16,v222
mf v[96:99],a[176:179],v[184:187],v[96:99]
ds_read_b64_tr_b16 a[216:217],v16 offset:8192
ds_read_b64_tr_b16 a[218:219],v16 offset:9216
mf v[100:103],a[180:183],v[184:187],v[100:103]
v_and_b32 v249,0xffff0000,v222
v_fmac_f32 v244,v248,v234
mf v[100:103],a[164:167],v[176:179],v[100:103]
ds_read_b64_tr_b16 a[220:221],v17 offset:8192
ds_read_b64_tr_b16 a[222:223],v17 offset:9216
mf v[104:107],a[168:171],v[176:179],v[104:107]
buffer_load_dwordx4 v20,s[16:19],s43 offen offset:2048  lds
mf v[104:107],a[184:187],v[184:187],v[104:107]
ds_read_b128 v[164:167],v6 offset:36864
ds_read_b128 v[160:163],v6 offset:32768
mf v[108:111],a[188:191],v[184:187],v[108:111]
v_fmac_f32 v245,v249,v234
v_lshlrev_b32 v248,16,v223
mf v[108:111],a[172:175],v[176:179],v[108:111]
ds_read_b128 v[172:175],v7 offset:36864
ds_read_b128 v[168:171],v7 offset:32768
mf v[124:127],a[172:175],v[180:183],v[124:127]
v_and_b32 v249,0xffff0000,v223
v_fmac_f32 v246,v248,v234
mf v[124:127],a[188:191],v[188:191],v[124:127]
buffer_load_dwordx4 v21,s[16:19],s43 offen offset:3072  lds
mf v[120:123],a[184:187],v[188:191],v[120:123]
v_fmac_f32 v247,v249,v234
v_lshlrev_b32 v248,16,v224
mf v[120:123],a[168:171],v[180:183],v[120:123]
v_and_b32 v249,0xffff0000,v224
v_fmac_f32 v240,v248,v235
mf v[116:119],a[164:167],v[180:183],v[116:119]
v_fmac_f32 v241,v249,v235
v_lshlrev_b32 v248,16,v225
mf v[116:119],a[180:183],v[188:191],v[116:119]
v_and_b32 v249,0xffff0000,v225
v_fmac_f32 v242,v248,v235
v_fmac_f32 v243,v249,v235
v_lshlrev_b32 v248,16,v226
v_and_b32 v249,0xffff0000,v226
v_fmac_f32 v244,v248,v235
v_fmac_f32 v245,v249,v235
v_lshlrev_b32 v248,16,v227
v_and_b32 v249,0xffff0000,v227
v_fmac_f32 v246,v248,v235
mf v[112:115],a[176:179],v[188:191],v[112:115]
mf v[112:115],a[160:163],v[180:183],v[112:115]
s_waitcnt lgkmcnt(0)
s_waitcnt vmcnt(8)
s_barrier
mf v[64:67],a[192:195],v[128:131],v[64:67]
ds_read_b128 v[148:151],v8 offset:20480
ds_read_b128 v[144:147],v8 offset:16384
mf v[64:67],a[208:211],v[136:139],v[64:67]
s_add_u32 m0,s44,32768
s_xor_b32 s43,s40,131584
mf v[68:71],a[212:215],v[136:139],v[68:71]
ds_read_b64_tr_b16 a[224:225],v14 offset:49152
ds_read_b64_tr_b16 a[226:227],v14 offset:50176
mf v[68:71],a[196:199],v[128:131],v[68:71]
buffer_load_dwordx4 v18,s[16:19],s43 offen  lds
mf v[72:75],a[200:203],v[128:131],v[72:75]
ds_read_b64_tr_b16 a[228:229],v15 offset:49152
ds_read_b64_tr_b16 a[230:231],v15 offset:50176
mf v[72:75],a[216:219],v[136:139],v[72:75]
v_fmac_f32 v247,v249,v235
v_lshlrev_b32 v248,16,v228
mf v[76:79],a[220:223],v[136:139],v[76:79]
ds_read_b64_tr_b16 a[232:233],v16 offset:49152
ds_read_b64_tr_b16 a[234:235],v16 offset:50176
mf v[76:79],a[204:207],v[128:131],v[76:79]
buffer_load_dwordx4 v19,s[16:19],s43 offen offset:1024  lds
mf v[92:95],a[204:207],v[132:135],v[92:95]
ds_read_b64_tr_b16 a[236:237],v17 offset:49152
ds_read_b64_tr_b16 a[238:239],v17 offset:50176
mf v[92:95],a[220:223],v[140:143],v[92:95]
buffer_load_dwordx4 v20,s[16:19],s43 offen offset:2048  lds
mf v[88:91],a[216:219],v[140:143],v[88:91]
ds_read_b128 v[156:159],v9 offset:20480
ds_read_b128 v[152:155],v9 offset:16384
mf v[88:91],a[200:203],v[132:135],v[88:91]
v_and_b32 v249,0xffff0000,v228
v_fmac_f32 v240,v248,v236
mf v[84:87],a[196:199],v[132:135],v[84:87]
buffer_load_dwordx4 v21,s[16:19],s43 offen offset:3072  lds
mf v[84:87],a[212:215],v[140:143],v[84:87]
ds_read_b64_tr_b16 a[240:241],v14 offset:57344
ds_read_b64_tr_b16 a[242:243],v14 offset:58368
mf v[80:83],a[208:211],v[140:143],v[80:83]
v_fmac_f32 v241,v249,v236
v_lshlrev_b32 v248,16,v229
mf v[80:83],a[192:195],v[132:135],v[80:83]
ds_read_b64_tr_b16 a[244:245],v15 offset:57344
ds_read_b64_tr_b16 a[246:247],v15 offset:58368
mf v[96:99],a[192:195],v[160:163],v[96:99]
s_add_u32 m0,s44,49152
s_xor_b32 s43,s40,131840
mf v[96:99],a[208:211],v[168:171],v[96:99]
ds_read_b64_tr_b16 a[248:249],v16 offset:57344
ds_read_b64_tr_b16 a[250:251],v16 offset:58368
mf v[100:103],a[212:215],v[168:171],v[100:103]
v_and_b32 v249,0xffff0000,v229
v_fmac_f32 v242,v248,v236
mf v[100:103],a[196:199],v[160:163],v[100:103]
ds_read_b64_tr_b16 a[252:253],v17 offset:57344
ds_read_b64_tr_b16 a[254:255],v17 offset:58368
mf v[104:107],a[200:203],v[160:163],v[104:107]
buffer_load_dwordx4 v18,s[16:19],s43 offen  lds
mf v[104:107],a[216:219],v[168:171],v[104:107]
ds_read_b128 v[180:183],v8 offset:36864
ds_read_b128 v[176:179],v8 offset:32768
mf v[108:111],a[220:223],v[168:171],v[108:111]
buffer_load_dwordx4 v19,s[16:19],s43 offen offset:1024  lds
mf v[108:111],a[204:207],v[160:163],v[108:111]
ds_read_b128 v[188:191],v9 offset:36864
ds_read_b128 v[184:187],v9 offset:32768
mf v[124:127],a[204:207],v[164:167],v[124:127]
v_fmac_f32 v243,v249,v236
v_lshlrev_b32 v248,16,v230
mf v[124:127],a[220:223],v[172:175],v[124:127]
buffer_load_dwordx4 v20,s[16:19],s43 offen offset:2048  lds
mf v[120:123],a[216:219],v[172:175],v[120:123]
v_and_b32 v249,0xffff0000,v230
v_fmac_f32 v244,v248,v236
mf v[120:123],a[200:203],v[164:167],v[120:123]
v_fmac_f32 v245,v249,v236
v_lshlrev_b32 v248,16,v231
mf v[116:119],a[196:199],v[164:167],v[116:119]
buffer_load_dwordx4 v21,s[16:19],s43 offen offset:3072  lds
mf v[116:119],a[212:215],v[172:175],v[116:119]
v_and_b32 v249,0xffff0000,v231
v_fmac_f32 v246,v248,v236
v_fmac_f32 v247,v249,v236
v_permlane32_swap_b32 v240,v244
v_permlane32_swap_b32 v241,v245
v_permlane32_swap_b32 v242,v246
v_permlane32_swap_b32 v243,v247
v_add_f32 v240,v240,v244
v_add_f32 v241,v241,v245
v_add_f32 v242,v242,v246
v_add_f32 v243,v243,v247
s_nop 0
v_permlane16_swap_b32 v240,v242
v_permlane16_swap_b32 v241,v243
v_add_f32 v240,v240,v242
v_add_f32 v241,v241,v243
s_nop 0
v_add_f32_dpp v240,v240,v240 row_ror:8 row_mask:0xf bank_mask:0xf
v_add_f32_dpp v241,v241,v241 row_ror:8 row_mask:0xf bank_mask:0xf
ds_write_b64 v252,v[240:241]
mf v[112:115],a[208:211],v[172:175],v[112:115]
mf v[112:115],a[192:195],v[164:167],v[112:115]
s_waitcnt lgkmcnt(0)
s_waitcnt vmcnt(8)
s_barrier
mf v[64:67],a[224:227],v[144:147],v[64:67]
ds_read_b128 v[132:135],v2 offset:4096
ds_read2_b32 v[240:241],v254 offset0:0 offset1:64
mf v[64:67],a[240:243],v[152:155],v[64:67]
ds_read_b128 v[128:131],v2 offset:0
mf v[68:71],a[244:247],v[152:155],v[68:71]
ds_read_b128 v[140:143],v3 offset:4096
mf v[68:71],a[228:231],v[144:147],v[68:71]
ds_read_b128 v[136:139],v3 offset:0
ds_read2_b32 v[242:243],v254 offset0:128 offset1:192
mf v[72:75],a[232:235],v[144:147],v[72:75]
mf v[72:75],a[248:251],v[152:155],v[72:75]
mf v[76:79],a[252:255],v[152:155],v[76:79]
mf v[76:79],a[236:239],v[144:147],v[76:79]
mf v[92:95],a[236:239],v[148:151],v[92:95]
mf v[92:95],a[252:255],v[156:159],v[92:95]
mf v[88:91],a[248:251],v[156:159],v[88:91]
mf v[88:91],a[232:235],v[148:151],v[88:91]
mf v[84:87],a[228:231],v[148:151],v[84:87]
mf v[84:87],a[244:247],v[156:159],v[84:87]
mf v[80:83],a[240:243],v[156:159],v[80:83]
mf v[80:83],a[224:227],v[148:151],v[80:83]
mf v[96:99],a[224:227],v[176:179],v[96:99]
mf v[96:99],a[240:243],v[184:187],v[96:99]
mf v[100:103],a[244:247],v[184:187],v[100:103]
mf v[100:103],a[228:231],v[176:179],v[100:103]
s_waitcnt lgkmcnt(4)
v_add_f32 v240,v240,v241
mf v[104:107],a[232:235],v[176:179],v[104:107]
mf v[104:107],a[248:251],v[184:187],v[104:107]
mf v[108:111],a[252:255],v[184:187],v[108:111]
cvt v160,v64,v65
cvt v161,v66,v67
mf v[108:111],a[236:239],v[176:179],v[108:111]
cvt v162,v68,v69
cvt v163,v70,v71
mf v[124:127],a[236:239],v[180:183],v[124:127]
cvt v164,v72,v73
cvt v165,v74,v75
mf v[124:127],a[252:255],v[188:191],v[124:127]
cvt v166,v76,v77
cvt v167,v78,v79
mf v[120:123],a[248:251],v[188:191],v[120:123]
s_waitcnt lgkmcnt(0)
v_add_f32 v242,v242,v243
v_add_f32 v240,v240,v242
mf v[120:123],a[232:235],v[180:183],v[120:123]
cvt v168,v80,v81
cvt v169,v82,v83
mf v[116:119],a[228:231],v[180:183],v[116:119]
cvt v170,v84,v85
cvt v171,v86,v87
mf v[116:119],a[244:247],v[188:191],v[116:119]
cvt v172,v88,v89
cvt v173,v90,v91
mf v[112:115],a[240:243],v[188:191],v[112:115]
cvt v174,v92,v93
cvt v175,v94,v95
mf v[112:115],a[224:227],v[180:183],v[112:115]
s_waitcnt lgkmcnt(0)
buffer_store_dword v240,v253,s[32:35],s67 offen sc1
mf v[64:67],a[0:3],v[128:131],0
s_add_u32 m0,s44,65536
s_xor_b32 s43,s40,196608
mf v[64:67],a[16:19],v[136:139],v[64:67]
ds_read_b128 v[156:159],v5 offset:4096
ds_read_b128 v[152:155],v5 offset:0
mf v[68:71],a[20:23],v[136:139],0
ds_read_b128 v[148:151],v4 offset:4096
ds_read_b128 v[144:147],v4 offset:0
mf v[68:71],a[4:7],v[128:131],v[68:71]
buffer_load_dwordx4 v18,s[16:19],s43 offen  lds
mf v[72:75],a[8:11],v[128:131],0
buffer_store_dwordx4 v[160:163],v32,s[28:31],s49 offen sc1
mf v[72:75],a[24:27],v[136:139],v[72:75]
mf v[76:79],a[28:31],v[136:139],0
mf v[76:79],a[12:15],v[128:131],v[76:79]
buffer_load_dwordx4 v19,s[16:19],s43 offen offset:1024  lds
mf v[92:95],a[12:15],v[132:135],0
v_lshlrev_b32 v212,16,v192
v_and_b32 v213,0xffff0000,v192
mf v[92:95],a[28:31],v[140:143],v[92:95]
mf v[88:91],a[24:27],v[140:143],0
s_waitcnt vmcnt(3)
buffer_atomic_add v35,v255,s[36:39],s68 offen sc1
mf v[88:91],a[8:11],v[132:135],v[88:91]
buffer_load_dwordx4 v20,s[16:19],s43 offen offset:2048  lds
mf v[84:87],a[4:7],v[132:135],0
v_lshlrev_b32 v214,16,v193
v_and_b32 v215,0xffff0000,v193
mf v[84:87],a[20:23],v[140:143],v[84:87]
mf v[80:83],a[16:19],v[140:143],0
v_lshlrev_b32 v216,16,v194
v_and_b32 v217,0xffff0000,v194
mf v[80:83],a[0:3],v[132:135],v[80:83]
buffer_load_dwordx4 v21,s[16:19],s43 offen offset:3072  lds
s_waitcnt lgkmcnt(0)
mf v[64:67],a[32:35],v[144:147],v[64:67]
mf v[64:67],a[48:51],v[152:155],v[64:67]
ds_read_b128 v[140:143],v3 offset:20480
ds_read_b128 v[136:139],v3 offset:16384
mf v[68:71],a[52:55],v[152:155],v[68:71]
ds_read_b128 v[132:135],v2 offset:20480
ds_read_b128 v[128:131],v2 offset:16384
mf v[68:71],a[36:39],v[144:147],v[68:71]
s_add_u32 m0,s44,81920
s_xor_b32 s43,s40,196864
mf v[72:75],a[40:43],v[144:147],v[72:75]
buffer_store_dwordx4 v[164:167],v32,s[28:31],s49 offen offset:1024 sc1
mf v[72:75],a[56:59],v[152:155],v[72:75]
v_lshlrev_b32 v218,16,v195
v_and_b32 v219,0xffff0000,v195
mf v[76:79],a[60:63],v[152:155],v[76:79]
v_lshlrev_b32 v220,16,v196
v_and_b32 v221,0xffff0000,v196
mf v[76:79],a[44:47],v[144:147],v[76:79]
buffer_load_dwordx4 v18,s[16:19],s43 offen  lds
mf v[92:95],a[44:47],v[148:151],v[92:95]
v_lshlrev_b32 v222,16,v197
v_and_b32 v223,0xffff0000,v197
mf v[92:95],a[60:63],v[156:159],v[92:95]
mf v[88:91],a[56:59],v[156:159],v[88:91]
mf v[88:91],a[40:43],v[148:151],v[88:91]
buffer_load_dwordx4 v19,s[16:19],s43 offen offset:1024  lds
mf v[84:87],a[36:39],v[148:151],v[84:87]
v_lshlrev_b32 v224,16,v198
v_and_b32 v225,0xffff0000,v198
mf v[84:87],a[52:55],v[156:159],v[84:87]
mf v[80:83],a[48:51],v[156:159],v[80:83]
mf v[80:83],a[32:35],v[148:151],v[80:83]
buffer_load_dwordx4 v20,s[16:19],s43 offen offset:2048  lds
s_waitcnt lgkmcnt(0)
mf v[64:67],a[64:67],v[128:131],v[64:67]
v_lshlrev_b32 v226,16,v199
v_and_b32 v227,0xffff0000,v199
mf v[64:67],a[80:83],v[136:139],v[64:67]
ds_read_b128 v[156:159],v5 offset:20480
ds_read_b128 v[152:155],v5 offset:16384
mf v[68:71],a[84:87],v[136:139],v[68:71]
ds_read_b128 v[148:151],v4 offset:20480
ds_read_b128 v[144:147],v4 offset:16384
mf v[68:71],a[68:71],v[128:131],v[68:71]
buffer_load_dwordx4 v21,s[16:19],s43 offen offset:3072  lds
mf v[72:75],a[72:75],v[128:131],v[72:75]
v_lshlrev_b32 v228,16,v200
v_and_b32 v229,0xffff0000,v200
mf v[72:75],a[88:91],v[136:139],v[72:75]
v_lshlrev_b32 v230,16,v201
v_and_b32 v231,0xffff0000,v201
mf v[76:79],a[92:95],v[136:139],v[76:79]
buffer_store_dwordx4 v[168:171],v38,s[28:31],s49 offen sc1
mf v[76:79],a[76:79],v[128:131],v[76:79]
mf v[92:95],a[76:79],v[132:135],v[92:95]
s_barrier
mf v[92:95],a[92:95],v[140:143],v[92:95]
v_lshlrev_b32 v232,16,v202
v_and_b32 v233,0xffff0000,v202
mf v[88:91],a[88:91],v[140:143],v[88:91]
s_add_u32 m0,s44,98304
s_xor_b32 s43,s40,197120
mf v[88:91],a[72:75],v[132:135],v[88:91]
mf v[84:87],a[68:71],v[132:135],v[84:87]
v_lshlrev_b32 v234,16,v203
v_and_b32 v235,0xffff0000,v203
mf v[84:87],a[84:87],v[140:143],v[84:87]
mf v[80:83],a[80:83],v[140:143],v[80:83]
mf v[80:83],a[64:67],v[132:135],v[80:83]
buffer_load_dwordx4 v18,s[16:19],s43 offen  lds
s_waitcnt lgkmcnt(0)
mf v[64:67],a[96:99],v[144:147],v[64:67]
v_add_f32 v204,v212,v213
v_add_f32 v205,v214,v215
mf v[64:67],a[112:115],v[152:155],v[64:67]
ds_read_b128 v[140:143],v3 offset:36864
ds_read_b128 v[136:139],v3 offset:32768
mf v[68:71],a[116:119],v[152:155],v[68:71]
ds_read_b128 v[132:135],v2 offset:36864
ds_read_b128 v[128:131],v2 offset:32768
mf v[68:71],a[100:103],v[144:147],v[68:71]
buffer_store_dwordx4 v[172:175],v38,s[28:31],s49 offen offset:1024 sc1
s_add_u32 s49,s49,32768
mf v[72:75],a[104:107],v[144:147],v[72:75]
v_add_f32 v204,v204,v216
v_add_f32 v205,v205,v217
mf v[72:75],a[120:123],v[152:155],v[72:75]
buffer_load_dwordx4 v19,s[16:19],s43 offen offset:1024  lds
mf v[76:79],a[124:127],v[152:155],v[76:79]
v_add_f32 v204,v204,v218
v_add_f32 v205,v205,v219
mf v[76:79],a[108:111],v[144:147],v[76:79]
mf v[92:95],a[108:111],v[148:151],v[92:95]
mf v[92:95],a[124:127],v[156:159],v[92:95]
v_add_f32 v204,v204,v220
v_add_f32 v205,v205,v221
mf v[88:91],a[120:123],v[156:159],v[88:91]
buffer_load_dwordx4 v20,s[16:19],s43 offen offset:2048  lds
mf v[88:91],a[104:107],v[148:151],v[88:91]
mf v[84:87],a[100:103],v[148:151],v[84:87]
v_add_f32 v204,v204,v222
v_add_f32 v205,v205,v223
mf v[84:87],a[116:119],v[156:159],v[84:87]
mf v[80:83],a[112:115],v[156:159],v[80:83]
mf v[80:83],a[96:99],v[148:151],v[80:83]
s_waitcnt lgkmcnt(0)
mf v[64:67],a[128:131],v[128:131],v[64:67]
buffer_load_dwordx4 v21,s[16:19],s43 offen offset:3072  lds
mf v[64:67],a[144:147],v[136:139],v[64:67]
ds_read_b128 v[156:159],v5 offset:36864
ds_read_b128 v[152:155],v5 offset:32768
mf v[68:71],a[148:151],v[136:139],v[68:71]
ds_read_b128 v[148:151],v4 offset:36864
ds_read_b128 v[144:147],v4 offset:32768
mf v[68:71],a[132:135],v[128:131],v[68:71]
v_add_f32 v204,v204,v224
v_add_f32 v205,v205,v225
mf v[72:75],a[136:139],v[128:131],v[72:75]
cvt v160,v96,v97
cvt v161,v98,v99
mf v[72:75],a[152:155],v[136:139],v[72:75]
v_add_f32 v204,v204,v226
v_add_f32 v205,v205,v227
mf v[76:79],a[156:159],v[136:139],v[76:79]
s_add_u32 m0,s44,114688
s_xor_b32 s43,s40,197376
mf v[76:79],a[140:143],v[128:131],v[76:79]
v_add_f32 v204,v204,v228
v_add_f32 v205,v205,v229
mf v[92:95],a[140:143],v[132:135],v[92:95]
v_add_f32 v204,v204,v230
v_add_f32 v205,v205,v231
mf v[92:95],a[156:159],v[140:143],v[92:95]
cvt v162,v100,v101
cvt v163,v102,v103
mf v[88:91],a[152:155],v[140:143],v[88:91]
v_add_f32 v204,v204,v232
v_add_f32 v205,v205,v233
mf v[88:91],a[136:139],v[132:135],v[88:91]
mf v[84:87],a[132:135],v[132:135],v[84:87]
v_add_f32 v204,v204,v234
v_add_f32 v205,v205,v235
mf v[84:87],a[148:151],v[140:143],v[84:87]
buffer_load_dwordx4 v18,s[16:19],s43 offen  lds
mf v[80:83],a[144:147],v[140:143],v[80:83]
mf v[80:83],a[128:131],v[132:135],v[80:83]
v_add_f32 v204,v204,v205
s_waitcnt lgkmcnt(0)
mf v[64:67],a[160:163],v[144:147],v[64:67]
buffer_store_dwordx4 v[160:163],v32,s[28:31],s49 offen sc1
cvt v164,v104,v105
mf v[64:67],a[176:179],v[152:155],v[64:67]
ds_read_b128 v[140:143],v3 offset:53248
ds_read_b128 v[136:139],v3 offset:49152
mf v[68:71],a[180:183],v[152:155],v[68:71]
ds_read_b128 v[132:135],v2 offset:53248
ds_read_b128 v[128:131],v2 offset:49152
mf v[68:71],a[164:167],v[144:147],v[68:71]
buffer_load_dwordx4 v19,s[16:19],s43 offen offset:1024  lds
mf v[72:75],a[168:171],v[144:147],v[72:75]
cvt v165,v106,v107
cvt v166,v108,v109
mf v[72:75],a[184:187],v[152:155],v[72:75]
v_add_f32_dpp v204,v204,v204 row_ror:8 row_mask:0xf bank_mask:0xf
v_mov_b32 v205,v204
mf v[76:79],a[188:191],v[152:155],v[76:79]
mf v[76:79],a[172:175],v[144:147],v[76:79]
mf v[92:95],a[172:175],v[148:151],v[92:95]
mf v[92:95],a[188:191],v[156:159],v[92:95]
v_permlane16_swap_b32 v204,v205
v_add_f32 v204,v204,v205
mf v[88:91],a[184:187],v[156:159],v[88:91]
buffer_load_dwordx4 v20,s[16:19],s43 offen offset:2048  lds
mf v[88:91],a[168:171],v[148:151],v[88:91]
v_mov_b32 v205,v204
mf v[84:87],a[164:167],v[148:151],v[84:87]
mf v[84:87],a[180:183],v[156:159],v[84:87]
cvt v167,v110,v111
buffer_store_dwordx4 v[164:167],v32,s[28:31],s49 offen offset:1024 sc1
mf v[80:83],a[176:179],v[156:159],v[80:83]
mf v[80:83],a[160:163],v[148:151],v[80:83]
s_waitcnt lgkmcnt(0)
mf v[64:67],a[192:195],v[128:131],v[64:67]
buffer_load_dwordx4 v21,s[16:19],s43 offen offset:3072  lds
mf v[64:67],a[208:211],v[136:139],v[64:67]
ds_read_b128 v[156:159],v5 offset:53248
ds_read_b128 v[152:155],v5 offset:49152
mf v[68:71],a[212:215],v[136:139],v[68:71]
ds_read_b128 v[148:151],v4 offset:53248
ds_read_b128 v[144:147],v4 offset:49152
mf v[68:71],a[196:199],v[128:131],v[68:71]
cvt v168,v112,v113
cvt v169,v114,v115
mf v[72:75],a[200:203],v[128:131],v[72:75]
cvt v170,v116,v117
cvt v171,v118,v119
mf v[72:75],a[216:219],v[136:139],v[72:75]
v_permlane32_swap_b32 v204,v205
v_add_f32 v204,v204,v205
ds_write_b32 v47,v204 offset:0
mf v[76:79],a[220:223],v[136:139],v[76:79]
mf v[76:79],a[204:207],v[128:131],v[76:79]
s_waitcnt lgkmcnt(0)
mf v[92:95],a[204:207],v[132:135],v[92:95]
s_waitcnt vmcnt(12)
s_barrier
mf v[92:95],a[220:223],v[140:143],v[92:95]
mf v[88:91],a[216:219],v[140:143],v[88:91]
s_add_u32 m0,s44,0
s_xor_b32 s43,s40,262144
mf v[88:91],a[200:203],v[132:135],v[88:91]
buffer_store_dwordx4 v[168:171],v38,s[28:31],s49 offen sc1
cvt v172,v120,v121
mf v[84:87],a[196:199],v[132:135],v[84:87]
ds_read_b128 v[208:211],v44 offset:0
mf v[84:87],a[212:215],v[140:143],v[84:87]
mf v[80:83],a[208:211],v[140:143],v[80:83]
mf v[80:83],a[192:195],v[132:135],v[80:83]
buffer_load_dwordx4 v18,s[16:19],s43 offen  lds
mf v[64:67],a[224:227],v[144:147],v[64:67]
cvt v173,v122,v123
cvt v174,v124,v125
mf v[64:67],a[240:243],v[152:155],v[64:67]
ds_read_b128 v[140:143],v7 offset:4096
ds_read_b128 v[136:139],v7 offset:0
mf v[68:71],a[244:247],v[152:155],v[68:71]
ds_read_b128 v[132:135],v6 offset:4096
ds_read_b128 v[128:131],v6 offset:0
mf v[68:71],a[228:231],v[144:147],v[68:71]
mf v[72:75],a[232:235],v[144:147],v[72:75]
mf v[72:75],a[248:251],v[152:155],v[72:75]
buffer_load_dwordx4 v19,s[16:19],s43 offen offset:1024  lds
cvt v175,v126,v127
mf v[76:79],a[252:255],v[152:155],v[76:79]
s_waitcnt lgkmcnt(4)
v_add_f32 v208,v208,v209
v_add_f32 v210,v210,v211
mf v[76:79],a[236:239],v[144:147],v[76:79]
v_add_f32 v208,v208,v210
v_mul_f32 v208,0x3acccccd,v208
mf v[92:95],a[236:239],v[148:151],v[92:95]
mf v[92:95],a[252:255],v[156:159],v[92:95]
v_mul_f32 v209,v208,v30
v_sub_f32 v212,v212,v208
mf v[88:91],a[248:251],v[156:159],v[88:91]
buffer_load_dwordx4 v20,s[16:19],s43 offen offset:2048  lds
mf v[88:91],a[232:235],v[148:151],v[88:91]
v_sub_f32 v213,v213,v208
v_sub_f32 v214,v214,v208
mf v[84:87],a[228:231],v[148:151],v[84:87]
mf v[84:87],a[244:247],v[156:159],v[84:87]
buffer_store_dwordx4 v[172:175],v38,s[28:31],s49 offen offset:1024 sc1
s_add_u32 s49,s49,32768
mf v[80:83],a[240:243],v[156:159],v[80:83]
v_sub_f32 v215,v215,v208
mf v[80:83],a[224:227],v[148:151],v[80:83]
s_waitcnt lgkmcnt(0)
mf v[96:99],a[0:3],v[128:131],0
buffer_load_dwordx4 v21,s[16:19],s43 offen offset:3072  lds
s_mov_b32 s72,s70
s_mov_b32 s73,s71
mf v[96:99],a[16:19],v[136:139],v[96:99]
ds_read_b128 v[156:159],v9 offset:4096
ds_read_b128 v[152:155],v9 offset:0
mf v[100:103],a[20:23],v[136:139],0
ds_read_b128 v[148:151],v8 offset:4096
ds_read_b128 v[144:147],v8 offset:0
mf v[100:103],a[4:7],v[128:131],v[100:103]
v_sub_f32 v216,v216,v208
v_sub_f32 v217,v217,v208
mf v[104:107],a[8:11],v[128:131],0
cvt v160,v64,v65
cvt v161,v66,v67
mf v[104:107],a[24:27],v[136:139],v[104:107]
v_sub_f32 v218,v218,v208
v_sub_f32 v219,v219,v208
mf v[108:111],a[28:31],v[136:139],0
s_add_u32 m0,s44,16384
s_xor_b32 s43,s40,262400
mf v[108:111],a[12:15],v[128:131],v[108:111]
v_sub_f32 v220,v220,v208
v_sub_f32 v221,v221,v208
mf v[124:127],a[12:15],v[132:135],0
mf v[124:127],a[28:31],v[140:143],v[124:127]
mf v[120:123],a[24:27],v[140:143],0
v_sub_f32 v222,v222,v208
v_sub_f32 v223,v223,v208
mf v[120:123],a[8:11],v[132:135],v[120:123]
mf v[116:119],a[4:7],v[132:135],0
s_mov_b32 s74,5242880
s_lshr_b32 s68,s2,5
mf v[116:119],a[20:23],v[140:143],v[116:119]
buffer_load_dwordx4 v18,s[16:19],s43 offen  lds
mf v[112:115],a[16:19],v[140:143],0
v_sub_f32 v224,v224,v208
v_sub_f32 v225,v225,v208
mf v[112:115],a[0:3],v[132:135],v[112:115]
s_waitcnt lgkmcnt(0)
mf v[96:99],a[32:35],v[144:147],v[96:99]
cvt v162,v68,v69
cvt v163,v70,v71
mf v[96:99],a[48:51],v[152:155],v[96:99]
ds_read_b128 v[140:143],v7 offset:20480
ds_read_b128 v[136:139],v7 offset:16384
mf v[100:103],a[52:55],v[152:155],v[100:103]
ds_read_b128 v[132:135],v6 offset:20480
ds_read_b128 v[128:131],v6 offset:16384
mf v[100:103],a[36:39],v[144:147],v[100:103]
buffer_load_dwordx4 v19,s[16:19],s43 offen offset:1024  lds
mf v[104:107],a[40:43],v[144:147],v[104:107]
v_sub_f32 v226,v226,v208
v_sub_f32 v227,v227,v208
mf v[104:107],a[56:59],v[152:155],v[104:107]
v_sub_f32 v228,v228,v209
v_sub_f32 v229,v229,v209
mf v[108:111],a[60:63],v[152:155],v[108:111]
mf v[108:111],a[44:47],v[144:147],v[108:111]
v_sub_f32 v230,v230,v209
v_sub_f32 v231,v231,v209
mf v[124:127],a[44:47],v[148:151],v[124:127]
mf v[124:127],a[60:63],v[156:159],v[124:127]
s_cmp_ge_u32 s68,5
s_cselect_b32 s71,5,0
mf v[120:123],a[56:59],v[156:159],v[120:123]
buffer_load_dwordx4 v20,s[16:19],s43 offen offset:2048  lds
mf v[120:123],a[40:43],v[148:151],v[120:123]
v_sub_f32 v232,v232,v209
v_sub_f32 v233,v233,v209
mf v[116:119],a[36:39],v[148:151],v[116:119]
mf v[116:119],a[52:55],v[156:159],v[116:119]
buffer_store_dwordx4 v[160:163],v32,s[28:31],s49 offen sc1
cvt v164,v72,v73
mf v[112:115],a[48:51],v[156:159],v[112:115]
v_sub_f32 v234,v234,v209
v_sub_f32 v235,v235,v209
mf v[112:115],a[32:35],v[148:151],v[112:115]
s_waitcnt lgkmcnt(0)
mf v[96:99],a[64:67],v[128:131],v[96:99]
buffer_load_dwordx4 v21,s[16:19],s43 offen offset:3072  lds
mf v[96:99],a[80:83],v[136:139],v[96:99]
ds_read_b128 v[156:159],v9 offset:20480
ds_read_b128 v[152:155],v9 offset:16384
mf v[100:103],a[84:87],v[136:139],v[100:103]
ds_read_b128 v[148:151],v8 offset:20480
ds_read_b128 v[144:147],v8 offset:16384
mf v[100:103],a[68:71],v[128:131],v[100:103]
v_mul_f32 v204,v212,v212
v_mul_f32 v205,v213,v213
mf v[104:107],a[72:75],v[128:131],v[104:107]
mf v[104:107],a[88:91],v[136:139],v[104:107]
v_fmac_f32 v204,v214,v214
v_fmac_f32 v205,v215,v215
mf v[108:111],a[92:95],v[136:139],v[108:111]
s_sub_u32 s68,s68,s71
s_lshl_b32 s71,s68,20
mf v[108:111],a[76:79],v[128:131],v[108:111]
mf v[124:127],a[76:79],v[132:135],v[124:127]
s_waitcnt vmcnt(11)
s_barrier
mf v[124:127],a[92:95],v[140:143],v[124:127]
cvt v165,v74,v75
cvt v166,v76,v77
mf v[120:123],a[88:91],v[140:143],v[120:123]
s_add_u32 m0,s44,32768
s_xor_b32 s43,s40,262656
mf v[120:123],a[72:75],v[132:135],v[120:123]
v_fmac_f32 v204,v216,v216
v_fmac_f32 v205,v217,v217
mf v[116:119],a[68:71],v[132:135],v[116:119]
v_fmac_f32 v204,v218,v218
v_fmac_f32 v205,v219,v219
mf v[116:119],a[84:87],v[140:143],v[116:119]
mf v[112:115],a[80:83],v[140:143],v[112:115]
mf v[112:115],a[64:67],v[132:135],v[112:115]
buffer_load_dwordx4 v18,s[16:19],s43 offen  lds
s_waitcnt lgkmcnt(0)
mf v[96:99],a[96:99],v[144:147],v[96:99]
v_fmac_f32 v204,v220,v220
v_fmac_f32 v205,v221,v221
mf v[96:99],a[112:115],v[152:155],v[96:99]
ds_read_b128 v[140:143],v7 offset:36864
ds_read_b128 v[136:139],v7 offset:32768
mf v[100:103],a[116:119],v[152:155],v[100:103]
ds_read_b128 v[132:135],v6 offset:36864
ds_read_b128 v[128:131],v6 offset:32768
mf v[100:103],a[100:103],v[144:147],v[100:103]
v_fmac_f32 v204,v222,v222
v_fmac_f32 v205,v223,v223
mf v[104:107],a[104:107],v[144:147],v[104:107]
cvt v167,v78,v79
buffer_store_dwordx4 v[164:167],v32,s[28:31],s49 offen offset:1024 sc1
mf v[104:107],a[120:123],v[152:155],v[104:107]
buffer_load_dwordx4 v19,s[16:19],s43 offen offset:1024  lds
s_add_u32 s71,s71,s42
mf v[108:111],a[124:127],v[152:155],v[108:111]
v_fmac_f32 v204,v224,v224
v_fmac_f32 v205,v225,v225
mf v[108:111],a[108:111],v[144:147],v[108:111]
mf v[124:127],a[108:111],v[148:151],v[124:127]
mf v[124:127],a[124:127],v[156:159],v[124:127]
v_fmac_f32 v204,v226,v226
v_fmac_f32 v205,v227,v227
mf v[120:123],a[120:123],v[156:159],v[120:123]
buffer_load_dwordx4 v20,s[16:19],s43 offen offset:2048  lds
mf v[120:123],a[104:107],v[148:151],v[120:123]
mf v[116:119],a[100:103],v[148:151],v[116:119]
v_fmac_f32 v204,v228,v228
v_fmac_f32 v205,v229,v229
mf v[116:119],a[116:119],v[156:159],v[116:119]
mf v[112:115],a[112:115],v[156:159],v[112:115]
mf v[112:115],a[96:99],v[148:151],v[112:115]
s_waitcnt lgkmcnt(0)
mf v[96:99],a[128:131],v[128:131],v[96:99]
buffer_load_dwordx4 v21,s[16:19],s43 offen offset:3072  lds
mf v[96:99],a[144:147],v[136:139],v[96:99]
ds_read_b128 v[156:159],v9 offset:36864
ds_read_b128 v[152:155],v9 offset:32768
mf v[100:103],a[148:151],v[136:139],v[100:103]
ds_read_b128 v[148:151],v8 offset:36864
ds_read_b128 v[144:147],v8 offset:32768
mf v[100:103],a[132:135],v[128:131],v[100:103]
v_fmac_f32 v204,v230,v230
v_fmac_f32 v205,v231,v231
mf v[104:107],a[136:139],v[128:131],v[104:107]
cvt v168,v80,v81
cvt v169,v82,v83
mf v[104:107],a[152:155],v[136:139],v[104:107]
v_fmac_f32 v204,v232,v232
v_fmac_f32 v205,v233,v233
mf v[108:111],a[156:159],v[136:139],v[108:111]
s_add_u32 m0,s44,49152
s_xor_b32 s43,s40,262912
mf v[108:111],a[140:143],v[128:131],v[108:111]
v_fmac_f32 v204,v234,v234
v_fmac_f32 v205,v235,v235
mf v[124:127],a[140:143],v[132:135],v[124:127]
mf v[124:127],a[156:159],v[140:143],v[124:127]
v_add_f32 v204,v204,v205
mf v[120:123],a[152:155],v[140:143],v[120:123]
mf v[120:123],a[136:139],v[132:135],v[120:123]
mf v[116:119],a[132:135],v[132:135],v[116:119]
mf v[116:119],a[148:151],v[140:143],v[116:119]
buffer_load_dwordx4 v18,s[16:19],s43 offen  lds
mf v[112:115],a[144:147],v[140:143],v[112:115]
cvt v170,v84,v85
cvt v171,v86,v87
mf v[112:115],a[128:131],v[132:135],v[112:115]
s_waitcnt lgkmcnt(0)
mf v[96:99],a[160:163],v[144:147],v[96:99]
v_add_f32_dpp v204,v204,v204 row_ror:8 row_mask:0xf bank_mask:0xf
v_mov_b32 v205,v204
mf v[96:99],a[176:179],v[152:155],v[96:99]
ds_read_b128 v[140:143],v7 offset:53248
ds_read_b128 v[136:139],v7 offset:49152
mf v[100:103],a[180:183],v[152:155],v[100:103]
ds_read_b128 v[132:135],v6 offset:53248
ds_read_b128 v[128:131],v6 offset:49152
mf v[100:103],a[164:167],v[144:147],v[100:103]
buffer_load_dwordx4 v19,s[16:19],s43 offen offset:1024  lds
mf v[104:107],a[168:171],v[144:147],v[104:107]
mf v[104:107],a[184:187],v[152:155],v[104:107]
mf v[108:111],a[188:191],v[152:155],v[108:111]
v_permlane16_swap_b32 v204,v205
v_add_f32 v204,v204,v205
mf v[108:111],a[172:175],v[144:147],v[108:111]
mf v[124:127],a[172:175],v[148:151],v[124:127]
mf v[124:127],a[188:191],v[156:159],v[124:127]
v_mov_b32 v205,v204
mf v[120:123],a[184:187],v[156:159],v[120:123]
buffer_load_dwordx4 v20,s[16:19],s43 offen offset:2048  lds
mf v[120:123],a[168:171],v[148:151],v[120:123]
mf v[116:119],a[164:167],v[148:151],v[116:119]
mf v[116:119],a[180:183],v[156:159],v[116:119]
buffer_store_dwordx4 v[168:171],v38,s[28:31],s49 offen sc1
cvt v172,v88,v89
mf v[112:115],a[176:179],v[156:159],v[112:115]
mf v[112:115],a[160:163],v[148:151],v[112:115]
s_waitcnt lgkmcnt(0)
mf v[96:99],a[192:195],v[128:131],v[96:99]
buffer_load_dwordx4 v21,s[16:19],s43 offen offset:3072  lds
mf v[96:99],a[208:211],v[136:139],v[96:99]
ds_read_b128 v[156:159],v9 offset:53248
ds_read_b128 v[152:155],v9 offset:49152
mf v[100:103],a[212:215],v[136:139],v[100:103]
ds_read_b128 v[148:151],v8 offset:53248
ds_read_b128 v[144:147],v8 offset:49152
mf v[100:103],a[196:199],v[128:131],v[100:103]
cvt v173,v90,v91
cvt v174,v92,v93
mf v[104:107],a[200:203],v[128:131],v[104:107]
buffer_load_dword v188,v37,s[36:39],0 offen sc1
mf v[104:107],a[216:219],v[136:139],v[104:107]
v_permlane32_swap_b32 v204,v205
v_add_f32 v204,v204,v205
ds_write_b32 v47,v204 offset:128
mf v[108:111],a[220:223],v[136:139],v[108:111]
mf v[108:111],a[204:207],v[128:131],v[108:111]
s_waitcnt lgkmcnt(0)
mf v[124:127],a[204:207],v[132:135],v[124:127]
s_waitcnt vmcnt(11)
s_barrier
mf v[124:127],a[220:223],v[140:143],v[124:127]
mf v[120:123],a[216:219],v[140:143],v[120:123]
s_add_u32 m0,s44,65536
s_xor_b32 s43,s40,327680
mf v[120:123],a[200:203],v[132:135],v[120:123]
ds_read_b128 v[208:211],v44 offset:128
mf v[116:119],a[196:199],v[132:135],v[116:119]
cvt v175,v94,v95
mf v[116:119],a[212:215],v[140:143],v[116:119]
mf v[112:115],a[208:211],v[140:143],v[112:115]
mf v[112:115],a[192:195],v[132:135],v[112:115]
buffer_load_dwordx4 v18,s[16:19],s43 offen  lds
mf v[96:99],a[224:227],v[144:147],v[96:99]
mf v[96:99],a[240:243],v[152:155],v[96:99]
ds_read_b128 v[140:143],v3 offset:4096
ds_read_b128 v[136:139],v3 offset:0
mf v[100:103],a[244:247],v[152:155],v[100:103]
ds_read_b128 v[132:135],v2 offset:4096
ds_read_b128 v[128:131],v2 offset:0
mf v[100:103],a[228:231],v[144:147],v[100:103]
mf v[104:107],a[232:235],v[144:147],v[104:107]
s_waitcnt lgkmcnt(4)
v_add_f32 v208,v208,v209
v_add_f32 v210,v210,v211
mf v[104:107],a[248:251],v[152:155],v[104:107]
buffer_load_dwordx4 v19,s[16:19],s43 offen offset:1024  lds
mf v[108:111],a[252:255],v[152:155],v[108:111]
buffer_store_dwordx4 v[172:175],v38,s[28:31],s49 offen offset:1024 sc1
s_add_u32 s49,s49,32768
mf v[108:111],a[236:239],v[144:147],v[108:111]
v_add_f32 v208,v208,v210
v_mov_b32 v209,0x3727c5ac
mf v[124:127],a[236:239],v[148:151],v[124:127]
v_fmac_f32 v209,0x3acccccd,v208
mf v[124:127],a[252:255],v[156:159],v[124:127]
mf v[120:123],a[248:251],v[156:159],v[120:123]
buffer_load_dwordx4 v20,s[16:19],s43 offen offset:2048  lds
mf v[120:123],a[232:235],v[148:151],v[120:123]
v_rsq_f32 v208,v209
mf v[116:119],a[228:231],v[148:151],v[116:119]
mf v[116:119],a[244:247],v[156:159],v[116:119]
mf v[112:115],a[240:243],v[156:159],v[112:115]
v_mul_f32 v212,v212,v208
v_mul_f32 v213,v213,v208
mf v[112:115],a[224:227],v[148:151],v[112:115]
LKm_chk:
s_waitcnt vmcnt(4)
v_cmp_ne_u32 vcc,20,v188
s_nop 0
s_cbranch_vccnz LKm_spin
s_waitcnt lgkmcnt(0)
mf v[64:67],a[0:3],v[128:131],0
buffer_load_dwordx4 v21,s[16:19],s43 offen offset:3072  lds
mf v[64:67],a[16:19],v[136:139],v[64:67]
ds_read_b128 v[156:159],v5 offset:4096
ds_read_b128 v[152:155],v5 offset:0
mf v[68:71],a[20:23],v[136:139],0
ds_read_b128 v[148:151],v4 offset:4096
ds_read_b128 v[144:147],v4 offset:0
mf v[68:71],a[4:7],v[128:131],v[68:71]
buffer_load_dwordx4 v[176:179],v40,s[32:35],0 offen sc1
mf v[72:75],a[8:11],v[128:131],0
cvt v160,v96,v97
cvt v161,v98,v99
mf v[72:75],a[24:27],v[136:139],v[72:75]
mf v[76:79],a[28:31],v[136:139],0
s_add_u32 m0,s44,81920
s_xor_b32 s43,s40,327936
mf v[76:79],a[12:15],v[128:131],v[76:79]
buffer_load_dwordx4 v[180:183],v40,s[32:35],s52 offen sc1
mf v[92:95],a[12:15],v[132:135],0
mf v[92:95],a[28:31],v[140:143],v[92:95]
mf v[88:91],a[24:27],v[140:143],0
buffer_load_dwordx4 v[184:187],v40,s[32:35],s53 offen sc1
mf v[88:91],a[8:11],v[132:135],v[88:91]
buffer_load_dwordx4 v[188:191],v40,s[32:35],s54 offen sc1
mf v[84:87],a[4:7],v[132:135],0
buffer_load_dwordx4 v[48:51],v39,s[32:35],0 offen sc1
mf v[84:87],a[20:23],v[140:143],v[84:87]
buffer_load_dwordx4 v18,s[16:19],s43 offen  lds
mf v[80:83],a[16:19],v[140:143],0
buffer_load_dwordx4 v[52:55],v39,s[32:35],s52 offen sc1
mf v[80:83],a[0:3],v[132:135],v[80:83]
buffer_load_dwordx4 v[56:59],v39,s[32:35],s53 offen sc1
s_waitcnt lgkmcnt(0)
mf v[64:67],a[32:35],v[144:147],v[64:67]
cvt v162,v100,v101
cvt v163,v102,v103
mf v[64:67],a[48:51],v[152:155],v[64:67]
ds_read_b128 v[140:143],v3 offset:20480
ds_read_b128 v[136:139],v3 offset:16384
mf v[68:71],a[52:55],v[152:155],v[68:71]
ds_read_b128 v[132:135],v2 offset:20480
ds_read_b128 v[128:131],v2 offset:16384
mf v[68:71],a[36:39],v[144:147],v[68:71]
buffer_load_dwordx4 v19,s[16:19],s43 offen offset:1024  lds
buffer_load_dwordx4 v[60:63],v39,s[32:35],s54 offen sc1
mf v[72:75],a[40:43],v[144:147],v[72:75]
v_mul_f32 v214,v214,v208
v_mul_f32 v215,v215,v208
mf v[72:75],a[56:59],v[152:155],v[72:75]
mf v[76:79],a[60:63],v[152:155],v[76:79]
mf v[76:79],a[44:47],v[144:147],v[76:79]
mf v[92:95],a[44:47],v[148:151],v[92:95]
v_mul_f32 v216,v216,v208
v_mul_f32 v217,v217,v208
mf v[92:95],a[60:63],v[156:159],v[92:95]
mf v[88:91],a[56:59],v[156:159],v[88:91]
buffer_load_dwordx4 v20,s[16:19],s43 offen offset:2048  lds
mf v[88:91],a[40:43],v[148:151],v[88:91]
mf v[84:87],a[36:39],v[148:151],v[84:87]
v_mul_f32 v218,v218,v208
v_mul_f32 v219,v219,v208
mf v[84:87],a[52:55],v[156:159],v[84:87]
buffer_store_dwordx4 v[160:163],v32,s[28:31],s49 offen sc1
cvt v164,v104,v105
mf v[80:83],a[48:51],v[156:159],v[80:83]
mf v[80:83],a[32:35],v[148:151],v[80:83]
s_waitcnt lgkmcnt(0)
mf v[64:67],a[64:67],v[128:131],v[64:67]
buffer_load_dwordx4 v21,s[16:19],s43 offen offset:3072  lds
mf v[64:67],a[80:83],v[136:139],v[64:67]
ds_read_b128 v[156:159],v5 offset:20480
ds_read_b128 v[152:155],v5 offset:16384
mf v[68:71],a[84:87],v[136:139],v[68:71]
ds_read_b128 v[148:151],v4 offset:20480
ds_read_b128 v[144:147],v4 offset:16384
mf v[68:71],a[68:71],v[128:131],v[68:71]
v_mul_f32 v220,v220,v208
v_mul_f32 v221,v221,v208
mf v[72:75],a[72:75],v[128:131],v[72:75]
v_mul_f32 v222,v222,v208
v_mul_f32 v223,v223,v208
mf v[72:75],a[88:91],v[136:139],v[72:75]
mf v[76:79],a[92:95],v[136:139],v[76:79]
mf v[76:79],a[76:79],v[128:131],v[76:79]
mf v[92:95],a[76:79],v[132:135],v[92:95]
s_barrier
mf v[92:95],a[92:95],v[140:143],v[92:95]
cvt v165,v106,v107
cvt v166,v108,v109
mf v[88:91],a[88:91],v[140:143],v[88:91]
s_add_u32 m0,s44,98304
s_xor_b32 s43,s40,328192
mf v[88:91],a[72:75],v[132:135],v[88:91]
v_mul_f32 v224,v224,v208
v_mul_f32 v225,v225,v208
mf v[84:87],a[68:71],v[132:135],v[84:87]
v_mul_f32 v226,v226,v208
v_mul_f32 v227,v227,v208
mf v[84:87],a[84:87],v[140:143],v[84:87]
mf v[80:83],a[80:83],v[140:143],v[80:83]
mf v[80:83],a[64:67],v[132:135],v[80:83]
buffer_load_dwordx4 v18,s[16:19],s43 offen  lds
s_waitcnt lgkmcnt(0)
mf v[64:67],a[96:99],v[144:147],v[64:67]
v_mul_f32 v228,v228,v208
v_mul_f32 v229,v229,v208
mf v[64:67],a[112:115],v[152:155],v[64:67]
ds_read_b128 v[140:143],v3 offset:36864
ds_read_b128 v[136:139],v3 offset:32768
mf v[68:71],a[116:119],v[152:155],v[68:71]
ds_read_b128 v[132:135],v2 offset:36864
ds_read_b128 v[128:131],v2 offset:32768
mf v[68:71],a[100:103],v[144:147],v[68:71]
s_waitcnt vmcnt(12)
v_add_f32 v176,v176,v180
s_waitcnt vmcnt(10)
v_add_f32 v184,v184,v188
mf v[72:75],a[104:107],v[144:147],v[72:75]
cvt v167,v110,v111
buffer_store_dwordx4 v[164:167],v32,s[28:31],s49 offen offset:1024 sc1
mf v[72:75],a[120:123],v[152:155],v[72:75]
buffer_load_dwordx4 v19,s[16:19],s43 offen offset:1024  lds
mf v[76:79],a[124:127],v[152:155],v[76:79]
v_mul_f32 v230,v230,v208
v_mul_f32 v231,v231,v208
mf v[76:79],a[108:111],v[144:147],v[76:79]
v_add_f32 v177,v177,v181
v_add_f32 v185,v185,v189
mf v[92:95],a[108:111],v[148:151],v[92:95]
v_mul_f32 v232,v232,v208
v_mul_f32 v233,v233,v208
mf v[92:95],a[124:127],v[156:159],v[92:95]
v_add_f32 v178,v178,v182
v_add_f32 v186,v186,v190
mf v[88:91],a[120:123],v[156:159],v[88:91]
buffer_load_dwordx4 v20,s[16:19],s43 offen offset:2048  lds
mf v[88:91],a[104:107],v[148:151],v[88:91]
v_add_f32 v179,v179,v183
v_add_f32 v187,v187,v191
mf v[84:87],a[100:103],v[148:151],v[84:87]
v_mul_f32 v234,v234,v208
v_mul_f32 v235,v235,v208
mf v[84:87],a[116:119],v[156:159],v[84:87]
v_add_f32 v176,v176,v184
v_add_f32 v177,v177,v185
mf v[80:83],a[112:115],v[156:159],v[80:83]
v_add_f32 v178,v178,v186
v_add_f32 v179,v179,v187
mf v[80:83],a[96:99],v[148:151],v[80:83]
cvt v180,v176,v177
cvt v181,v178,v179
v_lshlrev_b32 v176,16,v180
v_and_b32 v177,0xffff0000,v180
v_lshlrev_b32 v178,16,v181
v_and_b32 v179,0xffff0000,v181
v_add_f32 v184,v36,v176
v_add_f32 v185,v36,v177
s_waitcnt lgkmcnt(0)
mf v[64:67],a[128:131],v[128:131],v[64:67]
buffer_load_dwordx4 v21,s[16:19],s43 offen offset:3072  lds
mf v[64:67],a[144:147],v[136:139],v[64:67]
ds_read_b128 v[156:159],v5 offset:36864
ds_read_b128 v[152:155],v5 offset:32768
mf v[68:71],a[148:151],v[136:139],v[68:71]
ds_read_b128 v[148:151],v4 offset:36864
ds_read_b128 v[144:147],v4 offset:32768
mf v[68:71],a[132:135],v[128:131],v[68:71]
v_add_f32 v186,v36,v178
v_add_f32 v187,v36,v179
mf v[72:75],a[136:139],v[128:131],v[72:75]
cvt v168,v112,v113
cvt v169,v114,v115
mf v[72:75],a[152:155],v[136:139],v[72:75]
cvt v180,v184,v185
cvt v181,v186,v187
mf v[76:79],a[156:159],v[136:139],v[76:79]
s_add_u32 m0,s44,114688
s_xor_b32 s43,s40,328448
mf v[76:79],a[140:143],v[128:131],v[76:79]
v_lshlrev_b32 v184,16,v180
v_and_b32 v185,0xffff0000,v180
mf v[92:95],a[140:143],v[132:135],v[92:95]
v_lshlrev_b32 v186,16,v181
v_and_b32 v187,0xffff0000,v181
mf v[92:95],a[156:159],v[140:143],v[92:95]
v_mul_f32 v188,0x3e0293ee,v184
v_mul_f32 v189,0x3e0293ee,v185
mf v[88:91],a[152:155],v[140:143],v[88:91]
v_mul_f32 v190,0x3e0293ee,v186
v_mul_f32 v191,0x3e0293ee,v187
mf v[88:91],a[136:139],v[132:135],v[88:91]
ds_write_b128 v41,v[188:191]
s_waitcnt vmcnt(11)
v_add_f32 v48,v48,v52
mf v[84:87],a[132:135],v[132:135],v[84:87]
s_waitcnt vmcnt(8)
v_add_f32 v56,v56,v60
v_add_f32 v49,v49,v53
mf v[84:87],a[148:151],v[140:143],v[84:87]
buffer_load_dwordx4 v18,s[16:19],s43 offen  lds
mf v[80:83],a[144:147],v[140:143],v[80:83]
cvt v170,v116,v117
cvt v171,v118,v119
mf v[80:83],a[128:131],v[132:135],v[80:83]
s_waitcnt lgkmcnt(1)
mf v[64:67],a[160:163],v[144:147],v[64:67]
v_add_f32 v57,v57,v61
v_add_f32 v50,v50,v54
mf v[64:67],a[176:179],v[152:155],v[64:67]
ds_read_b128 v[140:143],v3 offset:53248
ds_read_b128 v[136:139],v3 offset:49152
mf v[68:71],a[180:183],v[152:155],v[68:71]
ds_read_b128 v[132:135],v2 offset:53248
ds_read_b128 v[128:131],v2 offset:49152
mf v[68:71],a[164:167],v[144:147],v[68:71]
buffer_load_dwordx4 v19,s[16:19],s43 offen offset:1024  lds
mf v[72:75],a[168:171],v[144:147],v[72:75]
v_add_f32 v58,v58,v62
v_add_f32 v51,v51,v55
mf v[72:75],a[184:187],v[152:155],v[72:75]
v_add_f32 v59,v59,v63
v_add_f32 v48,v48,v56
mf v[76:79],a[188:191],v[152:155],v[76:79]
v_add_f32 v49,v49,v57
v_add_f32 v50,v50,v58
mf v[76:79],a[172:175],v[144:147],v[76:79]
v_add_f32 v51,v51,v59
cvt v52,v48,v49
mf v[92:95],a[172:175],v[148:151],v[92:95]
cvt v53,v50,v51
v_lshlrev_b32 v48,16,v52
mf v[92:95],a[188:191],v[156:159],v[92:95]
v_and_b32 v49,0xffff0000,v52
v_lshlrev_b32 v50,16,v53
mf v[88:91],a[184:187],v[156:159],v[88:91]
buffer_load_dwordx4 v20,s[16:19],s43 offen offset:2048  lds
mf v[88:91],a[168:171],v[148:151],v[88:91]
v_and_b32 v51,0xffff0000,v53
v_add_f32 v56,1.0,v48
mf v[84:87],a[164:167],v[148:151],v[84:87]
v_add_f32 v57,1.0,v49
v_add_f32 v58,1.0,v50
mf v[84:87],a[180:183],v[156:159],v[84:87]
buffer_store_dwordx4 v[168:171],v38,s[28:31],s49 offen sc1
cvt v172,v120,v121
mf v[80:83],a[176:179],v[156:159],v[80:83]
v_add_f32 v59,1.0,v51
cvt v52,v56,v57
mf v[80:83],a[160:163],v[148:151],v[80:83]
s_waitcnt lgkmcnt(0)
mf v[64:67],a[192:195],v[128:131],v[64:67]
buffer_load_dwordx4 v21,s[16:19],s43 offen offset:3072  lds
mf v[64:67],a[208:211],v[136:139],v[64:67]
ds_read_b128 v[156:159],v5 offset:53248
ds_read_b128 v[152:155],v5 offset:49152
mf v[68:71],a[212:215],v[136:139],v[68:71]
ds_read_b128 v[148:151],v4 offset:53248
ds_read_b128 v[144:147],v4 offset:49152
mf v[68:71],a[196:199],v[128:131],v[68:71]
cvt v173,v122,v123
cvt v174,v124,v125
mf v[72:75],a[200:203],v[128:131],v[72:75]
cvt v53,v58,v59
v_lshlrev_b32 v56,16,v52
mf v[72:75],a[216:219],v[136:139],v[72:75]
v_and_b32 v57,0xffff0000,v52
v_lshlrev_b32 v58,16,v53
v_and_b32 v59,0xffff0000,v53
v_mul_f32 v60,0x3e0293ee,v56
v_mul_f32 v61,0x3e0293ee,v57
v_mul_f32 v62,0x3e0293ee,v58
v_mul_f32 v63,0x3e0293ee,v59
ds_write_b128 v42,v[60:63]
mf v[76:79],a[220:223],v[136:139],v[76:79]
mf v[76:79],a[204:207],v[128:131],v[76:79]
s_waitcnt lgkmcnt(0)
mf v[92:95],a[204:207],v[132:135],v[92:95]
s_waitcnt vmcnt(10)
s_barrier
mf v[92:95],a[220:223],v[140:143],v[92:95]
mf v[88:91],a[216:219],v[140:143],v[88:91]
s_add_u32 m0,s44,0
s_xor_b32 s43,s40,393216
mf v[88:91],a[200:203],v[132:135],v[88:91]
ds_read_b128 v[48:51],v31 offset:2560
ds_read_b128 v[52:55],v31 offset:2576
mf v[84:87],a[196:199],v[132:135],v[84:87]
cvt v175,v126,v127
mf v[84:87],a[212:215],v[140:143],v[84:87]
ds_read_b128 v[56:59],v31 offset:0
ds_read_b128 v[60:63],v31 offset:16
mf v[80:83],a[208:211],v[140:143],v[80:83]
mf v[80:83],a[192:195],v[132:135],v[80:83]
buffer_load_dwordx4 v18,s[16:19],s43 offen  lds
mf v[64:67],a[224:227],v[144:147],v[64:67]
mf v[64:67],a[240:243],v[152:155],v[64:67]
ds_read_b128 v[140:143],v7 offset:4096
ds_read_b128 v[136:139],v7 offset:0
mf v[68:71],a[244:247],v[152:155],v[68:71]
ds_read_b128 v[132:135],v6 offset:4096
ds_read_b128 v[128:131],v6 offset:0
mf v[68:71],a[228:231],v[144:147],v[68:71]
mf v[72:75],a[232:235],v[144:147],v[72:75]
mf v[72:75],a[248:251],v[152:155],v[72:75]
buffer_load_dwordx4 v19,s[16:19],s43 offen offset:1024  lds
mf v[76:79],a[252:255],v[152:155],v[76:79]
buffer_store_dwordx4 v[172:175],v38,s[28:31],s49 offen offset:1024 sc1
s_add_u32 s49,s49,32768
mf v[76:79],a[236:239],v[144:147],v[76:79]
s_waitcnt lgkmcnt(5)
v_fma_f32 v212,v212,v48,v56
v_fma_f32 v213,v213,v49,v57
mf v[92:95],a[236:239],v[148:151],v[92:95]
v_fma_f32 v214,v214,v50,v58
v_fma_f32 v215,v215,v51,v59
mf v[92:95],a[252:255],v[156:159],v[92:95]
s_waitcnt lgkmcnt(4)
v_fma_f32 v216,v216,v52,v60
v_fma_f32 v217,v217,v53,v61
mf v[88:91],a[248:251],v[156:159],v[88:91]
buffer_load_dwordx4 v20,s[16:19],s43 offen offset:2048  lds
mf v[88:91],a[232:235],v[148:151],v[88:91]
v_fma_f32 v218,v218,v54,v62
v_fma_f32 v219,v219,v55,v63
mf v[84:87],a[228:231],v[148:151],v[84:87]
cvt v192,v212,v213
cvt v193,v214,v215
mf v[84:87],a[244:247],v[156:159],v[84:87]
cvt v194,v216,v217
cvt v195,v218,v219
mf v[80:83],a[240:243],v[156:159],v[80:83]
s_mov_b32 s51,0
buffer_store_dwordx4 v[192:195],v46,s[60:63],s51 offen sc1
mf v[80:83],a[224:227],v[148:151],v[80:83]
s_waitcnt lgkmcnt(0)
mf v[96:99],a[0:3],v[128:131],0
buffer_load_dwordx4 v21,s[16:19],s43 offen offset:3072  lds
mf v[96:99],a[16:19],v[136:139],v[96:99]
ds_read_b128 v[156:159],v9 offset:4096
ds_read_b128 v[152:155],v9 offset:0
mf v[100:103],a[20:23],v[136:139],0
ds_read_b128 v[148:151],v8 offset:4096
ds_read_b128 v[144:147],v8 offset:0
mf v[100:103],a[4:7],v[128:131],v[100:103]
ds_read_b128 v[48:51],v31 offset:2816
ds_read_b128 v[52:55],v31 offset:2832
mf v[104:107],a[8:11],v[128:131],0
cvt v160,v64,v65
cvt v161,v66,v67
mf v[104:107],a[24:27],v[136:139],v[104:107]
ds_read_b128 v[56:59],v31 offset:256
ds_read_b128 v[60:63],v31 offset:272
mf v[108:111],a[28:31],v[136:139],0
s_add_u32 m0,s44,16384
s_xor_b32 s43,s40,393472
mf v[108:111],a[12:15],v[128:131],v[108:111]
mf v[124:127],a[12:15],v[132:135],0
mf v[124:127],a[28:31],v[140:143],v[124:127]
mf v[120:123],a[24:27],v[140:143],0
mf v[120:123],a[8:11],v[132:135],v[120:123]
mf v[116:119],a[4:7],v[132:135],0
mf v[116:119],a[20:23],v[140:143],v[116:119]
buffer_load_dwordx4 v18,s[16:19],s43 offen  lds
mf v[112:115],a[16:19],v[140:143],0
s_waitcnt lgkmcnt(1)
v_fma_f32 v220,v220,v48,v56
v_fma_f32 v221,v221,v49,v57
mf v[112:115],a[0:3],v[132:135],v[112:115]
mf v[96:99],a[32:35],v[144:147],v[96:99]
cvt v162,v68,v69
cvt v163,v70,v71
mf v[96:99],a[48:51],v[152:155],v[96:99]
ds_read_b128 v[140:143],v7 offset:20480
ds_read_b128 v[136:139],v7 offset:16384
mf v[100:103],a[52:55],v[152:155],v[100:103]
ds_read_b128 v[132:135],v6 offset:20480
ds_read_b128 v[128:131],v6 offset:16384
mf v[100:103],a[36:39],v[144:147],v[100:103]
buffer_load_dwordx4 v19,s[16:19],s43 offen offset:1024  lds
mf v[104:107],a[40:43],v[144:147],v[104:107]
v_fma_f32 v222,v222,v50,v58
v_fma_f32 v223,v223,v51,v59
mf v[104:107],a[56:59],v[152:155],v[104:107]
s_waitcnt lgkmcnt(4)
v_fma_f32 v224,v224,v52,v60
v_fma_f32 v225,v225,v53,v61
mf v[108:111],a[60:63],v[152:155],v[108:111]
v_fma_f32 v226,v226,v54,v62
v_fma_f32 v227,v227,v55,v63
mf v[108:111],a[44:47],v[144:147],v[108:111]
cvt v196,v220,v221
cvt v197,v222,v223
mf v[124:127],a[44:47],v[148:151],v[124:127]
cvt v198,v224,v225
cvt v199,v226,v227
mf v[124:127],a[60:63],v[156:159],v[124:127]
mf v[120:123],a[56:59],v[156:159],v[120:123]
buffer_load_dwordx4 v20,s[16:19],s43 offen offset:2048  lds
mf v[120:123],a[40:43],v[148:151],v[120:123]
s_mov_b32 s51,8192
buffer_store_dwordx4 v[196:199],v46,s[60:63],s51 offen sc1
mf v[116:119],a[36:39],v[148:151],v[116:119]
ds_read_b128 v[48:51],v31 offset:3072
ds_read_b128 v[52:55],v31 offset:3088
mf v[116:119],a[52:55],v[156:159],v[116:119]
buffer_store_dwordx4 v[160:163],v32,s[28:31],s49 offen sc1
cvt v164,v72,v73
mf v[112:115],a[48:51],v[156:159],v[112:115]
ds_read_b128 v[56:59],v31 offset:512
ds_read_b128 v[60:63],v31 offset:528
mf v[112:115],a[32:35],v[148:151],v[112:115]
s_waitcnt lgkmcnt(4)
mf v[96:99],a[64:67],v[128:131],v[96:99]
buffer_load_dwordx4 v21,s[16:19],s43 offen offset:3072  lds
mf v[96:99],a[80:83],v[136:139],v[96:99]
ds_read_b128 v[156:159],v9 offset:20480
ds_read_b128 v[152:155],v9 offset:16384
mf v[100:103],a[84:87],v[136:139],v[100:103]
ds_read_b128 v[148:151],v8 offset:20480
ds_read_b128 v[144:147],v8 offset:16384
mf v[100:103],a[68:71],v[128:131],v[100:103]
mf v[104:107],a[72:75],v[128:131],v[104:107]
mf v[104:107],a[88:91],v[136:139],v[104:107]
mf v[108:111],a[92:95],v[136:139],v[108:111]
mf v[108:111],a[76:79],v[128:131],v[108:111]
mf v[124:127],a[76:79],v[132:135],v[124:127]
s_waitcnt vmcnt(12)
s_barrier
mf v[124:127],a[92:95],v[140:143],v[124:127]
cvt v165,v74,v75
cvt v166,v76,v77
mf v[120:123],a[88:91],v[140:143],v[120:123]
s_add_u32 m0,s44,32768
s_xor_b32 s43,s40,393728
mf v[120:123],a[72:75],v[132:135],v[120:123]
s_waitcnt lgkmcnt(5)
v_fma_f32 v228,v228,v48,v56
v_fma_f32 v229,v229,v49,v57
mf v[116:119],a[68:71],v[132:135],v[116:119]
v_fma_f32 v230,v230,v50,v58
v_fma_f32 v231,v231,v51,v59
mf v[116:119],a[84:87],v[140:143],v[116:119]
mf v[112:115],a[80:83],v[140:143],v[112:115]
s_waitcnt lgkmcnt(4)
v_fma_f32 v232,v232,v52,v60
v_fma_f32 v233,v233,v53,v61
mf v[112:115],a[64:67],v[132:135],v[112:115]
buffer_load_dwordx4 v18,s[16:19],s43 offen  lds
s_waitcnt lgkmcnt(0)
mf v[96:99],a[96:99],v[144:147],v[96:99]
v_fma_f32 v234,v234,v54,v62
v_fma_f32 v235,v235,v55,v63
mf v[96:99],a[112:115],v[152:155],v[96:99]
ds_read_b128 v[140:143],v7 offset:36864
ds_read_b128 v[136:139],v7 offset:32768
mf v[100:103],a[116:119],v[152:155],v[100:103]
ds_read_b128 v[132:135],v6 offset:36864
ds_read_b128 v[128:131],v6 offset:32768
mf v[100:103],a[100:103],v[144:147],v[100:103]
cvt v200,v228,v229
cvt v201,v230,v231
mf v[104:107],a[104:107],v[144:147],v[104:107]
cvt v167,v78,v79
buffer_store_dwordx4 v[164:167],v32,s[28:31],s49 offen offset:1024 sc1
mf v[104:107],a[120:123],v[152:155],v[104:107]
buffer_load_dwordx4 v19,s[16:19],s43 offen offset:1024  lds
mf v[108:111],a[124:127],v[152:155],v[108:111]
cvt v202,v232,v233
cvt v203,v234,v235
mf v[108:111],a[108:111],v[144:147],v[108:111]
s_mov_b32 s51,16384
buffer_store_dwordx4 v[200:203],v25,s[60:63],s51 offen sc1
mf v[124:127],a[108:111],v[148:151],v[124:127]
mf v[124:127],a[124:127],v[156:159],v[124:127]
mf v[120:123],a[120:123],v[156:159],v[120:123]
buffer_load_dwordx4 v20,s[16:19],s43 offen offset:2048  lds
mf v[120:123],a[104:107],v[148:151],v[120:123]
mf v[116:119],a[100:103],v[148:151],v[116:119]
mf v[116:119],a[116:119],v[156:159],v[116:119]
mf v[112:115],a[112:115],v[156:159],v[112:115]
mf v[112:115],a[96:99],v[148:151],v[112:115]
s_waitcnt lgkmcnt(0)
mf v[96:99],a[128:131],v[128:131],v[96:99]
buffer_load_dwordx4 v21,s[16:19],s43 offen offset:3072  lds
mf v[96:99],a[144:147],v[136:139],v[96:99]
ds_read_b128 v[156:159],v9 offset:36864
ds_read_b128 v[152:155],v9 offset:32768
mf v[100:103],a[148:151],v[136:139],v[100:103]
ds_read_b128 v[148:151],v8 offset:36864
ds_read_b128 v[144:147],v8 offset:32768
mf v[100:103],a[132:135],v[128:131],v[100:103]
mf v[104:107],a[136:139],v[128:131],v[104:107]
cvt v168,v80,v81
cvt v169,v82,v83
mf v[104:107],a[152:155],v[136:139],v[104:107]
mf v[108:111],a[156:159],v[136:139],v[108:111]
s_add_u32 m0,s44,49152
s_xor_b32 s43,s40,393984
mf v[108:111],a[140:143],v[128:131],v[108:111]
mf v[124:127],a[140:143],v[132:135],v[124:127]
mf v[124:127],a[156:159],v[140:143],v[124:127]
mf v[120:123],a[152:155],v[140:143],v[120:123]
mf v[120:123],a[136:139],v[132:135],v[120:123]
mf v[116:119],a[132:135],v[132:135],v[116:119]
mf v[116:119],a[148:151],v[140:143],v[116:119]
buffer_load_dwordx4 v18,s[16:19],s43 offen  lds
mf v[112:115],a[144:147],v[140:143],v[112:115]
cvt v170,v84,v85
cvt v171,v86,v87
mf v[112:115],a[128:131],v[132:135],v[112:115]
s_waitcnt lgkmcnt(0)
mf v[96:99],a[160:163],v[144:147],v[96:99]
mf v[96:99],a[176:179],v[152:155],v[96:99]
ds_read_b128 v[140:143],v7 offset:53248
ds_read_b128 v[136:139],v7 offset:49152
mf v[100:103],a[180:183],v[152:155],v[100:103]
ds_read_b128 v[132:135],v6 offset:53248
ds_read_b128 v[128:131],v6 offset:49152
mf v[100:103],a[164:167],v[144:147],v[100:103]
buffer_load_dwordx4 v19,s[16:19],s43 offen offset:1024  lds
mf v[104:107],a[168:171],v[144:147],v[104:107]
mf v[104:107],a[184:187],v[152:155],v[104:107]
mf v[108:111],a[188:191],v[152:155],v[108:111]
mf v[108:111],a[172:175],v[144:147],v[108:111]
mf v[124:127],a[172:175],v[148:151],v[124:127]
mf v[124:127],a[188:191],v[156:159],v[124:127]
mf v[120:123],a[184:187],v[156:159],v[120:123]
buffer_load_dwordx4 v20,s[16:19],s43 offen offset:2048  lds
mf v[120:123],a[168:171],v[148:151],v[120:123]
mf v[116:119],a[164:167],v[148:151],v[116:119]
mf v[116:119],a[180:183],v[156:159],v[116:119]
buffer_store_dwordx4 v[168:171],v38,s[28:31],s49 offen sc1
cvt v172,v88,v89
mf v[112:115],a[176:179],v[156:159],v[112:115]
s_lshr_b32 s52,s2,4
s_lshl_b32 s52,s52,2
mf v[112:115],a[160:163],v[148:151],v[112:115]
s_waitcnt lgkmcnt(0)
mf v[96:99],a[192:195],v[128:131],v[96:99]
buffer_load_dwordx4 v21,s[16:19],s43 offen offset:3072  lds
mf v[96:99],a[208:211],v[136:139],v[96:99]
ds_read_b128 v[156:159],v9 offset:53248
ds_read_b128 v[152:155],v9 offset:49152
mf v[100:103],a[212:215],v[136:139],v[100:103]
ds_read_b128 v[148:151],v8 offset:53248
ds_read_b128 v[144:147],v8 offset:49152
mf v[100:103],a[196:199],v[128:131],v[100:103]
cvt v173,v90,v91
cvt v174,v92,v93
mf v[104:107],a[200:203],v[128:131],v[104:107]
s_bfe_u32 s53,s2,0x20001
s_add_u32 s52,s52,s53
mf v[104:107],a[216:219],v[136:139],v[104:107]
s_lshl_b32 s52,s52,7
mf v[108:111],a[220:223],v[136:139],v[108:111]
s_add_u32 s52,s52,16384
v_lshlrev_b32 v255,20,v1
mf v[108:111],a[204:207],v[128:131],v[108:111]
s_waitcnt vmcnt(7)
buffer_atomic_add v35,v255,s[8:11],s52 offen sc1
mf v[124:127],a[204:207],v[132:135],v[124:127]
s_barrier
mf v[124:127],a[220:223],v[140:143],v[124:127]
s_lshr_b32 s52,s2,5
s_sub_u32 s53,15,s52
mf v[120:123],a[216:219],v[140:143],v[120:123]
s_add_u32 m0,s44,65536
s_xor_b32 s43,s40,458752
mf v[120:123],a[200:203],v[132:135],v[120:123]
s_lshl_b32 s52,s52,2
s_lshl_b32 s53,s53,2
mf v[116:119],a[196:199],v[132:135],v[116:119]
cvt v175,v94,v95
mf v[116:119],a[212:215],v[140:143],v[116:119]
s_add_u32 s52,s52,s3
s_add_u32 s53,s53,s3
mf v[112:115],a[208:211],v[140:143],v[112:115]
mf v[112:115],a[192:195],v[132:135],v[112:115]
buffer_load_dwordx4 v18,s[16:19],s43 offen  lds
s_waitcnt lgkmcnt(0)
mf v[96:99],a[224:227],v[144:147],v[96:99]
s_lshr_b32 s50,s53,1
s_lshr_b32 s51,s52,1
mf v[96:99],a[240:243],v[152:155],v[96:99]
ds_read_b128 v[140:143],v3 offset:4096
ds_read_b128 v[136:139],v3 offset:0
mf v[100:103],a[244:247],v[152:155],v[100:103]
ds_read_b128 v[132:135],v2 offset:4096
ds_read_b128 v[128:131],v2 offset:0
mf v[100:103],a[228:231],v[144:147],v[100:103]
s_mul_i32 s50,s50,81920
s_mul_i32 s51,s51,81920
mf v[104:107],a[232:235],v[144:147],v[104:107]
s_and_b32 s54,s3,1
s_lshl_b32 s54,s54,11
mf v[104:107],a[248:251],v[152:155],v[104:107]
buffer_load_dwordx4 v19,s[16:19],s43 offen offset:1024  lds
mf v[108:111],a[252:255],v[152:155],v[108:111]
buffer_store_dwordx4 v[172:175],v38,s[28:31],s49 offen offset:1024 sc1
s_add_u32 s49,s49,32768
mf v[108:111],a[236:239],v[144:147],v[108:111]
s_lshl_b32 s70,s68,14
s_add_u32 s54,s54,s70
mf v[124:127],a[236:239],v[148:151],v[124:127]
s_add_u32 s50,s50,s54
s_add_u32 s51,s51,s54
mf v[124:127],a[252:255],v[156:159],v[124:127]
s_sub_u32 s53,s53,s52
s_lshl_b32 s53,s53,7
mf v[120:123],a[248:251],v[156:159],v[120:123]
buffer_load_dwordx4 v20,s[16:19],s43 offen offset:2048  lds
mf v[120:123],a[232:235],v[148:151],v[120:123]
v_and_b32 v37,1,v1
v_mul_u32_u24 v37,s53,v37
mf v[116:119],a[228:231],v[148:151],v[116:119]
mf v[116:119],a[244:247],v[156:159],v[116:119]
s_lshl_b32 s52,s52,7
s_add_u32 s52,s52,16384
mf v[112:115],a[240:243],v[156:159],v[112:115]
mf v[112:115],a[224:227],v[148:151],v[112:115]
s_waitcnt lgkmcnt(0)
mf v[64:67],a[0:3],v[128:131],0
buffer_load_dwordx4 v21,s[16:19],s43 offen offset:3072  lds
mf v[64:67],a[16:19],v[136:139],v[64:67]
ds_read_b128 v[156:159],v5 offset:4096
ds_read_b128 v[152:155],v5 offset:0
mf v[68:71],a[20:23],v[136:139],0
ds_read_b128 v[148:151],v4 offset:4096
ds_read_b128 v[144:147],v4 offset:0
mf v[68:71],a[4:7],v[128:131],v[68:71]
mf v[72:75],a[8:11],v[128:131],0
cvt v160,v96,v97
cvt v161,v98,v99
mf v[72:75],a[24:27],v[136:139],v[72:75]
mf v[76:79],a[28:31],v[136:139],0
s_add_u32 m0,s44,81920
s_xor_b32 s43,s40,459008
mf v[76:79],a[12:15],v[128:131],v[76:79]
mf v[92:95],a[12:15],v[132:135],0
mf v[92:95],a[28:31],v[140:143],v[92:95]
mf v[88:91],a[24:27],v[140:143],0
mf v[88:91],a[8:11],v[132:135],v[88:91]
mf v[84:87],a[4:7],v[132:135],0
mf v[84:87],a[20:23],v[140:143],v[84:87]
buffer_load_dwordx4 v18,s[16:19],s43 offen  lds
mf v[80:83],a[16:19],v[140:143],0
mf v[80:83],a[0:3],v[132:135],v[80:83]
s_waitcnt lgkmcnt(0)
mf v[64:67],a[32:35],v[144:147],v[64:67]
cvt v162,v100,v101
cvt v163,v102,v103
mf v[64:67],a[48:51],v[152:155],v[64:67]
ds_read_b128 v[140:143],v3 offset:20480
ds_read_b128 v[136:139],v3 offset:16384
mf v[68:71],a[52:55],v[152:155],v[68:71]
ds_read_b128 v[132:135],v2 offset:20480
ds_read_b128 v[128:131],v2 offset:16384
mf v[68:71],a[36:39],v[144:147],v[68:71]
buffer_load_dwordx4 v19,s[16:19],s43 offen offset:1024  lds
mf v[72:75],a[40:43],v[144:147],v[72:75]
mf v[72:75],a[56:59],v[152:155],v[72:75]
mf v[76:79],a[60:63],v[152:155],v[76:79]
mf v[76:79],a[44:47],v[144:147],v[76:79]
mf v[92:95],a[44:47],v[148:151],v[92:95]
mf v[92:95],a[60:63],v[156:159],v[92:95]
mf v[88:91],a[56:59],v[156:159],v[88:91]
buffer_load_dwordx4 v20,s[16:19],s43 offen offset:2048  lds
mf v[88:91],a[40:43],v[148:151],v[88:91]
mf v[84:87],a[36:39],v[148:151],v[84:87]
mf v[84:87],a[52:55],v[156:159],v[84:87]
buffer_store_dwordx4 v[160:163],v32,s[28:31],s49 offen sc1
cvt v164,v104,v105
mf v[80:83],a[48:51],v[156:159],v[80:83]
mf v[80:83],a[32:35],v[148:151],v[80:83]
s_waitcnt lgkmcnt(0)
mf v[64:67],a[64:67],v[128:131],v[64:67]
buffer_load_dwordx4 v21,s[16:19],s43 offen offset:3072  lds
mf v[64:67],a[80:83],v[136:139],v[64:67]
ds_read_b128 v[156:159],v5 offset:20480
ds_read_b128 v[152:155],v5 offset:16384
mf v[68:71],a[84:87],v[136:139],v[68:71]
ds_read_b128 v[148:151],v4 offset:20480
ds_read_b128 v[144:147],v4 offset:16384
mf v[68:71],a[68:71],v[128:131],v[68:71]
mf v[72:75],a[72:75],v[128:131],v[72:75]
mf v[72:75],a[88:91],v[136:139],v[72:75]
mf v[76:79],a[92:95],v[136:139],v[76:79]
mf v[76:79],a[76:79],v[128:131],v[76:79]
mf v[92:95],a[76:79],v[132:135],v[92:95]
s_waitcnt vmcnt(11)
s_barrier
mf v[92:95],a[92:95],v[140:143],v[92:95]
cvt v165,v106,v107
cvt v166,v108,v109
mf v[88:91],a[88:91],v[140:143],v[88:91]
s_add_u32 m0,s44,98304
s_xor_b32 s43,s40,459264
mf v[88:91],a[72:75],v[132:135],v[88:91]
mf v[84:87],a[68:71],v[132:135],v[84:87]
mf v[84:87],a[84:87],v[140:143],v[84:87]
mf v[80:83],a[80:83],v[140:143],v[80:83]
mf v[80:83],a[64:67],v[132:135],v[80:83]
buffer_load_dwordx4 v18,s[16:19],s43 offen  lds
s_waitcnt lgkmcnt(0)
mf v[64:67],a[96:99],v[144:147],v[64:67]
mf v[64:67],a[112:115],v[152:155],v[64:67]
ds_read_b128 v[140:143],v3 offset:36864
ds_read_b128 v[136:139],v3 offset:32768
mf v[68:71],a[116:119],v[152:155],v[68:71]
ds_read_b128 v[132:135],v2 offset:36864
ds_read_b128 v[128:131],v2 offset:32768
mf v[68:71],a[100:103],v[144:147],v[68:71]
mf v[72:75],a[104:107],v[144:147],v[72:75]
cvt v167,v110,v111
buffer_store_dwordx4 v[164:167],v32,s[28:31],s49 offen offset:1024 sc1
mf v[72:75],a[120:123],v[152:155],v[72:75]
buffer_load_dwordx4 v19,s[16:19],s43 offen offset:1024  lds
mf v[76:79],a[124:127],v[152:155],v[76:79]
mf v[76:79],a[108:111],v[144:147],v[76:79]
mf v[92:95],a[108:111],v[148:151],v[92:95]
mf v[92:95],a[124:127],v[156:159],v[92:95]
mf v[88:91],a[120:123],v[156:159],v[88:91]
buffer_load_dwordx4 v20,s[16:19],s43 offen offset:2048  lds
mf v[88:91],a[104:107],v[148:151],v[88:91]
mf v[84:87],a[100:103],v[148:151],v[84:87]
mf v[84:87],a[116:119],v[156:159],v[84:87]
mf v[80:83],a[112:115],v[156:159],v[80:83]
mf v[80:83],a[96:99],v[148:151],v[80:83]
s_waitcnt lgkmcnt(0)
mf v[64:67],a[128:131],v[128:131],v[64:67]
buffer_load_dwordx4 v21,s[16:19],s43 offen offset:3072  lds
mf v[64:67],a[144:147],v[136:139],v[64:67]
ds_read_b128 v[156:159],v5 offset:36864
ds_read_b128 v[152:155],v5 offset:32768
mf v[68:71],a[148:151],v[136:139],v[68:71]
ds_read_b128 v[148:151],v4 offset:36864
ds_read_b128 v[144:147],v4 offset:32768
mf v[68:71],a[132:135],v[128:131],v[68:71]
s_lshl_b32 s79,s45,7
v_xor_b32 v10,s79,v10
mf v[72:75],a[136:139],v[128:131],v[72:75]
cvt v168,v112,v113
cvt v169,v114,v115
mf v[72:75],a[152:155],v[136:139],v[72:75]
mf v[76:79],a[156:159],v[136:139],v[76:79]
s_add_u32 m0,s44,114688
s_xor_b32 s43,s40,459520
mf v[76:79],a[140:143],v[128:131],v[76:79]
v_xor_b32 v11,32,v10
v_xor_b32 v12,64,v10
mf v[92:95],a[140:143],v[132:135],v[92:95]
mf v[92:95],a[156:159],v[140:143],v[92:95]
mf v[88:91],a[152:155],v[140:143],v[88:91]
mf v[88:91],a[136:139],v[132:135],v[88:91]
mf v[84:87],a[132:135],v[132:135],v[84:87]
v_xor_b32 v13,96,v10
v_xor_b32 v14,128,v10
mf v[84:87],a[148:151],v[140:143],v[84:87]
buffer_load_dwordx4 v18,s[16:19],s43 offen  lds
mf v[80:83],a[144:147],v[140:143],v[80:83]
cvt v170,v116,v117
cvt v171,v118,v119
mf v[80:83],a[128:131],v[132:135],v[80:83]
s_waitcnt lgkmcnt(0)
mf v[64:67],a[160:163],v[144:147],v[64:67]
mf v[64:67],a[176:179],v[152:155],v[64:67]
ds_read_b128 v[140:143],v3 offset:53248
ds_read_b128 v[136:139],v3 offset:49152
mf v[68:71],a[180:183],v[152:155],v[68:71]
ds_read_b128 v[132:135],v2 offset:53248
ds_read_b128 v[128:131],v2 offset:49152
mf v[68:71],a[164:167],v[144:147],v[68:71]
buffer_load_dwordx4 v19,s[16:19],s43 offen offset:1024  lds
mf v[72:75],a[168:171],v[144:147],v[72:75]
v_xor_b32 v15,160,v10
v_xor_b32 v16,192,v10
mf v[72:75],a[184:187],v[152:155],v[72:75]
mf v[76:79],a[188:191],v[152:155],v[76:79]
mf v[76:79],a[172:175],v[144:147],v[76:79]
mf v[92:95],a[172:175],v[148:151],v[92:95]
v_xor_b32 v17,224,v10
mf v[92:95],a[188:191],v[156:159],v[92:95]
mf v[88:91],a[184:187],v[156:159],v[88:91]
buffer_load_dwordx4 v20,s[16:19],s43 offen offset:2048  lds
mf v[88:91],a[168:171],v[148:151],v[88:91]
mf v[84:87],a[164:167],v[148:151],v[84:87]
mf v[84:87],a[180:183],v[156:159],v[84:87]
buffer_store_dwordx4 v[168:171],v38,s[28:31],s49 offen sc1
cvt v172,v120,v121
mf v[80:83],a[176:179],v[156:159],v[80:83]
mf v[80:83],a[160:163],v[148:151],v[80:83]
s_waitcnt lgkmcnt(0)
mf v[64:67],a[192:195],v[128:131],v[64:67]
buffer_load_dwordx4 v21,s[16:19],s43 offen offset:3072  lds
mf v[64:67],a[208:211],v[136:139],v[64:67]
ds_read_b128 v[156:159],v5 offset:53248
ds_read_b128 v[152:155],v5 offset:49152
mf v[68:71],a[212:215],v[136:139],v[68:71]
ds_read_b128 v[148:151],v4 offset:53248
ds_read_b128 v[144:147],v4 offset:49152
mf v[68:71],a[196:199],v[128:131],v[68:71]
cvt v173,v122,v123
cvt v174,v124,v125
mf v[72:75],a[200:203],v[128:131],v[72:75]
buffer_load_dword v188,v37,s[8:11],s52 offen sc1
mf v[72:75],a[216:219],v[136:139],v[72:75]
mf v[76:79],a[220:223],v[136:139],v[76:79]
mf v[76:79],a[204:207],v[128:131],v[76:79]
mf v[92:95],a[204:207],v[132:135],v[92:95]
s_waitcnt vmcnt(11)
s_barrier
mf v[92:95],a[220:223],v[140:143],v[92:95]
mf v[88:91],a[216:219],v[140:143],v[88:91]
s_add_u32 m0,s44,0
s_add_u32 s69,s71,0
mf v[88:91],a[200:203],v[132:135],v[88:91]
mf v[84:87],a[196:199],v[132:135],v[84:87]
cvt v175,v126,v127
mf v[84:87],a[212:215],v[140:143],v[84:87]
mf v[80:83],a[208:211],v[140:143],v[80:83]
mf v[80:83],a[192:195],v[132:135],v[80:83]
buffer_load_dwordx4 v26,s[72:75],s69 offen lds
s_waitcnt lgkmcnt(0)
mf v[64:67],a[224:227],v[144:147],v[64:67]
mf v[64:67],a[240:243],v[152:155],v[64:67]
ds_read_b128 v[140:143],v7 offset:4096
ds_read_b128 v[136:139],v7 offset:0
mf v[68:71],a[244:247],v[152:155],v[68:71]
ds_read_b128 v[132:135],v6 offset:4096
ds_read_b128 v[128:131],v6 offset:0
mf v[68:71],a[228:231],v[144:147],v[68:71]
mf v[72:75],a[232:235],v[144:147],v[72:75]
mf v[72:75],a[248:251],v[152:155],v[72:75]
buffer_load_dwordx4 v27,s[72:75],s69 offen offset:1024 lds
mf v[76:79],a[252:255],v[152:155],v[76:79]
buffer_store_dwordx4 v[172:175],v38,s[28:31],s49 offen offset:1024 sc1
s_add_u32 s49,s49,32768
mf v[76:79],a[236:239],v[144:147],v[76:79]
mf v[92:95],a[236:239],v[148:151],v[92:95]
mf v[92:95],a[252:255],v[156:159],v[92:95]
mf v[88:91],a[248:251],v[156:159],v[88:91]
buffer_load_dwordx4 v28,s[72:75],s69 offen offset:2048 lds
mf v[88:91],a[232:235],v[148:151],v[88:91]
mf v[84:87],a[228:231],v[148:151],v[84:87]
mf v[84:87],a[244:247],v[156:159],v[84:87]
mf v[80:83],a[240:243],v[156:159],v[80:83]
mf v[80:83],a[224:227],v[148:151],v[80:83]
s_waitcnt lgkmcnt(0)
mf v[96:99],a[0:3],v[128:131],0
buffer_load_dwordx4 v29,s[72:75],s69 offen offset:3072 lds
mf v[96:99],a[16:19],v[136:139],v[96:99]
ds_read_b128 v[156:159],v9 offset:4096
ds_read_b128 v[152:155],v9 offset:0
mf v[100:103],a[20:23],v[136:139],0
ds_read_b128 v[148:151],v8 offset:4096
ds_read_b128 v[144:147],v8 offset:0
mf v[100:103],a[4:7],v[128:131],v[100:103]
mf v[104:107],a[8:11],v[128:131],0
cvt v160,v64,v65
cvt v161,v66,v67
mf v[104:107],a[24:27],v[136:139],v[104:107]
mf v[108:111],a[28:31],v[136:139],0
s_add_u32 m0,s44,16384
s_add_u32 s69,s71,524288
mf v[108:111],a[12:15],v[128:131],v[108:111]
mf v[124:127],a[12:15],v[132:135],0
mf v[124:127],a[28:31],v[140:143],v[124:127]
cvt v162,v68,v69
cvt v163,v70,v71
mf v[120:123],a[24:27],v[140:143],0
mf v[120:123],a[8:11],v[132:135],v[120:123]
mf v[116:119],a[4:7],v[132:135],0
mf v[116:119],a[20:23],v[140:143],v[116:119]
buffer_load_dwordx4 v26,s[72:75],s69 offen lds
mf v[112:115],a[16:19],v[140:143],0
mf v[112:115],a[0:3],v[132:135],v[112:115]
s_waitcnt lgkmcnt(0)
mf v[96:99],a[32:35],v[144:147],v[96:99]
buffer_store_dwordx4 v[160:163],v32,s[28:31],s49 offen sc1
cvt v164,v72,v73
mf v[96:99],a[48:51],v[152:155],v[96:99]
ds_read_b128 v[140:143],v7 offset:20480
ds_read_b128 v[136:139],v7 offset:16384
mf v[100:103],a[52:55],v[152:155],v[100:103]
ds_read_b128 v[132:135],v6 offset:20480
ds_read_b128 v[128:131],v6 offset:16384
mf v[100:103],a[36:39],v[144:147],v[100:103]
buffer_load_dwordx4 v27,s[72:75],s69 offen offset:1024 lds
mf v[104:107],a[40:43],v[144:147],v[104:107]
cvt v165,v74,v75
cvt v166,v76,v77
mf v[104:107],a[56:59],v[152:155],v[104:107]
mf v[108:111],a[60:63],v[152:155],v[108:111]
mf v[108:111],a[44:47],v[144:147],v[108:111]
mf v[124:127],a[44:47],v[148:151],v[124:127]
mf v[124:127],a[60:63],v[156:159],v[124:127]
mf v[120:123],a[56:59],v[156:159],v[120:123]
buffer_load_dwordx4 v28,s[72:75],s69 offen offset:2048 lds
mf v[120:123],a[40:43],v[148:151],v[120:123]
mf v[116:119],a[36:39],v[148:151],v[116:119]
mf v[116:119],a[52:55],v[156:159],v[116:119]
cvt v167,v78,v79
buffer_store_dwordx4 v[164:167],v32,s[28:31],s49 offen offset:1024 sc1
mf v[112:115],a[48:51],v[156:159],v[112:115]
mf v[112:115],a[32:35],v[148:151],v[112:115]
s_waitcnt lgkmcnt(0)
mf v[96:99],a[64:67],v[128:131],v[96:99]
buffer_load_dwordx4 v29,s[72:75],s69 offen offset:3072 lds
mf v[96:99],a[80:83],v[136:139],v[96:99]
ds_read_b128 v[156:159],v9 offset:20480
ds_read_b128 v[152:155],v9 offset:16384
mf v[100:103],a[84:87],v[136:139],v[100:103]
ds_read_b128 v[148:151],v8 offset:20480
ds_read_b128 v[144:147],v8 offset:16384
mf v[100:103],a[68:71],v[128:131],v[100:103]
cvt v168,v80,v81
cvt v169,v82,v83
mf v[104:107],a[72:75],v[128:131],v[104:107]
cvt v170,v84,v85
cvt v171,v86,v87
mf v[104:107],a[88:91],v[136:139],v[104:107]
mf v[108:111],a[92:95],v[136:139],v[108:111]
mf v[108:111],a[76:79],v[128:131],v[108:111]
mf v[124:127],a[76:79],v[132:135],v[124:127]
s_waitcnt vmcnt(12)
s_barrier
mf v[124:127],a[92:95],v[140:143],v[124:127]
mf v[120:123],a[88:91],v[140:143],v[120:123]
s_add_u32 m0,s44,32768
s_add_u32 s69,s71,1048576
s_cmp_ge_u32 s68,4
s_cselect_b32 s79,5242880,0
s_sub_u32 s69,s69,s79
mf v[120:123],a[72:75],v[132:135],v[120:123]
buffer_store_dwordx4 v[168:171],v38,s[28:31],s49 offen sc1
cvt v172,v88,v89
mf v[116:119],a[68:71],v[132:135],v[116:119]
mf v[116:119],a[84:87],v[140:143],v[116:119]
mf v[112:115],a[80:83],v[140:143],v[112:115]
mf v[112:115],a[64:67],v[132:135],v[112:115]
buffer_load_dwordx4 v26,s[72:75],s69 offen lds
s_waitcnt lgkmcnt(0)
mf v[96:99],a[96:99],v[144:147],v[96:99]
cvt v173,v90,v91
cvt v174,v92,v93
mf v[96:99],a[112:115],v[152:155],v[96:99]
ds_read_b128 v[140:143],v7 offset:36864
ds_read_b128 v[136:139],v7 offset:32768
mf v[100:103],a[116:119],v[152:155],v[100:103]
ds_read_b128 v[132:135],v6 offset:36864
ds_read_b128 v[128:131],v6 offset:32768
mf v[100:103],a[100:103],v[144:147],v[100:103]
mf v[104:107],a[104:107],v[144:147],v[104:107]
mf v[104:107],a[120:123],v[152:155],v[104:107]
buffer_load_dwordx4 v27,s[72:75],s69 offen offset:1024 lds
cvt v175,v94,v95
mf v[108:111],a[124:127],v[152:155],v[108:111]
mf v[108:111],a[108:111],v[144:147],v[108:111]
mf v[124:127],a[108:111],v[148:151],v[124:127]
mf v[124:127],a[124:127],v[156:159],v[124:127]
mf v[120:123],a[120:123],v[156:159],v[120:123]
buffer_load_dwordx4 v28,s[72:75],s69 offen offset:2048 lds
mf v[120:123],a[104:107],v[148:151],v[120:123]
mf v[116:119],a[100:103],v[148:151],v[116:119]
mf v[116:119],a[116:119],v[156:159],v[116:119]
buffer_store_dwordx4 v[172:175],v38,s[28:31],s49 offen offset:1024 sc1
s_add_u32 s49,s49,32768
mf v[112:115],a[112:115],v[156:159],v[112:115]
mf v[112:115],a[96:99],v[148:151],v[112:115]
LKh_chk:
s_waitcnt vmcnt(16)
v_cmp_ne_u32 vcc,16,v188
s_nop 0
s_cbranch_vccnz LKh_spin
s_waitcnt lgkmcnt(0)
mf v[96:99],a[128:131],v[128:131],v[96:99]
buffer_load_dwordx4 v29,s[72:75],s69 offen offset:3072 lds
mf v[96:99],a[144:147],v[136:139],v[96:99]
ds_read_b128 v[156:159],v9 offset:36864
ds_read_b128 v[152:155],v9 offset:32768
mf v[100:103],a[148:151],v[136:139],v[100:103]
ds_read_b128 v[148:151],v8 offset:36864
ds_read_b128 v[144:147],v8 offset:32768
mf v[100:103],a[132:135],v[128:131],v[100:103]
buffer_load_dwordx4 v[64:67],v32,s[60:63],s50 offen sc1
mf v[104:107],a[136:139],v[128:131],v[104:107]
mf v[104:107],a[152:155],v[136:139],v[104:107]
mf v[108:111],a[156:159],v[136:139],v[108:111]
s_add_u32 m0,s44,49152
s_add_u32 s69,s71,1572864
s_cmp_ge_u32 s68,4
s_cselect_b32 s79,5242880,0
s_sub_u32 s69,s69,s79
mf v[108:111],a[140:143],v[128:131],v[108:111]
buffer_load_dwordx4 v[68:71],v32,s[60:63],s50 offen offset:1024 sc1
s_add_u32 s50,s50,4096
mf v[124:127],a[140:143],v[132:135],v[124:127]
mf v[124:127],a[156:159],v[140:143],v[124:127]
mf v[120:123],a[152:155],v[140:143],v[120:123]
buffer_load_dwordx4 v[72:75],v32,s[60:63],s51 offen sc1
mf v[120:123],a[136:139],v[132:135],v[120:123]
mf v[116:119],a[132:135],v[132:135],v[116:119]
mf v[116:119],a[148:151],v[140:143],v[116:119]
buffer_load_dwordx4 v26,s[72:75],s69 offen lds
mf v[112:115],a[144:147],v[140:143],v[112:115]
mf v[112:115],a[128:131],v[132:135],v[112:115]
s_waitcnt lgkmcnt(0)
mf v[96:99],a[160:163],v[144:147],v[96:99]
buffer_load_dwordx4 v[76:79],v32,s[60:63],s51 offen offset:1024 sc1
s_add_u32 s51,s51,4096
mf v[96:99],a[176:179],v[152:155],v[96:99]
ds_read_b128 v[140:143],v7 offset:53248
ds_read_b128 v[136:139],v7 offset:49152
mf v[100:103],a[180:183],v[152:155],v[100:103]
ds_read_b128 v[132:135],v6 offset:53248
ds_read_b128 v[128:131],v6 offset:49152
mf v[100:103],a[164:167],v[144:147],v[100:103]
buffer_load_dwordx4 v27,s[72:75],s69 offen offset:1024 lds
mf v[104:107],a[168:171],v[144:147],v[104:107]
mf v[104:107],a[184:187],v[152:155],v[104:107]
mf v[108:111],a[188:191],v[152:155],v[108:111]
buffer_load_dwordx4 v[80:83],v32,s[60:63],s50 offen sc1
mf v[108:111],a[172:175],v[144:147],v[108:111]
buffer_load_dwordx4 v[84:87],v32,s[60:63],s50 offen offset:1024 sc1
s_add_u32 s50,s50,4096
mf v[124:127],a[172:175],v[148:151],v[124:127]
mf v[124:127],a[188:191],v[156:159],v[124:127]
mf v[120:123],a[184:187],v[156:159],v[120:123]
buffer_load_dwordx4 v28,s[72:75],s69 offen offset:2048 lds
mf v[120:123],a[168:171],v[148:151],v[120:123]
mf v[116:119],a[164:167],v[148:151],v[116:119]
mf v[116:119],a[180:183],v[156:159],v[116:119]
buffer_load_dwordx4 v[88:91],v32,s[60:63],s51 offen sc1
mf v[112:115],a[176:179],v[156:159],v[112:115]
mf v[112:115],a[160:163],v[148:151],v[112:115]
s_waitcnt lgkmcnt(0)
mf v[96:99],a[192:195],v[128:131],v[96:99]
buffer_load_dwordx4 v29,s[72:75],s69 offen offset:3072 lds
mf v[96:99],a[208:211],v[136:139],v[96:99]
ds_read_b128 v[156:159],v9 offset:53248
ds_read_b128 v[152:155],v9 offset:49152
mf v[100:103],a[212:215],v[136:139],v[100:103]
ds_read_b128 v[148:151],v8 offset:53248
ds_read_b128 v[144:147],v8 offset:49152
mf v[100:103],a[196:199],v[128:131],v[100:103]
buffer_load_dwordx4 v[92:95],v32,s[60:63],s51 offen offset:1024 sc1
s_add_u32 s51,s51,4096
mf v[104:107],a[200:203],v[128:131],v[104:107]
mf v[104:107],a[216:219],v[136:139],v[104:107]
mf v[108:111],a[220:223],v[136:139],v[108:111]
buffer_load_dwordx4 v[48:51],v32,s[60:63],s50 offen sc1
mf v[108:111],a[204:207],v[128:131],v[108:111]
mf v[124:127],a[204:207],v[132:135],v[124:127]
s_waitcnt vmcnt(19)
s_barrier
mf v[124:127],a[220:223],v[140:143],v[124:127]
buffer_load_dwordx4 v[52:55],v32,s[60:63],s50 offen offset:1024 sc1
s_add_u32 s50,s50,4096
mf v[120:123],a[216:219],v[140:143],v[120:123]
s_add_u32 m0,s44,65536
s_add_u32 s69,s71,2097152
s_cmp_ge_u32 s68,3
s_cselect_b32 s79,5242880,0
s_sub_u32 s69,s69,s79
mf v[120:123],a[200:203],v[132:135],v[120:123]
mf v[116:119],a[196:199],v[132:135],v[116:119]
buffer_load_dwordx4 v[56:59],v32,s[60:63],s51 offen sc1
mf v[116:119],a[212:215],v[140:143],v[116:119]
mf v[112:115],a[208:211],v[140:143],v[112:115]
buffer_load_dwordx4 v[60:63],v32,s[60:63],s51 offen offset:1024 sc1
s_add_u32 s51,s51,4096
mf v[112:115],a[192:195],v[132:135],v[112:115]
buffer_load_dwordx4 v26,s[72:75],s69 offen lds
s_waitcnt lgkmcnt(0)
mf v[96:99],a[224:227],v[144:147],v[96:99]
mf v[96:99],a[240:243],v[152:155],v[96:99]
mf v[100:103],a[244:247],v[152:155],v[100:103]
ds_read_b64_tr_b16 a[192:193],v10 offset:0
ds_read_b64_tr_b16 a[194:195],v10 offset:1024
mf v[100:103],a[228:231],v[144:147],v[100:103]
ds_read_b64_tr_b16 a[196:197],v11 offset:0
ds_read_b64_tr_b16 a[198:199],v11 offset:1024
mf v[104:107],a[232:235],v[144:147],v[104:107]
mf v[104:107],a[248:251],v[152:155],v[104:107]
buffer_load_dwordx4 v27,s[72:75],s69 offen offset:1024 lds
mf v[108:111],a[252:255],v[152:155],v[108:111]
ds_read_b64_tr_b16 a[200:201],v12 offset:0
ds_read_b64_tr_b16 a[202:203],v12 offset:1024
mf v[108:111],a[236:239],v[144:147],v[108:111]
ds_read_b64_tr_b16 a[204:205],v13 offset:0
ds_read_b64_tr_b16 a[206:207],v13 offset:1024
mf v[124:127],a[236:239],v[148:151],v[124:127]
ds_read_b64_tr_b16 a[208:209],v10 offset:8192
ds_read_b64_tr_b16 a[210:211],v10 offset:9216
mf v[124:127],a[252:255],v[156:159],v[124:127]
ds_read_b64_tr_b16 a[212:213],v11 offset:8192
ds_read_b64_tr_b16 a[214:215],v11 offset:9216
mf v[120:123],a[248:251],v[156:159],v[120:123]
buffer_load_dwordx4 v28,s[72:75],s69 offen offset:2048 lds
mf v[120:123],a[232:235],v[148:151],v[120:123]
ds_read_b64_tr_b16 a[216:217],v12 offset:8192
ds_read_b64_tr_b16 a[218:219],v12 offset:9216
mf v[116:119],a[228:231],v[148:151],v[116:119]
ds_read_b64_tr_b16 a[220:221],v13 offset:8192
ds_read_b64_tr_b16 a[222:223],v13 offset:9216
mf v[116:119],a[244:247],v[156:159],v[116:119]
mf v[112:115],a[240:243],v[156:159],v[112:115]
mf v[112:115],a[224:227],v[148:151],v[112:115]
cvt v160,v96,v97
cvt v161,v98,v99
cvt v162,v100,v101
cvt v163,v102,v103
buffer_store_dwordx4 v[160:163],v32,s[28:31],s49 offen sc1
cvt v164,v104,v105
cvt v165,v106,v107
cvt v166,v108,v109
cvt v167,v110,v111
buffer_store_dwordx4 v[164:167],v32,s[28:31],s49 offen offset:1024 sc1
cvt v168,v112,v113
cvt v169,v114,v115
cvt v170,v116,v117
cvt v171,v118,v119
buffer_store_dwordx4 v[168:171],v38,s[28:31],s49 offen sc1
cvt v172,v120,v121
cvt v173,v122,v123
cvt v174,v124,v125
cvt v175,v126,v127
buffer_store_dwordx4 v[172:175],v38,s[28:31],s49 offen offset:1024 sc1
s_add_u32 s49,s49,32768
buffer_load_dwordx4 v29,s[72:75],s69 offen offset:3072 lds
s_add_u32 m0,s44,81920
s_add_u32 s69,s71,2621440
s_cmp_ge_u32 s68,3
s_cselect_b32 s79,5242880,0
s_sub_u32 s69,s69,s79
buffer_load_dwordx4 v26,s[72:75],s69 offen lds
buffer_load_dwordx4 v27,s[72:75],s69 offen offset:1024 lds
buffer_load_dwordx4 v28,s[72:75],s69 offen offset:2048 lds
buffer_load_dwordx4 v29,s[72:75],s69 offen offset:3072 lds
s_branch Latt
LV:
s_mov_b32 s72,s24
s_mov_b32 s73,s25
s_mov_b32 s74,1280
s_mov_b32 s75,0x20000
s_mov_b32 s76,s26
s_mov_b32 s77,s27
s_cmp_lt_u32 s2,240
s_cselect_b32 s78,4915200,0
s_mov_b32 s79,0x20000
s_mov_b32 s36,s32
s_mov_b32 s37,s33
s_mov_b32 s38,256
s_mov_b32 s39,0x20000
s_add_u32 s32,s4,0
s_addc_u32 s33,s5,0
s_mov_b32 s34,61440
s_mov_b32 s35,0x20000
s_lshr_b32 s64,s2,2
s_and_b32 s65,s2,3
v_lshrrev_b32 v250,3,v0
s_mul_i32 s50,s65,160
v_add_u32 v250,s50,v250
v_mul_u32_u24 v251,7680,v250
v_and_b32 v252,7,v0
v_lshl_add_u32 v251,v252,4,v251
v_lshlrev_b32 v250,1,v250
s_lshl_b32 s66,s64,7
v_lshlrev_b32 v252,5,v252
v_lshrrev_b32 v253,5,v1
v_lshl_add_u32 v252,v253,4,v252
v_bfe_u32 v253,v1,4,1
v_lshl_add_u32 v252,v253,3,v252
s_lshl_b32 s50,s3,8
s_add_u32 s50,s50,137216
v_add_u32 v252,s50,v252
v_lshlrev_b32 v253,2,v1
v_add_u32 v254,137216,v253
s_mul_i32 s67,s65,15360
s_lshl_b32 s50,s64,8
s_add_u32 s67,s67,s50
s_cmp_lt_u32 s2,240
s_cselect_b32 s67,s67,0x1000000
s_cmp_eq_u32 s3,0
s_cselect_b32 s67,s67,0x1000000
s_lshl_b32 s68,s65,6
s_cmp_lt_u32 s2,80
s_cselect_b32 s68,s68,4096
s_cmp_eq_u32 s3,0
s_cselect_b32 s68,s68,4096
v_lshlrev_b32 v255,12,v1
v_and_b32 v37,3,v1
v_lshlrev_b32 v37,6,v37
v_mov_b32 v35,1
v_lshlrev_b32 v40,4,v0
s_cmp_eq_u32 s3,0
s_cselect_b32 s50,0,0x1000000
s_cselect_b32 s51,0,1024
v_add_u32 v39,4096,v32
v_add_u32 v39,s50,v39
s_add_u32 s51,s51,135168
v_add_u32 v42,s51,v32
v_cmp_gt_u32 vcc,160,v0
s_nop 1
v_cndmask_b32 v36,1.0,0,vcc
v_add_u32 v41,131072,v40
s_add_u32 s8,s4,87883776
s_addc_u32 s9,s5,0
s_mov_b32 s10,212992
s_mov_b32 s11,0x20000
s_mul_i32 s50,s2,2688
s_cmp_lt_u32 s68,4096
s_cselect_b32 s50,s50,0x100000
v_lshlrev_b32 v22,7,v1
v_mov_b32 v23,0x100000
v_cmp_gt_u32 vcc,21,v1
s_nop 1
v_cndmask_b32 v22,v23,v22,vcc
v_mov_b32 v48,0
v_mov_b32 v49,0
v_mov_b32 v50,0
v_mov_b32 v51,0
buffer_store_dwordx4 v[48:51],v22,s[8:11],s50 offen sc1
buffer_store_dwordx4 v[48:51],v22,s[8:11],s50 offen offset:16 sc1
s_mov_b32 s52,15360
s_mov_b32 s53,30720
s_mov_b32 s54,46080
s_mov_b32 s56,s12
s_mov_b32 s57,s13
s_mov_b32 s58,2621440
s_mov_b32 s59,0x20000
s_mov_b32 s63,0x20000
s_add_u32 s60,s4,131072
s_addc_u32 s61,s5,0
s_mov_b32 s62,2621440
v_and_b32 v44,7,v1
v_lshrrev_b32 v47,3,v1
s_mul_i32 s50,s3,20
v_add_u32 v47,s50,v47
s_lshl_b32 s51,s2,3
v_add_u32 v45,s51,v44
v_mul_u32_u24 v45,1280,v45
v_lshl_add_u32 v45,v47,4,v45
v_lshrrev_b32 v43,5,v1
v_lshl_add_u32 v24,v43,26,v45
v_lshlrev_b32 v31,5,v47
v_add_u32 v31,131072,v31
s_lshr_b32 s50,s2,4
s_lshl_b32 s50,s50,1
s_bfe_u32 s51,s2,0x10002
s_add_u32 s50,s50,s51
s_mul_i32 s50,s50,81920
s_bfe_u32 s51,s2,0x10001
s_lshl_b32 s51,s51,11
s_add_u32 s50,s50,s51
s_bfe_u32 s51,s2,0x10003
s_lshl_b32 s51,s51,10
s_add_u32 s50,s50,s51
s_and_b32 s51,s2,1
s_lshl_b32 s51,s51,7
s_add_u32 s50,s50,s51
v_lshrrev_b32 v46,2,v47
v_lshlrev_b32 v46,12,v46
v_and_b32 v47,3,v47
v_lshl_add_u32 v46,v47,8,v46
v_lshl_add_u32 v46,v44,4,v46
v_add_u32 v46,s50,v46
v_lshl_add_u32 v25,v43,26,v46
v_sub_u32 v43,1,v43
v_cvt_f32_u32 v30,v43
v_lshlrev_b32 v44,4,v44
v_add_u32 v44,138240,v44
s_lshl_b32 s50,s3,2
v_add_u32 v47,s50,v44
s_mov_b32 s24,s70
s_mov_b32 s25,s71
s_mov_b32 s26,5242880
s_mov_b32 s27,0x20000
s_lshr_b32 s50,s2,5
s_lshl_b32 s50,s50,2
s_add_u32 s50,s50,s3
s_lshl_b32 s50,s50,13
s_lshl_b32 s6,s14,8
s_add_u32 s6,s6,s50
v_lshrrev_b32 v22,1,v1
v_lshlrev_b32 v22,18,v22
v_and_b32 v23,1,v1
v_lshl_add_u32 v22,v23,7,v22
s_waitcnt vmcnt(6)
s_barrier
ds_read_b128 v[132:135],v2 offset:20480
ds_read_b128 v[128:131],v2 offset:16384
ds_read_b64_tr_b16 a[0:1],v10 offset:0
s_xor_b32 s43,s55,2
s_lshl_b32 s43,s43,19
s_add_u32 m0,s44,65536
s_add_u32 s43,s43,s42
ds_read_b64_tr_b16 a[2:3],v10 offset:1024
ds_read_b64_tr_b16 a[4:5],v11 offset:0
buffer_load_dwordx4 v26,s[20:23],s43 offen lds
ds_read_b64_tr_b16 a[6:7],v11 offset:1024
ds_read_b64_tr_b16 a[8:9],v12 offset:0
ds_read_b64_tr_b16 a[10:11],v12 offset:1024
buffer_load_dwordx4 v27,s[20:23],s43 offen offset:1024 lds
ds_read_b64_tr_b16 a[12:13],v13 offset:0
ds_read_b64_tr_b16 a[14:15],v13 offset:1024
buffer_load_dwordx4 v28,s[20:23],s43 offen offset:2048 lds
ds_read_b128 v[140:143],v3 offset:20480
ds_read_b128 v[136:139],v3 offset:16384
buffer_load_dwordx4 v29,s[20:23],s43 offen offset:3072 lds
ds_read_b64_tr_b16 a[16:17],v10 offset:8192
ds_read_b64_tr_b16 a[18:19],v10 offset:9216
ds_read_b64_tr_b16 a[20:21],v11 offset:8192
s_add_u32 m0,s44,81920
s_xor_b32 s43,s40,256
ds_read_b64_tr_b16 a[22:23],v11 offset:9216
ds_read_b64_tr_b16 a[24:25],v12 offset:8192
buffer_load_dwordx4 v18,s[16:19],s43 offen  lds
ds_read_b64_tr_b16 a[26:27],v12 offset:9216
ds_read_b64_tr_b16 a[28:29],v13 offset:8192
ds_read_b64_tr_b16 a[30:31],v13 offset:9216
buffer_load_dwordx4 v19,s[16:19],s43 offen offset:1024  lds
ds_read_b128 v[164:167],v2 offset:36864
ds_read_b128 v[160:163],v2 offset:32768
buffer_load_dwordx4 v20,s[16:19],s43 offen offset:2048  lds
ds_read_b128 v[172:175],v3 offset:36864
ds_read_b128 v[168:171],v3 offset:32768
buffer_load_dwordx4 v21,s[16:19],s43 offen offset:3072  lds
s_waitcnt lgkmcnt(0)
s_waitcnt vmcnt(10)
s_barrier
mf v[64:67],v[128:131],a[0:3],0
ds_read_b128 v[148:151],v4 offset:20480
ds_read_b128 v[144:147],v4 offset:16384
mf v[64:67],v[136:139],a[16:19],v[64:67]
s_add_u32 m0,s44,98304
s_xor_b32 s43,s40,65792
mf v[68:71],v[136:139],a[20:23],0
ds_read_b64_tr_b16 a[32:33],v10 offset:49152
ds_read_b64_tr_b16 a[34:35],v10 offset:50176
mf v[68:71],v[128:131],a[4:7],v[68:71]
buffer_load_dwordx4 v18,s[16:19],s43 offen  lds
mf v[72:75],v[128:131],a[8:11],0
ds_read_b64_tr_b16 a[36:37],v11 offset:49152
ds_read_b64_tr_b16 a[38:39],v11 offset:50176
mf v[72:75],v[136:139],a[24:27],v[72:75]
buffer_load_dwordx4 v19,s[16:19],s43 offen offset:1024  lds
mf v[76:79],v[136:139],a[28:31],0
ds_read_b64_tr_b16 a[40:41],v12 offset:49152
ds_read_b64_tr_b16 a[42:43],v12 offset:50176
mf v[76:79],v[128:131],a[12:15],v[76:79]
buffer_load_dwordx4 v20,s[16:19],s43 offen offset:2048  lds
mf v[92:95],v[132:135],a[12:15],0
ds_read_b64_tr_b16 a[44:45],v13 offset:49152
ds_read_b64_tr_b16 a[46:47],v13 offset:50176
mf v[92:95],v[140:143],a[28:31],v[92:95]
buffer_load_dwordx4 v21,s[16:19],s43 offen offset:3072  lds
mf v[88:91],v[140:143],a[24:27],0
ds_read_b128 v[156:159],v5 offset:20480
ds_read_b128 v[152:155],v5 offset:16384
mf v[88:91],v[132:135],a[8:11],v[88:91]
s_xor_b32 s43,s55,3
s_lshl_b32 s43,s43,19
s_add_u32 m0,s44,114688
s_add_u32 s43,s43,s42
mf v[84:87],v[132:135],a[4:7],0
buffer_load_dwordx4 v26,s[20:23],s43 offen lds
mf v[84:87],v[140:143],a[20:23],v[84:87]
ds_read_b64_tr_b16 a[48:49],v10 offset:57344
ds_read_b64_tr_b16 a[50:51],v10 offset:58368
mf v[80:83],v[140:143],a[16:19],0
buffer_load_dwordx4 v27,s[20:23],s43 offen offset:1024 lds
mf v[80:83],v[132:135],a[0:3],v[80:83]
ds_read_b64_tr_b16 a[52:53],v11 offset:57344
ds_read_b64_tr_b16 a[54:55],v11 offset:58368
mf v[96:99],v[160:163],a[0:3],0
mf v[96:99],v[168:171],a[16:19],v[96:99]
ds_read_b64_tr_b16 a[56:57],v12 offset:57344
ds_read_b64_tr_b16 a[58:59],v12 offset:58368
mf v[100:103],v[168:171],a[20:23],0
buffer_load_dwordx4 v28,s[20:23],s43 offen offset:2048 lds
mf v[100:103],v[160:163],a[4:7],v[100:103]
ds_read_b64_tr_b16 a[60:61],v13 offset:57344
ds_read_b64_tr_b16 a[62:63],v13 offset:58368
mf v[104:107],v[160:163],a[8:11],0
buffer_load_dwordx4 v29,s[20:23],s43 offen offset:3072 lds
mf v[104:107],v[168:171],a[24:27],v[104:107]
ds_read_b128 v[180:183],v4 offset:36864
ds_read_b128 v[176:179],v4 offset:32768
mf v[108:111],v[168:171],a[28:31],0
s_xor_b32 s43,s55,4
s_lshl_b32 s43,s43,19
s_add_u32 m0,s44,0
s_add_u32 s43,s43,s42
mf v[108:111],v[160:163],a[12:15],v[108:111]
ds_read_b128 v[188:191],v5 offset:36864
ds_read_b128 v[184:187],v5 offset:32768
mf v[124:127],v[164:167],a[12:15],0
buffer_load_dwordx4 v26,s[20:23],s43 offen lds
mf v[124:127],v[172:175],a[28:31],v[124:127]
buffer_load_dwordx4 v27,s[20:23],s43 offen offset:1024 lds
mf v[120:123],v[172:175],a[24:27],0
mf v[120:123],v[164:167],a[8:11],v[120:123]
buffer_load_dwordx4 v28,s[20:23],s43 offen offset:2048 lds
mf v[116:119],v[164:167],a[4:7],0
mf v[116:119],v[172:175],a[20:23],v[116:119]
buffer_load_dwordx4 v29,s[20:23],s43 offen offset:3072 lds
mf v[112:115],v[172:175],a[16:19],0
mf v[112:115],v[164:167],a[0:3],v[112:115]
s_waitcnt lgkmcnt(0)
s_waitcnt vmcnt(8)
s_barrier
mf v[64:67],v[144:147],a[32:35],v[64:67]
ds_read_b128 v[132:135],v6 offset:20480
ds_read_b128 v[128:131],v6 offset:16384
mf v[64:67],v[152:155],a[48:51],v[64:67]
s_add_u32 m0,s44,16384
s_xor_b32 s43,s40,512
mf v[68:71],v[152:155],a[52:55],v[68:71]
ds_read_b64_tr_b16 a[64:65],v14 offset:0
ds_read_b64_tr_b16 a[66:67],v14 offset:1024
mf v[68:71],v[144:147],a[36:39],v[68:71]
mf v[72:75],v[144:147],a[40:43],v[72:75]
ds_read_b64_tr_b16 a[68:69],v15 offset:0
ds_read_b64_tr_b16 a[70:71],v15 offset:1024
mf v[72:75],v[152:155],a[56:59],v[72:75]
mf v[76:79],v[152:155],a[60:63],v[76:79]
ds_read_b64_tr_b16 a[72:73],v16 offset:0
ds_read_b64_tr_b16 a[74:75],v16 offset:1024
mf v[76:79],v[144:147],a[44:47],v[76:79]
buffer_load_dwordx4 v18,s[16:19],s43 offen  lds
mf v[92:95],v[148:151],a[44:47],v[92:95]
ds_read_b64_tr_b16 a[76:77],v17 offset:0
ds_read_b64_tr_b16 a[78:79],v17 offset:1024
mf v[92:95],v[156:159],a[60:63],v[92:95]
buffer_load_dwordx4 v[212:215],v251,s[76:79],s66 offen
s_add_u32 s66,s66,245760
mf v[88:91],v[156:159],a[56:59],v[88:91]
ds_read_b128 v[140:143],v7 offset:20480
ds_read_b128 v[136:139],v7 offset:16384
mf v[88:91],v[148:151],a[40:43],v[88:91]
buffer_load_ushort v232,v250,s[72:75],0 offen offset:0
mf v[84:87],v[148:151],a[36:39],v[84:87]
buffer_load_dwordx4 v19,s[16:19],s43 offen offset:1024  lds
mf v[84:87],v[156:159],a[52:55],v[84:87]
ds_read_b64_tr_b16 a[80:81],v14 offset:8192
ds_read_b64_tr_b16 a[82:83],v14 offset:9216
mf v[80:83],v[156:159],a[48:51],v[80:83]
buffer_load_dwordx4 v[216:219],v251,s[76:79],s66 offen
s_add_u32 s66,s66,245760
mf v[80:83],v[148:151],a[32:35],v[80:83]
ds_read_b64_tr_b16 a[84:85],v15 offset:8192
ds_read_b64_tr_b16 a[86:87],v15 offset:9216
mf v[96:99],v[176:179],a[32:35],v[96:99]
buffer_load_ushort v233,v250,s[72:75],0 offen offset:64
mf v[96:99],v[184:187],a[48:51],v[96:99]
ds_read_b64_tr_b16 a[88:89],v16 offset:8192
ds_read_b64_tr_b16 a[90:91],v16 offset:9216
mf v[100:103],v[184:187],a[52:55],v[100:103]
buffer_load_dwordx4 v[220:223],v251,s[76:79],s66 offen
s_add_u32 s66,s66,245760
mf v[100:103],v[176:179],a[36:39],v[100:103]
ds_read_b64_tr_b16 a[92:93],v17 offset:8192
ds_read_b64_tr_b16 a[94:95],v17 offset:9216
mf v[104:107],v[176:179],a[40:43],v[104:107]
buffer_load_dwordx4 v20,s[16:19],s43 offen offset:2048  lds
buffer_load_ushort v234,v250,s[72:75],0 offen offset:128
mf v[104:107],v[184:187],a[56:59],v[104:107]
ds_read_b128 v[164:167],v6 offset:36864
ds_read_b128 v[160:163],v6 offset:32768
mf v[108:111],v[184:187],a[60:63],v[108:111]
buffer_load_dwordx4 v[224:227],v251,s[76:79],s66 offen
s_add_u32 s66,s66,245760
mf v[108:111],v[176:179],a[44:47],v[108:111]
ds_read_b128 v[172:175],v7 offset:36864
ds_read_b128 v[168:171],v7 offset:32768
mf v[124:127],v[180:183],a[44:47],v[124:127]
buffer_load_ushort v235,v250,s[72:75],0 offen offset:192
buffer_load_dwordx4 v[192:195],v45,s[56:59],0 offen offset:0
mf v[124:127],v[188:191],a[60:63],v[124:127]
buffer_load_dwordx4 v21,s[16:19],s43 offen offset:3072  lds
buffer_load_dwordx4 v[196:199],v45,s[56:59],0 offen offset:128
mf v[120:123],v[188:191],a[56:59],v[120:123]
mf v[120:123],v[180:183],a[40:43],v[120:123]
buffer_load_dwordx4 v[228:231],v251,s[76:79],s66 offen
s_add_u32 s66,s66,245760
mf v[116:119],v[180:183],a[36:39],v[116:119]
buffer_load_dwordx4 v[200:203],v24,s[56:59],0 offen offset:256
mf v[116:119],v[188:191],a[52:55],v[116:119]
buffer_load_ushort v236,v250,s[72:75],0 offen offset:256
mf v[112:115],v[188:191],a[48:51],v[112:115]
mf v[112:115],v[180:183],a[32:35],v[112:115]
s_waitcnt lgkmcnt(0)
s_waitcnt vmcnt(21)
s_barrier
mf v[64:67],v[128:131],a[64:67],v[64:67]
ds_read_b128 v[148:151],v8 offset:20480
ds_read_b128 v[144:147],v8 offset:16384
mf v[64:67],v[136:139],a[80:83],v[64:67]
s_add_u32 m0,s44,32768
s_xor_b32 s43,s40,66048
mf v[68:71],v[136:139],a[84:87],v[68:71]
ds_read_b64_tr_b16 a[96:97],v14 offset:49152
ds_read_b64_tr_b16 a[98:99],v14 offset:50176
mf v[68:71],v[128:131],a[68:71],v[68:71]
buffer_load_dwordx4 v18,s[16:19],s43 offen  lds
mf v[72:75],v[128:131],a[72:75],v[72:75]
ds_read_b64_tr_b16 a[100:101],v15 offset:49152
ds_read_b64_tr_b16 a[102:103],v15 offset:50176
mf v[72:75],v[136:139],a[88:91],v[72:75]
buffer_load_dwordx4 v19,s[16:19],s43 offen offset:1024  lds
mf v[76:79],v[136:139],a[92:95],v[76:79]
ds_read_b64_tr_b16 a[104:105],v16 offset:49152
ds_read_b64_tr_b16 a[106:107],v16 offset:50176
mf v[76:79],v[128:131],a[76:79],v[76:79]
buffer_load_dwordx4 v20,s[16:19],s43 offen offset:2048  lds
mf v[92:95],v[132:135],a[76:79],v[92:95]
ds_read_b64_tr_b16 a[108:109],v17 offset:49152
ds_read_b64_tr_b16 a[110:111],v17 offset:50176
mf v[92:95],v[140:143],a[92:95],v[92:95]
buffer_load_dwordx4 v21,s[16:19],s43 offen offset:3072  lds
mf v[88:91],v[140:143],a[88:91],v[88:91]
ds_read_b128 v[156:159],v9 offset:20480
ds_read_b128 v[152:155],v9 offset:16384
mf v[88:91],v[132:135],a[72:75],v[88:91]
s_xor_b32 s43,s55,5
s_lshl_b32 s43,s43,19
s_add_u32 m0,s44,49152
s_add_u32 s43,s43,s42
mf v[84:87],v[132:135],a[68:71],v[84:87]
buffer_load_dwordx4 v26,s[20:23],s43 offen lds
mf v[84:87],v[140:143],a[84:87],v[84:87]
ds_read_b64_tr_b16 a[112:113],v14 offset:57344
ds_read_b64_tr_b16 a[114:115],v14 offset:58368
mf v[80:83],v[140:143],a[80:83],v[80:83]
buffer_load_dwordx4 v27,s[20:23],s43 offen offset:1024 lds
mf v[80:83],v[132:135],a[64:67],v[80:83]
ds_read_b64_tr_b16 a[116:117],v15 offset:57344
ds_read_b64_tr_b16 a[118:119],v15 offset:58368
mf v[96:99],v[160:163],a[64:67],v[96:99]
mf v[96:99],v[168:171],a[80:83],v[96:99]
ds_read_b64_tr_b16 a[120:121],v16 offset:57344
ds_read_b64_tr_b16 a[122:123],v16 offset:58368
mf v[100:103],v[168:171],a[84:87],v[100:103]
buffer_load_dwordx4 v28,s[20:23],s43 offen offset:2048 lds
mf v[100:103],v[160:163],a[68:71],v[100:103]
ds_read_b64_tr_b16 a[124:125],v17 offset:57344
ds_read_b64_tr_b16 a[126:127],v17 offset:58368
mf v[104:107],v[160:163],a[72:75],v[104:107]
buffer_load_dwordx4 v29,s[20:23],s43 offen offset:3072 lds
mf v[104:107],v[168:171],a[88:91],v[104:107]
ds_read_b128 v[180:183],v8 offset:36864
ds_read_b128 v[176:179],v8 offset:32768
mf v[108:111],v[168:171],a[92:95],v[108:111]
s_xor_b32 s43,s55,6
s_lshl_b32 s43,s43,19
s_add_u32 m0,s44,65536
s_add_u32 s43,s43,s42
mf v[108:111],v[160:163],a[76:79],v[108:111]
ds_read_b128 v[188:191],v9 offset:36864
ds_read_b128 v[184:187],v9 offset:32768
mf v[124:127],v[164:167],a[76:79],v[124:127]
buffer_load_dwordx4 v26,s[20:23],s43 offen lds
mf v[124:127],v[172:175],a[92:95],v[124:127]
buffer_load_dwordx4 v27,s[20:23],s43 offen offset:1024 lds
mf v[120:123],v[172:175],a[88:91],v[120:123]
mf v[120:123],v[164:167],a[72:75],v[120:123]
buffer_load_dwordx4 v28,s[20:23],s43 offen offset:2048 lds
mf v[116:119],v[164:167],a[68:71],v[116:119]
mf v[116:119],v[172:175],a[84:87],v[116:119]
buffer_load_dwordx4 v29,s[20:23],s43 offen offset:3072 lds
mf v[112:115],v[172:175],a[80:83],v[112:115]
mf v[112:115],v[164:167],a[64:67],v[112:115]
s_waitcnt lgkmcnt(0)
s_waitcnt vmcnt(8)
s_barrier
mf v[64:67],v[144:147],a[96:99],v[64:67]
ds_read_b128 v[132:135],v2 offset:20480
ds_read_b128 v[128:131],v2 offset:16384
mf v[64:67],v[152:155],a[112:115],v[64:67]
s_add_u32 m0,s44,81920
s_xor_b32 s43,s40,768
mf v[68:71],v[152:155],a[116:119],v[68:71]
ds_read_b64_tr_b16 a[128:129],v10 offset:0
ds_read_b64_tr_b16 a[130:131],v10 offset:1024
mf v[68:71],v[144:147],a[100:103],v[68:71]
v_lshlrev_b32 v232,16,v232
v_mul_f32 v240,0xbfb8aa3b,v232
mf v[72:75],v[144:147],a[104:107],v[72:75]
ds_read_b64_tr_b16 a[132:133],v11 offset:0
ds_read_b64_tr_b16 a[134:135],v11 offset:1024
mf v[72:75],v[152:155],a[120:123],v[72:75]
v_lshlrev_b32 v233,16,v233
v_mul_f32 v241,0xbfb8aa3b,v233
mf v[76:79],v[152:155],a[124:127],v[76:79]
ds_read_b64_tr_b16 a[136:137],v12 offset:0
ds_read_b64_tr_b16 a[138:139],v12 offset:1024
mf v[76:79],v[144:147],a[108:111],v[76:79]
buffer_load_dwordx4 v18,s[16:19],s43 offen  lds
mf v[92:95],v[148:151],a[108:111],v[92:95]
ds_read_b64_tr_b16 a[140:141],v13 offset:0
ds_read_b64_tr_b16 a[142:143],v13 offset:1024
mf v[92:95],v[156:159],a[124:127],v[92:95]
v_lshlrev_b32 v234,16,v234
v_mul_f32 v242,0xbfb8aa3b,v234
mf v[88:91],v[156:159],a[120:123],v[88:91]
ds_read_b128 v[140:143],v3 offset:20480
ds_read_b128 v[136:139],v3 offset:16384
mf v[88:91],v[148:151],a[104:107],v[88:91]
v_lshlrev_b32 v235,16,v235
v_mul_f32 v243,0xbfb8aa3b,v235
mf v[84:87],v[148:151],a[100:103],v[84:87]
buffer_load_dwordx4 v19,s[16:19],s43 offen offset:1024  lds
mf v[84:87],v[156:159],a[116:119],v[84:87]
ds_read_b64_tr_b16 a[144:145],v10 offset:8192
ds_read_b64_tr_b16 a[146:147],v10 offset:9216
mf v[80:83],v[156:159],a[112:115],v[80:83]
v_lshlrev_b32 v236,16,v236
v_mul_f32 v244,0xbfb8aa3b,v236
mf v[80:83],v[148:151],a[96:99],v[80:83]
ds_read_b64_tr_b16 a[148:149],v11 offset:8192
ds_read_b64_tr_b16 a[150:151],v11 offset:9216
mf v[96:99],v[176:179],a[96:99],v[96:99]
v_exp_f32 v240,v240
mf v[96:99],v[184:187],a[112:115],v[96:99]
ds_read_b64_tr_b16 a[152:153],v12 offset:8192
ds_read_b64_tr_b16 a[154:155],v12 offset:9216
mf v[100:103],v[184:187],a[116:119],v[100:103]
v_exp_f32 v241,v241
mf v[100:103],v[176:179],a[100:103],v[100:103]
ds_read_b64_tr_b16 a[156:157],v13 offset:8192
ds_read_b64_tr_b16 a[158:159],v13 offset:9216
mf v[104:107],v[176:179],a[104:107],v[104:107]
buffer_load_dwordx4 v20,s[16:19],s43 offen offset:2048  lds
mf v[104:107],v[184:187],a[120:123],v[104:107]
ds_read_b128 v[164:167],v2 offset:36864
ds_read_b128 v[160:163],v2 offset:32768
mf v[108:111],v[184:187],a[124:127],v[108:111]
v_exp_f32 v242,v242
mf v[108:111],v[176:179],a[108:111],v[108:111]
ds_read_b128 v[172:175],v3 offset:36864
ds_read_b128 v[168:171],v3 offset:32768
mf v[124:127],v[180:183],a[108:111],v[124:127]
v_exp_f32 v243,v243
mf v[124:127],v[188:191],a[124:127],v[124:127]
buffer_load_dwordx4 v21,s[16:19],s43 offen offset:3072  lds
mf v[120:123],v[188:191],a[120:123],v[120:123]
v_exp_f32 v244,v244
mf v[120:123],v[180:183],a[104:107],v[120:123]
v_add_f32 v240,1.0,v240
v_add_f32 v241,1.0,v241
mf v[116:119],v[180:183],a[100:103],v[116:119]
v_add_f32 v242,1.0,v242
v_add_f32 v243,1.0,v243
mf v[116:119],v[188:191],a[116:119],v[116:119]
v_add_f32 v244,1.0,v244
v_rcp_f32 v240,v240
v_rcp_f32 v241,v241
v_rcp_f32 v242,v242
v_rcp_f32 v243,v243
v_rcp_f32 v244,v244
v_mul_f32 v232,v232,v240
v_mul_f32 v233,v233,v241
v_mul_f32 v234,v234,v242
v_mul_f32 v235,v235,v243
v_mul_f32 v236,v236,v244
cvt v232,v232,v232
v_lshlrev_b32 v232,16,v232
cvt v233,v233,v233
v_lshlrev_b32 v233,16,v233
mf v[112:115],v[188:191],a[112:115],v[112:115]
mf v[112:115],v[180:183],a[96:99],v[112:115]
s_waitcnt lgkmcnt(0)
s_waitcnt vmcnt(8)
s_barrier
mf v[64:67],v[128:131],a[128:131],v[64:67]
ds_read_b128 v[148:151],v4 offset:20480
ds_read_b128 v[144:147],v4 offset:16384
mf v[64:67],v[136:139],a[144:147],v[64:67]
s_add_u32 m0,s44,98304
s_xor_b32 s43,s40,66304
mf v[68:71],v[136:139],a[148:151],v[68:71]
ds_read_b64_tr_b16 a[160:161],v10 offset:49152
ds_read_b64_tr_b16 a[162:163],v10 offset:50176
mf v[68:71],v[128:131],a[132:135],v[68:71]
buffer_load_dwordx4 v18,s[16:19],s43 offen  lds
cvt v234,v234,v234
v_lshlrev_b32 v234,16,v234
mf v[72:75],v[128:131],a[136:139],v[72:75]
ds_read_b64_tr_b16 a[164:165],v11 offset:49152
ds_read_b64_tr_b16 a[166:167],v11 offset:50176
mf v[72:75],v[136:139],a[152:155],v[72:75]
buffer_load_dwordx4 v19,s[16:19],s43 offen offset:1024  lds
cvt v235,v235,v235
v_lshlrev_b32 v235,16,v235
mf v[76:79],v[136:139],a[156:159],v[76:79]
ds_read_b64_tr_b16 a[168:169],v12 offset:49152
ds_read_b64_tr_b16 a[170:171],v12 offset:50176
mf v[76:79],v[128:131],a[140:143],v[76:79]
buffer_load_dwordx4 v20,s[16:19],s43 offen offset:2048  lds
cvt v236,v236,v236
v_lshlrev_b32 v236,16,v236
mf v[92:95],v[132:135],a[140:143],v[92:95]
ds_read_b64_tr_b16 a[172:173],v13 offset:49152
ds_read_b64_tr_b16 a[174:175],v13 offset:50176
mf v[92:95],v[140:143],a[156:159],v[92:95]
buffer_load_dwordx4 v21,s[16:19],s43 offen offset:3072  lds
v_lshlrev_b32 v248,16,v212
v_and_b32 v249,0xffff0000,v212
mf v[88:91],v[140:143],a[152:155],v[88:91]
ds_read_b128 v[156:159],v5 offset:20480
ds_read_b128 v[152:155],v5 offset:16384
mf v[88:91],v[132:135],a[136:139],v[88:91]
s_xor_b32 s43,s55,7
s_lshl_b32 s43,s43,19
s_add_u32 m0,s44,114688
s_add_u32 s43,s43,s42
mf v[84:87],v[132:135],a[132:135],v[84:87]
buffer_load_dwordx4 v26,s[20:23],s43 offen lds
v_mul_f32 v240,v248,v232
v_mul_f32 v241,v249,v232
mf v[84:87],v[140:143],a[148:151],v[84:87]
ds_read_b64_tr_b16 a[176:177],v10 offset:57344
ds_read_b64_tr_b16 a[178:179],v10 offset:58368
mf v[80:83],v[140:143],a[144:147],v[80:83]
buffer_load_dwordx4 v27,s[20:23],s43 offen offset:1024 lds
mf v[80:83],v[132:135],a[128:131],v[80:83]
ds_read_b64_tr_b16 a[180:181],v11 offset:57344
ds_read_b64_tr_b16 a[182:183],v11 offset:58368
mf v[96:99],v[160:163],a[128:131],v[96:99]
v_lshlrev_b32 v248,16,v213
v_and_b32 v249,0xffff0000,v213
mf v[96:99],v[168:171],a[144:147],v[96:99]
ds_read_b64_tr_b16 a[184:185],v12 offset:57344
ds_read_b64_tr_b16 a[186:187],v12 offset:58368
mf v[100:103],v[168:171],a[148:151],v[100:103]
buffer_load_dwordx4 v28,s[20:23],s43 offen offset:2048 lds
v_mul_f32 v242,v248,v232
v_mul_f32 v243,v249,v232
mf v[100:103],v[160:163],a[132:135],v[100:103]
ds_read_b64_tr_b16 a[188:189],v13 offset:57344
ds_read_b64_tr_b16 a[190:191],v13 offset:58368
mf v[104:107],v[160:163],a[136:139],v[104:107]
buffer_load_dwordx4 v29,s[20:23],s43 offen offset:3072 lds
v_lshlrev_b32 v248,16,v214
v_and_b32 v249,0xffff0000,v214
mf v[104:107],v[168:171],a[152:155],v[104:107]
ds_read_b128 v[180:183],v4 offset:36864
ds_read_b128 v[176:179],v4 offset:32768
mf v[108:111],v[168:171],a[156:159],v[108:111]
s_add_u32 m0,s44,0
s_xor_b32 s43,s40,131072
mf v[108:111],v[160:163],a[140:143],v[108:111]
ds_read_b128 v[188:191],v5 offset:36864
ds_read_b128 v[184:187],v5 offset:32768
mf v[124:127],v[164:167],a[140:143],v[124:127]
buffer_load_dwordx4 v18,s[16:19],s43 offen  lds
mf v[124:127],v[172:175],a[156:159],v[124:127]
buffer_load_dwordx4 v19,s[16:19],s43 offen offset:1024  lds
mf v[120:123],v[172:175],a[152:155],v[120:123]
v_mul_f32 v244,v248,v232
v_mul_f32 v245,v249,v232
mf v[120:123],v[164:167],a[136:139],v[120:123]
buffer_load_dwordx4 v20,s[16:19],s43 offen offset:2048  lds
mf v[116:119],v[164:167],a[132:135],v[116:119]
v_lshlrev_b32 v248,16,v215
v_and_b32 v249,0xffff0000,v215
mf v[116:119],v[172:175],a[148:151],v[116:119]
buffer_load_dwordx4 v21,s[16:19],s43 offen offset:3072  lds
v_mul_f32 v246,v248,v232
v_mul_f32 v247,v249,v232
v_lshlrev_b32 v248,16,v216
v_and_b32 v249,0xffff0000,v216
v_fmac_f32 v240,v248,v233
v_fmac_f32 v241,v249,v233
v_lshlrev_b32 v248,16,v217
v_and_b32 v249,0xffff0000,v217
v_fmac_f32 v242,v248,v233
v_fmac_f32 v243,v249,v233
v_lshlrev_b32 v248,16,v218
v_and_b32 v249,0xffff0000,v218
v_fmac_f32 v244,v248,v233
v_fmac_f32 v245,v249,v233
v_lshlrev_b32 v248,16,v219
mf v[112:115],v[172:175],a[144:147],v[112:115]
mf v[112:115],v[164:167],a[128:131],v[112:115]
s_waitcnt lgkmcnt(0)
s_waitcnt vmcnt(8)
s_barrier
mf v[64:67],v[144:147],a[160:163],v[64:67]
ds_read_b128 v[132:135],v6 offset:20480
ds_read_b128 v[128:131],v6 offset:16384
mf v[64:67],v[152:155],a[176:179],v[64:67]
s_add_u32 m0,s44,16384
s_xor_b32 s43,s40,131328
mf v[68:71],v[152:155],a[180:183],v[68:71]
ds_read_b64_tr_b16 a[192:193],v14 offset:0
ds_read_b64_tr_b16 a[194:195],v14 offset:1024
mf v[68:71],v[144:147],a[164:167],v[68:71]
v_and_b32 v249,0xffff0000,v219
v_fmac_f32 v246,v248,v233
mf v[72:75],v[144:147],a[168:171],v[72:75]
ds_read_b64_tr_b16 a[196:197],v15 offset:0
ds_read_b64_tr_b16 a[198:199],v15 offset:1024
mf v[72:75],v[152:155],a[184:187],v[72:75]
v_fmac_f32 v247,v249,v233
v_lshlrev_b32 v248,16,v220
mf v[76:79],v[152:155],a[188:191],v[76:79]
ds_read_b64_tr_b16 a[200:201],v16 offset:0
ds_read_b64_tr_b16 a[202:203],v16 offset:1024
mf v[76:79],v[144:147],a[172:175],v[76:79]
buffer_load_dwordx4 v18,s[16:19],s43 offen  lds
mf v[92:95],v[148:151],a[172:175],v[92:95]
ds_read_b64_tr_b16 a[204:205],v17 offset:0
ds_read_b64_tr_b16 a[206:207],v17 offset:1024
mf v[92:95],v[156:159],a[188:191],v[92:95]
v_and_b32 v249,0xffff0000,v220
v_fmac_f32 v240,v248,v234
mf v[88:91],v[156:159],a[184:187],v[88:91]
ds_read_b128 v[140:143],v7 offset:20480
ds_read_b128 v[136:139],v7 offset:16384
mf v[88:91],v[148:151],a[168:171],v[88:91]
v_fmac_f32 v241,v249,v234
v_lshlrev_b32 v248,16,v221
mf v[84:87],v[148:151],a[164:167],v[84:87]
buffer_load_dwordx4 v19,s[16:19],s43 offen offset:1024  lds
mf v[84:87],v[156:159],a[180:183],v[84:87]
ds_read_b64_tr_b16 a[208:209],v14 offset:8192
ds_read_b64_tr_b16 a[210:211],v14 offset:9216
mf v[80:83],v[156:159],a[176:179],v[80:83]
v_and_b32 v249,0xffff0000,v221
v_fmac_f32 v242,v248,v234
mf v[80:83],v[148:151],a[160:163],v[80:83]
ds_read_b64_tr_b16 a[212:213],v15 offset:8192
ds_read_b64_tr_b16 a[214:215],v15 offset:9216
mf v[96:99],v[176:179],a[160:163],v[96:99]
v_fmac_f32 v243,v249,v234
v_lshlrev_b32 v248,16,v222
mf v[96:99],v[184:187],a[176:179],v[96:99]
ds_read_b64_tr_b16 a[216:217],v16 offset:8192
ds_read_b64_tr_b16 a[218:219],v16 offset:9216
mf v[100:103],v[184:187],a[180:183],v[100:103]
v_and_b32 v249,0xffff0000,v222
v_fmac_f32 v244,v248,v234
mf v[100:103],v[176:179],a[164:167],v[100:103]
ds_read_b64_tr_b16 a[220:221],v17 offset:8192
ds_read_b64_tr_b16 a[222:223],v17 offset:9216
mf v[104:107],v[176:179],a[168:171],v[104:107]
buffer_load_dwordx4 v20,s[16:19],s43 offen offset:2048  lds
mf v[104:107],v[184:187],a[184:187],v[104:107]
ds_read_b128 v[164:167],v6 offset:36864
ds_read_b128 v[160:163],v6 offset:32768
mf v[108:111],v[184:187],a[188:191],v[108:111]
v_fmac_f32 v245,v249,v234
v_lshlrev_b32 v248,16,v223
mf v[108:111],v[176:179],a[172:175],v[108:111]
ds_read_b128 v[172:175],v7 offset:36864
ds_read_b128 v[168:171],v7 offset:32768
mf v[124:127],v[180:183],a[172:175],v[124:127]
v_and_b32 v249,0xffff0000,v223
v_fmac_f32 v246,v248,v234
mf v[124:127],v[188:191],a[188:191],v[124:127]
buffer_load_dwordx4 v21,s[16:19],s43 offen offset:3072  lds
mf v[120:123],v[188:191],a[184:187],v[120:123]
v_fmac_f32 v247,v249,v234
v_lshlrev_b32 v248,16,v224
mf v[120:123],v[180:183],a[168:171],v[120:123]
v_and_b32 v249,0xffff0000,v224
v_fmac_f32 v240,v248,v235
mf v[116:119],v[180:183],a[164:167],v[116:119]
v_fmac_f32 v241,v249,v235
v_lshlrev_b32 v248,16,v225
mf v[116:119],v[188:191],a[180:183],v[116:119]
v_and_b32 v249,0xffff0000,v225
v_fmac_f32 v242,v248,v235
v_fmac_f32 v243,v249,v235
v_lshlrev_b32 v248,16,v226
v_and_b32 v249,0xffff0000,v226
v_fmac_f32 v244,v248,v235
v_fmac_f32 v245,v249,v235
v_lshlrev_b32 v248,16,v227
v_and_b32 v249,0xffff0000,v227
v_fmac_f32 v246,v248,v235
mf v[112:115],v[188:191],a[176:179],v[112:115]
mf v[112:115],v[180:183],a[160:163],v[112:115]
s_waitcnt lgkmcnt(0)
s_waitcnt vmcnt(8)
s_barrier
mf v[64:67],v[128:131],a[192:195],v[64:67]
ds_read_b128 v[148:151],v8 offset:20480
ds_read_b128 v[144:147],v8 offset:16384
mf v[64:67],v[136:139],a[208:211],v[64:67]
s_add_u32 m0,s44,32768
s_xor_b32 s43,s40,131584
mf v[68:71],v[136:139],a[212:215],v[68:71]
ds_read_b64_tr_b16 a[224:225],v14 offset:49152
ds_read_b64_tr_b16 a[226:227],v14 offset:50176
mf v[68:71],v[128:131],a[196:199],v[68:71]
buffer_load_dwordx4 v18,s[16:19],s43 offen  lds
mf v[72:75],v[128:131],a[200:203],v[72:75]
ds_read_b64_tr_b16 a[228:229],v15 offset:49152
ds_read_b64_tr_b16 a[230:231],v15 offset:50176
mf v[72:75],v[136:139],a[216:219],v[72:75]
v_fmac_f32 v247,v249,v235
v_lshlrev_b32 v248,16,v228
mf v[76:79],v[136:139],a[220:223],v[76:79]
ds_read_b64_tr_b16 a[232:233],v16 offset:49152
ds_read_b64_tr_b16 a[234:235],v16 offset:50176
mf v[76:79],v[128:131],a[204:207],v[76:79]
buffer_load_dwordx4 v19,s[16:19],s43 offen offset:1024  lds
mf v[92:95],v[132:135],a[204:207],v[92:95]
ds_read_b64_tr_b16 a[236:237],v17 offset:49152
ds_read_b64_tr_b16 a[238:239],v17 offset:50176
mf v[92:95],v[140:143],a[220:223],v[92:95]
buffer_load_dwordx4 v20,s[16:19],s43 offen offset:2048  lds
mf v[88:91],v[140:143],a[216:219],v[88:91]
ds_read_b128 v[156:159],v9 offset:20480
ds_read_b128 v[152:155],v9 offset:16384
mf v[88:91],v[132:135],a[200:203],v[88:91]
v_and_b32 v249,0xffff0000,v228
v_fmac_f32 v240,v248,v236
mf v[84:87],v[132:135],a[196:199],v[84:87]
buffer_load_dwordx4 v21,s[16:19],s43 offen offset:3072  lds
mf v[84:87],v[140:143],a[212:215],v[84:87]
ds_read_b64_tr_b16 a[240:241],v14 offset:57344
ds_read_b64_tr_b16 a[242:243],v14 offset:58368
mf v[80:83],v[140:143],a[208:211],v[80:83]
v_fmac_f32 v241,v249,v236
v_lshlrev_b32 v248,16,v229
mf v[80:83],v[132:135],a[192:195],v[80:83]
ds_read_b64_tr_b16 a[244:245],v15 offset:57344
ds_read_b64_tr_b16 a[246:247],v15 offset:58368
mf v[96:99],v[160:163],a[192:195],v[96:99]
s_add_u32 m0,s44,49152
s_xor_b32 s43,s40,131840
mf v[96:99],v[168:171],a[208:211],v[96:99]
ds_read_b64_tr_b16 a[248:249],v16 offset:57344
ds_read_b64_tr_b16 a[250:251],v16 offset:58368
mf v[100:103],v[168:171],a[212:215],v[100:103]
v_and_b32 v249,0xffff0000,v229
v_fmac_f32 v242,v248,v236
mf v[100:103],v[160:163],a[196:199],v[100:103]
ds_read_b64_tr_b16 a[252:253],v17 offset:57344
ds_read_b64_tr_b16 a[254:255],v17 offset:58368
mf v[104:107],v[160:163],a[200:203],v[104:107]
buffer_load_dwordx4 v18,s[16:19],s43 offen  lds
mf v[104:107],v[168:171],a[216:219],v[104:107]
ds_read_b128 v[180:183],v8 offset:36864
ds_read_b128 v[176:179],v8 offset:32768
mf v[108:111],v[168:171],a[220:223],v[108:111]
buffer_load_dwordx4 v19,s[16:19],s43 offen offset:1024  lds
mf v[108:111],v[160:163],a[204:207],v[108:111]
ds_read_b128 v[188:191],v9 offset:36864
ds_read_b128 v[184:187],v9 offset:32768
mf v[124:127],v[164:167],a[204:207],v[124:127]
v_fmac_f32 v243,v249,v236
v_lshlrev_b32 v248,16,v230
mf v[124:127],v[172:175],a[220:223],v[124:127]
buffer_load_dwordx4 v20,s[16:19],s43 offen offset:2048  lds
mf v[120:123],v[172:175],a[216:219],v[120:123]
v_and_b32 v249,0xffff0000,v230
v_fmac_f32 v244,v248,v236
mf v[120:123],v[164:167],a[200:203],v[120:123]
v_fmac_f32 v245,v249,v236
v_lshlrev_b32 v248,16,v231
mf v[116:119],v[164:167],a[196:199],v[116:119]
buffer_load_dwordx4 v21,s[16:19],s43 offen offset:3072  lds
mf v[116:119],v[172:175],a[212:215],v[116:119]
v_and_b32 v249,0xffff0000,v231
v_fmac_f32 v246,v248,v236
v_fmac_f32 v247,v249,v236
v_permlane32_swap_b32 v240,v244
v_permlane32_swap_b32 v241,v245
v_permlane32_swap_b32 v242,v246
v_permlane32_swap_b32 v243,v247
v_add_f32 v240,v240,v244
v_add_f32 v241,v241,v245
v_add_f32 v242,v242,v246
v_add_f32 v243,v243,v247
s_nop 0
v_permlane16_swap_b32 v240,v242
v_permlane16_swap_b32 v241,v243
v_add_f32 v240,v240,v242
v_add_f32 v241,v241,v243
s_nop 0
v_add_f32_dpp v240,v240,v240 row_ror:8 row_mask:0xf bank_mask:0xf
v_add_f32_dpp v241,v241,v241 row_ror:8 row_mask:0xf bank_mask:0xf
ds_write_b64 v252,v[240:241]
mf v[112:115],v[172:175],a[208:211],v[112:115]
mf v[112:115],v[164:167],a[192:195],v[112:115]
s_waitcnt lgkmcnt(0)
s_waitcnt vmcnt(8)
s_barrier
mf v[64:67],v[144:147],a[224:227],v[64:67]
ds_read_b128 v[132:135],v2 offset:4096
ds_read2_b32 v[240:241],v254 offset0:0 offset1:64
mf v[64:67],v[152:155],a[240:243],v[64:67]
ds_read_b128 v[128:131],v2 offset:0
mf v[68:71],v[152:155],a[244:247],v[68:71]
ds_read_b128 v[140:143],v3 offset:4096
mf v[68:71],v[144:147],a[228:231],v[68:71]
ds_read_b128 v[136:139],v3 offset:0
ds_read2_b32 v[242:243],v254 offset0:128 offset1:192
mf v[72:75],v[144:147],a[232:235],v[72:75]
mf v[72:75],v[152:155],a[248:251],v[72:75]
mf v[76:79],v[152:155],a[252:255],v[76:79]
mf v[76:79],v[144:147],a[236:239],v[76:79]
mf v[92:95],v[148:151],a[236:239],v[92:95]
mf v[92:95],v[156:159],a[252:255],v[92:95]
mf v[88:91],v[156:159],a[248:251],v[88:91]
mf v[88:91],v[148:151],a[232:235],v[88:91]
mf v[84:87],v[148:151],a[228:231],v[84:87]
mf v[84:87],v[156:159],a[244:247],v[84:87]
mf v[80:83],v[156:159],a[240:243],v[80:83]
mf v[80:83],v[148:151],a[224:227],v[80:83]
mf v[96:99],v[176:179],a[224:227],v[96:99]
mf v[96:99],v[184:187],a[240:243],v[96:99]
mf v[100:103],v[184:187],a[244:247],v[100:103]
mf v[100:103],v[176:179],a[228:231],v[100:103]
s_waitcnt lgkmcnt(4)
v_add_f32 v240,v240,v241
mf v[104:107],v[176:179],a[232:235],v[104:107]
mf v[104:107],v[184:187],a[248:251],v[104:107]
mf v[108:111],v[184:187],a[252:255],v[108:111]
cvt v160,v64,v65
cvt v161,v66,v67
mf v[108:111],v[176:179],a[236:239],v[108:111]
cvt v162,v80,v81
cvt v163,v82,v83
mf v[124:127],v[180:183],a[236:239],v[124:127]
cvt v164,v68,v69
cvt v165,v70,v71
mf v[124:127],v[188:191],a[252:255],v[124:127]
cvt v166,v84,v85
cvt v167,v86,v87
mf v[120:123],v[188:191],a[248:251],v[120:123]
s_waitcnt lgkmcnt(0)
v_add_f32 v242,v242,v243
v_add_f32 v240,v240,v242
mf v[120:123],v[180:183],a[232:235],v[120:123]
cvt v168,v72,v73
cvt v169,v74,v75
mf v[116:119],v[180:183],a[228:231],v[116:119]
cvt v170,v88,v89
cvt v171,v90,v91
mf v[116:119],v[188:191],a[244:247],v[116:119]
cvt v172,v76,v77
cvt v173,v78,v79
mf v[112:115],v[188:191],a[240:243],v[112:115]
cvt v174,v92,v93
cvt v175,v94,v95
mf v[112:115],v[180:183],a[224:227],v[112:115]
s_waitcnt lgkmcnt(0)
buffer_store_dword v240,v253,s[32:35],s67 offen sc1
mf v[64:67],v[128:131],a[0:3],0
s_add_u32 m0,s44,65536
s_xor_b32 s43,s40,196608
mf v[64:67],v[136:139],a[16:19],v[64:67]
ds_read_b128 v[156:159],v5 offset:4096
ds_read_b128 v[152:155],v5 offset:0
mf v[68:71],v[136:139],a[20:23],0
ds_read_b128 v[148:151],v4 offset:4096
ds_read_b128 v[144:147],v4 offset:0
mf v[68:71],v[128:131],a[4:7],v[68:71]
buffer_load_dwordx4 v18,s[16:19],s43 offen  lds
mf v[72:75],v[128:131],a[8:11],0
buffer_store_dwordx4 v[160:163],v32,s[28:31],s49 offen sc1
mf v[72:75],v[136:139],a[24:27],v[72:75]
mf v[76:79],v[136:139],a[28:31],0
mf v[76:79],v[128:131],a[12:15],v[76:79]
buffer_load_dwordx4 v19,s[16:19],s43 offen offset:1024  lds
mf v[92:95],v[132:135],a[12:15],0
v_lshlrev_b32 v212,16,v192
v_and_b32 v213,0xffff0000,v192
mf v[92:95],v[140:143],a[28:31],v[92:95]
mf v[88:91],v[140:143],a[24:27],0
s_waitcnt vmcnt(3)
buffer_atomic_add v35,v255,s[36:39],s68 offen sc1
mf v[88:91],v[132:135],a[8:11],v[88:91]
buffer_load_dwordx4 v20,s[16:19],s43 offen offset:2048  lds
mf v[84:87],v[132:135],a[4:7],0
v_lshlrev_b32 v214,16,v193
v_and_b32 v215,0xffff0000,v193
mf v[84:87],v[140:143],a[20:23],v[84:87]
mf v[80:83],v[140:143],a[16:19],0
v_lshlrev_b32 v216,16,v194
v_and_b32 v217,0xffff0000,v194
mf v[80:83],v[132:135],a[0:3],v[80:83]
buffer_load_dwordx4 v21,s[16:19],s43 offen offset:3072  lds
s_waitcnt lgkmcnt(0)
mf v[64:67],v[144:147],a[32:35],v[64:67]
mf v[64:67],v[152:155],a[48:51],v[64:67]
ds_read_b128 v[140:143],v3 offset:20480
ds_read_b128 v[136:139],v3 offset:16384
mf v[68:71],v[152:155],a[52:55],v[68:71]
ds_read_b128 v[132:135],v2 offset:20480
ds_read_b128 v[128:131],v2 offset:16384
mf v[68:71],v[144:147],a[36:39],v[68:71]
s_add_u32 m0,s44,81920
s_xor_b32 s43,s40,196864
mf v[72:75],v[144:147],a[40:43],v[72:75]
buffer_store_dwordx4 v[164:167],v32,s[28:31],s49 offen offset:1024 sc1
mf v[72:75],v[152:155],a[56:59],v[72:75]
v_lshlrev_b32 v218,16,v195
v_and_b32 v219,0xffff0000,v195
mf v[76:79],v[152:155],a[60:63],v[76:79]
v_lshlrev_b32 v220,16,v196
v_and_b32 v221,0xffff0000,v196
mf v[76:79],v[144:147],a[44:47],v[76:79]
buffer_load_dwordx4 v18,s[16:19],s43 offen  lds
mf v[92:95],v[148:151],a[44:47],v[92:95]
v_lshlrev_b32 v222,16,v197
v_and_b32 v223,0xffff0000,v197
mf v[92:95],v[156:159],a[60:63],v[92:95]
mf v[88:91],v[156:159],a[56:59],v[88:91]
mf v[88:91],v[148:151],a[40:43],v[88:91]
buffer_load_dwordx4 v19,s[16:19],s43 offen offset:1024  lds
mf v[84:87],v[148:151],a[36:39],v[84:87]
v_lshlrev_b32 v224,16,v198
v_and_b32 v225,0xffff0000,v198
mf v[84:87],v[156:159],a[52:55],v[84:87]
mf v[80:83],v[156:159],a[48:51],v[80:83]
mf v[80:83],v[148:151],a[32:35],v[80:83]
buffer_load_dwordx4 v20,s[16:19],s43 offen offset:2048  lds
s_waitcnt lgkmcnt(0)
mf v[64:67],v[128:131],a[64:67],v[64:67]
v_lshlrev_b32 v226,16,v199
v_and_b32 v227,0xffff0000,v199
mf v[64:67],v[136:139],a[80:83],v[64:67]
ds_read_b128 v[156:159],v5 offset:20480
ds_read_b128 v[152:155],v5 offset:16384
mf v[68:71],v[136:139],a[84:87],v[68:71]
ds_read_b128 v[148:151],v4 offset:20480
ds_read_b128 v[144:147],v4 offset:16384
mf v[68:71],v[128:131],a[68:71],v[68:71]
buffer_load_dwordx4 v21,s[16:19],s43 offen offset:3072  lds
mf v[72:75],v[128:131],a[72:75],v[72:75]
v_lshlrev_b32 v228,16,v200
v_and_b32 v229,0xffff0000,v200
mf v[72:75],v[136:139],a[88:91],v[72:75]
v_lshlrev_b32 v230,16,v201
v_and_b32 v231,0xffff0000,v201
mf v[76:79],v[136:139],a[92:95],v[76:79]
buffer_store_dwordx4 v[168:171],v32,s[28:31],s49 offen offset:2048 sc1
mf v[76:79],v[128:131],a[76:79],v[76:79]
mf v[92:95],v[132:135],a[76:79],v[92:95]
s_barrier
mf v[92:95],v[140:143],a[92:95],v[92:95]
v_lshlrev_b32 v232,16,v202
v_and_b32 v233,0xffff0000,v202
mf v[88:91],v[140:143],a[88:91],v[88:91]
s_add_u32 m0,s44,98304
s_xor_b32 s43,s40,197120
mf v[88:91],v[132:135],a[72:75],v[88:91]
mf v[84:87],v[132:135],a[68:71],v[84:87]
v_lshlrev_b32 v234,16,v203
v_and_b32 v235,0xffff0000,v203
mf v[84:87],v[140:143],a[84:87],v[84:87]
mf v[80:83],v[140:143],a[80:83],v[80:83]
mf v[80:83],v[132:135],a[64:67],v[80:83]
buffer_load_dwordx4 v18,s[16:19],s43 offen  lds
s_waitcnt lgkmcnt(0)
mf v[64:67],v[144:147],a[96:99],v[64:67]
v_add_f32 v204,v212,v213
v_add_f32 v205,v214,v215
mf v[64:67],v[152:155],a[112:115],v[64:67]
ds_read_b128 v[140:143],v3 offset:36864
ds_read_b128 v[136:139],v3 offset:32768
mf v[68:71],v[152:155],a[116:119],v[68:71]
ds_read_b128 v[132:135],v2 offset:36864
ds_read_b128 v[128:131],v2 offset:32768
mf v[68:71],v[144:147],a[100:103],v[68:71]
buffer_store_dwordx4 v[172:175],v32,s[28:31],s49 offen offset:3072 sc1
s_add_u32 s49,s49,32768
mf v[72:75],v[144:147],a[104:107],v[72:75]
v_add_f32 v204,v204,v216
v_add_f32 v205,v205,v217
mf v[72:75],v[152:155],a[120:123],v[72:75]
buffer_load_dwordx4 v19,s[16:19],s43 offen offset:1024  lds
mf v[76:79],v[152:155],a[124:127],v[76:79]
v_add_f32 v204,v204,v218
v_add_f32 v205,v205,v219
mf v[76:79],v[144:147],a[108:111],v[76:79]
mf v[92:95],v[148:151],a[108:111],v[92:95]
mf v[92:95],v[156:159],a[124:127],v[92:95]
v_add_f32 v204,v204,v220
v_add_f32 v205,v205,v221
mf v[88:91],v[156:159],a[120:123],v[88:91]
buffer_load_dwordx4 v20,s[16:19],s43 offen offset:2048  lds
mf v[88:91],v[148:151],a[104:107],v[88:91]
mf v[84:87],v[148:151],a[100:103],v[84:87]
v_add_f32 v204,v204,v222
v_add_f32 v205,v205,v223
mf v[84:87],v[156:159],a[116:119],v[84:87]
mf v[80:83],v[156:159],a[112:115],v[80:83]
mf v[80:83],v[148:151],a[96:99],v[80:83]
s_waitcnt lgkmcnt(0)
mf v[64:67],v[128:131],a[128:131],v[64:67]
buffer_load_dwordx4 v21,s[16:19],s43 offen offset:3072  lds
mf v[64:67],v[136:139],a[144:147],v[64:67]
ds_read_b128 v[156:159],v5 offset:36864
ds_read_b128 v[152:155],v5 offset:32768
mf v[68:71],v[136:139],a[148:151],v[68:71]
ds_read_b128 v[148:151],v4 offset:36864
ds_read_b128 v[144:147],v4 offset:32768
mf v[68:71],v[128:131],a[132:135],v[68:71]
v_add_f32 v204,v204,v224
v_add_f32 v205,v205,v225
mf v[72:75],v[128:131],a[136:139],v[72:75]
cvt v160,v96,v97
cvt v161,v98,v99
mf v[72:75],v[136:139],a[152:155],v[72:75]
v_add_f32 v204,v204,v226
v_add_f32 v205,v205,v227
mf v[76:79],v[136:139],a[156:159],v[76:79]
s_add_u32 m0,s44,114688
s_xor_b32 s43,s40,197376
mf v[76:79],v[128:131],a[140:143],v[76:79]
v_add_f32 v204,v204,v228
v_add_f32 v205,v205,v229
mf v[92:95],v[132:135],a[140:143],v[92:95]
v_add_f32 v204,v204,v230
v_add_f32 v205,v205,v231
mf v[92:95],v[140:143],a[156:159],v[92:95]
cvt v162,v112,v113
cvt v163,v114,v115
mf v[88:91],v[140:143],a[152:155],v[88:91]
v_add_f32 v204,v204,v232
v_add_f32 v205,v205,v233
mf v[88:91],v[132:135],a[136:139],v[88:91]
mf v[84:87],v[132:135],a[132:135],v[84:87]
v_add_f32 v204,v204,v234
v_add_f32 v205,v205,v235
mf v[84:87],v[140:143],a[148:151],v[84:87]
buffer_load_dwordx4 v18,s[16:19],s43 offen  lds
mf v[80:83],v[140:143],a[144:147],v[80:83]
mf v[80:83],v[132:135],a[128:131],v[80:83]
v_add_f32 v204,v204,v205
s_waitcnt lgkmcnt(0)
mf v[64:67],v[144:147],a[160:163],v[64:67]
buffer_store_dwordx4 v[160:163],v32,s[28:31],s49 offen sc1
cvt v164,v100,v101
mf v[64:67],v[152:155],a[176:179],v[64:67]
ds_read_b128 v[140:143],v3 offset:53248
ds_read_b128 v[136:139],v3 offset:49152
mf v[68:71],v[152:155],a[180:183],v[68:71]
ds_read_b128 v[132:135],v2 offset:53248
ds_read_b128 v[128:131],v2 offset:49152
mf v[68:71],v[144:147],a[164:167],v[68:71]
buffer_load_dwordx4 v19,s[16:19],s43 offen offset:1024  lds
mf v[72:75],v[144:147],a[168:171],v[72:75]
cvt v165,v102,v103
cvt v166,v116,v117
mf v[72:75],v[152:155],a[184:187],v[72:75]
v_add_f32_dpp v204,v204,v204 row_ror:8 row_mask:0xf bank_mask:0xf
v_mov_b32 v205,v204
mf v[76:79],v[152:155],a[188:191],v[76:79]
mf v[76:79],v[144:147],a[172:175],v[76:79]
mf v[92:95],v[148:151],a[172:175],v[92:95]
mf v[92:95],v[156:159],a[188:191],v[92:95]
v_permlane16_swap_b32 v204,v205
v_add_f32 v204,v204,v205
mf v[88:91],v[156:159],a[184:187],v[88:91]
buffer_load_dwordx4 v20,s[16:19],s43 offen offset:2048  lds
mf v[88:91],v[148:151],a[168:171],v[88:91]
v_mov_b32 v205,v204
mf v[84:87],v[148:151],a[164:167],v[84:87]
mf v[84:87],v[156:159],a[180:183],v[84:87]
cvt v167,v118,v119
buffer_store_dwordx4 v[164:167],v32,s[28:31],s49 offen offset:1024 sc1
mf v[80:83],v[156:159],a[176:179],v[80:83]
mf v[80:83],v[148:151],a[160:163],v[80:83]
s_waitcnt lgkmcnt(0)
mf v[64:67],v[128:131],a[192:195],v[64:67]
buffer_load_dwordx4 v21,s[16:19],s43 offen offset:3072  lds
mf v[64:67],v[136:139],a[208:211],v[64:67]
ds_read_b128 v[156:159],v5 offset:53248
ds_read_b128 v[152:155],v5 offset:49152
mf v[68:71],v[136:139],a[212:215],v[68:71]
ds_read_b128 v[148:151],v4 offset:53248
ds_read_b128 v[144:147],v4 offset:49152
mf v[68:71],v[128:131],a[196:199],v[68:71]
cvt v168,v104,v105
cvt v169,v106,v107
mf v[72:75],v[128:131],a[200:203],v[72:75]
cvt v170,v120,v121
cvt v171,v122,v123
mf v[72:75],v[136:139],a[216:219],v[72:75]
v_permlane32_swap_b32 v204,v205
v_add_f32 v204,v204,v205
ds_write_b32 v47,v204 offset:0
mf v[76:79],v[136:139],a[220:223],v[76:79]
mf v[76:79],v[128:131],a[204:207],v[76:79]
s_waitcnt lgkmcnt(0)
mf v[92:95],v[132:135],a[204:207],v[92:95]
s_waitcnt vmcnt(12)
s_barrier
mf v[92:95],v[140:143],a[220:223],v[92:95]
mf v[88:91],v[140:143],a[216:219],v[88:91]
s_add_u32 m0,s44,0
s_xor_b32 s43,s40,262144
mf v[88:91],v[132:135],a[200:203],v[88:91]
buffer_store_dwordx4 v[168:171],v32,s[28:31],s49 offen offset:2048 sc1
cvt v172,v108,v109
mf v[84:87],v[132:135],a[196:199],v[84:87]
ds_read_b128 v[208:211],v44 offset:0
mf v[84:87],v[140:143],a[212:215],v[84:87]
mf v[80:83],v[140:143],a[208:211],v[80:83]
mf v[80:83],v[132:135],a[192:195],v[80:83]
buffer_load_dwordx4 v18,s[16:19],s43 offen  lds
mf v[64:67],v[144:147],a[224:227],v[64:67]
cvt v173,v110,v111
cvt v174,v124,v125
mf v[64:67],v[152:155],a[240:243],v[64:67]
ds_read_b128 v[140:143],v7 offset:4096
ds_read_b128 v[136:139],v7 offset:0
mf v[68:71],v[152:155],a[244:247],v[68:71]
ds_read_b128 v[132:135],v6 offset:4096
ds_read_b128 v[128:131],v6 offset:0
mf v[68:71],v[144:147],a[228:231],v[68:71]
mf v[72:75],v[144:147],a[232:235],v[72:75]
mf v[72:75],v[152:155],a[248:251],v[72:75]
buffer_load_dwordx4 v19,s[16:19],s43 offen offset:1024  lds
cvt v175,v126,v127
mf v[76:79],v[152:155],a[252:255],v[76:79]
s_waitcnt lgkmcnt(4)
v_add_f32 v208,v208,v209
v_add_f32 v210,v210,v211
mf v[76:79],v[144:147],a[236:239],v[76:79]
v_add_f32 v208,v208,v210
v_mul_f32 v208,0x3acccccd,v208
mf v[92:95],v[148:151],a[236:239],v[92:95]
mf v[92:95],v[156:159],a[252:255],v[92:95]
v_mul_f32 v209,v208,v30
v_sub_f32 v212,v212,v208
mf v[88:91],v[156:159],a[248:251],v[88:91]
buffer_load_dwordx4 v20,s[16:19],s43 offen offset:2048  lds
mf v[88:91],v[148:151],a[232:235],v[88:91]
v_sub_f32 v213,v213,v208
v_sub_f32 v214,v214,v208
mf v[84:87],v[148:151],a[228:231],v[84:87]
mf v[84:87],v[156:159],a[244:247],v[84:87]
buffer_store_dwordx4 v[172:175],v32,s[28:31],s49 offen offset:3072 sc1
s_add_u32 s49,s49,32768
mf v[80:83],v[156:159],a[240:243],v[80:83]
v_sub_f32 v215,v215,v208
mf v[80:83],v[148:151],a[224:227],v[80:83]
s_waitcnt lgkmcnt(0)
mf v[96:99],v[128:131],a[0:3],0
buffer_load_dwordx4 v21,s[16:19],s43 offen offset:3072  lds
s_mov_b32 s72,s70
s_mov_b32 s73,s71
mf v[96:99],v[136:139],a[16:19],v[96:99]
ds_read_b128 v[156:159],v9 offset:4096
ds_read_b128 v[152:155],v9 offset:0
mf v[100:103],v[136:139],a[20:23],0
ds_read_b128 v[148:151],v8 offset:4096
ds_read_b128 v[144:147],v8 offset:0
mf v[100:103],v[128:131],a[4:7],v[100:103]
v_sub_f32 v216,v216,v208
v_sub_f32 v217,v217,v208
mf v[104:107],v[128:131],a[8:11],0
cvt v160,v64,v65
cvt v161,v66,v67
mf v[104:107],v[136:139],a[24:27],v[104:107]
v_sub_f32 v218,v218,v208
v_sub_f32 v219,v219,v208
mf v[108:111],v[136:139],a[28:31],0
s_add_u32 m0,s44,16384
s_xor_b32 s43,s40,262400
mf v[108:111],v[128:131],a[12:15],v[108:111]
v_sub_f32 v220,v220,v208
v_sub_f32 v221,v221,v208
mf v[124:127],v[132:135],a[12:15],0
mf v[124:127],v[140:143],a[28:31],v[124:127]
mf v[120:123],v[140:143],a[24:27],0
v_sub_f32 v222,v222,v208
v_sub_f32 v223,v223,v208
mf v[120:123],v[132:135],a[8:11],v[120:123]
mf v[116:119],v[132:135],a[4:7],0
s_mov_b32 s74,5242880
s_lshr_b32 s68,s2,5
mf v[116:119],v[140:143],a[20:23],v[116:119]
buffer_load_dwordx4 v18,s[16:19],s43 offen  lds
mf v[112:115],v[140:143],a[16:19],0
v_sub_f32 v224,v224,v208
v_sub_f32 v225,v225,v208
mf v[112:115],v[132:135],a[0:3],v[112:115]
s_waitcnt lgkmcnt(0)
mf v[96:99],v[144:147],a[32:35],v[96:99]
cvt v162,v80,v81
cvt v163,v82,v83
mf v[96:99],v[152:155],a[48:51],v[96:99]
ds_read_b128 v[140:143],v7 offset:20480
ds_read_b128 v[136:139],v7 offset:16384
mf v[100:103],v[152:155],a[52:55],v[100:103]
ds_read_b128 v[132:135],v6 offset:20480
ds_read_b128 v[128:131],v6 offset:16384
mf v[100:103],v[144:147],a[36:39],v[100:103]
buffer_load_dwordx4 v19,s[16:19],s43 offen offset:1024  lds
mf v[104:107],v[144:147],a[40:43],v[104:107]
v_sub_f32 v226,v226,v208
v_sub_f32 v227,v227,v208
mf v[104:107],v[152:155],a[56:59],v[104:107]
v_sub_f32 v228,v228,v209
v_sub_f32 v229,v229,v209
mf v[108:111],v[152:155],a[60:63],v[108:111]
mf v[108:111],v[144:147],a[44:47],v[108:111]
v_sub_f32 v230,v230,v209
v_sub_f32 v231,v231,v209
mf v[124:127],v[148:151],a[44:47],v[124:127]
mf v[124:127],v[156:159],a[60:63],v[124:127]
s_cmp_ge_u32 s68,5
s_cselect_b32 s71,5,0
mf v[120:123],v[156:159],a[56:59],v[120:123]
buffer_load_dwordx4 v20,s[16:19],s43 offen offset:2048  lds
mf v[120:123],v[148:151],a[40:43],v[120:123]
v_sub_f32 v232,v232,v209
v_sub_f32 v233,v233,v209
mf v[116:119],v[148:151],a[36:39],v[116:119]
mf v[116:119],v[156:159],a[52:55],v[116:119]
buffer_store_dwordx4 v[160:163],v32,s[28:31],s49 offen sc1
cvt v164,v68,v69
mf v[112:115],v[156:159],a[48:51],v[112:115]
v_sub_f32 v234,v234,v209
v_sub_f32 v235,v235,v209
mf v[112:115],v[148:151],a[32:35],v[112:115]
s_waitcnt lgkmcnt(0)
mf v[96:99],v[128:131],a[64:67],v[96:99]
buffer_load_dwordx4 v21,s[16:19],s43 offen offset:3072  lds
mf v[96:99],v[136:139],a[80:83],v[96:99]
ds_read_b128 v[156:159],v9 offset:20480
ds_read_b128 v[152:155],v9 offset:16384
mf v[100:103],v[136:139],a[84:87],v[100:103]
ds_read_b128 v[148:151],v8 offset:20480
ds_read_b128 v[144:147],v8 offset:16384
mf v[100:103],v[128:131],a[68:71],v[100:103]
v_mul_f32 v204,v212,v212
v_mul_f32 v205,v213,v213
mf v[104:107],v[128:131],a[72:75],v[104:107]
mf v[104:107],v[136:139],a[88:91],v[104:107]
v_fmac_f32 v204,v214,v214
v_fmac_f32 v205,v215,v215
mf v[108:111],v[136:139],a[92:95],v[108:111]
s_sub_u32 s68,s68,s71
s_lshl_b32 s71,s68,20
mf v[108:111],v[128:131],a[76:79],v[108:111]
mf v[124:127],v[132:135],a[76:79],v[124:127]
s_waitcnt vmcnt(11)
s_barrier
mf v[124:127],v[140:143],a[92:95],v[124:127]
cvt v165,v70,v71
cvt v166,v84,v85
mf v[120:123],v[140:143],a[88:91],v[120:123]
s_add_u32 m0,s44,32768
s_xor_b32 s43,s40,262656
mf v[120:123],v[132:135],a[72:75],v[120:123]
v_fmac_f32 v204,v216,v216
v_fmac_f32 v205,v217,v217
mf v[116:119],v[132:135],a[68:71],v[116:119]
v_fmac_f32 v204,v218,v218
v_fmac_f32 v205,v219,v219
mf v[116:119],v[140:143],a[84:87],v[116:119]
mf v[112:115],v[140:143],a[80:83],v[112:115]
mf v[112:115],v[132:135],a[64:67],v[112:115]
buffer_load_dwordx4 v18,s[16:19],s43 offen  lds
s_waitcnt lgkmcnt(0)
mf v[96:99],v[144:147],a[96:99],v[96:99]
v_fmac_f32 v204,v220,v220
v_fmac_f32 v205,v221,v221
mf v[96:99],v[152:155],a[112:115],v[96:99]
ds_read_b128 v[140:143],v7 offset:36864
ds_read_b128 v[136:139],v7 offset:32768
mf v[100:103],v[152:155],a[116:119],v[100:103]
ds_read_b128 v[132:135],v6 offset:36864
ds_read_b128 v[128:131],v6 offset:32768
mf v[100:103],v[144:147],a[100:103],v[100:103]
v_fmac_f32 v204,v222,v222
v_fmac_f32 v205,v223,v223
mf v[104:107],v[144:147],a[104:107],v[104:107]
cvt v167,v86,v87
buffer_store_dwordx4 v[164:167],v32,s[28:31],s49 offen offset:1024 sc1
mf v[104:107],v[152:155],a[120:123],v[104:107]
buffer_load_dwordx4 v19,s[16:19],s43 offen offset:1024  lds
s_add_u32 s71,s71,s42
mf v[108:111],v[152:155],a[124:127],v[108:111]
v_fmac_f32 v204,v224,v224
v_fmac_f32 v205,v225,v225
mf v[108:111],v[144:147],a[108:111],v[108:111]
mf v[124:127],v[148:151],a[108:111],v[124:127]
mf v[124:127],v[156:159],a[124:127],v[124:127]
v_fmac_f32 v204,v226,v226
v_fmac_f32 v205,v227,v227
mf v[120:123],v[156:159],a[120:123],v[120:123]
buffer_load_dwordx4 v20,s[16:19],s43 offen offset:2048  lds
mf v[120:123],v[148:151],a[104:107],v[120:123]
mf v[116:119],v[148:151],a[100:103],v[116:119]
v_fmac_f32 v204,v228,v228
v_fmac_f32 v205,v229,v229
mf v[116:119],v[156:159],a[116:119],v[116:119]
mf v[112:115],v[156:159],a[112:115],v[112:115]
mf v[112:115],v[148:151],a[96:99],v[112:115]
s_waitcnt lgkmcnt(0)
mf v[96:99],v[128:131],a[128:131],v[96:99]
buffer_load_dwordx4 v21,s[16:19],s43 offen offset:3072  lds
mf v[96:99],v[136:139],a[144:147],v[96:99]
ds_read_b128 v[156:159],v9 offset:36864
ds_read_b128 v[152:155],v9 offset:32768
mf v[100:103],v[136:139],a[148:151],v[100:103]
ds_read_b128 v[148:151],v8 offset:36864
ds_read_b128 v[144:147],v8 offset:32768
mf v[100:103],v[128:131],a[132:135],v[100:103]
v_fmac_f32 v204,v230,v230
v_fmac_f32 v205,v231,v231
mf v[104:107],v[128:131],a[136:139],v[104:107]
cvt v168,v72,v73
cvt v169,v74,v75
mf v[104:107],v[136:139],a[152:155],v[104:107]
v_fmac_f32 v204,v232,v232
v_fmac_f32 v205,v233,v233
mf v[108:111],v[136:139],a[156:159],v[108:111]
s_add_u32 m0,s44,49152
s_xor_b32 s43,s40,262912
mf v[108:111],v[128:131],a[140:143],v[108:111]
v_fmac_f32 v204,v234,v234
v_fmac_f32 v205,v235,v235
mf v[124:127],v[132:135],a[140:143],v[124:127]
mf v[124:127],v[140:143],a[156:159],v[124:127]
v_add_f32 v204,v204,v205
mf v[120:123],v[140:143],a[152:155],v[120:123]
mf v[120:123],v[132:135],a[136:139],v[120:123]
mf v[116:119],v[132:135],a[132:135],v[116:119]
mf v[116:119],v[140:143],a[148:151],v[116:119]
buffer_load_dwordx4 v18,s[16:19],s43 offen  lds
mf v[112:115],v[140:143],a[144:147],v[112:115]
cvt v170,v88,v89
cvt v171,v90,v91
mf v[112:115],v[132:135],a[128:131],v[112:115]
s_waitcnt lgkmcnt(0)
mf v[96:99],v[144:147],a[160:163],v[96:99]
v_add_f32_dpp v204,v204,v204 row_ror:8 row_mask:0xf bank_mask:0xf
v_mov_b32 v205,v204
mf v[96:99],v[152:155],a[176:179],v[96:99]
ds_read_b128 v[140:143],v7 offset:53248
ds_read_b128 v[136:139],v7 offset:49152
mf v[100:103],v[152:155],a[180:183],v[100:103]
ds_read_b128 v[132:135],v6 offset:53248
ds_read_b128 v[128:131],v6 offset:49152
mf v[100:103],v[144:147],a[164:167],v[100:103]
buffer_load_dwordx4 v19,s[16:19],s43 offen offset:1024  lds
mf v[104:107],v[144:147],a[168:171],v[104:107]
mf v[104:107],v[152:155],a[184:187],v[104:107]
mf v[108:111],v[152:155],a[188:191],v[108:111]
v_permlane16_swap_b32 v204,v205
v_add_f32 v204,v204,v205
mf v[108:111],v[144:147],a[172:175],v[108:111]
mf v[124:127],v[148:151],a[172:175],v[124:127]
mf v[124:127],v[156:159],a[188:191],v[124:127]
v_mov_b32 v205,v204
mf v[120:123],v[156:159],a[184:187],v[120:123]
buffer_load_dwordx4 v20,s[16:19],s43 offen offset:2048  lds
mf v[120:123],v[148:151],a[168:171],v[120:123]
mf v[116:119],v[148:151],a[164:167],v[116:119]
mf v[116:119],v[156:159],a[180:183],v[116:119]
buffer_store_dwordx4 v[168:171],v32,s[28:31],s49 offen offset:2048 sc1
cvt v172,v76,v77
mf v[112:115],v[156:159],a[176:179],v[112:115]
mf v[112:115],v[148:151],a[160:163],v[112:115]
s_waitcnt lgkmcnt(0)
mf v[96:99],v[128:131],a[192:195],v[96:99]
buffer_load_dwordx4 v21,s[16:19],s43 offen offset:3072  lds
mf v[96:99],v[136:139],a[208:211],v[96:99]
ds_read_b128 v[156:159],v9 offset:53248
ds_read_b128 v[152:155],v9 offset:49152
mf v[100:103],v[136:139],a[212:215],v[100:103]
ds_read_b128 v[148:151],v8 offset:53248
ds_read_b128 v[144:147],v8 offset:49152
mf v[100:103],v[128:131],a[196:199],v[100:103]
cvt v173,v78,v79
cvt v174,v92,v93
mf v[104:107],v[128:131],a[200:203],v[104:107]
buffer_load_dword v188,v37,s[36:39],0 offen sc1
mf v[104:107],v[136:139],a[216:219],v[104:107]
v_permlane32_swap_b32 v204,v205
v_add_f32 v204,v204,v205
ds_write_b32 v47,v204 offset:128
mf v[108:111],v[136:139],a[220:223],v[108:111]
mf v[108:111],v[128:131],a[204:207],v[108:111]
s_waitcnt lgkmcnt(0)
mf v[124:127],v[132:135],a[204:207],v[124:127]
s_waitcnt vmcnt(11)
s_barrier
mf v[124:127],v[140:143],a[220:223],v[124:127]
mf v[120:123],v[140:143],a[216:219],v[120:123]
s_add_u32 m0,s44,65536
s_xor_b32 s43,s40,327680
mf v[120:123],v[132:135],a[200:203],v[120:123]
ds_read_b128 v[208:211],v44 offset:128
mf v[116:119],v[132:135],a[196:199],v[116:119]
cvt v175,v94,v95
mf v[116:119],v[140:143],a[212:215],v[116:119]
mf v[112:115],v[140:143],a[208:211],v[112:115]
mf v[112:115],v[132:135],a[192:195],v[112:115]
buffer_load_dwordx4 v18,s[16:19],s43 offen  lds
mf v[96:99],v[144:147],a[224:227],v[96:99]
mf v[96:99],v[152:155],a[240:243],v[96:99]
ds_read_b128 v[140:143],v3 offset:4096
ds_read_b128 v[136:139],v3 offset:0
mf v[100:103],v[152:155],a[244:247],v[100:103]
ds_read_b128 v[132:135],v2 offset:4096
ds_read_b128 v[128:131],v2 offset:0
mf v[100:103],v[144:147],a[228:231],v[100:103]
mf v[104:107],v[144:147],a[232:235],v[104:107]
s_waitcnt lgkmcnt(4)
v_add_f32 v208,v208,v209
v_add_f32 v210,v210,v211
mf v[104:107],v[152:155],a[248:251],v[104:107]
buffer_load_dwordx4 v19,s[16:19],s43 offen offset:1024  lds
mf v[108:111],v[152:155],a[252:255],v[108:111]
buffer_store_dwordx4 v[172:175],v32,s[28:31],s49 offen offset:3072 sc1
s_add_u32 s49,s49,32768
mf v[108:111],v[144:147],a[236:239],v[108:111]
v_add_f32 v208,v208,v210
v_mov_b32 v209,0x3727c5ac
mf v[124:127],v[148:151],a[236:239],v[124:127]
v_fmac_f32 v209,0x3acccccd,v208
mf v[124:127],v[156:159],a[252:255],v[124:127]
mf v[120:123],v[156:159],a[248:251],v[120:123]
buffer_load_dwordx4 v20,s[16:19],s43 offen offset:2048  lds
mf v[120:123],v[148:151],a[232:235],v[120:123]
v_rsq_f32 v208,v209
mf v[116:119],v[148:151],a[228:231],v[116:119]
mf v[116:119],v[156:159],a[244:247],v[116:119]
mf v[112:115],v[156:159],a[240:243],v[112:115]
v_mul_f32 v212,v212,v208
v_mul_f32 v213,v213,v208
mf v[112:115],v[148:151],a[224:227],v[112:115]
LVm_chk:
s_waitcnt vmcnt(4)
v_cmp_ne_u32 vcc,20,v188
s_nop 0
s_cbranch_vccnz LVm_spin
s_waitcnt lgkmcnt(0)
mf v[64:67],v[128:131],a[0:3],0
buffer_load_dwordx4 v21,s[16:19],s43 offen offset:3072  lds
mf v[64:67],v[136:139],a[16:19],v[64:67]
ds_read_b128 v[156:159],v5 offset:4096
ds_read_b128 v[152:155],v5 offset:0
mf v[68:71],v[136:139],a[20:23],0
ds_read_b128 v[148:151],v4 offset:4096
ds_read_b128 v[144:147],v4 offset:0
mf v[68:71],v[128:131],a[4:7],v[68:71]
buffer_load_dwordx4 v[176:179],v40,s[32:35],0 offen sc1
mf v[72:75],v[128:131],a[8:11],0
cvt v160,v96,v97
cvt v161,v98,v99
mf v[72:75],v[136:139],a[24:27],v[72:75]
mf v[76:79],v[136:139],a[28:31],0
s_add_u32 m0,s44,81920
s_xor_b32 s43,s40,327936
mf v[76:79],v[128:131],a[12:15],v[76:79]
buffer_load_dwordx4 v[180:183],v40,s[32:35],s52 offen sc1
mf v[92:95],v[132:135],a[12:15],0
mf v[92:95],v[140:143],a[28:31],v[92:95]
mf v[88:91],v[140:143],a[24:27],0
buffer_load_dwordx4 v[184:187],v40,s[32:35],s53 offen sc1
mf v[88:91],v[132:135],a[8:11],v[88:91]
buffer_load_dwordx4 v[188:191],v40,s[32:35],s54 offen sc1
mf v[84:87],v[132:135],a[4:7],0
buffer_load_dwordx4 v[48:51],v39,s[32:35],0 offen sc1
mf v[84:87],v[140:143],a[20:23],v[84:87]
buffer_load_dwordx4 v18,s[16:19],s43 offen  lds
mf v[80:83],v[140:143],a[16:19],0
buffer_load_dwordx4 v[52:55],v39,s[32:35],s52 offen sc1
mf v[80:83],v[132:135],a[0:3],v[80:83]
buffer_load_dwordx4 v[56:59],v39,s[32:35],s53 offen sc1
s_waitcnt lgkmcnt(0)
mf v[64:67],v[144:147],a[32:35],v[64:67]
cvt v162,v112,v113
cvt v163,v114,v115
mf v[64:67],v[152:155],a[48:51],v[64:67]
ds_read_b128 v[140:143],v3 offset:20480
ds_read_b128 v[136:139],v3 offset:16384
mf v[68:71],v[152:155],a[52:55],v[68:71]
ds_read_b128 v[132:135],v2 offset:20480
ds_read_b128 v[128:131],v2 offset:16384
mf v[68:71],v[144:147],a[36:39],v[68:71]
buffer_load_dwordx4 v19,s[16:19],s43 offen offset:1024  lds
buffer_load_dwordx4 v[60:63],v39,s[32:35],s54 offen sc1
mf v[72:75],v[144:147],a[40:43],v[72:75]
v_mul_f32 v214,v214,v208
v_mul_f32 v215,v215,v208
mf v[72:75],v[152:155],a[56:59],v[72:75]
mf v[76:79],v[152:155],a[60:63],v[76:79]
mf v[76:79],v[144:147],a[44:47],v[76:79]
mf v[92:95],v[148:151],a[44:47],v[92:95]
v_mul_f32 v216,v216,v208
v_mul_f32 v217,v217,v208
mf v[92:95],v[156:159],a[60:63],v[92:95]
mf v[88:91],v[156:159],a[56:59],v[88:91]
buffer_load_dwordx4 v20,s[16:19],s43 offen offset:2048  lds
mf v[88:91],v[148:151],a[40:43],v[88:91]
mf v[84:87],v[148:151],a[36:39],v[84:87]
v_mul_f32 v218,v218,v208
v_mul_f32 v219,v219,v208
mf v[84:87],v[156:159],a[52:55],v[84:87]
buffer_store_dwordx4 v[160:163],v32,s[28:31],s49 offen sc1
cvt v164,v100,v101
mf v[80:83],v[156:159],a[48:51],v[80:83]
mf v[80:83],v[148:151],a[32:35],v[80:83]
s_waitcnt lgkmcnt(0)
mf v[64:67],v[128:131],a[64:67],v[64:67]
buffer_load_dwordx4 v21,s[16:19],s43 offen offset:3072  lds
mf v[64:67],v[136:139],a[80:83],v[64:67]
ds_read_b128 v[156:159],v5 offset:20480
ds_read_b128 v[152:155],v5 offset:16384
mf v[68:71],v[136:139],a[84:87],v[68:71]
ds_read_b128 v[148:151],v4 offset:20480
ds_read_b128 v[144:147],v4 offset:16384
mf v[68:71],v[128:131],a[68:71],v[68:71]
v_mul_f32 v220,v220,v208
v_mul_f32 v221,v221,v208
mf v[72:75],v[128:131],a[72:75],v[72:75]
v_mul_f32 v222,v222,v208
v_mul_f32 v223,v223,v208
mf v[72:75],v[136:139],a[88:91],v[72:75]
mf v[76:79],v[136:139],a[92:95],v[76:79]
mf v[76:79],v[128:131],a[76:79],v[76:79]
mf v[92:95],v[132:135],a[76:79],v[92:95]
s_barrier
mf v[92:95],v[140:143],a[92:95],v[92:95]
cvt v165,v102,v103
cvt v166,v116,v117
mf v[88:91],v[140:143],a[88:91],v[88:91]
s_add_u32 m0,s44,98304
s_xor_b32 s43,s40,328192
mf v[88:91],v[132:135],a[72:75],v[88:91]
v_mul_f32 v224,v224,v208
v_mul_f32 v225,v225,v208
mf v[84:87],v[132:135],a[68:71],v[84:87]
v_mul_f32 v226,v226,v208
v_mul_f32 v227,v227,v208
mf v[84:87],v[140:143],a[84:87],v[84:87]
mf v[80:83],v[140:143],a[80:83],v[80:83]
mf v[80:83],v[132:135],a[64:67],v[80:83]
buffer_load_dwordx4 v18,s[16:19],s43 offen  lds
s_waitcnt lgkmcnt(0)
mf v[64:67],v[144:147],a[96:99],v[64:67]
v_mul_f32 v228,v228,v208
v_mul_f32 v229,v229,v208
mf v[64:67],v[152:155],a[112:115],v[64:67]
ds_read_b128 v[140:143],v3 offset:36864
ds_read_b128 v[136:139],v3 offset:32768
mf v[68:71],v[152:155],a[116:119],v[68:71]
ds_read_b128 v[132:135],v2 offset:36864
ds_read_b128 v[128:131],v2 offset:32768
mf v[68:71],v[144:147],a[100:103],v[68:71]
s_waitcnt vmcnt(12)
v_add_f32 v176,v176,v180
s_waitcnt vmcnt(10)
v_add_f32 v184,v184,v188
mf v[72:75],v[144:147],a[104:107],v[72:75]
cvt v167,v118,v119
buffer_store_dwordx4 v[164:167],v32,s[28:31],s49 offen offset:1024 sc1
mf v[72:75],v[152:155],a[120:123],v[72:75]
buffer_load_dwordx4 v19,s[16:19],s43 offen offset:1024  lds
mf v[76:79],v[152:155],a[124:127],v[76:79]
v_mul_f32 v230,v230,v208
v_mul_f32 v231,v231,v208
mf v[76:79],v[144:147],a[108:111],v[76:79]
v_add_f32 v177,v177,v181
v_add_f32 v185,v185,v189
mf v[92:95],v[148:151],a[108:111],v[92:95]
v_mul_f32 v232,v232,v208
v_mul_f32 v233,v233,v208
mf v[92:95],v[156:159],a[124:127],v[92:95]
v_add_f32 v178,v178,v182
v_add_f32 v186,v186,v190
mf v[88:91],v[156:159],a[120:123],v[88:91]
buffer_load_dwordx4 v20,s[16:19],s43 offen offset:2048  lds
mf v[88:91],v[148:151],a[104:107],v[88:91]
v_add_f32 v179,v179,v183
v_add_f32 v187,v187,v191
mf v[84:87],v[148:151],a[100:103],v[84:87]
v_mul_f32 v234,v234,v208
v_mul_f32 v235,v235,v208
mf v[84:87],v[156:159],a[116:119],v[84:87]
v_add_f32 v176,v176,v184
v_add_f32 v177,v177,v185
mf v[80:83],v[156:159],a[112:115],v[80:83]
v_add_f32 v178,v178,v186
v_add_f32 v179,v179,v187
mf v[80:83],v[148:151],a[96:99],v[80:83]
cvt v180,v176,v177
cvt v181,v178,v179
v_lshlrev_b32 v176,16,v180
v_and_b32 v177,0xffff0000,v180
v_lshlrev_b32 v178,16,v181
v_and_b32 v179,0xffff0000,v181
v_add_f32 v184,v36,v176
v_add_f32 v185,v36,v177
s_waitcnt lgkmcnt(0)
mf v[64:67],v[128:131],a[128:131],v[64:67]
buffer_load_dwordx4 v21,s[16:19],s43 offen offset:3072  lds
mf v[64:67],v[136:139],a[144:147],v[64:67]
ds_read_b128 v[156:159],v5 offset:36864
ds_read_b128 v[152:155],v5 offset:32768
mf v[68:71],v[136:139],a[148:151],v[68:71]
ds_read_b128 v[148:151],v4 offset:36864
ds_read_b128 v[144:147],v4 offset:32768
mf v[68:71],v[128:131],a[132:135],v[68:71]
v_add_f32 v186,v36,v178
v_add_f32 v187,v36,v179
mf v[72:75],v[128:131],a[136:139],v[72:75]
cvt v168,v104,v105
cvt v169,v106,v107
mf v[72:75],v[136:139],a[152:155],v[72:75]
cvt v180,v184,v185
cvt v181,v186,v187
mf v[76:79],v[136:139],a[156:159],v[76:79]
s_add_u32 m0,s44,114688
s_xor_b32 s43,s40,328448
mf v[76:79],v[128:131],a[140:143],v[76:79]
v_lshlrev_b32 v184,16,v180
v_and_b32 v185,0xffff0000,v180
mf v[92:95],v[132:135],a[140:143],v[92:95]
v_lshlrev_b32 v186,16,v181
v_and_b32 v187,0xffff0000,v181
mf v[92:95],v[140:143],a[156:159],v[92:95]
v_mul_f32 v188,0x3e0293ee,v184
v_mul_f32 v189,0x3e0293ee,v185
mf v[88:91],v[140:143],a[152:155],v[88:91]
v_mul_f32 v190,0x3e0293ee,v186
v_mul_f32 v191,0x3e0293ee,v187
mf v[88:91],v[132:135],a[136:139],v[88:91]
ds_write_b128 v41,v[188:191]
s_waitcnt vmcnt(11)
v_add_f32 v48,v48,v52
mf v[84:87],v[132:135],a[132:135],v[84:87]
s_waitcnt vmcnt(8)
v_add_f32 v56,v56,v60
v_add_f32 v49,v49,v53
mf v[84:87],v[140:143],a[148:151],v[84:87]
buffer_load_dwordx4 v18,s[16:19],s43 offen  lds
mf v[80:83],v[140:143],a[144:147],v[80:83]
cvt v170,v120,v121
cvt v171,v122,v123
mf v[80:83],v[132:135],a[128:131],v[80:83]
s_waitcnt lgkmcnt(1)
mf v[64:67],v[144:147],a[160:163],v[64:67]
v_add_f32 v57,v57,v61
v_add_f32 v50,v50,v54
mf v[64:67],v[152:155],a[176:179],v[64:67]
ds_read_b128 v[140:143],v3 offset:53248
ds_read_b128 v[136:139],v3 offset:49152
mf v[68:71],v[152:155],a[180:183],v[68:71]
ds_read_b128 v[132:135],v2 offset:53248
ds_read_b128 v[128:131],v2 offset:49152
mf v[68:71],v[144:147],a[164:167],v[68:71]
buffer_load_dwordx4 v19,s[16:19],s43 offen offset:1024  lds
mf v[72:75],v[144:147],a[168:171],v[72:75]
v_add_f32 v58,v58,v62
v_add_f32 v51,v51,v55
mf v[72:75],v[152:155],a[184:187],v[72:75]
v_add_f32 v59,v59,v63
v_add_f32 v48,v48,v56
mf v[76:79],v[152:155],a[188:191],v[76:79]
v_add_f32 v49,v49,v57
v_add_f32 v50,v50,v58
mf v[76:79],v[144:147],a[172:175],v[76:79]
v_add_f32 v51,v51,v59
cvt v52,v48,v49
mf v[92:95],v[148:151],a[172:175],v[92:95]
cvt v53,v50,v51
v_lshlrev_b32 v48,16,v52
mf v[92:95],v[156:159],a[188:191],v[92:95]
v_and_b32 v49,0xffff0000,v52
v_lshlrev_b32 v50,16,v53
mf v[88:91],v[156:159],a[184:187],v[88:91]
buffer_load_dwordx4 v20,s[16:19],s43 offen offset:2048  lds
mf v[88:91],v[148:151],a[168:171],v[88:91]
v_and_b32 v51,0xffff0000,v53
v_add_f32 v56,1.0,v48
mf v[84:87],v[148:151],a[164:167],v[84:87]
v_add_f32 v57,1.0,v49
v_add_f32 v58,1.0,v50
mf v[84:87],v[156:159],a[180:183],v[84:87]
buffer_store_dwordx4 v[168:171],v32,s[28:31],s49 offen offset:2048 sc1
cvt v172,v108,v109
mf v[80:83],v[156:159],a[176:179],v[80:83]
v_add_f32 v59,1.0,v51
cvt v52,v56,v57
mf v[80:83],v[148:151],a[160:163],v[80:83]
s_waitcnt lgkmcnt(0)
mf v[64:67],v[128:131],a[192:195],v[64:67]
buffer_load_dwordx4 v21,s[16:19],s43 offen offset:3072  lds
mf v[64:67],v[136:139],a[208:211],v[64:67]
ds_read_b128 v[156:159],v5 offset:53248
ds_read_b128 v[152:155],v5 offset:49152
mf v[68:71],v[136:139],a[212:215],v[68:71]
ds_read_b128 v[148:151],v4 offset:53248
ds_read_b128 v[144:147],v4 offset:49152
mf v[68:71],v[128:131],a[196:199],v[68:71]
cvt v173,v110,v111
cvt v174,v124,v125
mf v[72:75],v[128:131],a[200:203],v[72:75]
cvt v53,v58,v59
v_lshlrev_b32 v56,16,v52
mf v[72:75],v[136:139],a[216:219],v[72:75]
v_and_b32 v57,0xffff0000,v52
v_lshlrev_b32 v58,16,v53
v_and_b32 v59,0xffff0000,v53
v_mul_f32 v60,0x3e0293ee,v56
v_mul_f32 v61,0x3e0293ee,v57
v_mul_f32 v62,0x3e0293ee,v58
v_mul_f32 v63,0x3e0293ee,v59
ds_write_b128 v42,v[60:63]
mf v[76:79],v[136:139],a[220:223],v[76:79]
mf v[76:79],v[128:131],a[204:207],v[76:79]
s_waitcnt lgkmcnt(0)
mf v[92:95],v[132:135],a[204:207],v[92:95]
s_waitcnt vmcnt(10)
s_barrier
mf v[92:95],v[140:143],a[220:223],v[92:95]
mf v[88:91],v[140:143],a[216:219],v[88:91]
s_add_u32 m0,s44,0
s_xor_b32 s43,s40,393216
mf v[88:91],v[132:135],a[200:203],v[88:91]
ds_read_b128 v[48:51],v31 offset:2560
ds_read_b128 v[52:55],v31 offset:2576
mf v[84:87],v[132:135],a[196:199],v[84:87]
cvt v175,v126,v127
mf v[84:87],v[140:143],a[212:215],v[84:87]
ds_read_b128 v[56:59],v31 offset:0
ds_read_b128 v[60:63],v31 offset:16
mf v[80:83],v[140:143],a[208:211],v[80:83]
mf v[80:83],v[132:135],a[192:195],v[80:83]
buffer_load_dwordx4 v18,s[16:19],s43 offen  lds
mf v[64:67],v[144:147],a[224:227],v[64:67]
mf v[64:67],v[152:155],a[240:243],v[64:67]
ds_read_b128 v[140:143],v7 offset:4096
ds_read_b128 v[136:139],v7 offset:0
mf v[68:71],v[152:155],a[244:247],v[68:71]
ds_read_b128 v[132:135],v6 offset:4096
ds_read_b128 v[128:131],v6 offset:0
mf v[68:71],v[144:147],a[228:231],v[68:71]
mf v[72:75],v[144:147],a[232:235],v[72:75]
mf v[72:75],v[152:155],a[248:251],v[72:75]
buffer_load_dwordx4 v19,s[16:19],s43 offen offset:1024  lds
mf v[76:79],v[152:155],a[252:255],v[76:79]
buffer_store_dwordx4 v[172:175],v32,s[28:31],s49 offen offset:3072 sc1
s_add_u32 s49,s49,32768
mf v[76:79],v[144:147],a[236:239],v[76:79]
s_waitcnt lgkmcnt(5)
v_fma_f32 v212,v212,v48,v56
v_fma_f32 v213,v213,v49,v57
mf v[92:95],v[148:151],a[236:239],v[92:95]
v_fma_f32 v214,v214,v50,v58
v_fma_f32 v215,v215,v51,v59
mf v[92:95],v[156:159],a[252:255],v[92:95]
s_waitcnt lgkmcnt(4)
v_fma_f32 v216,v216,v52,v60
v_fma_f32 v217,v217,v53,v61
mf v[88:91],v[156:159],a[248:251],v[88:91]
buffer_load_dwordx4 v20,s[16:19],s43 offen offset:2048  lds
mf v[88:91],v[148:151],a[232:235],v[88:91]
v_fma_f32 v218,v218,v54,v62
v_fma_f32 v219,v219,v55,v63
mf v[84:87],v[148:151],a[228:231],v[84:87]
cvt v192,v212,v213
cvt v193,v214,v215
mf v[84:87],v[156:159],a[244:247],v[84:87]
cvt v194,v216,v217
cvt v195,v218,v219
mf v[80:83],v[156:159],a[240:243],v[80:83]
s_mov_b32 s51,0
buffer_store_dwordx4 v[192:195],v46,s[60:63],s51 offen sc1
mf v[80:83],v[148:151],a[224:227],v[80:83]
s_waitcnt lgkmcnt(0)
mf v[96:99],v[128:131],a[0:3],0
buffer_load_dwordx4 v21,s[16:19],s43 offen offset:3072  lds
mf v[96:99],v[136:139],a[16:19],v[96:99]
ds_read_b128 v[156:159],v9 offset:4096
ds_read_b128 v[152:155],v9 offset:0
mf v[100:103],v[136:139],a[20:23],0
ds_read_b128 v[148:151],v8 offset:4096
ds_read_b128 v[144:147],v8 offset:0
mf v[100:103],v[128:131],a[4:7],v[100:103]
ds_read_b128 v[48:51],v31 offset:2816
ds_read_b128 v[52:55],v31 offset:2832
mf v[104:107],v[128:131],a[8:11],0
cvt v160,v64,v65
cvt v161,v66,v67
mf v[104:107],v[136:139],a[24:27],v[104:107]
ds_read_b128 v[56:59],v31 offset:256
ds_read_b128 v[60:63],v31 offset:272
mf v[108:111],v[136:139],a[28:31],0
s_add_u32 m0,s44,16384
s_xor_b32 s43,s40,393472
mf v[108:111],v[128:131],a[12:15],v[108:111]
mf v[124:127],v[132:135],a[12:15],0
mf v[124:127],v[140:143],a[28:31],v[124:127]
mf v[120:123],v[140:143],a[24:27],0
mf v[120:123],v[132:135],a[8:11],v[120:123]
mf v[116:119],v[132:135],a[4:7],0
mf v[116:119],v[140:143],a[20:23],v[116:119]
buffer_load_dwordx4 v18,s[16:19],s43 offen  lds
mf v[112:115],v[140:143],a[16:19],0
s_waitcnt lgkmcnt(1)
v_fma_f32 v220,v220,v48,v56
v_fma_f32 v221,v221,v49,v57
mf v[112:115],v[132:135],a[0:3],v[112:115]
mf v[96:99],v[144:147],a[32:35],v[96:99]
cvt v162,v80,v81
cvt v163,v82,v83
mf v[96:99],v[152:155],a[48:51],v[96:99]
ds_read_b128 v[140:143],v7 offset:20480
ds_read_b128 v[136:139],v7 offset:16384
mf v[100:103],v[152:155],a[52:55],v[100:103]
ds_read_b128 v[132:135],v6 offset:20480
ds_read_b128 v[128:131],v6 offset:16384
mf v[100:103],v[144:147],a[36:39],v[100:103]
buffer_load_dwordx4 v19,s[16:19],s43 offen offset:1024  lds
mf v[104:107],v[144:147],a[40:43],v[104:107]
v_fma_f32 v222,v222,v50,v58
v_fma_f32 v223,v223,v51,v59
mf v[104:107],v[152:155],a[56:59],v[104:107]
s_waitcnt lgkmcnt(4)
v_fma_f32 v224,v224,v52,v60
v_fma_f32 v225,v225,v53,v61
mf v[108:111],v[152:155],a[60:63],v[108:111]
v_fma_f32 v226,v226,v54,v62
v_fma_f32 v227,v227,v55,v63
mf v[108:111],v[144:147],a[44:47],v[108:111]
cvt v196,v220,v221
cvt v197,v222,v223
mf v[124:127],v[148:151],a[44:47],v[124:127]
cvt v198,v224,v225
cvt v199,v226,v227
mf v[124:127],v[156:159],a[60:63],v[124:127]
mf v[120:123],v[156:159],a[56:59],v[120:123]
buffer_load_dwordx4 v20,s[16:19],s43 offen offset:2048  lds
mf v[120:123],v[148:151],a[40:43],v[120:123]
s_mov_b32 s51,8192
buffer_store_dwordx4 v[196:199],v46,s[60:63],s51 offen sc1
mf v[116:119],v[148:151],a[36:39],v[116:119]
ds_read_b128 v[48:51],v31 offset:3072
ds_read_b128 v[52:55],v31 offset:3088
mf v[116:119],v[156:159],a[52:55],v[116:119]
buffer_store_dwordx4 v[160:163],v32,s[28:31],s49 offen sc1
cvt v164,v68,v69
mf v[112:115],v[156:159],a[48:51],v[112:115]
ds_read_b128 v[56:59],v31 offset:512
ds_read_b128 v[60:63],v31 offset:528
mf v[112:115],v[148:151],a[32:35],v[112:115]
s_waitcnt lgkmcnt(4)
mf v[96:99],v[128:131],a[64:67],v[96:99]
buffer_load_dwordx4 v21,s[16:19],s43 offen offset:3072  lds
mf v[96:99],v[136:139],a[80:83],v[96:99]
ds_read_b128 v[156:159],v9 offset:20480
ds_read_b128 v[152:155],v9 offset:16384
mf v[100:103],v[136:139],a[84:87],v[100:103]
ds_read_b128 v[148:151],v8 offset:20480
ds_read_b128 v[144:147],v8 offset:16384
mf v[100:103],v[128:131],a[68:71],v[100:103]
mf v[104:107],v[128:131],a[72:75],v[104:107]
mf v[104:107],v[136:139],a[88:91],v[104:107]
mf v[108:111],v[136:139],a[92:95],v[108:111]
mf v[108:111],v[128:131],a[76:79],v[108:111]
mf v[124:127],v[132:135],a[76:79],v[124:127]
s_waitcnt vmcnt(12)
s_barrier
mf v[124:127],v[140:143],a[92:95],v[124:127]
cvt v165,v70,v71
cvt v166,v84,v85
mf v[120:123],v[140:143],a[88:91],v[120:123]
s_add_u32 m0,s44,32768
s_xor_b32 s43,s40,393728
mf v[120:123],v[132:135],a[72:75],v[120:123]
s_waitcnt lgkmcnt(5)
v_fma_f32 v228,v228,v48,v56
v_fma_f32 v229,v229,v49,v57
mf v[116:119],v[132:135],a[68:71],v[116:119]
v_fma_f32 v230,v230,v50,v58
v_fma_f32 v231,v231,v51,v59
mf v[116:119],v[140:143],a[84:87],v[116:119]
mf v[112:115],v[140:143],a[80:83],v[112:115]
s_waitcnt lgkmcnt(4)
v_fma_f32 v232,v232,v52,v60
v_fma_f32 v233,v233,v53,v61
mf v[112:115],v[132:135],a[64:67],v[112:115]
buffer_load_dwordx4 v18,s[16:19],s43 offen  lds
s_waitcnt lgkmcnt(0)
mf v[96:99],v[144:147],a[96:99],v[96:99]
v_fma_f32 v234,v234,v54,v62
v_fma_f32 v235,v235,v55,v63
mf v[96:99],v[152:155],a[112:115],v[96:99]
ds_read_b128 v[140:143],v7 offset:36864
ds_read_b128 v[136:139],v7 offset:32768
mf v[100:103],v[152:155],a[116:119],v[100:103]
ds_read_b128 v[132:135],v6 offset:36864
ds_read_b128 v[128:131],v6 offset:32768
mf v[100:103],v[144:147],a[100:103],v[100:103]
cvt v200,v228,v229
cvt v201,v230,v231
mf v[104:107],v[144:147],a[104:107],v[104:107]
cvt v167,v86,v87
buffer_store_dwordx4 v[164:167],v32,s[28:31],s49 offen offset:1024 sc1
mf v[104:107],v[152:155],a[120:123],v[104:107]
buffer_load_dwordx4 v19,s[16:19],s43 offen offset:1024  lds
mf v[108:111],v[152:155],a[124:127],v[108:111]
cvt v202,v232,v233
cvt v203,v234,v235
mf v[108:111],v[144:147],a[108:111],v[108:111]
s_mov_b32 s51,16384
buffer_store_dwordx4 v[200:203],v25,s[60:63],s51 offen sc1
mf v[124:127],v[148:151],a[108:111],v[124:127]
mf v[124:127],v[156:159],a[124:127],v[124:127]
mf v[120:123],v[156:159],a[120:123],v[120:123]
buffer_load_dwordx4 v20,s[16:19],s43 offen offset:2048  lds
mf v[120:123],v[148:151],a[104:107],v[120:123]
mf v[116:119],v[148:151],a[100:103],v[116:119]
mf v[116:119],v[156:159],a[116:119],v[116:119]
mf v[112:115],v[156:159],a[112:115],v[112:115]
mf v[112:115],v[148:151],a[96:99],v[112:115]
s_waitcnt lgkmcnt(0)
mf v[96:99],v[128:131],a[128:131],v[96:99]
buffer_load_dwordx4 v21,s[16:19],s43 offen offset:3072  lds
mf v[96:99],v[136:139],a[144:147],v[96:99]
ds_read_b128 v[156:159],v9 offset:36864
ds_read_b128 v[152:155],v9 offset:32768
mf v[100:103],v[136:139],a[148:151],v[100:103]
ds_read_b128 v[148:151],v8 offset:36864
ds_read_b128 v[144:147],v8 offset:32768
mf v[100:103],v[128:131],a[132:135],v[100:103]
mf v[104:107],v[128:131],a[136:139],v[104:107]
cvt v168,v72,v73
cvt v169,v74,v75
mf v[104:107],v[136:139],a[152:155],v[104:107]
mf v[108:111],v[136:139],a[156:159],v[108:111]
s_add_u32 m0,s44,49152
s_xor_b32 s43,s40,393984
mf v[108:111],v[128:131],a[140:143],v[108:111]
mf v[124:127],v[132:135],a[140:143],v[124:127]
mf v[124:127],v[140:143],a[156:159],v[124:127]
mf v[120:123],v[140:143],a[152:155],v[120:123]
mf v[120:123],v[132:135],a[136:139],v[120:123]
mf v[116:119],v[132:135],a[132:135],v[116:119]
mf v[116:119],v[140:143],a[148:151],v[116:119]
buffer_load_dwordx4 v18,s[16:19],s43 offen  lds
mf v[112:115],v[140:143],a[144:147],v[112:115]
cvt v170,v88,v89
cvt v171,v90,v91
mf v[112:115],v[132:135],a[128:131],v[112:115]
s_waitcnt lgkmcnt(0)
mf v[96:99],v[144:147],a[160:163],v[96:99]
mf v[96:99],v[152:155],a[176:179],v[96:99]
ds_read_b128 v[140:143],v7 offset:53248
ds_read_b128 v[136:139],v7 offset:49152
mf v[100:103],v[152:155],a[180:183],v[100:103]
ds_read_b128 v[132:135],v6 offset:53248
ds_read_b128 v[128:131],v6 offset:49152
mf v[100:103],v[144:147],a[164:167],v[100:103]
buffer_load_dwordx4 v19,s[16:19],s43 offen offset:1024  lds
mf v[104:107],v[144:147],a[168:171],v[104:107]
mf v[104:107],v[152:155],a[184:187],v[104:107]
mf v[108:111],v[152:155],a[188:191],v[108:111]
mf v[108:111],v[144:147],a[172:175],v[108:111]
mf v[124:127],v[148:151],a[172:175],v[124:127]
mf v[124:127],v[156:159],a[188:191],v[124:127]
mf v[120:123],v[156:159],a[184:187],v[120:123]
buffer_load_dwordx4 v20,s[16:19],s43 offen offset:2048  lds
mf v[120:123],v[148:151],a[168:171],v[120:123]
mf v[116:119],v[148:151],a[164:167],v[116:119]
mf v[116:119],v[156:159],a[180:183],v[116:119]
buffer_store_dwordx4 v[168:171],v32,s[28:31],s49 offen offset:2048 sc1
cvt v172,v76,v77
mf v[112:115],v[156:159],a[176:179],v[112:115]
s_lshr_b32 s52,s2,4
s_lshl_b32 s52,s52,2
mf v[112:115],v[148:151],a[160:163],v[112:115]
s_waitcnt lgkmcnt(0)
mf v[96:99],v[128:131],a[192:195],v[96:99]
buffer_load_dwordx4 v21,s[16:19],s43 offen offset:3072  lds
mf v[96:99],v[136:139],a[208:211],v[96:99]
ds_read_b128 v[156:159],v9 offset:53248
ds_read_b128 v[152:155],v9 offset:49152
mf v[100:103],v[136:139],a[212:215],v[100:103]
ds_read_b128 v[148:151],v8 offset:53248
ds_read_b128 v[144:147],v8 offset:49152
mf v[100:103],v[128:131],a[196:199],v[100:103]
cvt v173,v78,v79
cvt v174,v92,v93
mf v[104:107],v[128:131],a[200:203],v[104:107]
s_bfe_u32 s53,s2,0x20001
s_add_u32 s52,s52,s53
mf v[104:107],v[136:139],a[216:219],v[104:107]
s_lshl_b32 s52,s52,7
mf v[108:111],v[136:139],a[220:223],v[108:111]
s_add_u32 s52,s52,16384
v_lshlrev_b32 v255,20,v1
mf v[108:111],v[128:131],a[204:207],v[108:111]
s_waitcnt vmcnt(7)
buffer_atomic_add v35,v255,s[8:11],s52 offen sc1
mf v[124:127],v[132:135],a[204:207],v[124:127]
s_barrier
mf v[124:127],v[140:143],a[220:223],v[124:127]
s_lshr_b32 s52,s2,5
s_sub_u32 s53,15,s52
mf v[120:123],v[140:143],a[216:219],v[120:123]
s_add_u32 m0,s44,65536
s_xor_b32 s43,s40,458752
mf v[120:123],v[132:135],a[200:203],v[120:123]
s_lshl_b32 s52,s52,2
s_lshl_b32 s53,s53,2
mf v[116:119],v[132:135],a[196:199],v[116:119]
cvt v175,v94,v95
mf v[116:119],v[140:143],a[212:215],v[116:119]
s_add_u32 s52,s52,s3
s_add_u32 s53,s53,s3
mf v[112:115],v[140:143],a[208:211],v[112:115]
mf v[112:115],v[132:135],a[192:195],v[112:115]
buffer_load_dwordx4 v18,s[16:19],s43 offen  lds
s_waitcnt lgkmcnt(0)
mf v[96:99],v[144:147],a[224:227],v[96:99]
s_lshr_b32 s50,s53,1
s_lshr_b32 s51,s52,1
mf v[96:99],v[152:155],a[240:243],v[96:99]
ds_read_b128 v[140:143],v3 offset:4096
ds_read_b128 v[136:139],v3 offset:0
mf v[100:103],v[152:155],a[244:247],v[100:103]
ds_read_b128 v[132:135],v2 offset:4096
ds_read_b128 v[128:131],v2 offset:0
mf v[100:103],v[144:147],a[228:231],v[100:103]
s_mul_i32 s50,s50,81920
s_mul_i32 s51,s51,81920
mf v[104:107],v[144:147],a[232:235],v[104:107]
s_and_b32 s54,s3,1
s_lshl_b32 s54,s54,11
mf v[104:107],v[152:155],a[248:251],v[104:107]
buffer_load_dwordx4 v19,s[16:19],s43 offen offset:1024  lds
mf v[108:111],v[152:155],a[252:255],v[108:111]
buffer_store_dwordx4 v[172:175],v32,s[28:31],s49 offen offset:3072 sc1
s_add_u32 s49,s49,32768
mf v[108:111],v[144:147],a[236:239],v[108:111]
s_lshl_b32 s70,s68,14
s_add_u32 s54,s54,s70
mf v[124:127],v[148:151],a[236:239],v[124:127]
s_add_u32 s50,s50,s54
s_add_u32 s51,s51,s54
mf v[124:127],v[156:159],a[252:255],v[124:127]
s_sub_u32 s53,s53,s52
s_lshl_b32 s53,s53,7
mf v[120:123],v[156:159],a[248:251],v[120:123]
buffer_load_dwordx4 v20,s[16:19],s43 offen offset:2048  lds
mf v[120:123],v[148:151],a[232:235],v[120:123]
v_and_b32 v37,1,v1
v_mul_u32_u24 v37,s53,v37
mf v[116:119],v[148:151],a[228:231],v[116:119]
mf v[116:119],v[156:159],a[244:247],v[116:119]
s_lshl_b32 s52,s52,7
s_add_u32 s52,s52,16384
mf v[112:115],v[156:159],a[240:243],v[112:115]
mf v[112:115],v[148:151],a[224:227],v[112:115]
s_waitcnt lgkmcnt(0)
mf v[64:67],v[128:131],a[0:3],0
buffer_load_dwordx4 v21,s[16:19],s43 offen offset:3072  lds
mf v[64:67],v[136:139],a[16:19],v[64:67]
ds_read_b128 v[156:159],v5 offset:4096
ds_read_b128 v[152:155],v5 offset:0
mf v[68:71],v[136:139],a[20:23],0
ds_read_b128 v[148:151],v4 offset:4096
ds_read_b128 v[144:147],v4 offset:0
mf v[68:71],v[128:131],a[4:7],v[68:71]
mf v[72:75],v[128:131],a[8:11],0
cvt v160,v96,v97
cvt v161,v98,v99
mf v[72:75],v[136:139],a[24:27],v[72:75]
mf v[76:79],v[136:139],a[28:31],0
s_add_u32 m0,s44,81920
s_xor_b32 s43,s40,459008
mf v[76:79],v[128:131],a[12:15],v[76:79]
mf v[92:95],v[132:135],a[12:15],0
mf v[92:95],v[140:143],a[28:31],v[92:95]
mf v[88:91],v[140:143],a[24:27],0
mf v[88:91],v[132:135],a[8:11],v[88:91]
mf v[84:87],v[132:135],a[4:7],0
mf v[84:87],v[140:143],a[20:23],v[84:87]
buffer_load_dwordx4 v18,s[16:19],s43 offen  lds
mf v[80:83],v[140:143],a[16:19],0
mf v[80:83],v[132:135],a[0:3],v[80:83]
s_waitcnt lgkmcnt(0)
mf v[64:67],v[144:147],a[32:35],v[64:67]
cvt v162,v112,v113
cvt v163,v114,v115
mf v[64:67],v[152:155],a[48:51],v[64:67]
ds_read_b128 v[140:143],v3 offset:20480
ds_read_b128 v[136:139],v3 offset:16384
mf v[68:71],v[152:155],a[52:55],v[68:71]
ds_read_b128 v[132:135],v2 offset:20480
ds_read_b128 v[128:131],v2 offset:16384
mf v[68:71],v[144:147],a[36:39],v[68:71]
buffer_load_dwordx4 v19,s[16:19],s43 offen offset:1024  lds
mf v[72:75],v[144:147],a[40:43],v[72:75]
mf v[72:75],v[152:155],a[56:59],v[72:75]
mf v[76:79],v[152:155],a[60:63],v[76:79]
mf v[76:79],v[144:147],a[44:47],v[76:79]
mf v[92:95],v[148:151],a[44:47],v[92:95]
mf v[92:95],v[156:159],a[60:63],v[92:95]
mf v[88:91],v[156:159],a[56:59],v[88:91]
buffer_load_dwordx4 v20,s[16:19],s43 offen offset:2048  lds
mf v[88:91],v[148:151],a[40:43],v[88:91]
mf v[84:87],v[148:151],a[36:39],v[84:87]
mf v[84:87],v[156:159],a[52:55],v[84:87]
buffer_store_dwordx4 v[160:163],v32,s[28:31],s49 offen sc1
cvt v164,v100,v101
mf v[80:83],v[156:159],a[48:51],v[80:83]
mf v[80:83],v[148:151],a[32:35],v[80:83]
s_waitcnt lgkmcnt(0)
mf v[64:67],v[128:131],a[64:67],v[64:67]
buffer_load_dwordx4 v21,s[16:19],s43 offen offset:3072  lds
mf v[64:67],v[136:139],a[80:83],v[64:67]
ds_read_b128 v[156:159],v5 offset:20480
ds_read_b128 v[152:155],v5 offset:16384
mf v[68:71],v[136:139],a[84:87],v[68:71]
ds_read_b128 v[148:151],v4 offset:20480
ds_read_b128 v[144:147],v4 offset:16384
mf v[68:71],v[128:131],a[68:71],v[68:71]
mf v[72:75],v[128:131],a[72:75],v[72:75]
mf v[72:75],v[136:139],a[88:91],v[72:75]
mf v[76:79],v[136:139],a[92:95],v[76:79]
mf v[76:79],v[128:131],a[76:79],v[76:79]
mf v[92:95],v[132:135],a[76:79],v[92:95]
s_waitcnt vmcnt(11)
s_barrier
mf v[92:95],v[140:143],a[92:95],v[92:95]
cvt v165,v102,v103
cvt v166,v116,v117
mf v[88:91],v[140:143],a[88:91],v[88:91]
s_add_u32 m0,s44,98304
s_xor_b32 s43,s40,459264
mf v[88:91],v[132:135],a[72:75],v[88:91]
mf v[84:87],v[132:135],a[68:71],v[84:87]
mf v[84:87],v[140:143],a[84:87],v[84:87]
mf v[80:83],v[140:143],a[80:83],v[80:83]
mf v[80:83],v[132:135],a[64:67],v[80:83]
buffer_load_dwordx4 v18,s[16:19],s43 offen  lds
s_waitcnt lgkmcnt(0)
mf v[64:67],v[144:147],a[96:99],v[64:67]
mf v[64:67],v[152:155],a[112:115],v[64:67]
ds_read_b128 v[140:143],v3 offset:36864
ds_read_b128 v[136:139],v3 offset:32768
mf v[68:71],v[152:155],a[116:119],v[68:71]
ds_read_b128 v[132:135],v2 offset:36864
ds_read_b128 v[128:131],v2 offset:32768
mf v[68:71],v[144:147],a[100:103],v[68:71]
mf v[72:75],v[144:147],a[104:107],v[72:75]
cvt v167,v118,v119
buffer_store_dwordx4 v[164:167],v32,s[28:31],s49 offen offset:1024 sc1
mf v[72:75],v[152:155],a[120:123],v[72:75]
buffer_load_dwordx4 v19,s[16:19],s43 offen offset:1024  lds
mf v[76:79],v[152:155],a[124:127],v[76:79]
mf v[76:79],v[144:147],a[108:111],v[76:79]
mf v[92:95],v[148:151],a[108:111],v[92:95]
mf v[92:95],v[156:159],a[124:127],v[92:95]
mf v[88:91],v[156:159],a[120:123],v[88:91]
buffer_load_dwordx4 v20,s[16:19],s43 offen offset:2048  lds
mf v[88:91],v[148:151],a[104:107],v[88:91]
mf v[84:87],v[148:151],a[100:103],v[84:87]
mf v[84:87],v[156:159],a[116:119],v[84:87]
mf v[80:83],v[156:159],a[112:115],v[80:83]
mf v[80:83],v[148:151],a[96:99],v[80:83]
s_waitcnt lgkmcnt(0)
mf v[64:67],v[128:131],a[128:131],v[64:67]
buffer_load_dwordx4 v21,s[16:19],s43 offen offset:3072  lds
mf v[64:67],v[136:139],a[144:147],v[64:67]
ds_read_b128 v[156:159],v5 offset:36864
ds_read_b128 v[152:155],v5 offset:32768
mf v[68:71],v[136:139],a[148:151],v[68:71]
ds_read_b128 v[148:151],v4 offset:36864
ds_read_b128 v[144:147],v4 offset:32768
mf v[68:71],v[128:131],a[132:135],v[68:71]
s_lshl_b32 s79,s45,7
v_xor_b32 v10,s79,v10
mf v[72:75],v[128:131],a[136:139],v[72:75]
cvt v168,v104,v105
cvt v169,v106,v107
mf v[72:75],v[136:139],a[152:155],v[72:75]
mf v[76:79],v[136:139],a[156:159],v[76:79]
s_add_u32 m0,s44,114688
s_xor_b32 s43,s40,459520
mf v[76:79],v[128:131],a[140:143],v[76:79]
v_xor_b32 v11,32,v10
v_xor_b32 v12,64,v10
mf v[92:95],v[132:135],a[140:143],v[92:95]
mf v[92:95],v[140:143],a[156:159],v[92:95]
mf v[88:91],v[140:143],a[152:155],v[88:91]
mf v[88:91],v[132:135],a[136:139],v[88:91]
mf v[84:87],v[132:135],a[132:135],v[84:87]
v_xor_b32 v13,96,v10
v_xor_b32 v14,128,v10
mf v[84:87],v[140:143],a[148:151],v[84:87]
buffer_load_dwordx4 v18,s[16:19],s43 offen  lds
mf v[80:83],v[140:143],a[144:147],v[80:83]
cvt v170,v120,v121
cvt v171,v122,v123
mf v[80:83],v[132:135],a[128:131],v[80:83]
s_waitcnt lgkmcnt(0)
mf v[64:67],v[144:147],a[160:163],v[64:67]
mf v[64:67],v[152:155],a[176:179],v[64:67]
ds_read_b128 v[140:143],v3 offset:53248
ds_read_b128 v[136:139],v3 offset:49152
mf v[68:71],v[152:155],a[180:183],v[68:71]
ds_read_b128 v[132:135],v2 offset:53248
ds_read_b128 v[128:131],v2 offset:49152
mf v[68:71],v[144:147],a[164:167],v[68:71]
buffer_load_dwordx4 v19,s[16:19],s43 offen offset:1024  lds
mf v[72:75],v[144:147],a[168:171],v[72:75]
v_xor_b32 v15,160,v10
v_xor_b32 v16,192,v10
mf v[72:75],v[152:155],a[184:187],v[72:75]
mf v[76:79],v[152:155],a[188:191],v[76:79]
mf v[76:79],v[144:147],a[172:175],v[76:79]
mf v[92:95],v[148:151],a[172:175],v[92:95]
v_xor_b32 v17,224,v10
mf v[92:95],v[156:159],a[188:191],v[92:95]
mf v[88:91],v[156:159],a[184:187],v[88:91]
buffer_load_dwordx4 v20,s[16:19],s43 offen offset:2048  lds
mf v[88:91],v[148:151],a[168:171],v[88:91]
mf v[84:87],v[148:151],a[164:167],v[84:87]
mf v[84:87],v[156:159],a[180:183],v[84:87]
buffer_store_dwordx4 v[168:171],v32,s[28:31],s49 offen offset:2048 sc1
cvt v172,v108,v109
mf v[80:83],v[156:159],a[176:179],v[80:83]
mf v[80:83],v[148:151],a[160:163],v[80:83]
s_waitcnt lgkmcnt(0)
mf v[64:67],v[128:131],a[192:195],v[64:67]
buffer_load_dwordx4 v21,s[16:19],s43 offen offset:3072  lds
mf v[64:67],v[136:139],a[208:211],v[64:67]
ds_read_b128 v[156:159],v5 offset:53248
ds_read_b128 v[152:155],v5 offset:49152
mf v[68:71],v[136:139],a[212:215],v[68:71]
ds_read_b128 v[148:151],v4 offset:53248
ds_read_b128 v[144:147],v4 offset:49152
mf v[68:71],v[128:131],a[196:199],v[68:71]
cvt v173,v110,v111
cvt v174,v124,v125
mf v[72:75],v[128:131],a[200:203],v[72:75]
buffer_load_dword v188,v37,s[8:11],s52 offen sc1
mf v[72:75],v[136:139],a[216:219],v[72:75]
mf v[76:79],v[136:139],a[220:223],v[76:79]
mf v[76:79],v[128:131],a[204:207],v[76:79]
mf v[92:95],v[132:135],a[204:207],v[92:95]
s_waitcnt vmcnt(11)
s_barrier
mf v[92:95],v[140:143],a[220:223],v[92:95]
mf v[88:91],v[140:143],a[216:219],v[88:91]
s_add_u32 m0,s44,0
s_add_u32 s69,s71,0
mf v[88:91],v[132:135],a[200:203],v[88:91]
mf v[84:87],v[132:135],a[196:199],v[84:87]
cvt v175,v126,v127
mf v[84:87],v[140:143],a[212:215],v[84:87]
mf v[80:83],v[140:143],a[208:211],v[80:83]
mf v[80:83],v[132:135],a[192:195],v[80:83]
buffer_load_dwordx4 v26,s[72:75],s69 offen lds
s_waitcnt lgkmcnt(0)
mf v[64:67],v[144:147],a[224:227],v[64:67]
mf v[64:67],v[152:155],a[240:243],v[64:67]
ds_read_b128 v[140:143],v7 offset:4096
ds_read_b128 v[136:139],v7 offset:0
mf v[68:71],v[152:155],a[244:247],v[68:71]
ds_read_b128 v[132:135],v6 offset:4096
ds_read_b128 v[128:131],v6 offset:0
mf v[68:71],v[144:147],a[228:231],v[68:71]
mf v[72:75],v[144:147],a[232:235],v[72:75]
mf v[72:75],v[152:155],a[248:251],v[72:75]
buffer_load_dwordx4 v27,s[72:75],s69 offen offset:1024 lds
mf v[76:79],v[152:155],a[252:255],v[76:79]
buffer_store_dwordx4 v[172:175],v32,s[28:31],s49 offen offset:3072 sc1
s_add_u32 s49,s49,32768
mf v[76:79],v[144:147],a[236:239],v[76:79]
mf v[92:95],v[148:151],a[236:239],v[92:95]
mf v[92:95],v[156:159],a[252:255],v[92:95]
mf v[88:91],v[156:159],a[248:251],v[88:91]
buffer_load_dwordx4 v28,s[72:75],s69 offen offset:2048 lds
mf v[88:91],v[148:151],a[232:235],v[88:91]
mf v[84:87],v[148:151],a[228:231],v[84:87]
mf v[84:87],v[156:159],a[244:247],v[84:87]
mf v[80:83],v[156:159],a[240:243],v[80:83]
mf v[80:83],v[148:151],a[224:227],v[80:83]
s_waitcnt lgkmcnt(0)
mf v[96:99],v[128:131],a[0:3],0
buffer_load_dwordx4 v29,s[72:75],s69 offen offset:3072 lds
mf v[96:99],v[136:139],a[16:19],v[96:99]
ds_read_b128 v[156:159],v9 offset:4096
ds_read_b128 v[152:155],v9 offset:0
mf v[100:103],v[136:139],a[20:23],0
ds_read_b128 v[148:151],v8 offset:4096
ds_read_b128 v[144:147],v8 offset:0
mf v[100:103],v[128:131],a[4:7],v[100:103]
mf v[104:107],v[128:131],a[8:11],0
cvt v160,v64,v65
cvt v161,v66,v67
mf v[104:107],v[136:139],a[24:27],v[104:107]
mf v[108:111],v[136:139],a[28:31],0
s_add_u32 m0,s44,16384
s_add_u32 s69,s71,524288
mf v[108:111],v[128:131],a[12:15],v[108:111]
mf v[124:127],v[132:135],a[12:15],0
mf v[124:127],v[140:143],a[28:31],v[124:127]
cvt v162,v80,v81
cvt v163,v82,v83
mf v[120:123],v[140:143],a[24:27],0
mf v[120:123],v[132:135],a[8:11],v[120:123]
mf v[116:119],v[132:135],a[4:7],0
mf v[116:119],v[140:143],a[20:23],v[116:119]
buffer_load_dwordx4 v26,s[72:75],s69 offen lds
mf v[112:115],v[140:143],a[16:19],0
mf v[112:115],v[132:135],a[0:3],v[112:115]
s_waitcnt lgkmcnt(0)
mf v[96:99],v[144:147],a[32:35],v[96:99]
buffer_store_dwordx4 v[160:163],v32,s[28:31],s49 offen sc1
cvt v164,v68,v69
mf v[96:99],v[152:155],a[48:51],v[96:99]
ds_read_b128 v[140:143],v7 offset:20480
ds_read_b128 v[136:139],v7 offset:16384
mf v[100:103],v[152:155],a[52:55],v[100:103]
ds_read_b128 v[132:135],v6 offset:20480
ds_read_b128 v[128:131],v6 offset:16384
mf v[100:103],v[144:147],a[36:39],v[100:103]
buffer_load_dwordx4 v27,s[72:75],s69 offen offset:1024 lds
mf v[104:107],v[144:147],a[40:43],v[104:107]
cvt v165,v70,v71
cvt v166,v84,v85
mf v[104:107],v[152:155],a[56:59],v[104:107]
mf v[108:111],v[152:155],a[60:63],v[108:111]
mf v[108:111],v[144:147],a[44:47],v[108:111]
mf v[124:127],v[148:151],a[44:47],v[124:127]
mf v[124:127],v[156:159],a[60:63],v[124:127]
mf v[120:123],v[156:159],a[56:59],v[120:123]
buffer_load_dwordx4 v28,s[72:75],s69 offen offset:2048 lds
mf v[120:123],v[148:151],a[40:43],v[120:123]
mf v[116:119],v[148:151],a[36:39],v[116:119]
mf v[116:119],v[156:159],a[52:55],v[116:119]
cvt v167,v86,v87
buffer_store_dwordx4 v[164:167],v32,s[28:31],s49 offen offset:1024 sc1
mf v[112:115],v[156:159],a[48:51],v[112:115]
mf v[112:115],v[148:151],a[32:35],v[112:115]
s_waitcnt lgkmcnt(0)
mf v[96:99],v[128:131],a[64:67],v[96:99]
buffer_load_dwordx4 v29,s[72:75],s69 offen offset:3072 lds
mf v[96:99],v[136:139],a[80:83],v[96:99]
ds_read_b128 v[156:159],v9 offset:20480
ds_read_b128 v[152:155],v9 offset:16384
mf v[100:103],v[136:139],a[84:87],v[100:103]
ds_read_b128 v[148:151],v8 offset:20480
ds_read_b128 v[144:147],v8 offset:16384
mf v[100:103],v[128:131],a[68:71],v[100:103]
cvt v168,v72,v73
cvt v169,v74,v75
mf v[104:107],v[128:131],a[72:75],v[104:107]
cvt v170,v88,v89
cvt v171,v90,v91
mf v[104:107],v[136:139],a[88:91],v[104:107]
mf v[108:111],v[136:139],a[92:95],v[108:111]
mf v[108:111],v[128:131],a[76:79],v[108:111]
mf v[124:127],v[132:135],a[76:79],v[124:127]
s_waitcnt vmcnt(12)
s_barrier
mf v[124:127],v[140:143],a[92:95],v[124:127]
mf v[120:123],v[140:143],a[88:91],v[120:123]
s_add_u32 m0,s44,32768
s_add_u32 s69,s71,1048576
s_cmp_ge_u32 s68,4
s_cselect_b32 s79,5242880,0
s_sub_u32 s69,s69,s79
mf v[120:123],v[132:135],a[72:75],v[120:123]
buffer_store_dwordx4 v[168:171],v32,s[28:31],s49 offen offset:2048 sc1
cvt v172,v76,v77
mf v[116:119],v[132:135],a[68:71],v[116:119]
mf v[116:119],v[140:143],a[84:87],v[116:119]
mf v[112:115],v[140:143],a[80:83],v[112:115]
mf v[112:115],v[132:135],a[64:67],v[112:115]
buffer_load_dwordx4 v26,s[72:75],s69 offen lds
s_waitcnt lgkmcnt(0)
mf v[96:99],v[144:147],a[96:99],v[96:99]
cvt v173,v78,v79
cvt v174,v92,v93
mf v[96:99],v[152:155],a[112:115],v[96:99]
ds_read_b128 v[140:143],v7 offset:36864
ds_read_b128 v[136:139],v7 offset:32768
mf v[100:103],v[152:155],a[116:119],v[100:103]
ds_read_b128 v[132:135],v6 offset:36864
ds_read_b128 v[128:131],v6 offset:32768
mf v[100:103],v[144:147],a[100:103],v[100:103]
mf v[104:107],v[144:147],a[104:107],v[104:107]
mf v[104:107],v[152:155],a[120:123],v[104:107]
buffer_load_dwordx4 v27,s[72:75],s69 offen offset:1024 lds
cvt v175,v94,v95
mf v[108:111],v[152:155],a[124:127],v[108:111]
mf v[108:111],v[144:147],a[108:111],v[108:111]
mf v[124:127],v[148:151],a[108:111],v[124:127]
mf v[124:127],v[156:159],a[124:127],v[124:127]
mf v[120:123],v[156:159],a[120:123],v[120:123]
buffer_load_dwordx4 v28,s[72:75],s69 offen offset:2048 lds
mf v[120:123],v[148:151],a[104:107],v[120:123]
mf v[116:119],v[148:151],a[100:103],v[116:119]
mf v[116:119],v[156:159],a[116:119],v[116:119]
buffer_store_dwordx4 v[172:175],v32,s[28:31],s49 offen offset:3072 sc1
s_add_u32 s49,s49,32768
mf v[112:115],v[156:159],a[112:115],v[112:115]
mf v[112:115],v[148:151],a[96:99],v[112:115]
LVh_chk:
s_waitcnt vmcnt(16)
v_cmp_ne_u32 vcc,16,v188
s_nop 0
s_cbranch_vccnz LVh_spin
s_waitcnt lgkmcnt(0)
mf v[96:99],v[128:131],a[128:131],v[96:99]
buffer_load_dwordx4 v29,s[72:75],s69 offen offset:3072 lds
mf v[96:99],v[136:139],a[144:147],v[96:99]
ds_read_b128 v[156:159],v9 offset:36864
ds_read_b128 v[152:155],v9 offset:32768
mf v[100:103],v[136:139],a[148:151],v[100:103]
ds_read_b128 v[148:151],v8 offset:36864
ds_read_b128 v[144:147],v8 offset:32768
mf v[100:103],v[128:131],a[132:135],v[100:103]
buffer_load_dwordx4 v[64:67],v32,s[60:63],s50 offen sc1
mf v[104:107],v[128:131],a[136:139],v[104:107]
mf v[104:107],v[136:139],a[152:155],v[104:107]
mf v[108:111],v[136:139],a[156:159],v[108:111]
s_add_u32 m0,s44,49152
s_add_u32 s69,s71,1572864
s_cmp_ge_u32 s68,4
s_cselect_b32 s79,5242880,0
s_sub_u32 s69,s69,s79
mf v[108:111],v[128:131],a[140:143],v[108:111]
buffer_load_dwordx4 v[68:71],v32,s[60:63],s50 offen offset:1024 sc1
s_add_u32 s50,s50,4096
mf v[124:127],v[132:135],a[140:143],v[124:127]
mf v[124:127],v[140:143],a[156:159],v[124:127]
mf v[120:123],v[140:143],a[152:155],v[120:123]
buffer_load_dwordx4 v[72:75],v32,s[60:63],s51 offen sc1
mf v[120:123],v[132:135],a[136:139],v[120:123]
mf v[116:119],v[132:135],a[132:135],v[116:119]
mf v[116:119],v[140:143],a[148:151],v[116:119]
buffer_load_dwordx4 v26,s[72:75],s69 offen lds
mf v[112:115],v[140:143],a[144:147],v[112:115]
mf v[112:115],v[132:135],a[128:131],v[112:115]
s_waitcnt lgkmcnt(0)
mf v[96:99],v[144:147],a[160:163],v[96:99]
buffer_load_dwordx4 v[76:79],v32,s[60:63],s51 offen offset:1024 sc1
s_add_u32 s51,s51,4096
mf v[96:99],v[152:155],a[176:179],v[96:99]
ds_read_b128 v[140:143],v7 offset:53248
ds_read_b128 v[136:139],v7 offset:49152
mf v[100:103],v[152:155],a[180:183],v[100:103]
ds_read_b128 v[132:135],v6 offset:53248
ds_read_b128 v[128:131],v6 offset:49152
mf v[100:103],v[144:147],a[164:167],v[100:103]
buffer_load_dwordx4 v27,s[72:75],s69 offen offset:1024 lds
mf v[104:107],v[144:147],a[168:171],v[104:107]
mf v[104:107],v[152:155],a[184:187],v[104:107]
mf v[108:111],v[152:155],a[188:191],v[108:111]
buffer_load_dwordx4 v[80:83],v32,s[60:63],s50 offen sc1
mf v[108:111],v[144:147],a[172:175],v[108:111]
buffer_load_dwordx4 v[84:87],v32,s[60:63],s50 offen offset:1024 sc1
s_add_u32 s50,s50,4096
mf v[124:127],v[148:151],a[172:175],v[124:127]
mf v[124:127],v[156:159],a[188:191],v[124:127]
mf v[120:123],v[156:159],a[184:187],v[120:123]
buffer_load_dwordx4 v28,s[72:75],s69 offen offset:2048 lds
mf v[120:123],v[148:151],a[168:171],v[120:123]
mf v[116:119],v[148:151],a[164:167],v[116:119]
mf v[116:119],v[156:159],a[180:183],v[116:119]
buffer_load_dwordx4 v[88:91],v32,s[60:63],s51 offen sc1
mf v[112:115],v[156:159],a[176:179],v[112:115]
mf v[112:115],v[148:151],a[160:163],v[112:115]
s_waitcnt lgkmcnt(0)
mf v[96:99],v[128:131],a[192:195],v[96:99]
buffer_load_dwordx4 v29,s[72:75],s69 offen offset:3072 lds
mf v[96:99],v[136:139],a[208:211],v[96:99]
ds_read_b128 v[156:159],v9 offset:53248
ds_read_b128 v[152:155],v9 offset:49152
mf v[100:103],v[136:139],a[212:215],v[100:103]
ds_read_b128 v[148:151],v8 offset:53248
ds_read_b128 v[144:147],v8 offset:49152
mf v[100:103],v[128:131],a[196:199],v[100:103]
buffer_load_dwordx4 v[92:95],v32,s[60:63],s51 offen offset:1024 sc1
s_add_u32 s51,s51,4096
mf v[104:107],v[128:131],a[200:203],v[104:107]
mf v[104:107],v[136:139],a[216:219],v[104:107]
mf v[108:111],v[136:139],a[220:223],v[108:111]
buffer_load_dwordx4 v[48:51],v32,s[60:63],s50 offen sc1
mf v[108:111],v[128:131],a[204:207],v[108:111]
mf v[124:127],v[132:135],a[204:207],v[124:127]
s_waitcnt vmcnt(19)
s_barrier
mf v[124:127],v[140:143],a[220:223],v[124:127]
buffer_load_dwordx4 v[52:55],v32,s[60:63],s50 offen offset:1024 sc1
s_add_u32 s50,s50,4096
mf v[120:123],v[140:143],a[216:219],v[120:123]
s_add_u32 m0,s44,65536
s_add_u32 s69,s71,2097152
s_cmp_ge_u32 s68,3
s_cselect_b32 s79,5242880,0
s_sub_u32 s69,s69,s79
mf v[120:123],v[132:135],a[200:203],v[120:123]
mf v[116:119],v[132:135],a[196:199],v[116:119]
buffer_load_dwordx4 v[56:59],v32,s[60:63],s51 offen sc1
mf v[116:119],v[140:143],a[212:215],v[116:119]
mf v[112:115],v[140:143],a[208:211],v[112:115]
buffer_load_dwordx4 v[60:63],v32,s[60:63],s51 offen offset:1024 sc1
s_add_u32 s51,s51,4096
mf v[112:115],v[132:135],a[192:195],v[112:115]
buffer_load_dwordx4 v26,s[72:75],s69 offen lds
s_waitcnt lgkmcnt(0)
mf v[96:99],v[144:147],a[224:227],v[96:99]
mf v[96:99],v[152:155],a[240:243],v[96:99]
mf v[100:103],v[152:155],a[244:247],v[100:103]
ds_read_b64_tr_b16 a[192:193],v10 offset:0
ds_read_b64_tr_b16 a[194:195],v10 offset:1024
mf v[100:103],v[144:147],a[228:231],v[100:103]
ds_read_b64_tr_b16 a[196:197],v11 offset:0
ds_read_b64_tr_b16 a[198:199],v11 offset:1024
mf v[104:107],v[144:147],a[232:235],v[104:107]
mf v[104:107],v[152:155],a[248:251],v[104:107]
buffer_load_dwordx4 v27,s[72:75],s69 offen offset:1024 lds
mf v[108:111],v[152:155],a[252:255],v[108:111]
ds_read_b64_tr_b16 a[200:201],v12 offset:0
ds_read_b64_tr_b16 a[202:203],v12 offset:1024
mf v[108:111],v[144:147],a[236:239],v[108:111]
ds_read_b64_tr_b16 a[204:205],v13 offset:0
ds_read_b64_tr_b16 a[206:207],v13 offset:1024
mf v[124:127],v[148:151],a[236:239],v[124:127]
ds_read_b64_tr_b16 a[208:209],v10 offset:8192
ds_read_b64_tr_b16 a[210:211],v10 offset:9216
mf v[124:127],v[156:159],a[252:255],v[124:127]
ds_read_b64_tr_b16 a[212:213],v11 offset:8192
ds_read_b64_tr_b16 a[214:215],v11 offset:9216
mf v[120:123],v[156:159],a[248:251],v[120:123]
buffer_load_dwordx4 v28,s[72:75],s69 offen offset:2048 lds
mf v[120:123],v[148:151],a[232:235],v[120:123]
ds_read_b64_tr_b16 a[216:217],v12 offset:8192
ds_read_b64_tr_b16 a[218:219],v12 offset:9216
mf v[116:119],v[148:151],a[228:231],v[116:119]
ds_read_b64_tr_b16 a[220:221],v13 offset:8192
ds_read_b64_tr_b16 a[222:223],v13 offset:9216
mf v[116:119],v[156:159],a[244:247],v[116:119]
mf v[112:115],v[156:159],a[240:243],v[112:115]
mf v[112:115],v[148:151],a[224:227],v[112:115]
cvt v160,v96,v97
cvt v161,v98,v99
s_nop 5
cvt v162,v112,v113
cvt v163,v114,v115
buffer_store_dwordx4 v[160:163],v32,s[28:31],s49 offen sc1
cvt v164,v100,v101
cvt v165,v102,v103
cvt v166,v116,v117
cvt v167,v118,v119
buffer_store_dwordx4 v[164:167],v32,s[28:31],s49 offen offset:1024 sc1
cvt v168,v104,v105
cvt v169,v106,v107
cvt v170,v120,v121
cvt v171,v122,v123
buffer_store_dwordx4 v[168:171],v32,s[28:31],s49 offen offset:2048 sc1
cvt v172,v108,v109
cvt v173,v110,v111
cvt v174,v124,v125
cvt v175,v126,v127
buffer_store_dwordx4 v[172:175],v32,s[28:31],s49 offen offset:3072 sc1
s_add_u32 s49,s49,32768
buffer_load_dwordx4 v29,s[72:75],s69 offen offset:3072 lds
s_add_u32 m0,s44,81920
s_add_u32 s69,s71,2621440
s_cmp_ge_u32 s68,3
s_cselect_b32 s79,5242880,0
s_sub_u32 s69,s69,s79
buffer_load_dwordx4 v26,s[72:75],s69 offen lds
buffer_load_dwordx4 v27,s[72:75],s69 offen offset:1024 lds
buffer_load_dwordx4 v28,s[72:75],s69 offen offset:2048 lds
buffer_load_dwordx4 v29,s[72:75],s69 offen offset:3072 lds
Latt:
s_mov_b32 s48,s42
s_mov_b32 s57,s44
v_mov_b32 v2,v32
buffer_load_dwordx4 a[144:147],v2,s[60:63],s50 offen sc1
buffer_load_dwordx4 a[148:151],v2,s[60:63],s50 offen offset:1024 sc1
s_add_u32 s50,s50,4096
buffer_load_dwordx4 a[152:155],v2,s[60:63],s51 offen sc1
buffer_load_dwordx4 a[156:159],v2,s[60:63],s51 offen offset:1024 sc1
s_add_u32 s51,s51,4096
s_cmp_eq_u32 s68,4
s_cselect_b32 s70,81920,0
s_sub_u32 s50,s50,s70
s_sub_u32 s51,s51,s70
s_waitcnt vmcnt(31) lgkmcnt(14)
mf v[128:131],a[192:195],v[64:67],0
ds_read_b64_tr_b16 a[224:225],v14 offset:0
ds_read_b64_tr_b16 a[226:227],v14 offset:1024
s_waitcnt vmcnt(25) lgkmcnt(8)
mf v[128:131],a[208:211],v[80:83],v[128:131]
buffer_load_dwordx4 a[160:163],v2,s[60:63],s50 offen sc1
s_waitcnt lgkmcnt(6)
mf v[144:147],a[212:215],v[80:83],0
mf v[144:147],a[196:199],v[64:67],v[144:147]
ds_read_b64_tr_b16 a[228:229],v15 offset:0
ds_read_b64_tr_b16 a[230:231],v15 offset:1024
mf v[160:163],a[200:203],v[64:67],0
s_waitcnt lgkmcnt(6)
mf v[160:163],a[216:219],v[80:83],v[160:163]
s_waitcnt lgkmcnt(4)
mf v[176:179],a[220:223],v[80:83],0
ds_read_b64_tr_b16 a[232:233],v16 offset:0
ds_read_b64_tr_b16 a[234:235],v16 offset:1024
mf v[176:179],a[204:207],v[64:67],v[176:179]
mf v[180:183],a[204:207],v[68:71],0
buffer_load_dwordx4 a[164:167],v2,s[60:63],s50 offen offset:1024 sc1
s_add_u32 s50,s50,4096
s_waitcnt vmcnt(26)
mf v[180:183],a[220:223],v[84:87],v[180:183]
ds_read_b64_tr_b16 a[236:237],v17 offset:0
ds_read_b64_tr_b16 a[238:239],v17 offset:1024
mf v[164:167],a[216:219],v[84:87],0
s_load_dwordx2 s[20:21],s[0:1],40
s_load_dwordx2 s[22:23],s[0:1],72
mf v[164:167],a[200:203],v[68:71],v[164:167]
s_load_dwordx2 s[32:33],s[0:1],56
s_load_dwordx2 s[34:35],s[0:1],64
mf v[148:151],a[196:199],v[68:71],0
ds_read_b64_tr_b16 a[240:241],v14 offset:8192
ds_read_b64_tr_b16 a[242:243],v14 offset:9216
mf v[148:151],a[212:215],v[84:87],v[148:151]
s_lshr_b32 s15,s2,5
s_sub_u32 s13,15,s15
mf v[132:135],a[208:211],v[84:87],0
s_lshl_b32 s56,s14,20
s_add_u32 s56,s56,2752512
mf v[132:135],a[192:195],v[68:71],v[132:135]
mf v[136:139],a[192:195],v[72:75],0
ds_read_b64_tr_b16 a[244:245],v15 offset:8192
ds_read_b64_tr_b16 a[246:247],v15 offset:9216
s_waitcnt vmcnt(24)
mf v[136:139],a[208:211],v[88:91],v[136:139]
buffer_load_dwordx4 a[168:171],v2,s[60:63],s51 offen sc1
mf v[152:155],a[212:215],v[88:91],0
ds_read_b64_tr_b16 a[248:249],v16 offset:8192
ds_read_b64_tr_b16 a[250:251],v16 offset:9216
mf v[152:155],a[196:199],v[72:75],v[152:155]
s_add_u32 s16,s4,s56
s_addc_u32 s17,s5,0
mf v[168:171],a[200:203],v[72:75],0
s_add_u32 s18,s13,1
s_lshl_b32 s18,s18,16
mf v[168:171],a[216:219],v[88:91],v[168:171]
ds_read_b64_tr_b16 a[252:253],v17 offset:8192
ds_read_b64_tr_b16 a[254:255],v17 offset:9216
mf v[184:187],a[220:223],v[88:91],0
s_mov_b32 s19,0x20000
mf v[184:187],a[204:207],v[72:75],v[184:187]
mf v[188:191],a[204:207],v[76:79],0
buffer_load_dwordx4 a[172:175],v2,s[60:63],s51 offen offset:1024 sc1
s_add_u32 s51,s51,4096
s_waitcnt vmcnt(24)
mf v[188:191],a[220:223],v[92:95],v[188:191]
s_add_u32 s28,s4,36372480
s_addc_u32 s29,s5,0
mf v[172:175],a[216:219],v[92:95],0
s_mov_b32 s30,16777216
s_mov_b32 s31,0x20000
mf v[172:175],a[200:203],v[76:79],v[172:175]
s_mov_b32 s40,s57
s_add_u32 s41,s57,32768
mf v[156:159],a[196:199],v[76:79],0
s_add_u32 s42,s57,32768
s_add_u32 s43,s57,65536
mf v[156:159],a[212:215],v[92:95],v[156:159]
s_lshl_b32 s12,s3,13
s_add_u32 s12,s12,131072
mf v[140:143],a[208:211],v[92:95],0
s_lshl_b32 s58,s3,4
mf v[140:143],a[192:195],v[76:79],v[140:143]
s_waitcnt lgkmcnt(0)
mf v[192:195],a[224:227],v[64:67],0
ds_read_b64_tr_b16 a[192:193],v10 offset:16384
ds_read_b64_tr_b16 a[194:195],v10 offset:17408
mf v[192:195],a[240:243],v[80:83],v[192:195]
buffer_load_dwordx4 a[176:179],v2,s[60:63],s50 offen sc1
mf v[208:211],a[244:247],v[80:83],0
v_and_b32 v5,3,v1
v_lshlrev_b32 v5,3,v5
mf v[208:211],a[228:231],v[64:67],v[208:211]
ds_read_b64_tr_b16 a[196:197],v11 offset:16384
ds_read_b64_tr_b16 a[198:199],v11 offset:17408
mf v[224:227],a[232:235],v[64:67],0
v_lshrrev_b32 v46,2,v1
v_lshl_add_u32 v47,v46,7,v5
mf v[224:227],a[248:251],v[80:83],v[224:227]
v_lshl_add_u32 v46,v46,8,v5
v_bfe_u32 v5,v1,2,3
mf v[240:243],a[252:255],v[80:83],0
ds_read_b64_tr_b16 a[200:201],v12 offset:16384
ds_read_b64_tr_b16 a[202:203],v12 offset:17408
mf v[240:243],a[236:239],v[64:67],v[240:243]
mf v[244:247],a[236:239],v[68:71],0
buffer_load_dwordx4 a[180:183],v2,s[60:63],s50 offen offset:1024 sc1
s_add_u32 s50,s50,4096
mf v[244:247],a[252:255],v[84:87],v[244:247]
ds_read_b64_tr_b16 a[204:205],v13 offset:16384
ds_read_b64_tr_b16 a[206:207],v13 offset:17408
mf v[228:231],a[248:251],v[84:87],0
v_lshl_add_u32 v46,v5,5,v46
v_bfe_u32 v5,v1,3,2
mf v[228:231],a[232:235],v[68:71],v[228:231]
v_lshl_add_u32 v47,v5,5,v47
v_add_u32 v46,s12,v46
mf v[212:215],a[228:231],v[68:71],0
ds_read_b64_tr_b16 a[208:209],v10 offset:24576
ds_read_b64_tr_b16 a[210:211],v10 offset:25600
mf v[212:215],a[244:247],v[84:87],v[212:215]
v_add_u32 v47,s12,v47
v_mul_u32_u24 v45,1280,v34
mf v[196:199],a[240:243],v[84:87],0
v_lshlrev_b32 v5,1,v34
v_xor_b32 v5,v5,v33
mf v[196:199],a[224:227],v[68:71],v[196:199]
mf v[200:203],a[224:227],v[72:75],0
ds_read_b64_tr_b16 a[212:213],v11 offset:24576
ds_read_b64_tr_b16 a[214:215],v11 offset:25600
mf v[200:203],a[240:243],v[88:91],v[200:203]
buffer_load_dwordx4 a[184:187],v2,s[60:63],s51 offen sc1
mf v[216:219],a[244:247],v[88:91],0
ds_read_b64_tr_b16 a[216:217],v12 offset:24576
ds_read_b64_tr_b16 a[218:219],v12 offset:25600
mf v[216:219],a[228:231],v[72:75],v[216:219]
v_lshl_add_u32 v45,v5,4,v45
v_add_u32 v3,0x10000,v2
mf v[232:235],a[232:235],v[72:75],0
v_add_u32 v4,0x8000,v2
v_lshlrev_b32 v5,2,v34
mf v[232:235],a[248:251],v[88:91],v[232:235]
ds_read_b64_tr_b16 a[220:221],v13 offset:24576
ds_read_b64_tr_b16 a[222:223],v13 offset:25600
mf v[248:251],a[252:255],v[88:91],0
v_sub_u32 v5,v33,v5
v_add_u32 v5,s58,v5
mf v[248:251],a[236:239],v[72:75],v[248:251]
mf v[252:255],a[236:239],v[76:79],0
buffer_load_dwordx4 a[188:191],v2,s[60:63],s51 offen offset:1024 sc1
s_add_u32 s51,s51,4096
mf v[252:255],a[252:255],v[92:95],v[252:255]
v_mov_b32 v7,0xff800000
v_add_u32 v0,49152,v2
mf v[236:239],a[248:251],v[92:95],0
v_mov_b32 v40,0
v_mov_b32 v41,0
mf v[236:239],a[232:235],v[76:79],v[236:239]
v_mov_b32 v42,0
v_mov_b32 v43,0
mf v[220:223],a[228:231],v[76:79],0
v_mov_b32 v36,0x3f803f80
v_mov_b32 v37,0x3f803f80
mf v[220:223],a[244:247],v[92:95],v[220:223]
v_mov_b32 v38,0x3f803f80
v_mov_b32 v39,0x3f803f80
mf v[204:207],a[240:243],v[92:95],0
mf v[204:207],a[224:227],v[76:79],v[204:207]
s_waitcnt lgkmcnt(0)
s_waitcnt vmcnt(27)
mf v[128:131],a[192:195],v[48:51],v[128:131]
ds_read_b64_tr_b16 a[224:225],v14 offset:16384
ds_read_b64_tr_b16 a[226:227],v14 offset:17408
s_waitcnt vmcnt(11)
mf v[128:131],a[208:211],a[144:147],v[128:131]
buffer_load_dwordx4 v[96:99],v2,s[60:63],s50 offen sc1
mf v[144:147],a[212:215],a[144:147],v[144:147]
s_lshl_b32 s52,s2,2
s_add_u32 s52,s52,s3
mf v[144:147],a[196:199],v[48:51],v[144:147]
ds_read_b64_tr_b16 a[228:229],v15 offset:16384
ds_read_b64_tr_b16 a[230:231],v15 offset:17408
mf v[160:163],a[200:203],v[48:51],v[160:163]
s_add_u32 s52,s52,896
s_and_b32 s52,s52,1023
mf v[160:163],a[216:219],a[144:147],v[160:163]
s_cmp_lt_u32 s52,640
s_cselect_b32 s20,s20,s22
s_cselect_b32 s21,s21,s23
s_cselect_b32 s53,0,640
s_cselect_b32 s55,0,9699328
s_mov_b32 s22,2211840
s_cselect_b32 s22,5242880,s22
mf v[176:179],a[220:223],a[144:147],v[176:179]
ds_read_b64_tr_b16 a[232:233],v16 offset:16384
ds_read_b64_tr_b16 a[234:235],v16 offset:17408
mf v[176:179],a[204:207],v[48:51],v[176:179]
mf v[180:183],a[204:207],v[52:55],v[180:183]
buffer_load_dwordx4 v[100:103],v2,s[60:63],s50 offen offset:1024 sc1
s_add_u32 s50,s50,4096
s_waitcnt vmcnt(12)
mf v[180:183],a[220:223],a[148:151],v[180:183]
ds_read_b64_tr_b16 a[236:237],v17 offset:16384
ds_read_b64_tr_b16 a[238:239],v17 offset:17408
mf v[164:167],a[216:219],a[148:151],v[164:167]
s_mov_b32 s23,0x20000
s_sub_u32 s53,s52,s53
mf v[164:167],a[200:203],v[52:55],v[164:167]
s_lshl_b32 s59,s53,13
s_add_u32 s55,s55,s59
mf v[148:151],a[196:199],v[52:55],v[148:151]
ds_read_b64_tr_b16 a[240:241],v14 offset:24576
ds_read_b64_tr_b16 a[242:243],v14 offset:25600
mf v[148:151],a[212:215],a[148:151],v[148:151]
mf v[132:135],a[208:211],a[148:151],v[132:135]
s_mul_i32 s54,s53,52429
s_lshr_b32 s54,s54,18
mf v[132:135],a[192:195],v[52:55],v[132:135]
mf v[136:139],a[192:195],v[56:59],v[136:139]
ds_read_b64_tr_b16 a[244:245],v15 offset:24576
ds_read_b64_tr_b16 a[246:247],v15 offset:25600
s_waitcnt vmcnt(11)
mf v[136:139],a[208:211],a[152:155],v[136:139]
buffer_load_dwordx4 v[104:107],v2,s[60:63],s51 offen sc1
mf v[152:155],a[212:215],a[152:155],v[152:155]
ds_read_b64_tr_b16 a[248:249],v16 offset:24576
ds_read_b64_tr_b16 a[250:251],v16 offset:25600
mf v[152:155],a[196:199],v[56:59],v[152:155]
s_mul_i32 s54,s54,39680
s_lshl_b32 s53,s53,8
mf v[168:171],a[200:203],v[56:59],v[168:171]
s_add_u32 s53,s53,s54
mf v[168:171],a[216:219],a[152:155],v[168:171]
ds_read_b64_tr_b16 a[252:253],v17 offset:24576
ds_read_b64_tr_b16 a[254:255],v17 offset:25600
mf v[184:187],a[220:223],a[152:155],v[184:187]
s_cmp_lt_u32 s52,910
s_cselect_b32 s55,s55,0x10000000
mf v[184:187],a[204:207],v[56:59],v[184:187]
mf v[188:191],a[204:207],v[60:63],v[188:191]
buffer_load_dwordx4 v[108:111],v2,s[60:63],s51 offen offset:1024 sc1
s_add_u32 s51,s51,4096
s_waitcnt vmcnt(12)
mf v[188:191],a[220:223],a[156:159],v[188:191]
s_add_u32 s36,s4,53149696
s_addc_u32 s37,s5,0
mf v[172:175],a[216:219],a[156:159],v[172:175]
mf v[172:175],a[200:203],v[60:63],v[172:175]
mf v[156:159],a[196:199],v[60:63],v[156:159]
s_mov_b32 s38,11911168
s_mov_b32 s39,0x20000
mf v[156:159],a[212:215],a[156:159],v[156:159]
mf v[140:143],a[208:211],a[156:159],v[140:143]
mf v[140:143],a[192:195],v[60:63],v[140:143]
s_waitcnt lgkmcnt(0)
mf v[192:195],a[224:227],v[48:51],v[192:195]
s_barrier
mf v[192:195],a[240:243],a[144:147],v[192:195]
ds_read_b64_tr_b16 a[192:193],v10 offset:32768
ds_read_b64_tr_b16 a[194:195],v10 offset:33792
mf v[208:211],a[244:247],a[144:147],v[208:211]
buffer_load_dwordx4 v[112:115],v2,s[60:63],s50 offen sc1
mf v[208:211],a[228:231],v[48:51],v[208:211]
s_lshl_b32 s46,s14,7
s_add_u32 s46,s46,26624
mf v[224:227],a[232:235],v[48:51],v[224:227]
ds_read_b64_tr_b16 a[196:197],v11 offset:32768
ds_read_b64_tr_b16 a[198:199],v11 offset:33792
mf v[224:227],a[248:251],a[144:147],v[224:227]
mf v[240:243],a[252:255],a[144:147],v[240:243]
buffer_load_dwordx4 v[116:119],v2,s[60:63],s50 offen offset:1024 sc1
s_add_u32 s50,s50,4096
mf v[240:243],a[236:239],v[48:51],v[240:243]
mf v[244:247],a[236:239],v[52:55],v[244:247]
ds_read_b64_tr_b16 a[200:201],v12 offset:32768
ds_read_b64_tr_b16 a[202:203],v12 offset:33792
mf v[244:247],a[252:255],a[148:151],v[244:247]
mf v[228:231],a[248:251],a[148:151],v[228:231]
ds_read_b64_tr_b16 a[204:205],v13 offset:32768
ds_read_b64_tr_b16 a[206:207],v13 offset:33792
mf v[228:231],a[232:235],v[52:55],v[228:231]
buffer_load_dwordx4 v[120:123],v2,s[60:63],s51 offen sc1
mf v[212:215],a[228:231],v[52:55],v[212:215]
v_mov_b32 v18,1
v_lshlrev_b32 v19,20,v1
mf v[212:215],a[244:247],a[148:151],v[212:215]
ds_read_b64_tr_b16 a[208:209],v10 offset:40960
ds_read_b64_tr_b16 a[210:211],v10 offset:41984
mf v[196:199],a[240:243],a[148:151],v[196:199]
mf v[196:199],a[224:227],v[52:55],v[196:199]
mf v[200:203],a[224:227],v[56:59],v[200:203]
ds_read_b64_tr_b16 a[212:213],v11 offset:40960
ds_read_b64_tr_b16 a[214:215],v11 offset:41984
mf v[200:203],a[240:243],a[152:155],v[200:203]
buffer_load_dwordx4 v[124:127],v2,s[60:63],s51 offen offset:1024 sc1
s_add_u32 s51,s51,4096
mf v[216:219],a[244:247],a[152:155],v[216:219]
mf v[216:219],a[228:231],v[56:59],v[216:219]
ds_read_b64_tr_b16 a[216:217],v12 offset:40960
ds_read_b64_tr_b16 a[218:219],v12 offset:41984
mf v[232:235],a[232:235],v[56:59],v[232:235]
buffer_atomic_add v18,v19,s[8:11],s46 offen sc1
mf v[232:235],a[248:251],a[152:155],v[232:235]
s_cmp_eq_u32 s68,3
s_cselect_b32 s70,81920,0
mf v[248:251],a[252:255],a[152:155],v[248:251]
ds_read_b64_tr_b16 a[220:221],v13 offset:40960
ds_read_b64_tr_b16 a[222:223],v13 offset:41984
mf v[248:251],a[236:239],v[56:59],v[248:251]
mf v[252:255],a[236:239],v[60:63],v[252:255]
mf v[252:255],a[252:255],a[156:159],v[252:255]
mf v[236:239],a[248:251],a[156:159],v[236:239]
s_sub_u32 s50,s50,s70
s_sub_u32 s51,s51,s70
mf v[236:239],a[232:235],v[60:63],v[236:239]
mf v[220:223],a[228:231],v[60:63],v[220:223]
mf v[220:223],a[244:247],a[156:159],v[220:223]
mf v[204:207],a[240:243],a[156:159],v[204:207]
mf v[204:207],a[224:227],v[60:63],v[204:207]
s_waitcnt lgkmcnt(0)
s_waitcnt vmcnt(16)
mf v[128:131],a[192:195],a[160:163],v[128:131]
ds_read_b64_tr_b16 a[224:225],v14 offset:32768
ds_read_b64_tr_b16 a[226:227],v14 offset:33792
s_waitcnt vmcnt(12)
mf v[128:131],a[208:211],a[176:179],v[128:131]
buffer_load_dwordx4 a[128:131],v2,s[60:63],s50 offen sc1
mf v[144:147],a[212:215],a[176:179],v[144:147]
s_lshr_b32 s52,s2,1
s_xor_b32 s52,s52,127
mf v[144:147],a[196:199],a[160:163],v[144:147]
ds_read_b64_tr_b16 a[228:229],v15 offset:32768
ds_read_b64_tr_b16 a[230:231],v15 offset:33792
mf v[160:163],a[200:203],a[160:163],v[160:163]
s_lshl_b32 s52,s52,2
s_add_u32 s52,s52,s3
mf v[160:163],a[216:219],a[176:179],v[160:163]
s_and_b32 s59,s2,1
s_lshl_b32 s59,s59,9
mf v[176:179],a[220:223],a[176:179],v[176:179]
ds_read_b64_tr_b16 a[232:233],v16 offset:32768
ds_read_b64_tr_b16 a[234:235],v16 offset:33792
mf v[176:179],a[204:207],a[160:163],v[176:179]
s_add_u32 s52,s52,s59
mf v[180:183],a[204:207],a[164:167],v[180:183]
buffer_load_dwordx4 a[132:135],v2,s[60:63],s50 offen offset:1024 sc1
s_add_u32 s50,s50,4096
s_waitcnt vmcnt(13)
mf v[180:183],a[220:223],a[180:183],v[180:183]
ds_read_b64_tr_b16 a[236:237],v17 offset:32768
ds_read_b64_tr_b16 a[238:239],v17 offset:33792
mf v[164:167],a[216:219],a[180:183],v[164:167]
s_cmp_lt_u32 s52,270
s_cselect_b32 s32,s32,s34
s_cselect_b32 s33,s33,s35
s_cselect_b32 s59,0,270
s_cselect_b32 s7,0,4
mf v[164:167],a[200:203],a[164:167],v[164:167]
buffer_load_dwordx4 a[136:139],v2,s[60:63],s51 offen sc1
mf v[148:151],a[196:199],a[164:167],v[148:151]
ds_read_b64_tr_b16 a[240:241],v14 offset:40960
ds_read_b64_tr_b16 a[242:243],v14 offset:41984
mf v[148:151],a[212:215],a[180:183],v[148:151]
s_cmp_lt_u32 s52,540
s_cselect_b32 s34,2211840,0
s_cselect_b32 s45,0,0x10000000
mf v[132:135],a[208:211],a[180:183],v[132:135]
s_mov_b32 s35,0x20000
s_sub_u32 s52,s52,s59
mf v[132:135],a[192:195],a[164:167],v[132:135]
mf v[136:139],a[192:195],a[168:171],v[136:139]
ds_read_b64_tr_b16 a[244:245],v15 offset:40960
ds_read_b64_tr_b16 a[246:247],v15 offset:41984
s_waitcnt vmcnt(13)
mf v[136:139],a[208:211],a[184:187],v[136:139]
buffer_load_dwordx4 a[140:143],v2,s[60:63],s51 offen offset:1024 sc1
s_add_u32 s51,s51,4096
mf v[152:155],a[212:215],a[184:187],v[152:155]
ds_read_b64_tr_b16 a[248:249],v16 offset:40960
ds_read_b64_tr_b16 a[250:251],v16 offset:41984
mf v[152:155],a[196:199],a[168:171],v[152:155]
s_lshl_b32 s59,s52,4
s_add_u32 s7,s7,s59
mf v[168:171],a[200:203],a[168:171],v[168:171]
s_lshl_b32 s7,s7,10
s_add_u32 s7,s7,5242880
mf v[168:171],a[216:219],a[184:187],v[168:171]
ds_read_b64_tr_b16 a[252:253],v17 offset:40960
ds_read_b64_tr_b16 a[254:255],v17 offset:41984
mf v[184:187],a[220:223],a[184:187],v[184:187]
s_add_u32 m0,s57,98304
s_add_u32 s69,s71,3145728
s_cmp_ge_u32 s68,2
s_cselect_b32 s79,5242880,0
s_sub_u32 s69,s69,s79
mf v[184:187],a[204:207],a[168:171],v[184:187]
mf v[188:191],a[204:207],a[172:175],v[188:191]
s_add_u32 s7,s7,s45
s_mul_i32 s59,s52,52429
s_waitcnt vmcnt(13)
mf v[188:191],a[220:223],a[188:191],v[188:191]
s_lshr_b32 s59,s59,19
s_mul_i32 s6,s59,10
mf v[172:175],a[216:219],a[188:191],v[172:175]
buffer_load_dwordx4 v26,s[72:75],s69 offen lds
mf v[172:175],a[200:203],a[172:175],v[172:175]
s_sub_u32 s6,s52,s6
s_mul_i32 s6,s6,221184
mf v[156:159],a[196:199],a[172:175],v[156:159]
s_lshl_b32 s59,s59,7
s_add_u32 s6,s6,s59
mf v[156:159],a[212:215],a[188:191],v[156:159]
mf v[140:143],a[208:211],a[188:191],v[140:143]
mf v[140:143],a[192:195],a[172:175],v[140:143]
s_waitcnt lgkmcnt(0)
mf v[192:195],a[224:227],a[160:163],v[192:195]
ds_read_b64_tr_b16 a[192:193],v10 offset:49152
ds_read_b64_tr_b16 a[194:195],v10 offset:50176
mf v[192:195],a[240:243],a[176:179],v[192:195]
buffer_load_dwordx4 a[144:147],v2,s[60:63],s50 offen sc1
mf v[208:211],a[244:247],a[176:179],v[208:211]
awr a0,0
awr a1,0
mf v[208:211],a[228:231],a[160:163],v[208:211]
ds_read_b64_tr_b16 a[196:197],v11 offset:49152
ds_read_b64_tr_b16 a[198:199],v11 offset:50176
mf v[224:227],a[232:235],a[160:163],v[224:227]
awr a2,0
awr a3,0
mf v[224:227],a[248:251],a[176:179],v[224:227]
buffer_load_dwordx4 a[148:151],v2,s[60:63],s50 offen offset:1024 sc1
s_add_u32 s50,s50,4096
mf v[240:243],a[252:255],a[176:179],v[240:243]
ds_read_b64_tr_b16 a[200:201],v12 offset:49152
ds_read_b64_tr_b16 a[202:203],v12 offset:50176
mf v[240:243],a[236:239],a[160:163],v[240:243]
mf v[244:247],a[236:239],a[164:167],v[244:247]
awr a4,0
awr a5,0
mf v[244:247],a[252:255],a[180:183],v[244:247]
ds_read_b64_tr_b16 a[204:205],v13 offset:49152
ds_read_b64_tr_b16 a[206:207],v13 offset:50176
mf v[228:231],a[248:251],a[180:183],v[228:231]
buffer_load_dwordx4 a[152:155],v2,s[60:63],s51 offen sc1
mf v[228:231],a[232:235],a[164:167],v[228:231]
awr a6,0
awr a7,0
mf v[212:215],a[228:231],a[164:167],v[212:215]
ds_read_b64_tr_b16 a[208:209],v10 offset:57344
ds_read_b64_tr_b16 a[210:211],v10 offset:58368
mf v[212:215],a[244:247],a[180:183],v[212:215]
buffer_load_dwordx4 a[156:159],v2,s[60:63],s51 offen offset:1024 sc1
s_add_u32 s51,s51,4096
mf v[196:199],a[240:243],a[180:183],v[196:199]
mf v[196:199],a[224:227],a[164:167],v[196:199]
mf v[200:203],a[224:227],a[168:171],v[200:203]
ds_read_b64_tr_b16 a[212:213],v11 offset:57344
ds_read_b64_tr_b16 a[214:215],v11 offset:58368
mf v[200:203],a[240:243],a[184:187],v[200:203]
awr a8,0
awr a9,0
mf v[216:219],a[244:247],a[184:187],v[216:219]
ds_read_b64_tr_b16 a[216:217],v12 offset:57344
ds_read_b64_tr_b16 a[218:219],v12 offset:58368
mf v[216:219],a[228:231],a[168:171],v[216:219]
buffer_load_dwordx4 v27,s[72:75],s69 offen offset:1024 lds
mf v[232:235],a[232:235],a[168:171],v[232:235]
awr a10,0
awr a11,0
mf v[232:235],a[248:251],a[184:187],v[232:235]
ds_read_b64_tr_b16 a[220:221],v13 offset:57344
ds_read_b64_tr_b16 a[222:223],v13 offset:58368
mf v[248:251],a[252:255],a[184:187],v[248:251]
buffer_load_dwordx4 v28,s[72:75],s69 offen offset:2048 lds
mf v[248:251],a[236:239],a[168:171],v[248:251]
mf v[252:255],a[236:239],a[172:175],v[252:255]
awr a12,0
awr a13,0
mf v[252:255],a[252:255],a[188:191],v[252:255]
mf v[236:239],a[248:251],a[188:191],v[236:239]
buffer_load_dwordx4 v29,s[72:75],s69 offen offset:3072 lds
mf v[236:239],a[232:235],a[172:175],v[236:239]
awr a14,0
awr a15,0
mf v[220:223],a[228:231],a[172:175],v[220:223]
mf v[220:223],a[244:247],a[188:191],v[220:223]
mf v[204:207],a[240:243],a[188:191],v[204:207]
mf v[204:207],a[224:227],a[172:175],v[204:207]
s_waitcnt lgkmcnt(0)
s_waitcnt vmcnt(20)
mf v[128:131],a[192:195],v[96:99],v[128:131]
ds_read_b64_tr_b16 a[224:225],v14 offset:49152
ds_read_b64_tr_b16 a[226:227],v14 offset:50176
s_waitcnt vmcnt(16)
mf v[128:131],a[208:211],v[112:115],v[128:131]
buffer_load_dwordx4 a[160:163],v2,s[60:63],s50 offen sc1
mf v[144:147],a[212:215],v[112:115],v[144:147]
awr a16,0
awr a17,0
mf v[144:147],a[196:199],v[96:99],v[144:147]
ds_read_b64_tr_b16 a[228:229],v15 offset:49152
ds_read_b64_tr_b16 a[230:231],v15 offset:50176
mf v[160:163],a[200:203],v[96:99],v[160:163]
awr a18,0
awr a19,0
mf v[160:163],a[216:219],v[112:115],v[160:163]
mf v[176:179],a[220:223],v[112:115],v[176:179]
ds_read_b64_tr_b16 a[232:233],v16 offset:49152
ds_read_b64_tr_b16 a[234:235],v16 offset:50176
mf v[176:179],a[204:207],v[96:99],v[176:179]
mf v[180:183],a[204:207],v[100:103],v[180:183]
buffer_load_dwordx4 a[164:167],v2,s[60:63],s50 offen offset:1024 sc1
s_add_u32 s50,s50,4096
s_waitcnt vmcnt(17)
mf v[180:183],a[220:223],v[116:119],v[180:183]
ds_read_b64_tr_b16 a[236:237],v17 offset:49152
ds_read_b64_tr_b16 a[238:239],v17 offset:50176
mf v[164:167],a[216:219],v[116:119],v[164:167]
awr a20,0
awr a21,0
mf v[164:167],a[200:203],v[100:103],v[164:167]
buffer_load_dwordx4 a[168:171],v2,s[60:63],s51 offen sc1
mf v[148:151],a[196:199],v[100:103],v[148:151]
ds_read_b64_tr_b16 a[240:241],v14 offset:57344
ds_read_b64_tr_b16 a[242:243],v14 offset:58368
mf v[148:151],a[212:215],v[116:119],v[148:151]
awr a22,0
awr a23,0
mf v[132:135],a[208:211],v[116:119],v[132:135]
mf v[132:135],a[192:195],v[100:103],v[132:135]
mf v[136:139],a[192:195],v[104:107],v[136:139]
ds_read_b64_tr_b16 a[244:245],v15 offset:57344
ds_read_b64_tr_b16 a[246:247],v15 offset:58368
s_waitcnt vmcnt(17)
mf v[136:139],a[208:211],v[120:123],v[136:139]
buffer_load_dwordx4 a[172:175],v2,s[60:63],s51 offen offset:1024 sc1
s_add_u32 s51,s51,4096
mf v[152:155],a[212:215],v[120:123],v[152:155]
ds_read_b64_tr_b16 a[248:249],v16 offset:57344
ds_read_b64_tr_b16 a[250:251],v16 offset:58368
mf v[152:155],a[196:199],v[104:107],v[152:155]
awr a24,0
awr a25,0
mf v[168:171],a[200:203],v[104:107],v[168:171]
awr a26,0
awr a27,0
mf v[168:171],a[216:219],v[120:123],v[168:171]
ds_read_b64_tr_b16 a[252:253],v17 offset:57344
ds_read_b64_tr_b16 a[254:255],v17 offset:58368
mf v[184:187],a[220:223],v[120:123],v[184:187]
s_add_u32 m0,s57,114688
s_add_u32 s69,s71,3670016
s_cmp_ge_u32 s68,2
s_cselect_b32 s79,5242880,0
s_sub_u32 s69,s69,s79
mf v[184:187],a[204:207],v[104:107],v[184:187]
mf v[188:191],a[204:207],v[108:111],v[188:191]
awr a28,0
awr a29,0
s_waitcnt vmcnt(17)
mf v[188:191],a[220:223],v[124:127],v[188:191]
mf v[172:175],a[216:219],v[124:127],v[172:175]
buffer_load_dwordx4 v26,s[72:75],s69 offen lds
mf v[172:175],a[200:203],v[108:111],v[172:175]
awr a30,0
awr a31,0
mf v[156:159],a[196:199],v[108:111],v[156:159]
mf v[156:159],a[212:215],v[124:127],v[156:159]
mf v[140:143],a[208:211],v[124:127],v[140:143]
mf v[140:143],a[192:195],v[108:111],v[140:143]
s_waitcnt lgkmcnt(0)
mf v[192:195],a[224:227],v[96:99],v[192:195]
s_barrier
mf v[192:195],a[240:243],v[112:115],v[192:195]
v_xor_b32 v10,0x10000,v10
v_xor_b32 v11,0x10000,v11
mf v[208:211],a[244:247],v[112:115],v[208:211]
v_xor_b32 v12,0x10000,v12
v_xor_b32 v13,0x10000,v13
mf v[208:211],a[228:231],v[96:99],v[208:211]
v_xor_b32 v14,0x10000,v14
v_xor_b32 v15,0x10000,v15
mf v[224:227],a[232:235],v[96:99],v[224:227]
v_xor_b32 v16,0x10000,v16
v_xor_b32 v17,0x10000,v17
mf v[224:227],a[248:251],v[112:115],v[224:227]
ds_read_b64_tr_b16 a[192:193],v10 offset:0
ds_read_b64_tr_b16 a[194:195],v10 offset:1024
mf v[240:243],a[252:255],v[112:115],v[240:243]
buffer_load_dwordx4 a[176:179],v2,s[60:63],s50 offen sc1
awr a32,0
awr a33,0
mf v[240:243],a[236:239],v[96:99],v[240:243]
awr a34,0
awr a35,0
mf v[244:247],a[236:239],v[100:103],v[244:247]
ds_read_b64_tr_b16 a[196:197],v11 offset:0
ds_read_b64_tr_b16 a[198:199],v11 offset:1024
mf v[244:247],a[252:255],v[116:119],v[244:247]
buffer_load_dwordx4 a[180:183],v2,s[60:63],s50 offen offset:1024 sc1
s_add_u32 s50,s50,4096
mf v[228:231],a[248:251],v[116:119],v[228:231]
ds_read_b64_tr_b16 a[200:201],v12 offset:0
ds_read_b64_tr_b16 a[202:203],v12 offset:1024
mf v[228:231],a[232:235],v[100:103],v[228:231]
buffer_load_dwordx4 a[184:187],v2,s[60:63],s51 offen sc1
awr a36,0
awr a37,0
mf v[212:215],a[228:231],v[100:103],v[212:215]
ds_read_b64_tr_b16 a[204:205],v13 offset:0
ds_read_b64_tr_b16 a[206:207],v13 offset:1024
mf v[212:215],a[244:247],v[116:119],v[212:215]
buffer_load_dwordx4 a[188:191],v2,s[60:63],s51 offen offset:1024 sc1
s_add_u32 s51,s51,4096
mf v[196:199],a[240:243],v[116:119],v[196:199]
s_cmp_eq_u32 s68,2
s_cselect_b32 s70,81920,0
mf v[196:199],a[224:227],v[100:103],v[196:199]
awr a38,0
awr a39,0
mf v[200:203],a[224:227],v[104:107],v[200:203]
ds_read_b64_tr_b16 a[208:209],v10 offset:8192
ds_read_b64_tr_b16 a[210:211],v10 offset:9216
mf v[200:203],a[240:243],v[120:123],v[200:203]
ds_read_b64_tr_b16 a[212:213],v11 offset:8192
ds_read_b64_tr_b16 a[214:215],v11 offset:9216
mf v[216:219],a[244:247],v[120:123],v[216:219]
s_sub_u32 s50,s50,s70
s_sub_u32 s51,s51,s70
mf v[216:219],a[228:231],v[104:107],v[216:219]
awr a40,0
awr a41,0
mf v[232:235],a[232:235],v[104:107],v[232:235]
ds_read_b64_tr_b16 a[216:217],v12 offset:8192
ds_read_b64_tr_b16 a[218:219],v12 offset:9216
mf v[232:235],a[248:251],v[120:123],v[232:235]
buffer_load_dwordx4 v27,s[72:75],s69 offen offset:1024 lds
mf v[248:251],a[252:255],v[120:123],v[248:251]
ds_read_b64_tr_b16 a[220:221],v13 offset:8192
ds_read_b64_tr_b16 a[222:223],v13 offset:9216
mf v[248:251],a[236:239],v[104:107],v[248:251]
mf v[252:255],a[236:239],v[108:111],v[252:255]
buffer_load_dwordx4 v28,s[72:75],s69 offen offset:2048 lds
mf v[252:255],a[252:255],v[124:127],v[252:255]
awr a42,0
awr a43,0
mf v[236:239],a[248:251],v[124:127],v[236:239]
awr a44,0
awr a45,0
mf v[236:239],a[232:235],v[108:111],v[236:239]
buffer_load_dwordx4 v29,s[72:75],s69 offen offset:3072 lds
mf v[220:223],a[228:231],v[108:111],v[220:223]
awr a46,0
awr a47,0
mf v[220:223],a[244:247],v[124:127],v[220:223]
mf v[204:207],a[240:243],v[124:127],v[204:207]
mf v[204:207],a[224:227],v[108:111],v[204:207]
s_waitcnt lgkmcnt(0)
s_waitcnt vmcnt(23)
mf v[128:131],a[192:195],a[128:131],v[128:131]
ds_read_b64_tr_b16 a[224:225],v14 offset:0
ds_read_b64_tr_b16 a[226:227],v14 offset:1024
s_waitcnt vmcnt(18)
mf v[128:131],a[208:211],a[144:147],v[128:131]
buffer_load_dwordx4 v[96:99],v2,s[60:63],s50 offen sc1
mf v[144:147],a[212:215],a[144:147],v[144:147]
awr a48,0
awr a49,0
mf v[144:147],a[196:199],a[128:131],v[144:147]
ds_read_b64_tr_b16 a[228:229],v15 offset:0
ds_read_b64_tr_b16 a[230:231],v15 offset:1024
mf v[160:163],a[200:203],a[128:131],v[160:163]
awr a50,0
awr a51,0
mf v[160:163],a[216:219],a[144:147],v[160:163]
mf v[176:179],a[220:223],a[144:147],v[176:179]
ds_read_b64_tr_b16 a[232:233],v16 offset:0
ds_read_b64_tr_b16 a[234:235],v16 offset:1024
mf v[176:179],a[204:207],a[128:131],v[176:179]
mf v[180:183],a[204:207],a[132:135],v[180:183]
buffer_load_dwordx4 v[100:103],v2,s[60:63],s50 offen offset:1024 sc1
s_add_u32 s50,s50,4096
s_waitcnt vmcnt(19)
mf v[180:183],a[220:223],a[148:151],v[180:183]
ds_read_b64_tr_b16 a[236:237],v17 offset:0
ds_read_b64_tr_b16 a[238:239],v17 offset:1024
mf v[164:167],a[216:219],a[148:151],v[164:167]
awr a52,0
awr a53,0
mf v[164:167],a[200:203],a[132:135],v[164:167]
buffer_load_dwordx4 v[104:107],v2,s[60:63],s51 offen sc1
mf v[148:151],a[196:199],a[132:135],v[148:151]
ds_read_b64_tr_b16 a[240:241],v14 offset:8192
ds_read_b64_tr_b16 a[242:243],v14 offset:9216
mf v[148:151],a[212:215],a[148:151],v[148:151]
awr a54,0
awr a55,0
mf v[132:135],a[208:211],a[148:151],v[132:135]
mf v[132:135],a[192:195],a[132:135],v[132:135]
mf v[136:139],a[192:195],a[136:139],v[136:139]
ds_read_b64_tr_b16 a[244:245],v15 offset:8192
ds_read_b64_tr_b16 a[246:247],v15 offset:9216
s_waitcnt vmcnt(19)
mf v[136:139],a[208:211],a[152:155],v[136:139]
buffer_load_dwordx4 v[108:111],v2,s[60:63],s51 offen offset:1024 sc1
s_add_u32 s51,s51,4096
mf v[152:155],a[212:215],a[152:155],v[152:155]
ds_read_b64_tr_b16 a[248:249],v16 offset:8192
ds_read_b64_tr_b16 a[250:251],v16 offset:9216
mf v[152:155],a[196:199],a[136:139],v[152:155]
awr a56,0
awr a57,0
mf v[168:171],a[200:203],a[136:139],v[168:171]
awr a58,0
awr a59,0
mf v[168:171],a[216:219],a[152:155],v[168:171]
ds_read_b64_tr_b16 a[252:253],v17 offset:8192
ds_read_b64_tr_b16 a[254:255],v17 offset:9216
mf v[184:187],a[220:223],a[152:155],v[184:187]
s_add_u32 m0,s57,0
s_add_u32 s69,s71,4194304
s_cmp_ge_u32 s68,1
s_cselect_b32 s79,5242880,0
s_sub_u32 s69,s69,s79
mf v[184:187],a[204:207],a[136:139],v[184:187]
mf v[188:191],a[204:207],a[140:143],v[188:191]
awr a60,0
awr a61,0
s_waitcnt vmcnt(19)
mf v[188:191],a[220:223],a[156:159],v[188:191]
mf v[172:175],a[216:219],a[156:159],v[172:175]
buffer_load_dwordx4 v26,s[72:75],s69 offen lds
mf v[172:175],a[200:203],a[140:143],v[172:175]
awr a62,0
awr a63,0
mf v[156:159],a[196:199],a[140:143],v[156:159]
mf v[156:159],a[212:215],a[156:159],v[156:159]
mf v[140:143],a[208:211],a[156:159],v[140:143]
mf v[140:143],a[192:195],a[140:143],v[140:143]
s_waitcnt lgkmcnt(0)
mf v[192:195],a[224:227],a[128:131],v[192:195]
ds_read_b64_tr_b16 a[192:193],v10 offset:16384
ds_read_b64_tr_b16 a[194:195],v10 offset:17408
mf v[192:195],a[240:243],a[144:147],v[192:195]
buffer_load_dwordx4 v[112:115],v2,s[60:63],s50 offen sc1
awr a64,0
awr a65,0
mf v[208:211],a[244:247],a[144:147],v[208:211]
s_add_u32 s64,s4,0
s_addc_u32 s65,s5,0
mf v[208:211],a[228:231],a[128:131],v[208:211]
ds_read_b64_tr_b16 a[196:197],v11 offset:16384
ds_read_b64_tr_b16 a[198:199],v11 offset:17408
mf v[224:227],a[232:235],a[128:131],v[224:227]
s_mov_b32 s66,61440
s_mov_b32 s67,0x20000
mf v[224:227],a[248:251],a[144:147],v[224:227]
buffer_load_dwordx4 v[116:119],v2,s[60:63],s50 offen offset:1024 sc1
s_add_u32 s50,s50,4096
mf v[240:243],a[252:255],a[144:147],v[240:243]
ds_read_b64_tr_b16 a[200:201],v12 offset:16384
ds_read_b64_tr_b16 a[202:203],v12 offset:17408
mf v[240:243],a[236:239],a[128:131],v[240:243]
awr a66,0
awr a67,0
mf v[244:247],a[236:239],a[132:135],v[244:247]
s_add_u32 s24,s4,65536
s_addc_u32 s25,s5,0
mf v[244:247],a[252:255],a[148:151],v[244:247]
ds_read_b64_tr_b16 a[204:205],v13 offset:16384
ds_read_b64_tr_b16 a[206:207],v13 offset:17408
mf v[228:231],a[248:251],a[148:151],v[228:231]
buffer_load_dwordx4 v[120:123],v2,s[60:63],s51 offen sc1
awr a68,0
awr a69,0
mf v[228:231],a[232:235],a[132:135],v[228:231]
s_mov_b32 s26,15360
s_mov_b32 s27,0x20000
mf v[212:215],a[228:231],a[132:135],v[212:215]
ds_read_b64_tr_b16 a[208:209],v10 offset:24576
ds_read_b64_tr_b16 a[210:211],v10 offset:25600
mf v[212:215],a[244:247],a[148:151],v[212:215]
buffer_load_dwordx4 v[124:127],v2,s[60:63],s51 offen offset:1024 sc1
s_add_u32 s51,s51,4096
mf v[196:199],a[240:243],a[148:151],v[196:199]
s_lshl_b32 s76,s2,2
s_add_u32 s76,s76,s3
mf v[196:199],a[224:227],a[132:135],v[196:199]
awr a70,0
awr a71,0
mf v[200:203],a[224:227],a[136:139],v[200:203]
ds_read_b64_tr_b16 a[212:213],v11 offset:24576
ds_read_b64_tr_b16 a[214:215],v11 offset:25600
mf v[200:203],a[240:243],a[152:155],v[200:203]
s_lshl_b32 s77,s76,6
s_add_u32 s77,s77,320
mf v[216:219],a[244:247],a[152:155],v[216:219]
ds_read_b64_tr_b16 a[216:217],v12 offset:24576
ds_read_b64_tr_b16 a[218:219],v12 offset:25600
mf v[216:219],a[228:231],a[136:139],v[216:219]
buffer_load_dwordx4 v27,s[72:75],s69 offen offset:1024 lds
awr a72,0
awr a73,0
mf v[232:235],a[232:235],a[136:139],v[232:235]
s_cmp_lt_u32 s76,10
s_cselect_b32 s77,s77,0x100000
s_cselect_b32 s78,31,0
s_cselect_b32 s46,26624,s46
mf v[232:235],a[248:251],a[152:155],v[232:235]
ds_read_b64_tr_b16 a[220:221],v13 offset:24576
ds_read_b64_tr_b16 a[222:223],v13 offset:25600
mf v[248:251],a[252:255],a[152:155],v[248:251]
buffer_load_dwordx4 v28,s[72:75],s69 offen offset:2048 lds
awr a74,0
awr a75,0
mf v[248:251],a[236:239],a[136:139],v[248:251]
mf v[252:255],a[236:239],a[140:143],v[252:255]
v_add_u32 v64,s77,v1
v_lshlrev_b32 v65,4,v64
mf v[252:255],a[252:255],a[156:159],v[252:255]
v_subrev_u32 v67,640,v64
v_cmp_gt_u32 vcc,160,v67
mf v[236:239],a[248:251],a[156:159],v[236:239]
buffer_load_dwordx4 v29,s[72:75],s69 offen offset:3072 lds
mf v[236:239],a[232:235],a[140:143],v[236:239]
v_and_b32 v19,s78,v1
v_lshlrev_b32 v19,7,v19
mf v[220:223],a[228:231],a[140:143],v[220:223]
v_cndmask_b32 v67,0,1.0,vcc
mf v[220:223],a[244:247],a[156:159],v[220:223]
awr a76,0
awr a77,0
mf v[204:207],a[240:243],a[156:159],v[204:207]
awr a78,0
awr a79,0
mf v[204:207],a[224:227],a[140:143],v[204:207]
s_waitcnt lgkmcnt(0)
s_waitcnt vmcnt(23)
mf v[128:131],a[192:195],a[160:163],v[128:131]
ds_read_b64_tr_b16 a[224:225],v14 offset:16384
ds_read_b64_tr_b16 a[226:227],v14 offset:17408
s_waitcnt vmcnt(18)
mf v[128:131],a[208:211],a[176:179],v[128:131]
buffer_load_dwordx4 a[128:131],v2,s[60:63],s50 offen sc1
buffer_load_dword v18,v19,s[8:11],s46 offen sc1
mf v[144:147],a[212:215],a[176:179],v[144:147]
awr a80,0
awr a81,0
mf v[144:147],a[196:199],a[160:163],v[144:147]
ds_read_b64_tr_b16 a[228:229],v15 offset:16384
ds_read_b64_tr_b16 a[230:231],v15 offset:17408
mf v[160:163],a[200:203],a[160:163],v[160:163]
awr a82,0
awr a83,0
mf v[160:163],a[216:219],a[176:179],v[160:163]
mf v[176:179],a[220:223],a[176:179],v[176:179]
ds_read_b64_tr_b16 a[232:233],v16 offset:16384
ds_read_b64_tr_b16 a[234:235],v16 offset:17408
mf v[176:179],a[204:207],a[160:163],v[176:179]
mf v[180:183],a[204:207],a[164:167],v[180:183]
buffer_load_dwordx4 a[132:135],v2,s[60:63],s50 offen offset:1024 sc1
s_add_u32 s50,s50,4096
s_waitcnt vmcnt(20)
mf v[180:183],a[220:223],a[180:183],v[180:183]
ds_read_b64_tr_b16 a[236:237],v17 offset:16384
ds_read_b64_tr_b16 a[238:239],v17 offset:17408
mf v[164:167],a[216:219],a[180:183],v[164:167]
awr a84,0
awr a85,0
mf v[164:167],a[200:203],a[164:167],v[164:167]
buffer_load_dwordx4 a[136:139],v2,s[60:63],s51 offen sc1
mf v[148:151],a[196:199],a[164:167],v[148:151]
ds_read_b64_tr_b16 a[240:241],v14 offset:24576
ds_read_b64_tr_b16 a[242:243],v14 offset:25600
mf v[148:151],a[212:215],a[180:183],v[148:151]
awr a86,0
awr a87,0
mf v[132:135],a[208:211],a[180:183],v[132:135]
mf v[132:135],a[192:195],a[164:167],v[132:135]
mf v[136:139],a[192:195],a[168:171],v[136:139]
ds_read_b64_tr_b16 a[244:245],v15 offset:24576
ds_read_b64_tr_b16 a[246:247],v15 offset:25600
s_waitcnt vmcnt(20)
mf v[136:139],a[208:211],a[184:187],v[136:139]
buffer_load_dwordx4 a[140:143],v2,s[60:63],s51 offen offset:1024 sc1
s_add_u32 s51,s51,4096
mf v[152:155],a[212:215],a[184:187],v[152:155]
ds_read_b64_tr_b16 a[248:249],v16 offset:24576
ds_read_b64_tr_b16 a[250:251],v16 offset:25600
mf v[152:155],a[196:199],a[168:171],v[152:155]
awr a88,0
awr a89,0
mf v[168:171],a[200:203],a[168:171],v[168:171]
awr a90,0
awr a91,0
mf v[168:171],a[216:219],a[184:187],v[168:171]
ds_read_b64_tr_b16 a[252:253],v17 offset:24576
ds_read_b64_tr_b16 a[254:255],v17 offset:25600
mf v[184:187],a[220:223],a[184:187],v[184:187]
s_add_u32 m0,s57,16384
s_add_u32 s69,s71,4718592
s_cmp_ge_u32 s68,1
s_cselect_b32 s79,5242880,0
s_sub_u32 s69,s69,s79
mf v[184:187],a[204:207],a[168:171],v[184:187]
mf v[188:191],a[204:207],a[172:175],v[188:191]
awr a92,0
awr a93,0
s_waitcnt vmcnt(20)
mf v[188:191],a[220:223],a[188:191],v[188:191]
mf v[172:175],a[216:219],a[188:191],v[172:175]
buffer_load_dwordx4 v26,s[72:75],s69 offen lds
mf v[172:175],a[200:203],a[172:175],v[172:175]
awr a94,0
awr a95,0
mf v[156:159],a[196:199],a[172:175],v[156:159]
mf v[156:159],a[212:215],a[188:191],v[156:159]
mf v[140:143],a[208:211],a[188:191],v[140:143]
mf v[140:143],a[192:195],a[172:175],v[140:143]
s_waitcnt lgkmcnt(0)
mf v[192:195],a[224:227],a[160:163],v[192:195]
s_waitcnt vmcnt(18)
s_barrier
mf v[192:195],a[240:243],a[176:179],v[192:195]
ds_read_b64_tr_b16 a[192:193],v10 offset:32768
ds_read_b64_tr_b16 a[194:195],v10 offset:33792
mf v[208:211],a[244:247],a[176:179],v[208:211]
buffer_load_dwordx4 a[144:147],v2,s[60:63],s50 offen sc1
mf v[208:211],a[228:231],a[160:163],v[208:211]
awr a96,0
awr a97,0
mf v[224:227],a[232:235],a[160:163],v[224:227]
ds_read_b64_tr_b16 a[196:197],v11 offset:32768
ds_read_b64_tr_b16 a[198:199],v11 offset:33792
mf v[224:227],a[248:251],a[176:179],v[224:227]
buffer_load_dwordx4 a[148:151],v2,s[60:63],s50 offen offset:1024 sc1
s_add_u32 s50,s50,4096
mf v[240:243],a[252:255],a[176:179],v[240:243]
awr a98,0
awr a99,0
mf v[240:243],a[236:239],a[160:163],v[240:243]
buffer_load_dwordx4 a[152:155],v2,s[60:63],s51 offen sc1
mf v[244:247],a[236:239],a[164:167],v[244:247]
ds_read_b64_tr_b16 a[200:201],v12 offset:32768
ds_read_b64_tr_b16 a[202:203],v12 offset:33792
mf v[244:247],a[252:255],a[180:183],v[244:247]
awr a100,0
awr a101,0
mf v[228:231],a[248:251],a[180:183],v[228:231]
ds_read_b64_tr_b16 a[204:205],v13 offset:32768
ds_read_b64_tr_b16 a[206:207],v13 offset:33792
mf v[228:231],a[232:235],a[164:167],v[228:231]
buffer_load_dwordx4 a[156:159],v2,s[60:63],s51 offen offset:1024 sc1
s_add_u32 s51,s51,4096
mf v[212:215],a[228:231],a[164:167],v[212:215]
awr a102,0
awr a103,0
mf v[212:215],a[244:247],a[180:183],v[212:215]
ds_read_b64_tr_b16 a[208:209],v10 offset:40960
ds_read_b64_tr_b16 a[210:211],v10 offset:41984
mf v[196:199],a[240:243],a[180:183],v[196:199]
s_cmp_eq_u32 s68,1
s_cselect_b32 s70,81920,0
mf v[196:199],a[224:227],a[164:167],v[196:199]
mf v[200:203],a[224:227],a[168:171],v[200:203]
ds_read_b64_tr_b16 a[212:213],v11 offset:40960
ds_read_b64_tr_b16 a[214:215],v11 offset:41984
mf v[200:203],a[240:243],a[184:187],v[200:203]
s_sub_u32 s50,s50,s70
s_sub_u32 s51,s51,s70
mf v[216:219],a[244:247],a[184:187],v[216:219]
awr a104,0
awr a105,0
mf v[216:219],a[228:231],a[168:171],v[216:219]
ds_read_b64_tr_b16 a[216:217],v12 offset:40960
ds_read_b64_tr_b16 a[218:219],v12 offset:41984
mf v[232:235],a[232:235],a[168:171],v[232:235]
awr a106,0
awr a107,0
mf v[232:235],a[248:251],a[184:187],v[232:235]
buffer_load_dwordx4 v27,s[72:75],s69 offen offset:1024 lds
mf v[248:251],a[252:255],a[184:187],v[248:251]
ds_read_b64_tr_b16 a[220:221],v13 offset:40960
ds_read_b64_tr_b16 a[222:223],v13 offset:41984
mf v[248:251],a[236:239],a[168:171],v[248:251]
mf v[252:255],a[236:239],a[172:175],v[252:255]
buffer_load_dwordx4 v28,s[72:75],s69 offen offset:2048 lds
mf v[252:255],a[252:255],a[188:191],v[252:255]
awr a108,0
awr a109,0
mf v[236:239],a[248:251],a[188:191],v[236:239]
mf v[236:239],a[232:235],a[172:175],v[236:239]
buffer_load_dwordx4 v29,s[72:75],s69 offen offset:3072 lds
mf v[220:223],a[228:231],a[172:175],v[220:223]
awr a110,0
awr a111,0
mf v[220:223],a[244:247],a[188:191],v[220:223]
mf v[204:207],a[240:243],a[188:191],v[204:207]
mf v[204:207],a[224:227],a[172:175],v[204:207]
s_waitcnt lgkmcnt(0)
s_waitcnt vmcnt(24)
mf v[128:131],a[192:195],v[96:99],v[128:131]
ds_read_b64_tr_b16 a[224:225],v14 offset:32768
ds_read_b64_tr_b16 a[226:227],v14 offset:33792
s_waitcnt vmcnt(19)
mf v[128:131],a[208:211],v[112:115],v[128:131]
buffer_load_dwordx4 a[160:163],v2,s[60:63],s50 offen sc1
mf v[144:147],a[212:215],v[112:115],v[144:147]
s_getpc_b64 s[72:73]
ct2:
s_add_u32 s72,s72,Lkv_chk-ct2
s_addc_u32 s73,s73,0
mf v[144:147],a[196:199],v[96:99],v[144:147]
ds_read_b64_tr_b16 a[228:229],v15 offset:32768
ds_read_b64_tr_b16 a[230:231],v15 offset:33792
mf v[160:163],a[200:203],v[96:99],v[160:163]
awr a112,0
awr a113,0
mf v[160:163],a[216:219],v[112:115],v[160:163]
awr a114,0
awr a115,0
mf v[176:179],a[220:223],v[112:115],v[176:179]
ds_read_b64_tr_b16 a[232:233],v16 offset:32768
ds_read_b64_tr_b16 a[234:235],v16 offset:33792
mf v[176:179],a[204:207],v[96:99],v[176:179]
mf v[180:183],a[204:207],v[100:103],v[180:183]
buffer_load_dwordx4 a[164:167],v2,s[60:63],s50 offen offset:1024 sc1
s_add_u32 s50,s50,4096
s_waitcnt vmcnt(20)
mf v[180:183],a[220:223],v[116:119],v[180:183]
ds_read_b64_tr_b16 a[236:237],v17 offset:32768
ds_read_b64_tr_b16 a[238:239],v17 offset:33792
mf v[164:167],a[216:219],v[116:119],v[164:167]
s_mov_b32 s74,code_end-Lkv_chk
s_mov_b32 s75,0x20000
mf v[164:167],a[200:203],v[100:103],v[164:167]
awr a116,0
awr a117,0
mf v[148:151],a[196:199],v[100:103],v[148:151]
ds_read_b64_tr_b16 a[240:241],v14 offset:40960
ds_read_b64_tr_b16 a[242:243],v14 offset:41984
mf v[148:151],a[212:215],v[116:119],v[148:151]
s_bfe_u32 s76,s2,0x50003
s_lshl_b32 s76,s76,2
mf v[132:135],a[208:211],v[116:119],v[132:135]
awr a118,0
awr a119,0
mf v[132:135],a[192:195],v[100:103],v[132:135]
mf v[136:139],a[192:195],v[104:107],v[136:139]
ds_read_b64_tr_b16 a[244:245],v15 offset:40960
ds_read_b64_tr_b16 a[246:247],v15 offset:41984
s_waitcnt vmcnt(19)
mf v[136:139],a[208:211],v[120:123],v[136:139]
buffer_load_dwordx4 a[168:171],v2,s[60:63],s51 offen sc1
mf v[152:155],a[212:215],v[120:123],v[152:155]
ds_read_b64_tr_b16 a[248:249],v16 offset:40960
ds_read_b64_tr_b16 a[250:251],v16 offset:41984
mf v[152:155],a[196:199],v[104:107],v[152:155]
s_add_u32 s76,s76,s3
s_lshl_b32 s76,s76,7
mf v[168:171],a[200:203],v[104:107],v[168:171]
awr a120,0
awr a121,0
mf v[168:171],a[216:219],v[120:123],v[168:171]
ds_read_b64_tr_b16 a[252:253],v17 offset:40960
ds_read_b64_tr_b16 a[254:255],v17 offset:41984
mf v[184:187],a[220:223],v[120:123],v[184:187]
awr a122,0
awr a123,0
mf v[184:187],a[204:207],v[104:107],v[184:187]
mf v[188:191],a[204:207],v[108:111],v[188:191]
buffer_load_dwordx4 a[172:175],v2,s[60:63],s51 offen offset:1024 sc1
s_add_u32 s51,s51,4096
s_waitcnt vmcnt(20)
mf v[188:191],a[220:223],v[124:127],v[188:191]
v_lshlrev_b32 v20,14,v1
buffer_load_dword v21,v20,s[72:75],s76 offen
mf v[172:175],a[216:219],v[124:127],v[172:175]
awr a124,0
awr a125,0
mf v[172:175],a[200:203],v[108:111],v[172:175]
awr a126,0
awr a127,0
mf v[156:159],a[196:199],v[108:111],v[156:159]
mf v[156:159],a[212:215],v[124:127],v[156:159]
mf v[140:143],a[208:211],v[124:127],v[140:143]
mf v[140:143],a[192:195],v[108:111],v[140:143]
s_waitcnt lgkmcnt(0)
Lkv_chk:
s_waitcnt vmcnt(16)
v_cmp_ne_u32 vcc,32,v18
s_nop 0
s_cbranch_vccnz Lkv_spin
mf v[192:195],a[224:227],v[96:99],v[192:195]
ds_read_b64_tr_b16 a[192:193],v10 offset:49152
ds_read_b64_tr_b16 a[194:195],v10 offset:50176
mf v[192:195],a[240:243],v[112:115],v[192:195]
buffer_load_dwordx4 a[176:179],v2,s[60:63],s50 offen sc1
mf v[208:211],a[244:247],v[112:115],v[208:211]
s_mov_b32 s76,0
buffer_load_dwordx4 v[68:71],v65,s[64:67],s76 offen sc1
mf v[208:211],a[228:231],v[96:99],v[208:211]
ds_read_b64_tr_b16 a[196:197],v11 offset:49152
ds_read_b64_tr_b16 a[198:199],v11 offset:50176
mf v[224:227],a[232:235],v[96:99],v[224:227]
mf v[224:227],a[248:251],v[112:115],v[224:227]
mf v[240:243],a[252:255],v[112:115],v[240:243]
ds_read_b64_tr_b16 a[200:201],v12 offset:49152
ds_read_b64_tr_b16 a[202:203],v12 offset:50176
mf v[240:243],a[236:239],v[96:99],v[240:243]
mf v[244:247],a[236:239],v[100:103],v[244:247]
buffer_load_dwordx4 a[180:183],v2,s[60:63],s50 offen offset:1024 sc1
s_add_u32 s50,s50,4096
mf v[244:247],a[252:255],v[116:119],v[244:247]
ds_read_b64_tr_b16 a[204:205],v13 offset:49152
ds_read_b64_tr_b16 a[206:207],v13 offset:50176
mf v[228:231],a[248:251],v[116:119],v[228:231]
s_mov_b32 s76,15360
buffer_load_dwordx4 v[72:75],v65,s[64:67],s76 offen sc1
mf v[228:231],a[232:235],v[100:103],v[228:231]
buffer_load_dwordx4 a[184:187],v2,s[60:63],s51 offen sc1
mf v[212:215],a[228:231],v[100:103],v[212:215]
ds_read_b64_tr_b16 a[208:209],v10 offset:57344
ds_read_b64_tr_b16 a[210:211],v10 offset:58368
mf v[212:215],a[244:247],v[116:119],v[212:215]
mf v[196:199],a[240:243],v[116:119],v[196:199]
mf v[196:199],a[224:227],v[100:103],v[196:199]
mf v[200:203],a[224:227],v[104:107],v[200:203]
ds_read_b64_tr_b16 a[212:213],v11 offset:57344
ds_read_b64_tr_b16 a[214:215],v11 offset:58368
mf v[200:203],a[240:243],v[120:123],v[200:203]
buffer_load_dwordx4 a[188:191],v2,s[60:63],s51 offen offset:1024 sc1
s_add_u32 s51,s51,4096
mf v[216:219],a[244:247],v[120:123],v[216:219]
ds_read_b64_tr_b16 a[216:217],v12 offset:57344
ds_read_b64_tr_b16 a[218:219],v12 offset:58368
mf v[216:219],a[228:231],v[104:107],v[216:219]
s_mov_b32 s76,30720
buffer_load_dwordx4 v[76:79],v65,s[64:67],s76 offen sc1
mf v[232:235],a[232:235],v[104:107],v[232:235]
mf v[232:235],a[248:251],v[120:123],v[232:235]
ds_read_b64_tr_b16 a[220:221],v13 offset:57344
ds_read_b64_tr_b16 a[222:223],v13 offset:58368
mf v[248:251],a[252:255],v[120:123],v[248:251]
s_add_u32 m0,s57,32768
mf v[248:251],a[236:239],v[104:107],v[248:251]
mf v[252:255],a[236:239],v[108:111],v[252:255]
s_mov_b32 s76,46080
buffer_load_dwordx4 v[80:83],v65,s[64:67],s76 offen sc1
mf v[252:255],a[252:255],v[124:127],v[252:255]
mf v[236:239],a[248:251],v[124:127],v[236:239]
buffer_load_dwordx4 v2,s[16:19],s40 offen sc1 lds
mf v[236:239],a[232:235],v[108:111],v[236:239]
mf v[220:223],a[228:231],v[108:111],v[220:223]
mf v[220:223],a[244:247],v[124:127],v[220:223]
mf v[204:207],a[240:243],v[124:127],v[204:207]
mf v[204:207],a[224:227],v[108:111],v[204:207]
s_waitcnt lgkmcnt(0)
mf v[128:131],a[192:195],a[128:131],v[128:131]
ds_read_b64_tr_b16 a[224:225],v14 offset:49152
ds_read_b64_tr_b16 a[226:227],v14 offset:50176
s_waitcnt vmcnt(20)
mf v[128:131],a[208:211],a[144:147],v[128:131]
buffer_load_dwordx4 v[96:99],v2,s[60:63],s50 offen sc1
mf v[144:147],a[212:215],a[144:147],v[144:147]
mf v[144:147],a[196:199],a[128:131],v[144:147]
ds_read_b64_tr_b16 a[228:229],v15 offset:49152
ds_read_b64_tr_b16 a[230:231],v15 offset:50176
mf v[160:163],a[200:203],a[128:131],v[160:163]
mf v[160:163],a[216:219],a[144:147],v[160:163]
buffer_load_dwordx4 v[100:103],v2,s[60:63],s50 offen offset:1024 sc1
s_add_u32 s50,s50,4096
mf v[176:179],a[220:223],a[144:147],v[176:179]
ds_read_b64_tr_b16 a[232:233],v16 offset:49152
ds_read_b64_tr_b16 a[234:235],v16 offset:50176
mf v[176:179],a[204:207],a[128:131],v[176:179]
mf v[180:183],a[204:207],a[132:135],v[180:183]
s_waitcnt vmcnt(21)
mf v[180:183],a[220:223],a[148:151],v[180:183]
ds_read_b64_tr_b16 a[236:237],v17 offset:49152
ds_read_b64_tr_b16 a[238:239],v17 offset:50176
mf v[164:167],a[216:219],a[148:151],v[164:167]
buffer_load_dwordx4 v[104:107],v2,s[60:63],s51 offen sc1
mf v[164:167],a[200:203],a[132:135],v[164:167]
mf v[148:151],a[196:199],a[132:135],v[148:151]
ds_read_b64_tr_b16 a[240:241],v14 offset:57344
ds_read_b64_tr_b16 a[242:243],v14 offset:58368
mf v[148:151],a[212:215],a[148:151],v[148:151]
buffer_load_dwordx4 v[108:111],v2,s[60:63],s51 offen offset:1024 sc1
s_add_u32 s51,s51,4096
mf v[132:135],a[208:211],a[148:151],v[132:135]
mf v[132:135],a[192:195],a[132:135],v[132:135]
mf v[136:139],a[192:195],a[136:139],v[136:139]
ds_read_b64_tr_b16 a[244:245],v15 offset:57344
ds_read_b64_tr_b16 a[246:247],v15 offset:58368
s_waitcnt vmcnt(22)
mf v[136:139],a[208:211],a[152:155],v[136:139]
mf v[152:155],a[212:215],a[152:155],v[152:155]
ds_read_b64_tr_b16 a[248:249],v16 offset:57344
ds_read_b64_tr_b16 a[250:251],v16 offset:58368
mf v[152:155],a[196:199],a[136:139],v[152:155]
buffer_load_dwordx4 v2,s[16:19],s40 offen offset:1024 sc1 lds
mf v[168:171],a[200:203],a[136:139],v[168:171]
mf v[168:171],a[216:219],a[152:155],v[168:171]
ds_read_b64_tr_b16 a[252:253],v17 offset:57344
ds_read_b64_tr_b16 a[254:255],v17 offset:58368
mf v[184:187],a[220:223],a[152:155],v[184:187]
buffer_load_dwordx4 v2,s[16:19],s40 offen offset:2048 sc1 lds
mf v[184:187],a[204:207],a[136:139],v[184:187]
mf v[188:191],a[204:207],a[140:143],v[188:191]
s_waitcnt vmcnt(23)
mf v[188:191],a[220:223],a[156:159],v[188:191]
mf v[172:175],a[216:219],a[156:159],v[172:175]
buffer_load_dwordx4 v2,s[16:19],s40 offen offset:3072 sc1 lds
mf v[172:175],a[200:203],a[140:143],v[172:175]
mf v[156:159],a[196:199],a[140:143],v[156:159]
mf v[156:159],a[212:215],a[156:159],v[156:159]
mf v[140:143],a[208:211],a[156:159],v[140:143]
mf v[140:143],a[192:195],a[140:143],v[140:143]
s_waitcnt lgkmcnt(0)
mf v[192:195],a[224:227],a[128:131],v[192:195]
s_waitcnt vmcnt(21)
s_barrier
mf v[192:195],a[240:243],a[144:147],v[192:195]
v_xor_b32 v10,0x10000,v10
v_xor_b32 v11,0x10000,v11
mf v[208:211],a[244:247],a[144:147],v[208:211]
v_xor_b32 v12,0x10000,v12
v_xor_b32 v13,0x10000,v13
mf v[208:211],a[228:231],a[128:131],v[208:211]
v_xor_b32 v14,0x10000,v14
v_xor_b32 v15,0x10000,v15
mf v[224:227],a[232:235],a[128:131],v[224:227]
v_xor_b32 v16,0x10000,v16
v_xor_b32 v17,0x10000,v17
mf v[224:227],a[248:251],a[144:147],v[224:227]
ds_read_b64_tr_b16 a[192:193],v10 offset:0
ds_read_b64_tr_b16 a[194:195],v10 offset:1024
mf v[240:243],a[252:255],a[144:147],v[240:243]
buffer_load_dwordx4 v[112:115],v2,s[60:63],s50 offen sc1
s_waitcnt vmcnt(13)
v_add_f32 v68,v68,v72
s_waitcnt vmcnt(9)
v_add_f32 v76,v76,v80
mf v[240:243],a[236:239],a[128:131],v[240:243]
v_add_f32 v69,v69,v73
v_add_f32 v77,v77,v81
mf v[244:247],a[236:239],a[132:135],v[244:247]
ds_read_b64_tr_b16 a[196:197],v11 offset:0
ds_read_b64_tr_b16 a[198:199],v11 offset:1024
mf v[244:247],a[252:255],a[148:151],v[244:247]
buffer_load_dwordx4 v[116:119],v2,s[60:63],s50 offen offset:1024 sc1
s_add_u32 s50,s50,4096
mf v[228:231],a[248:251],a[148:151],v[228:231]
ds_read_b64_tr_b16 a[200:201],v12 offset:0
ds_read_b64_tr_b16 a[202:203],v12 offset:1024
mf v[228:231],a[232:235],a[132:135],v[228:231]
buffer_load_dwordx4 v[120:123],v2,s[60:63],s51 offen sc1
mf v[212:215],a[228:231],a[132:135],v[212:215]
ds_read_b64_tr_b16 a[204:205],v13 offset:0
ds_read_b64_tr_b16 a[206:207],v13 offset:1024
mf v[212:215],a[244:247],a[148:151],v[212:215]
buffer_load_dwordx4 v[124:127],v2,s[60:63],s51 offen offset:1024 sc1
s_add_u32 s51,s51,4096
mf v[196:199],a[240:243],a[148:151],v[196:199]
v_add_f32 v70,v70,v74
v_add_f32 v78,v78,v82
mf v[196:199],a[224:227],a[132:135],v[196:199]
mf v[200:203],a[224:227],a[136:139],v[200:203]
ds_read_b64_tr_b16 a[208:209],v10 offset:8192
ds_read_b64_tr_b16 a[210:211],v10 offset:9216
mf v[200:203],a[240:243],a[152:155],v[200:203]
ds_read_b64_tr_b16 a[212:213],v11 offset:8192
ds_read_b64_tr_b16 a[214:215],v11 offset:9216
mf v[216:219],a[244:247],a[152:155],v[216:219]
s_add_u32 m0,s57,49152
mf v[216:219],a[228:231],a[136:139],v[216:219]
v_add_f32 v71,v71,v75
v_add_f32 v79,v79,v83
mf v[232:235],a[232:235],a[136:139],v[232:235]
ds_read_b64_tr_b16 a[216:217],v12 offset:8192
ds_read_b64_tr_b16 a[218:219],v12 offset:9216
mf v[232:235],a[248:251],a[152:155],v[232:235]
v_add_f32 v68,v68,v76
v_add_f32 v69,v69,v77
mf v[248:251],a[252:255],a[152:155],v[248:251]
ds_read_b64_tr_b16 a[220:221],v13 offset:8192
ds_read_b64_tr_b16 a[222:223],v13 offset:9216
mf v[248:251],a[236:239],a[136:139],v[248:251]
buffer_load_dwordx4 v2,s[16:19],s41 offen sc1 lds
mf v[252:255],a[236:239],a[140:143],v[252:255]
v_add_f32 v70,v70,v78
v_add_f32 v71,v71,v79
mf v[252:255],a[252:255],a[156:159],v[252:255]
mf v[236:239],a[248:251],a[156:159],v[236:239]
buffer_load_dwordx4 v2,s[16:19],s41 offen offset:1024 sc1 lds
mf v[236:239],a[232:235],a[140:143],v[236:239]
cvt v72,v68,v69
cvt v73,v70,v71
mf v[220:223],a[228:231],a[140:143],v[220:223]
mf v[220:223],a[244:247],a[156:159],v[220:223]
mf v[204:207],a[240:243],a[156:159],v[204:207]
mf v[204:207],a[224:227],a[140:143],v[204:207]
s_waitcnt lgkmcnt(0)
mf v[128:131],a[192:195],a[160:163],v[128:131]
ds_read_b64_tr_b16 a[224:225],v14 offset:0
ds_read_b64_tr_b16 a[226:227],v14 offset:1024
mf v[128:131],a[208:211],a[176:179],v[128:131]
buffer_load_dwordx4 v2,s[16:19],s41 offen offset:2048 sc1 lds
mf v[144:147],a[212:215],a[176:179],v[144:147]
v_lshlrev_b32 v68,16,v72
v_and_b32 v69,0xffff0000,v72
mf v[144:147],a[196:199],a[160:163],v[144:147]
ds_read_b64_tr_b16 a[228:229],v15 offset:0
ds_read_b64_tr_b16 a[230:231],v15 offset:1024
mf v[160:163],a[200:203],a[160:163],v[160:163]
v_lshlrev_b32 v70,16,v73
v_and_b32 v71,0xffff0000,v73
mf v[160:163],a[216:219],a[176:179],v[160:163]
v_add_f32 v68,v67,v68
v_add_f32 v69,v67,v69
mf v[176:179],a[220:223],a[176:179],v[176:179]
ds_read_b64_tr_b16 a[232:233],v16 offset:0
ds_read_b64_tr_b16 a[234:235],v16 offset:1024
mf v[176:179],a[204:207],a[160:163],v[176:179]
mf v[180:183],a[204:207],a[164:167],v[180:183]
v_add_f32 v70,v67,v70
v_add_f32 v71,v67,v71
mf v[180:183],a[220:223],a[180:183],v[180:183]
ds_read_b64_tr_b16 a[236:237],v17 offset:0
ds_read_b64_tr_b16 a[238:239],v17 offset:1024
mf v[164:167],a[216:219],a[180:183],v[164:167]
cvt v72,v68,v69
cvt v73,v70,v71
mf v[164:167],a[200:203],a[164:167],v[164:167]
buffer_load_dwordx4 v2,s[16:19],s41 offen offset:3072 sc1 lds
mf v[148:151],a[196:199],a[164:167],v[148:151]
ds_read_b64_tr_b16 a[240:241],v14 offset:8192
ds_read_b64_tr_b16 a[242:243],v14 offset:9216
mf v[148:151],a[212:215],a[180:183],v[148:151]
v_lshlrev_b32 v68,16,v72
v_and_b32 v69,0xffff0000,v72
mf v[132:135],a[208:211],a[180:183],v[132:135]
v_lshlrev_b32 v70,16,v73
v_and_b32 v71,0xffff0000,v73
mf v[132:135],a[192:195],a[164:167],v[132:135]
mf v[136:139],a[192:195],a[168:171],v[136:139]
ds_read_b64_tr_b16 a[244:245],v15 offset:8192
ds_read_b64_tr_b16 a[246:247],v15 offset:9216
mf v[136:139],a[208:211],a[184:187],v[136:139]
buffer_store_dwordx4 v[68:71],v65,s[24:27],0 offen sc1
s_lshr_b32 s63,s2,5
mf v[152:155],a[212:215],a[184:187],v[152:155]
ds_read_b64_tr_b16 a[248:249],v16 offset:8192
ds_read_b64_tr_b16 a[250:251],v16 offset:9216
mf v[152:155],a[196:199],a[168:171],v[152:155]
s_sub_u32 s45,7,s63
mf v[168:171],a[200:203],a[168:171],v[168:171]
s_bitcmp1_b32 s2,0
s_cselect_b32 s59,s45,s63
s_cselect_b32 s46,4,0
s_cselect_b32 s50,8,0
mf v[168:171],a[216:219],a[184:187],v[168:171]
ds_read_b64_tr_b16 a[252:253],v17 offset:8192
ds_read_b64_tr_b16 a[254:255],v17 offset:9216
mf v[184:187],a[220:223],a[184:187],v[184:187]
s_add_u32 s40,s40,16384
mf v[184:187],a[204:207],a[168:171],v[184:187]
mf v[188:191],a[204:207],a[172:175],v[188:191]
s_add_u32 s50,s50,s63
s_lshl_b32 s63,s59,5
mf v[188:191],a[220:223],a[188:191],v[188:191]
s_bfe_u32 s45,s2,0x20001
s_lshl_b32 s59,s45,1
mf v[172:175],a[216:219],a[188:191],v[172:175]
s_add_u32 s63,s63,s59
s_lshl_b32 s63,s63,2
mf v[172:175],a[200:203],a[172:175],v[172:175]
s_add_u32 s63,s63,s3
s_lshl_b32 s63,s63,7
mf v[156:159],a[196:199],a[172:175],v[156:159]
s_add_u32 s63,s63,s46
mf v[156:159],a[212:215],a[188:191],v[156:159]
mf v[140:143],a[208:211],a[188:191],v[140:143]
mf v[140:143],a[192:195],a[172:175],v[140:143]
s_waitcnt lgkmcnt(0)
mf v[192:195],a[224:227],a[160:163],v[192:195]
ds_read_b64_tr_b16 a[192:193],v10 offset:16384
ds_read_b64_tr_b16 a[194:195],v10 offset:17408
mf v[192:195],a[240:243],a[176:179],v[192:195]
s_add_u32 m0,s57,65536
mf v[208:211],a[244:247],a[176:179],v[208:211]
s_add_u32 s63,s63,81920
s_lshr_b32 s46,s3,1
mf v[208:211],a[228:231],a[160:163],v[208:211]
ds_read_b64_tr_b16 a[196:197],v11 offset:16384
ds_read_b64_tr_b16 a[198:199],v11 offset:17408
mf v[224:227],a[232:235],a[160:163],v[224:227]
buffer_load_dwordx4 v2,s[16:19],s40 offen sc1 lds
mf v[224:227],a[248:251],a[176:179],v[224:227]
s_lshl_b32 s50,s50,1
s_add_u32 s50,s50,s46
mf v[240:243],a[252:255],a[176:179],v[240:243]
ds_read_b64_tr_b16 a[200:201],v12 offset:16384
ds_read_b64_tr_b16 a[202:203],v12 offset:17408
mf v[240:243],a[236:239],a[160:163],v[240:243]
buffer_load_dwordx4 v2,s[16:19],s40 offen offset:1024 sc1 lds
mf v[244:247],a[236:239],a[164:167],v[244:247]
s_lshl_b32 s50,s50,7
s_lshl_b32 s51,s45,5
mf v[244:247],a[252:255],a[180:183],v[244:247]
ds_read_b64_tr_b16 a[204:205],v13 offset:16384
ds_read_b64_tr_b16 a[206:207],v13 offset:17408
mf v[228:231],a[248:251],a[180:183],v[228:231]
buffer_load_dwordx4 v2,s[16:19],s40 offen offset:2048 sc1 lds
mf v[228:231],a[232:235],a[164:167],v[228:231]
buffer_load_dwordx4 v2,s[16:19],s40 offen offset:3072 sc1 lds
mf v[212:215],a[228:231],a[164:167],v[212:215]
ds_read_b64_tr_b16 a[208:209],v10 offset:24576
ds_read_b64_tr_b16 a[210:211],v10 offset:25600
mf v[212:215],a[244:247],a[180:183],v[212:215]
s_add_u32 s50,s50,s51
s_lshl_b32 s50,s50,12
mf v[196:199],a[240:243],a[180:183],v[196:199]
s_add_u32 m0,s57,81920
mf v[196:199],a[224:227],a[164:167],v[196:199]
mf v[200:203],a[224:227],a[168:171],v[200:203]
ds_read_b64_tr_b16 a[212:213],v11 offset:24576
ds_read_b64_tr_b16 a[214:215],v11 offset:25600
mf v[200:203],a[240:243],a[184:187],v[200:203]
buffer_load_dwordx4 v0,s[16:19],s40 offen sc1 lds
mf v[216:219],a[244:247],a[184:187],v[216:219]
ds_read_b64_tr_b16 a[216:217],v12 offset:24576
ds_read_b64_tr_b16 a[218:219],v12 offset:25600
mf v[216:219],a[228:231],a[168:171],v[216:219]
s_and_b32 s59,s3,1
s_add_u32 s51,s51,s59
mf v[232:235],a[232:235],a[168:171],v[232:235]
buffer_load_dwordx4 v0,s[16:19],s40 offen offset:1024 sc1 lds
mf v[232:235],a[248:251],a[184:187],v[232:235]
ds_read_b64_tr_b16 a[220:221],v13 offset:24576
ds_read_b64_tr_b16 a[222:223],v13 offset:25600
mf v[248:251],a[252:255],a[184:187],v[248:251]
buffer_load_dwordx4 v0,s[16:19],s40 offen offset:2048 sc1 lds
mf v[248:251],a[236:239],a[168:171],v[248:251]
mf v[252:255],a[236:239],a[172:175],v[252:255]
s_lshl_b32 s52,s59,1
s_add_u32 s52,s52,s46
mf v[252:255],a[252:255],a[188:191],v[252:255]
buffer_load_dwordx4 v0,s[16:19],s40 offen offset:3072 sc1 lds
mf v[236:239],a[248:251],a[188:191],v[236:239]
s_mul_i32 s52,s52,5120
s_lshl_b32 s59,s59,11
mf v[236:239],a[232:235],a[172:175],v[236:239]
s_add_u32 s50,s50,s59
s_lshl_b32 s51,s51,3
mf v[220:223],a[228:231],a[172:175],v[220:223]
s_add_u32 s40,s40,32768
mf v[220:223],a[244:247],a[188:191],v[220:223]
s_add_u32 s51,s51,s46
s_bfe_u32 s59,s2,0x20003
mf v[204:207],a[240:243],a[188:191],v[204:207]
s_lshl_b32 s59,s59,1
s_add_u32 s51,s51,s59
s_mul_i32 s51,s51,5120
s_lshl_b32 s60,s13,1
s_lshr_b32 s59,s3,1
s_add_u32 s60,s60,s59
s_lshl_b32 s60,s60,7
s_lshl_b32 s59,s14,2
s_add_u32 s60,s60,s59
s_lshl_b32 s60,s60,12
s_and_b32 s59,s3,1
s_lshl_b32 s59,s59,11
s_add_u32 s60,s60,s59
s_lshl_b32 s61,s15,1
s_lshr_b32 s59,s3,1
s_add_u32 s61,s61,s59
s_lshl_b32 s61,s61,7
s_lshl_b32 s59,s14,2
s_add_u32 s61,s61,s59
s_lshl_b32 s61,s61,12
s_and_b32 s59,s3,1
s_lshl_b32 s59,s59,11
s_add_u32 s61,s61,s59
mf v[204:207],a[224:227],a[172:175],v[204:207]
s_waitcnt lgkmcnt(0)
s_waitcnt vmcnt(23)
mf v[128:131],a[192:195],v[96:99],v[128:131]
ds_read_b64_tr_b16 a[224:225],v14 offset:16384
ds_read_b64_tr_b16 a[226:227],v14 offset:17408
s_waitcnt vmcnt(16)
mf v[128:131],a[208:211],v[112:115],v[128:131]
s_add_u32 m0,s57,98304
mf v[144:147],a[212:215],v[112:115],v[144:147]
s_lshl_b32 s48,s2,2
s_add_u32 s48,s48,s3
mf v[144:147],a[196:199],v[96:99],v[144:147]
ds_read_b64_tr_b16 a[228:229],v15 offset:16384
ds_read_b64_tr_b16 a[230:231],v15 offset:17408
mf v[160:163],a[200:203],v[96:99],v[160:163]
buffer_load_dwordx4 v2,s[16:19],s40 offen sc1 lds
mf v[160:163],a[216:219],v[112:115],v[160:163]
s_lshl_b32 s48,s48,7
s_add_u32 s24,s48,81920
mf v[176:179],a[220:223],v[112:115],v[176:179]
ds_read_b64_tr_b16 a[232:233],v16 offset:16384
ds_read_b64_tr_b16 a[234:235],v16 offset:17408
mf v[176:179],a[204:207],v[96:99],v[176:179]
buffer_load_dwordx4 v2,s[16:19],s40 offen offset:1024 sc1 lds
mf v[180:183],a[204:207],v[100:103],v[180:183]
s_add_u32 s49,s24,4
s_mov_b32 s26,0x100000
s_waitcnt vmcnt(17)
mf v[180:183],a[220:223],v[116:119],v[180:183]
ds_read_b64_tr_b16 a[236:237],v17 offset:16384
ds_read_b64_tr_b16 a[238:239],v17 offset:17408
mf v[164:167],a[216:219],v[116:119],v[164:167]
buffer_load_dwordx4 v2,s[16:19],s40 offen offset:2048 sc1 lds
mf v[164:167],a[200:203],v[100:103],v[164:167]
buffer_load_dwordx4 v2,s[16:19],s40 offen offset:3072 sc1 lds
mf v[148:151],a[196:199],v[100:103],v[148:151]
ds_read_b64_tr_b16 a[240:241],v14 offset:24576
ds_read_b64_tr_b16 a[242:243],v14 offset:25600
mf v[148:151],a[212:215],v[116:119],v[148:151]
s_mov_b32 s27,0x100000
s_mov_b32 s62,0x58800000
mf v[132:135],a[208:211],v[116:119],v[132:135]
s_add_u32 m0,s57,114688
mf v[132:135],a[192:195],v[100:103],v[132:135]
mf v[136:139],a[192:195],v[104:107],v[136:139]
ds_read_b64_tr_b16 a[244:245],v15 offset:24576
ds_read_b64_tr_b16 a[246:247],v15 offset:25600
s_waitcnt vmcnt(18)
mf v[136:139],a[208:211],v[120:123],v[136:139]
buffer_load_dwordx4 v0,s[16:19],s40 offen sc1 lds
mf v[152:155],a[212:215],v[120:123],v[152:155]
ds_read_b64_tr_b16 a[248:249],v16 offset:24576
ds_read_b64_tr_b16 a[250:251],v16 offset:25600
mf v[152:155],a[196:199],v[104:107],v[152:155]
s_and_b32 s56,s2,7
s_lshl_b32 s56,s56,7
mf v[168:171],a[200:203],v[104:107],v[168:171]
buffer_load_dwordx4 v0,s[16:19],s40 offen offset:1024 sc1 lds
mf v[168:171],a[216:219],v[120:123],v[168:171]
ds_read_b64_tr_b16 a[252:253],v17 offset:24576
ds_read_b64_tr_b16 a[254:255],v17 offset:25600
mf v[184:187],a[220:223],v[120:123],v[184:187]
buffer_load_dwordx4 v0,s[16:19],s40 offen offset:2048 sc1 lds
mf v[184:187],a[204:207],v[104:107],v[184:187]
mf v[188:191],a[204:207],v[108:111],v[188:191]
s_add_u32 s25,s56,24576
s_sub_u32 s59,s2,32
s_waitcnt vmcnt(20)
mf v[188:191],a[220:223],v[124:127],v[188:191]
buffer_load_dwordx4 v0,s[16:19],s40 offen offset:3072 sc1 lds
mf v[172:175],a[216:219],v[124:127],v[172:175]
s_cmp_lt_u32 s59,160
s_cselect_b32 s59,0,1024
mf v[172:175],a[200:203],v[108:111],v[172:175]
s_add_u32 s25,s25,s59
s_mov_b32 s47,24576
mf v[156:159],a[196:199],v[108:111],v[156:159]
s_add_u32 s40,s40,32768
mf v[156:159],a[212:215],v[124:127],v[156:159]
mf v[140:143],a[208:211],v[124:127],v[140:143]
mf v[140:143],a[192:195],v[108:111],v[140:143]
s_waitcnt lgkmcnt(0)
mf v[192:195],a[224:227],v[96:99],v[192:195]
s_waitcnt vmcnt(17)
s_barrier
mf v[192:195],a[240:243],v[112:115],v[192:195]
mf v[208:211],a[244:247],v[112:115],v[208:211]
mf v[208:211],a[228:231],v[96:99],v[208:211]
mf v[224:227],a[232:235],v[96:99],v[224:227]
ds_read_b128 a[192:195],v4 offset:0
mf v[224:227],a[248:251],v[112:115],v[224:227]
cvt v24,v128,v129
cvt v25,v130,v131
mf v[240:243],a[252:255],v[112:115],v[240:243]
ds_read_b128 a[196:199],v4 offset:1024
mf v[240:243],a[236:239],v[96:99],v[240:243]
mf v[244:247],a[236:239],v[100:103],v[244:247]
ds_read_b128 a[200:203],v4 offset:2048
mf v[244:247],a[252:255],v[116:119],v[244:247]
cvt v26,v144,v145
cvt v27,v146,v147
mf v[228:231],a[248:251],v[116:119],v[228:231]
ds_read_b128 a[204:207],v4 offset:3072
mf v[228:231],a[232:235],v[100:103],v[228:231]
awr a128,v24
awr a129,v25
mf v[212:215],a[228:231],v[100:103],v[212:215]
ds_read_b128 a[208:211],v4 offset:4096
mf v[212:215],a[244:247],v[116:119],v[212:215]
awr a130,v26
awr a131,v27
mf v[196:199],a[240:243],v[116:119],v[196:199]
ds_read_b128 a[212:215],v4 offset:5120
mf v[196:199],a[224:227],v[100:103],v[196:199]
mf v[200:203],a[224:227],v[104:107],v[200:203]
ds_read_b128 a[216:219],v4 offset:6144
mf v[200:203],a[240:243],v[120:123],v[200:203]
cvt v28,v160,v161
cvt v29,v162,v163
mf v[216:219],a[244:247],v[120:123],v[216:219]
ds_read_b128 a[220:223],v4 offset:7168
mf v[216:219],a[228:231],v[104:107],v[216:219]
cvt v30,v176,v177
cvt v31,v178,v179
mf v[232:235],a[232:235],v[104:107],v[232:235]
awr a144,v28
awr a145,v29
mf v[232:235],a[248:251],v[120:123],v[232:235]
awr a146,v30
awr a147,v31
mf v[248:251],a[252:255],v[120:123],v[248:251]
cvt v32,v132,v133
cvt v33,v134,v135
mf v[248:251],a[236:239],v[104:107],v[248:251]
mf v[252:255],a[236:239],v[108:111],v[252:255]
cvt v34,v148,v149
cvt v35,v150,v151
mf v[252:255],a[252:255],v[124:127],v[252:255]
awr a132,v32
awr a133,v33
mf v[236:239],a[248:251],v[124:127],v[236:239]
awr a134,v34
awr a135,v35
mf v[236:239],a[232:235],v[108:111],v[236:239]
cvt v24,v164,v165
cvt v25,v166,v167
mf v[220:223],a[228:231],v[108:111],v[220:223]
cvt v26,v180,v181
cvt v27,v182,v183
mf v[220:223],a[244:247],v[124:127],v[220:223]
awr a148,v24
awr a149,v25
mf v[204:207],a[240:243],v[124:127],v[204:207]
awr a150,v26
awr a151,v27
mf v[204:207],a[224:227],v[108:111],v[204:207]
cvt v28,v192,v193
cvt v29,v194,v195
cvt v30,v208,v209
cvt v31,v210,v211
awr a160,v28
awr a161,v29
awr a162,v30
awr a163,v31
cvt v32,v224,v225
cvt v33,v226,v227
cvt v34,v240,v241
cvt v35,v242,v243
awr a176,v32
awr a177,v33
awr a178,v34
awr a179,v35
s_waitcnt lgkmcnt(7)
mf v[128:131],a[192:195],a[128:131],0
ds_read_b128 a[224:227],v4 offset:8192
ds_read_b128 a[228:231],v4 offset:9216
s_waitcnt lgkmcnt(8)
mf v[128:131],a[196:199],a[144:147],v[128:131]
ds_read_b128 a[232:235],v4 offset:10240
ds_read_b128 a[236:239],v4 offset:11264
s_waitcnt lgkmcnt(9)
mf v[128:131],a[200:203],a[160:163],v[128:131]
ds_read_b128 a[240:243],v4 offset:12288
ds_read_b128 a[244:247],v4 offset:13312
s_add_u32 m0,s12,0
s_nop 0
buffer_load_dwordx4 v45,s[20:23],s53 offen lds
v_xor_b32 v45,128,v45
s_waitcnt lgkmcnt(10)
mf v[128:131],a[204:207],a[176:179],v[128:131]
ds_read_b128 a[248:251],v4 offset:14336
ds_read_b128 a[252:255],v4 offset:15360
s_waitcnt lgkmcnt(8)
mf v[144:147],a[220:223],a[176:179],0
cvt v24,v196,v197
cvt v25,v198,v199
mf v[144:147],a[216:219],a[160:163],v[144:147]
cvt v26,v212,v213
cvt v27,v214,v215
mf v[144:147],a[212:215],a[144:147],v[144:147]
awr a164,v24
awr a165,v25
mf v[144:147],a[208:211],a[128:131],v[144:147]
awr a166,v26
awr a167,v27
s_waitcnt lgkmcnt(7)
mf v[160:163],a[224:227],a[128:131],0
cvt v28,v228,v229
cvt v29,v230,v231
s_add_u32 m0,s12,1024
s_add_u32 s53,s53,5120
buffer_load_dwordx4 v45,s[20:23],s53 offen lds
v_xor_b32 v45,128,v45
s_waitcnt lgkmcnt(6)
mf v[160:163],a[228:231],a[144:147],v[160:163]
cvt v30,v244,v245
cvt v31,v246,v247
s_waitcnt lgkmcnt(5)
mf v[160:163],a[232:235],a[160:163],v[160:163]
awr a180,v28
awr a181,v29
s_waitcnt lgkmcnt(4)
mf v[160:163],a[236:239],a[176:179],v[160:163]
awr a182,v30
awr a183,v31
s_waitcnt lgkmcnt(0)
mf v[176:179],a[252:255],a[176:179],0
cvt v32,v136,v137
cvt v33,v138,v139
mf v[176:179],a[248:251],a[160:163],v[176:179]
cvt v34,v152,v153
cvt v35,v154,v155
mf v[176:179],a[244:247],a[144:147],v[176:179]
awr a136,v32
awr a137,v33
s_add_u32 m0,s12,2048
s_add_u32 s53,s53,5120
buffer_load_dwordx4 v45,s[20:23],s53 offen lds
v_xor_b32 v45,128,v45
mf v[176:179],a[240:243],a[128:131],v[176:179]
awr a138,v34
awr a139,v35
mf v[132:135],a[192:195],a[132:135],0
cvt v24,v168,v169
cvt v25,v170,v171
mf v[132:135],a[196:199],a[148:151],v[132:135]
cvt v26,v184,v185
cvt v27,v186,v187
mf v[132:135],a[200:203],a[164:167],v[132:135]
awr a152,v24
awr a153,v25
mf v[132:135],a[204:207],a[180:183],v[132:135]
awr a154,v26
awr a155,v27
mf v[148:151],a[220:223],a[180:183],0
cvt v28,v200,v201
cvt v29,v202,v203
mf v[148:151],a[216:219],a[164:167],v[148:151]
cvt v30,v216,v217
cvt v31,v218,v219
mf v[148:151],a[212:215],a[148:151],v[148:151]
s_add_u32 m0,s12,3072
s_add_u32 s53,s53,5120
buffer_load_dwordx4 v45,s[20:23],s53 offen lds
v_xor_b32 v45,128,v45
mf v[148:151],a[208:211],a[132:135],v[148:151]
awr a168,v28
awr a169,v29
mf v[164:167],a[224:227],a[132:135],0
awr a170,v30
awr a171,v31
mf v[164:167],a[228:231],a[148:151],v[164:167]
cvt v32,v232,v233
cvt v33,v234,v235
mf v[164:167],a[232:235],a[164:167],v[164:167]
cvt v34,v248,v249
cvt v35,v250,v251
mf v[164:167],a[236:239],a[180:183],v[164:167]
awr a184,v32
awr a185,v33
mf v[180:183],a[252:255],a[180:183],0
awr a186,v34
awr a187,v35
mf v[180:183],a[248:251],a[164:167],v[180:183]
s_add_u32 m0,s12,4096
s_add_u32 s53,s53,5120
buffer_load_dwordx4 v45,s[20:23],s53 offen lds
v_xor_b32 v45,128,v45
mf v[180:183],a[244:247],a[148:151],v[180:183]
cvt v24,v140,v141
cvt v25,v142,v143
mf v[180:183],a[240:243],a[132:135],v[180:183]
cvt v26,v156,v157
cvt v27,v158,v159
mf v[136:139],a[192:195],a[136:139],0
awr a140,v24
awr a141,v25
mf v[136:139],a[196:199],a[152:155],v[136:139]
awr a142,v26
awr a143,v27
mf v[136:139],a[200:203],a[168:171],v[136:139]
cvt v28,v172,v173
cvt v29,v174,v175
mf v[136:139],a[204:207],a[184:187],v[136:139]
cvt v30,v188,v189
cvt v31,v190,v191
mf v[152:155],a[220:223],a[184:187],0
awr a156,v28
awr a157,v29
mf v[152:155],a[216:219],a[168:171],v[152:155]
awr a158,v30
awr a159,v31
mf v[152:155],a[212:215],a[152:155],v[152:155]
s_add_u32 m0,s12,5120
s_add_u32 s53,s53,5120
buffer_load_dwordx4 v45,s[20:23],s53 offen lds
v_xor_b32 v45,128,v45
mf v[152:155],a[208:211],a[136:139],v[152:155]
cvt v32,v204,v205
cvt v33,v206,v207
s_add_u32 m0,s12,6144
s_add_u32 s53,s53,5120
buffer_load_dwordx4 v45,s[20:23],s53 offen lds
v_xor_b32 v45,128,v45
mf v[168:171],a[224:227],a[136:139],0
cvt v34,v220,v221
cvt v35,v222,v223
mf v[168:171],a[228:231],a[152:155],v[168:171]
awr a172,v32
awr a173,v33
mf v[168:171],a[232:235],a[168:171],v[168:171]
awr a174,v34
awr a175,v35
mf v[168:171],a[236:239],a[184:187],v[168:171]
cvt v24,v236,v237
cvt v25,v238,v239
mf v[184:187],a[252:255],a[184:187],0
cvt v26,v252,v253
cvt v27,v254,v255
mf v[184:187],a[248:251],a[168:171],v[184:187]
awr a188,v24
awr a189,v25
mf v[184:187],a[244:247],a[152:155],v[184:187]
awr a190,v26
awr a191,v27
mf v[184:187],a[240:243],a[136:139],v[184:187]
s_add_u32 m0,s12,7168
s_add_u32 s53,s53,5120
buffer_load_dwordx4 v45,s[20:23],s53 offen lds
v_xor_b32 v45,128,v45
mf v[140:143],a[192:195],a[140:143],0
v_max3_f32 v96,v128,v129,v130
v_max3_f32 v97,v132,v133,v134
mf v[140:143],a[196:199],a[156:159],v[140:143]
v_max3_f32 v96,v96,v131,v144
v_max3_f32 v97,v97,v135,v148
mf v[140:143],a[200:203],a[172:175],v[140:143]
v_max3_f32 v96,v96,v145,v146
v_max3_f32 v97,v97,v149,v150
mf v[140:143],a[204:207],a[188:191],v[140:143]
v_max3_f32 v96,v96,v147,v160
v_max3_f32 v97,v97,v151,v164
mf v[156:159],a[220:223],a[188:191],0
v_max3_f32 v96,v96,v161,v162
v_max3_f32 v97,v97,v165,v166
ds_read_b128 a[192:195],v4 offset:16384
mf v[156:159],a[216:219],a[172:175],v[156:159]
v_max3_f32 v96,v96,v163,v176
v_max3_f32 v97,v97,v167,v180
ds_read_b128 a[196:199],v4 offset:17408
mf v[156:159],a[212:215],a[156:159],v[156:159]
v_max3_f32 v96,v96,v177,v178
v_max3_f32 v97,v97,v181,v182
ds_read_b128 a[200:203],v4 offset:18432
ds_read_b128 a[204:207],v4 offset:19456
mf v[156:159],a[208:211],a[140:143],v[156:159]
v_max_f32 v96,v96,v179
v_max_f32 v97,v97,v183
mf v[172:175],a[224:227],a[140:143],0
v_mov_b32 v100,v96
v_mov_b32 v101,v97
ds_read_b128 a[208:211],v4 offset:20480
mf v[172:175],a[228:231],a[156:159],v[172:175]
v_permlane16_swap_b32 v96,v100
v_permlane16_swap_b32 v97,v101
ds_read_b128 a[212:215],v4 offset:21504
mf v[172:175],a[232:235],a[172:175],v[172:175]
v_max_f32 v96,v96,v100
v_max_f32 v97,v97,v101
ds_read_b128 a[216:219],v4 offset:22528
ds_read_b128 a[220:223],v4 offset:23552
mf v[172:175],a[236:239],a[188:191],v[172:175]
v_mov_b32 v100,v96
v_mov_b32 v101,v97
mf v[188:191],a[252:255],a[188:191],0
v_permlane32_swap_b32 v96,v100
v_permlane32_swap_b32 v97,v101
ds_read_b128 a[224:227],v4 offset:24576
mf v[188:191],a[248:251],a[172:175],v[188:191]
v_max_f32 v96,v96,v100
v_max_f32 v97,v97,v101
ds_read_b128 a[228:231],v4 offset:25600
mf v[188:191],a[244:247],a[156:159],v[188:191]
v_sub_f32 v48,0,v96
v_sub_f32 v49,0,v96
ds_read_b128 a[232:235],v4 offset:26624
ds_read_b128 a[236:239],v4 offset:27648
mf v[188:191],a[240:243],a[140:143],v[188:191]
v_sub_f32 v50,0,v96
v_sub_f32 v51,0,v96
v_sub_f32 v52,0,v97
v_sub_f32 v53,0,v97
v_sub_f32 v54,0,v97
v_sub_f32 v55,0,v97
ds_read_b128 a[240:243],v4 offset:28672
ds_read_b128 a[244:247],v4 offset:29696
ds_read_b128 a[248:251],v4 offset:30720
ds_read_b128 a[252:255],v4 offset:31744
s_cmp_eq_u32 s15,0
s_cbranch_scc1 Lq0m
Lq0c:
v_add_f32 v128,v128,v48
v_add_f32 v129,v129,v48
v_add_f32 v130,v130,v48
v_add_f32 v131,v131,v48
v_add_f32 v144,v144,v48
v_add_f32 v145,v145,v48
v_add_f32 v146,v146,v48
v_add_f32 v147,v147,v48
v_add_f32 v160,v160,v48
v_add_f32 v161,v161,v48
v_add_f32 v162,v162,v48
v_add_f32 v163,v163,v48
v_add_f32 v176,v176,v48
v_add_f32 v177,v177,v48
v_add_f32 v178,v178,v48
v_add_f32 v179,v179,v48
s_waitcnt lgkmcnt(0)
mf v[192:195],a[192:195],a[128:131],v[48:51]
v_max3_f32 v98,v136,v137,v138
v_max3_f32 v99,v140,v141,v142
v_max3_f32 v98,v98,v139,v152
v_max3_f32 v99,v99,v143,v156
mf v[192:195],a[196:199],a[144:147],v[192:195]
v_max3_f32 v98,v98,v153,v154
v_max3_f32 v99,v99,v157,v158
v_max3_f32 v98,v98,v155,v168
mf v[192:195],a[200:203],a[160:163],v[192:195]
v_max3_f32 v99,v99,v159,v172
v_max3_f32 v98,v98,v169,v170
v_max3_f32 v99,v99,v173,v174
v_max3_f32 v98,v98,v171,v184
mf v[192:195],a[204:207],a[176:179],v[192:195]
v_max3_f32 v99,v99,v175,v188
v_max3_f32 v98,v98,v185,v186
v_max3_f32 v99,v99,v189,v190
mf v[208:211],a[220:223],a[176:179],v[48:51]
s_add_u32 m0,s57,0
v_max_f32 v98,v98,v187
v_max_f32 v99,v99,v191
v_mov_b32 v102,v98
mf v[208:211],a[216:219],a[160:163],v[208:211]
v_mov_b32 v103,v99
v_permlane16_swap_b32 v98,v102
s_nop 0
v_permlane16_swap_b32 v99,v103
v_max_f32 v98,v98,v102
mf v[208:211],a[212:215],a[144:147],v[208:211]
v_max_f32 v99,v99,v103
v_mov_b32 v102,v98
v_mov_b32 v103,v99
mf v[208:211],a[208:211],a[128:131],v[208:211]
buffer_load_dwordx4 v2,s[16:19],s40 offen sc1 lds
v_permlane32_swap_b32 v98,v102
v_permlane32_swap_b32 v99,v103
v_max_f32 v98,v98,v102
v_max_f32 v99,v99,v103
mf v[224:227],a[224:227],a[128:131],v[48:51]
v_sub_f32 v56,0,v98
v_sub_f32 v57,0,v98
v_sub_f32 v58,0,v98
mf v[224:227],a[228:231],a[144:147],v[224:227]
v_sub_f32 v59,0,v98
v_sub_f32 v60,0,v99
v_sub_f32 v61,0,v99
mf v[224:227],a[232:235],a[160:163],v[224:227]
buffer_load_dwordx4 v2,s[16:19],s40 offen offset:1024 sc1 lds
v_sub_f32 v62,0,v99
v_sub_f32 v63,0,v99
v_exp_f32 v24,v128
mf v[224:227],a[236:239],a[176:179],v[224:227]
v_exp_f32 v25,v129
v_add_f32 v132,v132,v52
mf v[240:243],a[252:255],a[176:179],v[48:51]
v_add_f32 v133,v133,v52
v_exp_f32 v26,v130
mf v[240:243],a[248:251],a[160:163],v[240:243]
buffer_load_dwordx4 v2,s[16:19],s40 offen offset:2048 sc1 lds
v_exp_f32 v27,v131
v_add_f32 v134,v134,v52
v_add_f32 v135,v135,v52
mf v[240:243],a[244:247],a[144:147],v[240:243]
cvt v64,v24,v25
v_exp_f32 v28,v144
mf v[240:243],a[240:243],a[128:131],v[240:243]
v_exp_f32 v29,v145
v_add_f32 v148,v148,v52
v_add_f32 v149,v149,v52
mf v[196:199],a[192:195],a[132:135],v[52:55]
buffer_load_dwordx4 v2,s[16:19],s40 offen offset:3072 sc1 lds
cvt v65,v26,v27
v_exp_f32 v30,v146
mf v[196:199],a[196:199],a[148:151],v[196:199]
v_exp_f32 v31,v147
v_add_f32 v150,v150,v52
mf v[196:199],a[200:203],a[164:167],v[196:199]
v_add_f32 v151,v151,v52
cvt v66,v28,v29
v_exp_f32 v32,v160
mf v[196:199],a[204:207],a[180:183],v[196:199]
s_add_u32 m0,s57,16384
v_exp_f32 v33,v161
v_add_f32 v164,v164,v52
mf v[212:215],a[220:223],a[180:183],v[52:55]
v_add_f32 v165,v165,v52
cvt v67,v30,v31
v_exp_f32 v34,v162
mf v[212:215],a[216:219],a[164:167],v[212:215]
v_exp_f32 v35,v163
v_add_f32 v166,v166,v52
mf v[212:215],a[212:215],a[148:151],v[212:215]
buffer_load_dwordx4 v0,s[16:19],s40 offen sc1 lds
v_add_f32 v167,v167,v52
cvt v80,v32,v33
mf v[8:11],v[36:39],v[64:67],0
v_exp_f32 v24,v176
v_exp_f32 v25,v177
mf v[212:215],a[208:211],a[132:135],v[212:215]
v_add_f32 v180,v180,v52
v_add_f32 v181,v181,v52
cvt v81,v34,v35
mf v[228:231],a[224:227],a[132:135],v[52:55]
v_exp_f32 v26,v178
v_exp_f32 v27,v179
mf v[228:231],a[228:231],a[148:151],v[228:231]
buffer_load_dwordx4 v0,s[16:19],s40 offen offset:1024 sc1 lds
v_add_f32 v182,v182,v52
v_add_f32 v183,v183,v52
mf v[228:231],a[232:235],a[164:167],v[228:231]
cvt v82,v24,v25
v_exp_f32 v28,v132
v_exp_f32 v29,v133
mf v[228:231],a[236:239],a[180:183],v[228:231]
v_add_f32 v136,v136,v56
v_add_f32 v137,v137,v56
mf v[244:247],a[252:255],a[180:183],v[52:55]
buffer_load_dwordx4 v0,s[16:19],s40 offen offset:2048 sc1 lds
cvt v83,v26,v27
v_exp_f32 v30,v134
v_exp_f32 v31,v135
mf v[244:247],a[248:251],a[164:167],v[244:247]
v_add_f32 v138,v138,v56
v_add_f32 v139,v139,v56
mf v[244:247],a[244:247],a[148:151],v[244:247]
cvt v68,v28,v29
mf v[8:11],v[36:39],v[80:83],v[8:11]
v_exp_f32 v32,v148
v_exp_f32 v33,v149
mf v[244:247],a[240:243],a[132:135],v[244:247]
buffer_load_dwordx4 v0,s[16:19],s40 offen offset:3072 sc1 lds
v_add_f32 v152,v152,v56
v_add_f32 v153,v153,v56
cvt v69,v30,v31
v_exp_f32 v34,v150
mf v[200:203],a[192:195],a[136:139],v[56:59]
v_exp_f32 v35,v151
mf v[200:203],a[196:199],a[152:155],v[200:203]
v_add_f32 v154,v154,v56
v_add_f32 v155,v155,v56
cvt v70,v32,v33
mf v[200:203],a[200:203],a[168:171],v[200:203]
s_add_u32 s40,s40,32768
v_exp_f32 v24,v164
v_exp_f32 v25,v165
mf v[200:203],a[204:207],a[184:187],v[200:203]
v_add_f32 v168,v168,v56
v_add_f32 v169,v169,v56
cvt v71,v34,v35
mf v[216:219],a[220:223],a[184:187],v[56:59]
v_exp_f32 v26,v166
v_exp_f32 v27,v167
mf v[216:219],a[216:219],a[168:171],v[216:219]
v_add_f32 v170,v170,v56
v_add_f32 v171,v171,v56
cvt v84,v24,v25
mf v[216:219],a[212:215],a[152:155],v[216:219]
mf v[12:15],v[36:39],v[68:71],0
v_exp_f32 v28,v180
v_exp_f32 v29,v181
v_add_f32 v184,v184,v56
mf v[216:219],a[208:211],a[136:139],v[216:219]
v_add_f32 v185,v185,v56
cvt v85,v26,v27
v_exp_f32 v30,v182
mf v[232:235],a[224:227],a[136:139],v[56:59]
v_exp_f32 v31,v183
v_add_f32 v186,v186,v56
mf v[232:235],a[228:231],a[152:155],v[232:235]
v_add_f32 v187,v187,v56
cvt v86,v28,v29
v_exp_f32 v32,v136
mf v[232:235],a[232:235],a[168:171],v[232:235]
v_exp_f32 v33,v137
v_add_f32 v140,v140,v60
mf v[232:235],a[236:239],a[184:187],v[232:235]
v_add_f32 v141,v141,v60
cvt v87,v30,v31
v_exp_f32 v34,v138
mf v[248:251],a[252:255],a[184:187],v[56:59]
s_waitcnt vmcnt(24)
s_barrier
v_exp_f32 v35,v139
v_add_f32 v142,v142,v60
mf v[248:251],a[248:251],a[168:171],v[248:251]
v_add_f32 v143,v143,v60
cvt v72,v32,v33
mf v[12:15],v[36:39],v[84:87],v[12:15]
v_exp_f32 v24,v152
v_exp_f32 v25,v153
mf v[248:251],a[244:247],a[152:155],v[248:251]
v_add_f32 v156,v156,v60
v_add_f32 v157,v157,v60
mf v[248:251],a[240:243],a[136:139],v[248:251]
cvt v73,v34,v35
v_exp_f32 v26,v154
v_exp_f32 v27,v155
mf v[204:207],a[192:195],a[140:143],v[60:63]
v_add_f32 v158,v158,v60
v_add_f32 v159,v159,v60
mf v[204:207],a[196:199],a[156:159],v[204:207]
cvt v74,v24,v25
v_exp_f32 v28,v168
v_exp_f32 v29,v169
mf v[204:207],a[200:203],a[172:175],v[204:207]
v_add_f32 v172,v172,v60
v_add_f32 v173,v173,v60
mf v[204:207],a[204:207],a[188:191],v[204:207]
cvt v75,v26,v27
v_exp_f32 v30,v170
mf v[220:223],a[220:223],a[188:191],v[60:63]
ds_read_b128 a[192:195],v3 offset:0
ds_read_b128 a[196:199],v3 offset:8192
v_exp_f32 v31,v171
v_add_f32 v174,v174,v60
v_add_f32 v175,v175,v60
mf v[220:223],a[216:219],a[172:175],v[220:223]
ds_read_b128 a[200:203],v3 offset:1024
ds_read_b128 a[204:207],v3 offset:9216
cvt v88,v28,v29
mf v[16:19],v[36:39],v[72:75],0
v_exp_f32 v32,v184
v_exp_f32 v33,v185
mf v[220:223],a[212:215],a[156:159],v[220:223]
v_add_f32 v188,v188,v60
v_add_f32 v189,v189,v60
cvt v89,v30,v31
v_exp_f32 v34,v186
mf v[220:223],a[208:211],a[140:143],v[220:223]
v_exp_f32 v35,v187
mf v[236:239],a[224:227],a[140:143],v[60:63]
ds_read_b128 a[208:211],v3 offset:2048
ds_read_b128 a[212:215],v3 offset:10240
v_add_f32 v190,v190,v60
v_add_f32 v191,v191,v60
cvt v90,v32,v33
mf v[236:239],a[228:231],a[156:159],v[236:239]
ds_read_b128 a[216:219],v3 offset:3072
ds_read_b128 a[220:223],v3 offset:11264
v_exp_f32 v24,v140
v_exp_f32 v25,v141
mf v[236:239],a[232:235],a[172:175],v[236:239]
cvt v91,v34,v35
v_exp_f32 v26,v142
mf v[236:239],a[236:239],a[188:191],v[236:239]
v_exp_f32 v27,v143
cvt v76,v24,v25
mf v[252:255],a[252:255],a[188:191],v[60:63]
mf v[16:19],v[36:39],v[88:91],v[16:19]
v_exp_f32 v28,v156
v_exp_f32 v29,v157
cvt v77,v26,v27
v_exp_f32 v30,v158
mf v[252:255],a[248:251],a[172:175],v[252:255]
v_exp_f32 v31,v159
mf v[252:255],a[244:247],a[156:159],v[252:255]
cvt v78,v28,v29
v_exp_f32 v32,v172
v_exp_f32 v33,v173
mf v[252:255],a[240:243],a[140:143],v[252:255]
cvt v79,v30,v31
v_exp_f32 v34,v174
v_exp_f32 v35,v175
cvt v92,v32,v33
mf v[20:23],v[36:39],v[76:79],0
v_exp_f32 v24,v188
v_exp_f32 v25,v189
cvt v93,v34,v35
v_exp_f32 v26,v190
v_exp_f32 v27,v191
cvt v94,v24,v25
cvt v95,v26,v27
v_xor_b32 v4,0x10000,v4
s_waitcnt lgkmcnt(0)
mf v[20:23],v[36:39],v[92:95],v[20:23]
s_sub_u32 s44,s15,1
s_cmp_eq_u32 s15,0
s_cbranch_scc1 Lq1m
s_cmp_eq_u32 s15,1
s_cbranch_scc1 LDM0
.p2align 6
LDF0:
mf a[0:3],a[192:195],v[64:67],a[0:3]
v_add_f32 v40,v40,v8
v_add_f32 v41,v41,v12
mf a[0:3],a[196:199],v[80:83],a[0:3]
ds_read_b128 a[224:227],v3 offset:4096
s_add_u32 m0,s42,0
mf a[16:19],a[204:207],v[80:83],a[16:19]
ds_read_b128 a[232:235],v3 offset:5120
ds_read_b128 a[228:231],v3 offset:12288
mf a[16:19],a[200:203],v[64:67],a[16:19]
v_exp_f32 v24,v192
mf a[20:23],a[200:203],v[68:71],a[20:23]
ds_read_b128 a[236:239],v3 offset:13312
buffer_load_dwordx4 v2,s[16:19],s40 offen sc1 lds
mf a[20:23],a[204:207],v[84:87],a[20:23]
v_exp_f32 v25,v193
mf a[4:7],a[196:199],v[84:87],a[4:7]
v_add_f32 v42,v42,v16
v_add_f32 v43,v43,v20
mf a[4:7],a[192:195],v[68:71],a[4:7]
v_exp_f32 v26,v194
mf a[8:11],a[192:195],v[72:75],a[8:11]
ds_read_b128 a[244:247],v3 offset:14336
ds_read_b128 a[240:243],v3 offset:6144
mf a[8:11],a[196:199],v[88:91],a[8:11]
v_exp_f32 v27,v195
mf a[24:27],a[204:207],v[88:91],a[24:27]
cvt v96,v24,v25
cvt v97,v26,v27
mf a[24:27],a[200:203],v[72:75],a[24:27]
v_exp_f32 v28,v208
mf a[28:31],a[200:203],v[76:79],a[28:31]
ds_read_b128 a[252:255],v3 offset:15360
ds_read_b128 a[248:251],v3 offset:7168
mf a[28:31],a[204:207],v[92:95],a[28:31]
v_exp_f32 v29,v209
mf a[12:15],a[196:199],v[92:95],a[12:15]
v_exp_f32 v30,v210
mf a[12:15],a[192:195],v[76:79],a[12:15]
v_exp_f32 v31,v211
mf a[44:47],a[208:211],v[76:79],a[44:47]
cvt v98,v28,v29
cvt v99,v30,v31
mf a[44:47],a[212:215],v[92:95],a[44:47]
v_exp_f32 v32,v224
mf a[60:63],a[220:223],v[92:95],a[60:63]
v_exp_f32 v33,v225
mf a[60:63],a[216:219],v[76:79],a[60:63]
v_exp_f32 v34,v226
mf v[8:11],v[36:39],v[96:99],0
mf a[56:59],a[216:219],v[72:75],a[56:59]
buffer_load_dwordx4 v2,s[16:19],s40 offen offset:1024 sc1 lds
mf a[56:59],a[220:223],v[88:91],a[56:59]
v_exp_f32 v35,v227
mf a[40:43],a[212:215],v[88:91],a[40:43]
cvt v112,v32,v33
cvt v113,v34,v35
mf a[40:43],a[208:211],v[72:75],a[40:43]
v_exp_f32 v24,v240
mf a[36:39],a[208:211],v[68:71],a[36:39]
v_exp_f32 v25,v241
mf a[36:39],a[212:215],v[84:87],a[36:39]
mf a[52:55],a[220:223],v[84:87],a[52:55]
v_exp_f32 v26,v242
mf a[52:55],a[216:219],v[68:71],a[52:55]
mf a[48:51],a[216:219],v[64:67],a[48:51]
v_exp_f32 v27,v243
mf a[48:51],a[220:223],v[80:83],a[48:51]
cvt v114,v24,v25
cvt v115,v26,v27
mf a[32:35],a[212:215],v[80:83],a[32:35]
s_waitcnt lgkmcnt(0)
mf a[32:35],a[208:211],v[64:67],a[32:35]
v_exp_f32 v28,v196
mf v[8:11],v[36:39],v[112:115],v[8:11]
v_exp_f32 v29,v197
mf a[64:67],a[224:227],v[64:67],a[64:67]
ds_read_b128 a[196:199],v3 offset:17408
ds_read_b128 a[192:195],v3 offset:16384
mf a[64:67],a[228:231],v[80:83],a[64:67]
ds_read_b128 a[204:207],v3 offset:19456
ds_read_b128 a[200:203],v3 offset:18432
mf a[80:83],a[236:239],v[80:83],a[80:83]
ds_read_b128 a[212:215],v3 offset:21504
ds_read_b128 a[208:211],v3 offset:20480
mf a[80:83],a[232:235],v[64:67],a[80:83]
ds_read_b128 a[220:223],v3 offset:23552
ds_read_b128 a[216:219],v3 offset:22528
mf a[84:87],a[232:235],v[68:71],a[84:87]
v_exp_f32 v30,v198
mf a[84:87],a[236:239],v[84:87],a[84:87]
buffer_load_dwordx4 v2,s[16:19],s40 offen offset:2048 sc1 lds
mf a[68:71],a[228:231],v[84:87],a[68:71]
v_exp_f32 v31,v199
mf a[68:71],a[224:227],v[68:71],a[68:71]
cvt v100,v28,v29
cvt v101,v30,v31
mf a[72:75],a[224:227],v[72:75],a[72:75]
v_exp_f32 v32,v212
mf a[72:75],a[228:231],v[88:91],a[72:75]
v_exp_f32 v33,v213
mf a[88:91],a[236:239],v[88:91],a[88:91]
v_exp_f32 v34,v214
mf a[88:91],a[232:235],v[72:75],a[88:91]
v_exp_f32 v35,v215
mf a[92:95],a[232:235],v[76:79],a[92:95]
cvt v102,v32,v33
cvt v103,v34,v35
mf a[92:95],a[236:239],v[92:95],a[92:95]
v_exp_f32 v24,v228
mf a[76:79],a[228:231],v[92:95],a[76:79]
v_exp_f32 v25,v229
mf a[76:79],a[224:227],v[76:79],a[76:79]
mf v[12:15],v[36:39],v[100:103],0
v_exp_f32 v26,v230
mf a[108:111],a[240:243],v[76:79],a[108:111]
mf a[108:111],a[244:247],v[92:95],a[108:111]
v_exp_f32 v27,v231
mf a[124:127],a[252:255],v[92:95],a[124:127]
cvt v116,v24,v25
cvt v117,v26,v27
mf a[124:127],a[248:251],v[76:79],a[124:127]
v_exp_f32 v28,v244
mf a[120:123],a[248:251],v[72:75],a[120:123]
mf a[120:123],a[252:255],v[88:91],a[120:123]
v_exp_f32 v29,v245
mf a[104:107],a[244:247],v[88:91],a[104:107]
buffer_load_dwordx4 v2,s[16:19],s40 offen offset:3072 sc1 lds
mf a[104:107],a[240:243],v[72:75],a[104:107]
v_exp_f32 v30,v246
mf a[100:103],a[240:243],v[68:71],a[100:103]
mf a[100:103],a[244:247],v[84:87],a[100:103]
v_exp_f32 v31,v247
mf a[116:119],a[252:255],v[84:87],a[116:119]
cvt v118,v28,v29
cvt v119,v30,v31
mf a[116:119],a[248:251],v[68:71],a[116:119]
v_exp_f32 v32,v200
mf a[112:115],a[248:251],v[64:67],a[112:115]
mf a[112:115],a[252:255],v[80:83],a[112:115]
v_exp_f32 v33,v201
mf v[12:15],v[36:39],v[116:119],v[12:15]
s_waitcnt lgkmcnt(0)
mf a[96:99],a[244:247],v[80:83],a[96:99]
v_exp_f32 v34,v202
mf a[96:99],a[240:243],v[64:67],a[96:99]
mf v[140:143],a[192:195],a[140:143],v[60:63]
ds_read_b128 a[228:231],v3 offset:25600
ds_read_b128 a[224:227],v3 offset:24576
mf v[140:143],a[196:199],a[156:159],v[140:143]
ds_read_b128 a[236:239],v3 offset:27648
ds_read_b128 a[232:235],v3 offset:26624
mf v[140:143],a[200:203],a[172:175],v[140:143]
ds_read_b128 a[244:247],v3 offset:29696
ds_read_b128 a[240:243],v3 offset:28672
mf v[140:143],a[204:207],a[188:191],v[140:143]
ds_read_b128 a[252:255],v3 offset:31744
ds_read_b128 a[248:251],v3 offset:30720
mf v[136:139],a[204:207],a[184:187],v[56:59]
v_exp_f32 v35,v203
mf v[136:139],a[200:203],a[168:171],v[136:139]
cvt v104,v32,v33
cvt v105,v34,v35
mf v[136:139],a[196:199],a[152:155],v[136:139]
v_exp_f32 v24,v216
mf v[136:139],a[192:195],a[136:139],v[136:139]
s_add_u32 m0,s42,16384
s_nop 0
buffer_load_dwordx4 v0,s[16:19],s40 offen sc1 lds
mf v[132:135],a[192:195],a[132:135],v[52:55]
v_exp_f32 v25,v217
mf v[132:135],a[196:199],a[148:151],v[132:135]
v_exp_f32 v26,v218
mf v[132:135],a[200:203],a[164:167],v[132:135]
v_exp_f32 v27,v219
mf v[132:135],a[204:207],a[180:183],v[132:135]
cvt v106,v24,v25
cvt v107,v26,v27
mf v[128:131],a[204:207],a[176:179],v[48:51]
v_exp_f32 v28,v232
mf v[128:131],a[200:203],a[160:163],v[128:131]
v_exp_f32 v29,v233
mf v[128:131],a[196:199],a[144:147],v[128:131]
v_exp_f32 v30,v234
mf v[128:131],a[192:195],a[128:131],v[128:131]
v_exp_f32 v31,v235
mf v[16:19],v[36:39],v[104:107],0
cvt v120,v28,v29
cvt v121,v30,v31
mf v[144:147],a[208:211],a[128:131],v[48:51]
v_exp_f32 v32,v248
mf v[144:147],a[212:215],a[144:147],v[144:147]
mf v[144:147],a[216:219],a[160:163],v[144:147]
v_exp_f32 v33,v249
mf v[144:147],a[220:223],a[176:179],v[144:147]
mf v[148:151],a[220:223],a[180:183],v[52:55]
v_exp_f32 v34,v250
mf v[148:151],a[216:219],a[164:167],v[148:151]
mf v[148:151],a[212:215],a[148:151],v[148:151]
v_exp_f32 v35,v251
mf v[148:151],a[208:211],a[132:135],v[148:151]
cvt v122,v32,v33
cvt v123,v34,v35
mf v[152:155],a[208:211],a[136:139],v[56:59]
buffer_load_dwordx4 v0,s[16:19],s40 offen offset:1024 sc1 lds
mf v[152:155],a[212:215],a[152:155],v[152:155]
v_exp_f32 v24,v204
mf v[152:155],a[216:219],a[168:171],v[152:155]
v_exp_f32 v25,v205
mf v[152:155],a[220:223],a[184:187],v[152:155]
mf v[16:19],v[36:39],v[120:123],v[16:19]
v_exp_f32 v26,v206
mf v[156:159],a[220:223],a[188:191],v[60:63]
mf v[156:159],a[216:219],a[172:175],v[156:159]
v_exp_f32 v27,v207
mf v[156:159],a[212:215],a[156:159],v[156:159]
cvt v108,v24,v25
cvt v109,v26,v27
mf v[156:159],a[208:211],a[140:143],v[156:159]
s_waitcnt lgkmcnt(0)
mf v[172:175],a[224:227],a[140:143],v[60:63]
s_waitcnt vmcnt(14)
s_barrier
mf v[172:175],a[228:231],a[156:159],v[172:175]
ds_read_b128 a[196:199],v4 offset:8192
ds_read_b128 a[192:195],v4 offset:0
mf v[172:175],a[232:235],a[172:175],v[172:175]
ds_read_b128 a[204:207],v4 offset:9216
ds_read_b128 a[200:203],v4 offset:1024
mf v[172:175],a[236:239],a[188:191],v[172:175]
v_exp_f32 v28,v220
mf v[168:171],a[236:239],a[184:187],v[56:59]
ds_read_b128 a[212:215],v4 offset:10240
ds_read_b128 a[208:211],v4 offset:2048
mf v[168:171],a[232:235],a[168:171],v[168:171]
v_exp_f32 v29,v221
mf v[168:171],a[228:231],a[152:155],v[168:171]
ds_read_b128 a[220:223],v4 offset:11264
ds_read_b128 a[216:219],v4 offset:3072
mf v[168:171],a[224:227],a[136:139],v[168:171]
v_exp_f32 v30,v222
mf v[164:167],a[224:227],a[132:135],v[52:55]
v_xor_b32 v3,0x10000,v3
mf v[164:167],a[228:231],a[148:151],v[164:167]
v_exp_f32 v31,v223
mf v[164:167],a[232:235],a[164:167],v[164:167]
cvt v110,v28,v29
cvt v111,v30,v31
mf v[164:167],a[236:239],a[180:183],v[164:167]
v_exp_f32 v32,v236
mf v[160:163],a[236:239],a[176:179],v[48:51]
buffer_load_dwordx4 v0,s[16:19],s40 offen offset:2048 sc1 lds
mf v[160:163],a[232:235],a[160:163],v[160:163]
v_exp_f32 v33,v237
mf v[160:163],a[228:231],a[144:147],v[160:163]
v_exp_f32 v34,v238
mf v[160:163],a[224:227],a[128:131],v[160:163]
v_exp_f32 v35,v239
mf v[20:23],v[36:39],v[108:111],0
cvt v124,v32,v33
cvt v125,v34,v35
mf v[176:179],a[240:243],a[128:131],v[48:51]
v_exp_f32 v24,v252
mf v[176:179],a[244:247],a[144:147],v[176:179]
v_exp_f32 v25,v253
mf v[176:179],a[248:251],a[160:163],v[176:179]
v_exp_f32 v26,v254
mf v[176:179],a[252:255],a[176:179],v[176:179]
mf v[180:183],a[252:255],a[180:183],v[52:55]
v_exp_f32 v27,v255
mf v[180:183],a[248:251],a[164:167],v[180:183]
cvt v126,v24,v25
cvt v127,v26,v27
mf v[180:183],a[244:247],a[148:151],v[180:183]
mf v[180:183],a[240:243],a[132:135],v[180:183]
mf v[20:23],v[36:39],v[124:127],v[20:23]
mf v[184:187],a[240:243],a[136:139],v[56:59]
mf v[184:187],a[244:247],a[152:155],v[184:187]
buffer_load_dwordx4 v0,s[16:19],s40 offen offset:3072 sc1 lds
s_add_u32 s40,s40,32768
mf v[184:187],a[248:251],a[168:171],v[184:187]
s_xor_b32 s42,s42,0x10000
mf v[184:187],a[252:255],a[184:187],v[184:187]
mf v[188:191],a[252:255],a[188:191],v[60:63]
mf v[188:191],a[248:251],a[172:175],v[188:191]
v_max3_f32 v44,v8,v12,v16
mf v[188:191],a[244:247],a[156:159],v[188:191]
v_max_f32 v44,v44,v20
v_cmp_lt_f32 vcc,s62,v44
mf v[188:191],a[240:243],a[140:143],v[188:191]
s_waitcnt lgkmcnt(0)
s_cbranch_vccnz LDF0_rare
LDF0_post:
LDF1:
mf a[0:3],a[192:195],v[96:99],a[0:3]
v_add_f32 v40,v40,v8
v_add_f32 v41,v41,v12
mf a[0:3],a[196:199],v[112:115],a[0:3]
ds_read_b128 a[224:227],v4 offset:4096
s_add_u32 m0,s43,0
mf a[16:19],a[204:207],v[112:115],a[16:19]
ds_read_b128 a[232:235],v4 offset:5120
ds_read_b128 a[228:231],v4 offset:12288
mf a[16:19],a[200:203],v[96:99],a[16:19]
v_exp_f32 v24,v128
mf a[20:23],a[200:203],v[100:103],a[20:23]
ds_read_b128 a[236:239],v4 offset:13312
buffer_load_dwordx4 v2,s[16:19],s40 offen sc1 lds
mf a[20:23],a[204:207],v[116:119],a[20:23]
v_exp_f32 v25,v129
mf a[4:7],a[196:199],v[116:119],a[4:7]
v_add_f32 v42,v42,v16
v_add_f32 v43,v43,v20
mf a[4:7],a[192:195],v[100:103],a[4:7]
v_exp_f32 v26,v130
mf a[8:11],a[192:195],v[104:107],a[8:11]
ds_read_b128 a[244:247],v4 offset:14336
ds_read_b128 a[240:243],v4 offset:6144
mf a[8:11],a[196:199],v[120:123],a[8:11]
v_exp_f32 v27,v131
mf a[24:27],a[204:207],v[120:123],a[24:27]
cvt v64,v24,v25
cvt v65,v26,v27
mf a[24:27],a[200:203],v[104:107],a[24:27]
v_exp_f32 v28,v144
mf a[28:31],a[200:203],v[108:111],a[28:31]
ds_read_b128 a[252:255],v4 offset:15360
ds_read_b128 a[248:251],v4 offset:7168
mf a[28:31],a[204:207],v[124:127],a[28:31]
v_exp_f32 v29,v145
mf a[12:15],a[196:199],v[124:127],a[12:15]
v_exp_f32 v30,v146
mf a[12:15],a[192:195],v[108:111],a[12:15]
v_exp_f32 v31,v147
mf a[44:47],a[208:211],v[108:111],a[44:47]
cvt v66,v28,v29
cvt v67,v30,v31
mf a[44:47],a[212:215],v[124:127],a[44:47]
v_exp_f32 v32,v160
mf a[60:63],a[220:223],v[124:127],a[60:63]
v_exp_f32 v33,v161
mf a[60:63],a[216:219],v[108:111],a[60:63]
v_exp_f32 v34,v162
mf v[8:11],v[36:39],v[64:67],0
mf a[56:59],a[216:219],v[104:107],a[56:59]
buffer_load_dwordx4 v2,s[16:19],s40 offen offset:1024 sc1 lds
mf a[56:59],a[220:223],v[120:123],a[56:59]
v_exp_f32 v35,v163
mf a[40:43],a[212:215],v[120:123],a[40:43]
cvt v80,v32,v33
cvt v81,v34,v35
mf a[40:43],a[208:211],v[104:107],a[40:43]
v_exp_f32 v24,v176
mf a[36:39],a[208:211],v[100:103],a[36:39]
v_exp_f32 v25,v177
mf a[36:39],a[212:215],v[116:119],a[36:39]
mf a[52:55],a[220:223],v[116:119],a[52:55]
v_exp_f32 v26,v178
mf a[52:55],a[216:219],v[100:103],a[52:55]
mf a[48:51],a[216:219],v[96:99],a[48:51]
v_exp_f32 v27,v179
mf a[48:51],a[220:223],v[112:115],a[48:51]
cvt v82,v24,v25
cvt v83,v26,v27
mf a[32:35],a[212:215],v[112:115],a[32:35]
s_waitcnt lgkmcnt(0)
mf a[32:35],a[208:211],v[96:99],a[32:35]
v_exp_f32 v28,v132
mf v[8:11],v[36:39],v[80:83],v[8:11]
v_exp_f32 v29,v133
mf a[64:67],a[224:227],v[96:99],a[64:67]
ds_read_b128 a[196:199],v4 offset:17408
ds_read_b128 a[192:195],v4 offset:16384
mf a[64:67],a[228:231],v[112:115],a[64:67]
ds_read_b128 a[204:207],v4 offset:19456
ds_read_b128 a[200:203],v4 offset:18432
mf a[80:83],a[236:239],v[112:115],a[80:83]
ds_read_b128 a[212:215],v4 offset:21504
ds_read_b128 a[208:211],v4 offset:20480
mf a[80:83],a[232:235],v[96:99],a[80:83]
ds_read_b128 a[220:223],v4 offset:23552
ds_read_b128 a[216:219],v4 offset:22528
mf a[84:87],a[232:235],v[100:103],a[84:87]
v_exp_f32 v30,v134
mf a[84:87],a[236:239],v[116:119],a[84:87]
buffer_load_dwordx4 v2,s[16:19],s40 offen offset:2048 sc1 lds
mf a[68:71],a[228:231],v[116:119],a[68:71]
v_exp_f32 v31,v135
mf a[68:71],a[224:227],v[100:103],a[68:71]
cvt v68,v28,v29
cvt v69,v30,v31
mf a[72:75],a[224:227],v[104:107],a[72:75]
v_exp_f32 v32,v148
mf a[72:75],a[228:231],v[120:123],a[72:75]
v_exp_f32 v33,v149
mf a[88:91],a[236:239],v[120:123],a[88:91]
v_exp_f32 v34,v150
mf a[88:91],a[232:235],v[104:107],a[88:91]
v_exp_f32 v35,v151
mf a[92:95],a[232:235],v[108:111],a[92:95]
cvt v70,v32,v33
cvt v71,v34,v35
mf a[92:95],a[236:239],v[124:127],a[92:95]
v_exp_f32 v24,v164
mf a[76:79],a[228:231],v[124:127],a[76:79]
v_exp_f32 v25,v165
mf a[76:79],a[224:227],v[108:111],a[76:79]
mf v[12:15],v[36:39],v[68:71],0
v_exp_f32 v26,v166
mf a[108:111],a[240:243],v[108:111],a[108:111]
mf a[108:111],a[244:247],v[124:127],a[108:111]
v_exp_f32 v27,v167
mf a[124:127],a[252:255],v[124:127],a[124:127]
cvt v84,v24,v25
cvt v85,v26,v27
mf a[124:127],a[248:251],v[108:111],a[124:127]
v_exp_f32 v28,v180
mf a[120:123],a[248:251],v[104:107],a[120:123]
mf a[120:123],a[252:255],v[120:123],a[120:123]
v_exp_f32 v29,v181
mf a[104:107],a[244:247],v[120:123],a[104:107]
buffer_load_dwordx4 v2,s[16:19],s40 offen offset:3072 sc1 lds
mf a[104:107],a[240:243],v[104:107],a[104:107]
v_exp_f32 v30,v182
mf a[100:103],a[240:243],v[100:103],a[100:103]
mf a[100:103],a[244:247],v[116:119],a[100:103]
v_exp_f32 v31,v183
mf a[116:119],a[252:255],v[116:119],a[116:119]
cvt v86,v28,v29
cvt v87,v30,v31
mf a[116:119],a[248:251],v[100:103],a[116:119]
v_exp_f32 v32,v136
mf a[112:115],a[248:251],v[96:99],a[112:115]
mf a[112:115],a[252:255],v[112:115],a[112:115]
v_exp_f32 v33,v137
mf v[12:15],v[36:39],v[84:87],v[12:15]
s_waitcnt lgkmcnt(0)
mf a[96:99],a[244:247],v[112:115],a[96:99]
v_exp_f32 v34,v138
mf a[96:99],a[240:243],v[96:99],a[96:99]
mf v[204:207],a[192:195],a[140:143],v[60:63]
ds_read_b128 a[228:231],v4 offset:25600
ds_read_b128 a[224:227],v4 offset:24576
mf v[204:207],a[196:199],a[156:159],v[204:207]
ds_read_b128 a[236:239],v4 offset:27648
ds_read_b128 a[232:235],v4 offset:26624
mf v[204:207],a[200:203],a[172:175],v[204:207]
ds_read_b128 a[244:247],v4 offset:29696
ds_read_b128 a[240:243],v4 offset:28672
mf v[204:207],a[204:207],a[188:191],v[204:207]
ds_read_b128 a[252:255],v4 offset:31744
ds_read_b128 a[248:251],v4 offset:30720
mf v[200:203],a[204:207],a[184:187],v[56:59]
v_exp_f32 v35,v139
mf v[200:203],a[200:203],a[168:171],v[200:203]
cvt v72,v32,v33
cvt v73,v34,v35
mf v[200:203],a[196:199],a[152:155],v[200:203]
v_exp_f32 v24,v152
mf v[200:203],a[192:195],a[136:139],v[200:203]
s_add_u32 m0,s43,16384
s_nop 0
buffer_load_dwordx4 v0,s[16:19],s40 offen sc1 lds
mf v[196:199],a[192:195],a[132:135],v[52:55]
v_exp_f32 v25,v153
mf v[196:199],a[196:199],a[148:151],v[196:199]
v_exp_f32 v26,v154
mf v[196:199],a[200:203],a[164:167],v[196:199]
v_exp_f32 v27,v155
mf v[196:199],a[204:207],a[180:183],v[196:199]
cvt v74,v24,v25
cvt v75,v26,v27
mf v[192:195],a[204:207],a[176:179],v[48:51]
v_exp_f32 v28,v168
mf v[192:195],a[200:203],a[160:163],v[192:195]
v_exp_f32 v29,v169
mf v[192:195],a[196:199],a[144:147],v[192:195]
v_exp_f32 v30,v170
mf v[192:195],a[192:195],a[128:131],v[192:195]
v_exp_f32 v31,v171
mf v[16:19],v[36:39],v[72:75],0
cvt v88,v28,v29
cvt v89,v30,v31
mf v[208:211],a[208:211],a[128:131],v[48:51]
v_exp_f32 v32,v184
mf v[208:211],a[212:215],a[144:147],v[208:211]
mf v[208:211],a[216:219],a[160:163],v[208:211]
v_exp_f32 v33,v185
mf v[208:211],a[220:223],a[176:179],v[208:211]
mf v[212:215],a[220:223],a[180:183],v[52:55]
v_exp_f32 v34,v186
mf v[212:215],a[216:219],a[164:167],v[212:215]
mf v[212:215],a[212:215],a[148:151],v[212:215]
v_exp_f32 v35,v187
mf v[212:215],a[208:211],a[132:135],v[212:215]
cvt v90,v32,v33
cvt v91,v34,v35
mf v[216:219],a[208:211],a[136:139],v[56:59]
buffer_load_dwordx4 v0,s[16:19],s40 offen offset:1024 sc1 lds
mf v[216:219],a[212:215],a[152:155],v[216:219]
v_exp_f32 v24,v140
mf v[216:219],a[216:219],a[168:171],v[216:219]
v_exp_f32 v25,v141
mf v[216:219],a[220:223],a[184:187],v[216:219]
mf v[16:19],v[36:39],v[88:91],v[16:19]
v_exp_f32 v26,v142
mf v[220:223],a[220:223],a[188:191],v[60:63]
mf v[220:223],a[216:219],a[172:175],v[220:223]
v_exp_f32 v27,v143
mf v[220:223],a[212:215],a[156:159],v[220:223]
cvt v76,v24,v25
cvt v77,v26,v27
mf v[220:223],a[208:211],a[140:143],v[220:223]
s_waitcnt lgkmcnt(0)
mf v[236:239],a[224:227],a[140:143],v[60:63]
s_waitcnt vmcnt(14)
s_barrier
mf v[236:239],a[228:231],a[156:159],v[236:239]
ds_read_b128 a[196:199],v3 offset:8192
ds_read_b128 a[192:195],v3 offset:0
mf v[236:239],a[232:235],a[172:175],v[236:239]
ds_read_b128 a[204:207],v3 offset:9216
ds_read_b128 a[200:203],v3 offset:1024
mf v[236:239],a[236:239],a[188:191],v[236:239]
v_exp_f32 v28,v156
mf v[232:235],a[236:239],a[184:187],v[56:59]
ds_read_b128 a[212:215],v3 offset:10240
ds_read_b128 a[208:211],v3 offset:2048
mf v[232:235],a[232:235],a[168:171],v[232:235]
v_exp_f32 v29,v157
mf v[232:235],a[228:231],a[152:155],v[232:235]
ds_read_b128 a[220:223],v3 offset:11264
ds_read_b128 a[216:219],v3 offset:3072
mf v[232:235],a[224:227],a[136:139],v[232:235]
v_exp_f32 v30,v158
mf v[228:231],a[224:227],a[132:135],v[52:55]
v_xor_b32 v4,0x10000,v4
mf v[228:231],a[228:231],a[148:151],v[228:231]
v_exp_f32 v31,v159
mf v[228:231],a[232:235],a[164:167],v[228:231]
cvt v78,v28,v29
cvt v79,v30,v31
mf v[228:231],a[236:239],a[180:183],v[228:231]
v_exp_f32 v32,v172
mf v[224:227],a[236:239],a[176:179],v[48:51]
buffer_load_dwordx4 v0,s[16:19],s40 offen offset:2048 sc1 lds
mf v[224:227],a[232:235],a[160:163],v[224:227]
v_exp_f32 v33,v173
mf v[224:227],a[228:231],a[144:147],v[224:227]
v_exp_f32 v34,v174
mf v[224:227],a[224:227],a[128:131],v[224:227]
v_exp_f32 v35,v175
mf v[20:23],v[36:39],v[76:79],0
cvt v92,v32,v33
cvt v93,v34,v35
mf v[240:243],a[240:243],a[128:131],v[48:51]
v_exp_f32 v24,v188
mf v[240:243],a[244:247],a[144:147],v[240:243]
v_exp_f32 v25,v189
mf v[240:243],a[248:251],a[160:163],v[240:243]
v_exp_f32 v26,v190
mf v[240:243],a[252:255],a[176:179],v[240:243]
mf v[244:247],a[252:255],a[180:183],v[52:55]
v_exp_f32 v27,v191
mf v[244:247],a[248:251],a[164:167],v[244:247]
cvt v94,v24,v25
cvt v95,v26,v27
mf v[244:247],a[244:247],a[148:151],v[244:247]
mf v[244:247],a[240:243],a[132:135],v[244:247]
mf v[20:23],v[36:39],v[92:95],v[20:23]
mf v[248:251],a[240:243],a[136:139],v[56:59]
mf v[248:251],a[244:247],a[152:155],v[248:251]
buffer_load_dwordx4 v0,s[16:19],s40 offen offset:3072 sc1 lds
s_add_u32 s40,s40,32768
mf v[248:251],a[248:251],a[168:171],v[248:251]
s_xor_b32 s43,s43,0x10000
s_sub_u32 s44,s44,1
mf v[248:251],a[252:255],a[184:187],v[248:251]
s_cmp_lg_u32 s44,0
mf v[252:255],a[252:255],a[188:191],v[60:63]
mf v[252:255],a[248:251],a[172:175],v[252:255]
v_max3_f32 v44,v8,v12,v16
mf v[252:255],a[244:247],a[156:159],v[252:255]
v_max_f32 v44,v44,v20
v_cmp_lt_f32 vcc,s62,v44
mf v[252:255],a[240:243],a[140:143],v[252:255]
s_waitcnt lgkmcnt(0)
s_cbranch_vccnz LDF1_rare
LDF1_post:
s_cbranch_scc1 LDF0
LDM0:
mf a[0:3],a[192:195],v[64:67],a[0:3]
v_add_f32 v40,v40,v8
v_add_f32 v41,v41,v12
mf a[0:3],a[196:199],v[80:83],a[0:3]
ds_read_b128 a[224:227],v3 offset:4096
s_add_u32 m0,s42,0
mf a[16:19],a[204:207],v[80:83],a[16:19]
v_cmp_le_i32 s[64:65],0,v5
v_cmp_le_i32 s[66:67],1,v5
mf a[16:19],a[200:203],v[64:67],a[16:19]
v_exp_f32 v24,v192
mf a[20:23],a[200:203],v[68:71],a[20:23]
ds_read_b128 a[228:231],v3 offset:12288
buffer_load_dwordx4 v2,s[16:19],s40 offen sc1 lds
mf a[20:23],a[204:207],v[84:87],a[20:23]
v_exp_f32 v25,v193
mf a[4:7],a[196:199],v[84:87],a[4:7]
v_add_f32 v42,v42,v16
v_add_f32 v43,v43,v20
mf a[4:7],a[192:195],v[68:71],a[4:7]
v_exp_f32 v26,v194
mf a[8:11],a[192:195],v[72:75],a[8:11]
v_cmp_le_i32 s[68:69],2,v5
v_cmp_le_i32 s[70:71],3,v5
mf a[8:11],a[196:199],v[88:91],a[8:11]
v_exp_f32 v27,v195
mf a[24:27],a[204:207],v[88:91],a[24:27]
cvt v96,v24,v25
cvt v97,v26,v27
mf a[24:27],a[200:203],v[72:75],a[24:27]
v_exp_f32 v28,v208
mf a[28:31],a[200:203],v[76:79],a[28:31]
v_cndmask_b32 v136,v7,v56,s[64:65]
v_cmp_le_i32 s[72:73],16,v5
mf a[28:31],a[204:207],v[92:95],a[28:31]
v_exp_f32 v29,v209
mf a[12:15],a[196:199],v[92:95],a[12:15]
v_cndmask_b32 v137,v7,v56,s[66:67]
v_cmp_le_i32 s[74:75],17,v5
mf a[12:15],a[192:195],v[76:79],a[12:15]
v_exp_f32 v30,v210
mf a[44:47],a[208:211],v[76:79],a[44:47]
v_cndmask_b32 v138,v7,v56,s[68:69]
v_cmp_le_i32 s[76:77],18,v5
mf a[44:47],a[212:215],v[92:95],a[44:47]
v_exp_f32 v31,v211
mf a[60:63],a[220:223],v[92:95],a[60:63]
cvt v98,v28,v29
cvt v99,v30,v31
mf a[60:63],a[216:219],v[76:79],a[60:63]
v_exp_f32 v32,v224
mf a[56:59],a[216:219],v[72:75],a[56:59]
v_cndmask_b32 v139,v7,v56,s[70:71]
v_cmp_le_i32 s[78:79],19,v5
mf a[56:59],a[220:223],v[88:91],a[56:59]
v_exp_f32 v33,v225
mf v[8:11],v[36:39],v[96:99],0
ds_read_b128 a[232:235],v3 offset:5120
buffer_load_dwordx4 v2,s[16:19],s40 offen offset:1024 sc1 lds
mf a[40:43],a[212:215],v[88:91],a[40:43]
v_exp_f32 v34,v226
mf a[40:43],a[208:211],v[72:75],a[40:43]
v_cndmask_b32 v152,v7,v56,s[72:73]
v_cmp_le_i32 s[64:65],32,v5
mf a[36:39],a[208:211],v[68:71],a[36:39]
ds_read_b128 a[240:243],v3 offset:6144
ds_read_b128 a[236:239],v3 offset:13312
mf a[36:39],a[212:215],v[84:87],a[36:39]
ds_read_b128 a[248:251],v3 offset:7168
ds_read_b128 a[244:247],v3 offset:14336
mf a[52:55],a[220:223],v[84:87],a[52:55]
ds_read_b128 a[252:255],v3 offset:15360
mf a[52:55],a[216:219],v[68:71],a[52:55]
v_exp_f32 v35,v227
mf a[48:51],a[216:219],v[64:67],a[48:51]
v_exp_f32 v24,v240
mf a[48:51],a[220:223],v[80:83],a[48:51]
v_exp_f32 v25,v241
mf a[32:35],a[212:215],v[80:83],a[32:35]
v_exp_f32 v26,v242
v_cndmask_b32 v153,v7,v56,s[74:75]
v_cmp_le_i32 s[66:67],33,v5
mf a[32:35],a[208:211],v[64:67],a[32:35]
cvt v112,v32,v33
cvt v113,v34,v35
s_waitcnt lgkmcnt(0)
mf a[64:67],a[224:227],v[64:67],a[64:67]
v_exp_f32 v27,v243
mf a[64:67],a[228:231],v[80:83],a[64:67]
cvt v114,v24,v25
cvt v115,v26,v27
mf a[80:83],a[236:239],v[80:83],a[80:83]
v_exp_f32 v28,v196
v_cndmask_b32 v154,v7,v56,s[76:77]
v_cmp_le_i32 s[68:69],34,v5
mf a[80:83],a[232:235],v[64:67],a[80:83]
v_cndmask_b32 v155,v7,v56,s[78:79]
v_cmp_le_i32 s[70:71],35,v5
mf v[8:11],v[36:39],v[112:115],v[8:11]
v_exp_f32 v29,v197
mf a[84:87],a[232:235],v[68:71],a[84:87]
v_cndmask_b32 v168,v7,v56,s[64:65]
v_cmp_le_i32 s[72:73],48,v5
mf a[84:87],a[236:239],v[84:87],a[84:87]
v_exp_f32 v30,v198
mf a[68:71],a[228:231],v[84:87],a[68:71]
ds_read_b128 a[192:195],v3 offset:16384
buffer_load_dwordx4 v2,s[16:19],s40 offen offset:2048 sc1 lds
mf a[68:71],a[224:227],v[68:71],a[68:71]
v_exp_f32 v31,v199
mf a[72:75],a[224:227],v[72:75],a[72:75]
v_exp_f32 v32,v212
mf a[72:75],a[228:231],v[88:91],a[72:75]
cvt v100,v28,v29
cvt v101,v30,v31
mf a[88:91],a[236:239],v[88:91],a[88:91]
v_exp_f32 v33,v213
mf a[88:91],a[232:235],v[72:75],a[88:91]
v_cndmask_b32 v169,v7,v56,s[66:67]
v_cmp_le_i32 s[74:75],49,v5
mf a[92:95],a[232:235],v[76:79],a[92:95]
v_exp_f32 v34,v214
mf a[92:95],a[236:239],v[92:95],a[92:95]
v_cndmask_b32 v170,v7,v56,s[68:69]
v_cmp_le_i32 s[76:77],50,v5
mf a[76:79],a[228:231],v[92:95],a[76:79]
v_exp_f32 v35,v215
mf a[76:79],a[224:227],v[76:79],a[76:79]
cvt v102,v32,v33
cvt v103,v34,v35
mf a[108:111],a[240:243],v[76:79],a[108:111]
v_exp_f32 v24,v228
mf a[108:111],a[244:247],v[92:95],a[108:111]
v_cndmask_b32 v171,v7,v56,s[70:71]
v_cmp_le_i32 s[78:79],51,v5
mf v[12:15],v[36:39],v[100:103],0
v_exp_f32 v25,v229
mf a[124:127],a[252:255],v[92:95],a[124:127]
v_cndmask_b32 v184,v7,v56,s[72:73]
v_cndmask_b32 v185,v7,v56,s[74:75]
mf a[124:127],a[248:251],v[76:79],a[124:127]
v_exp_f32 v26,v230
mf a[120:123],a[248:251],v[72:75],a[120:123]
ds_read_b128 a[200:203],v3 offset:18432
ds_read_b128 a[196:199],v3 offset:17408
mf a[120:123],a[252:255],v[88:91],a[120:123]
v_exp_f32 v27,v231
mf a[104:107],a[244:247],v[88:91],a[104:107]
cvt v116,v24,v25
cvt v117,v26,v27
mf a[104:107],a[240:243],v[72:75],a[104:107]
v_exp_f32 v28,v244
mf a[100:103],a[240:243],v[68:71],a[100:103]
ds_read_b128 a[208:211],v3 offset:20480
ds_read_b128 a[204:207],v3 offset:19456
mf a[100:103],a[244:247],v[84:87],a[100:103]
v_cndmask_b32 v186,v7,v56,s[76:77]
v_cndmask_b32 v187,v7,v56,s[78:79]
mf a[116:119],a[252:255],v[84:87],a[116:119]
ds_read_b128 a[216:219],v3 offset:22528
ds_read_b128 a[212:215],v3 offset:21504
mf a[116:119],a[248:251],v[68:71],a[116:119]
ds_read_b128 a[220:223],v3 offset:23552
buffer_load_dwordx4 v2,s[16:19],s40 offen offset:3072 sc1 lds
mf a[112:115],a[248:251],v[64:67],a[112:115]
v_exp_f32 v29,v245
mf a[112:115],a[252:255],v[80:83],a[112:115]
v_exp_f32 v30,v246
mf a[96:99],a[244:247],v[80:83],a[96:99]
v_exp_f32 v31,v247
mf a[96:99],a[240:243],v[64:67],a[96:99]
v_exp_f32 v32,v200
s_waitcnt lgkmcnt(0)
mf v[140:143],a[192:195],a[140:143],v[60:63]
cvt v118,v28,v29
cvt v119,v30,v31
mf v[140:143],a[196:199],a[156:159],v[140:143]
v_exp_f32 v33,v201
mf v[140:143],a[200:203],a[172:175],v[140:143]
ds_read_b128 a[228:231],v3 offset:25600
ds_read_b128 a[224:227],v3 offset:24576
mf v[140:143],a[204:207],a[188:191],v[140:143]
v_exp_f32 v34,v202
mf v[12:15],v[36:39],v[116:119],v[12:15]
ds_read_b128 a[236:239],v3 offset:27648
ds_read_b128 a[232:235],v3 offset:26624
mf v[136:139],a[204:207],a[184:187],v[136:139]
v_exp_f32 v35,v203
mf v[136:139],a[200:203],a[168:171],v[136:139]
cvt v104,v32,v33
cvt v105,v34,v35
mf v[136:139],a[196:199],a[152:155],v[136:139]
v_exp_f32 v24,v216
mf v[136:139],a[192:195],a[136:139],v[136:139]
s_add_u32 m0,s42,16384
s_nop 0
buffer_load_dwordx4 v0,s[16:19],s40 offen sc1 lds
mf v[132:135],a[192:195],a[132:135],v[52:55]
v_exp_f32 v25,v217
mf v[132:135],a[196:199],a[148:151],v[132:135]
ds_read_b128 a[244:247],v3 offset:29696
ds_read_b128 a[240:243],v3 offset:28672
mf v[132:135],a[200:203],a[164:167],v[132:135]
v_exp_f32 v26,v218
mf v[132:135],a[204:207],a[180:183],v[132:135]
ds_read_b128 a[252:255],v3 offset:31744
ds_read_b128 a[248:251],v3 offset:30720
mf v[128:131],a[204:207],a[176:179],v[48:51]
v_exp_f32 v27,v219
mf v[128:131],a[200:203],a[160:163],v[128:131]
cvt v106,v24,v25
cvt v107,v26,v27
mf v[128:131],a[196:199],a[144:147],v[128:131]
v_exp_f32 v28,v232
mf v[128:131],a[192:195],a[128:131],v[128:131]
v_exp_f32 v29,v233
mf v[16:19],v[36:39],v[104:107],0
v_exp_f32 v30,v234
mf v[144:147],a[208:211],a[128:131],v[48:51]
v_exp_f32 v31,v235
mf v[144:147],a[212:215],a[144:147],v[144:147]
cvt v120,v28,v29
cvt v121,v30,v31
mf v[144:147],a[216:219],a[160:163],v[144:147]
v_exp_f32 v32,v248
mf v[144:147],a[220:223],a[176:179],v[144:147]
v_exp_f32 v33,v249
mf v[148:151],a[220:223],a[180:183],v[52:55]
v_exp_f32 v34,v250
mf v[148:151],a[216:219],a[164:167],v[148:151]
mf v[148:151],a[212:215],a[148:151],v[148:151]
v_exp_f32 v35,v251
mf v[148:151],a[208:211],a[132:135],v[148:151]
cvt v122,v32,v33
cvt v123,v34,v35
mf v[152:155],a[208:211],a[136:139],v[152:155]
buffer_load_dwordx4 v0,s[16:19],s40 offen offset:1024 sc1 lds
mf v[152:155],a[212:215],a[152:155],v[152:155]
v_exp_f32 v24,v204
mf v[152:155],a[216:219],a[168:171],v[152:155]
v_exp_f32 v25,v205
mf v[152:155],a[220:223],a[184:187],v[152:155]
mf v[16:19],v[36:39],v[120:123],v[16:19]
v_exp_f32 v26,v206
mf v[156:159],a[220:223],a[188:191],v[60:63]
mf v[156:159],a[216:219],a[172:175],v[156:159]
v_exp_f32 v27,v207
mf v[156:159],a[212:215],a[156:159],v[156:159]
cvt v108,v24,v25
cvt v109,v26,v27
mf v[156:159],a[208:211],a[140:143],v[156:159]
s_waitcnt lgkmcnt(0)
mf v[172:175],a[224:227],a[140:143],v[60:63]
s_waitcnt vmcnt(14)
s_barrier
mf v[172:175],a[228:231],a[156:159],v[172:175]
ds_read_b128 a[196:199],v4 offset:8192
ds_read_b128 a[192:195],v4 offset:0
mf v[172:175],a[232:235],a[172:175],v[172:175]
ds_read_b128 a[204:207],v4 offset:9216
ds_read_b128 a[200:203],v4 offset:1024
mf v[172:175],a[236:239],a[188:191],v[172:175]
v_exp_f32 v28,v220
mf v[168:171],a[236:239],a[184:187],v[168:171]
ds_read_b128 a[212:215],v4 offset:10240
ds_read_b128 a[208:211],v4 offset:2048
mf v[168:171],a[232:235],a[168:171],v[168:171]
v_exp_f32 v29,v221
mf v[168:171],a[228:231],a[152:155],v[168:171]
ds_read_b128 a[220:223],v4 offset:11264
ds_read_b128 a[216:219],v4 offset:3072
mf v[168:171],a[224:227],a[136:139],v[168:171]
v_exp_f32 v30,v222
mf v[164:167],a[224:227],a[132:135],v[52:55]
v_xor_b32 v3,0x10000,v3
mf v[164:167],a[228:231],a[148:151],v[164:167]
v_exp_f32 v31,v223
mf v[164:167],a[232:235],a[164:167],v[164:167]
cvt v110,v28,v29
cvt v111,v30,v31
mf v[164:167],a[236:239],a[180:183],v[164:167]
v_exp_f32 v32,v236
mf v[160:163],a[236:239],a[176:179],v[48:51]
buffer_load_dwordx4 v0,s[16:19],s40 offen offset:2048 sc1 lds
mf v[160:163],a[232:235],a[160:163],v[160:163]
v_exp_f32 v33,v237
mf v[160:163],a[228:231],a[144:147],v[160:163]
v_exp_f32 v34,v238
mf v[160:163],a[224:227],a[128:131],v[160:163]
v_exp_f32 v35,v239
mf v[20:23],v[36:39],v[108:111],0
cvt v124,v32,v33
cvt v125,v34,v35
mf v[176:179],a[240:243],a[128:131],v[48:51]
v_exp_f32 v24,v252
mf v[176:179],a[244:247],a[144:147],v[176:179]
v_exp_f32 v25,v253
mf v[176:179],a[248:251],a[160:163],v[176:179]
v_exp_f32 v26,v254
mf v[176:179],a[252:255],a[176:179],v[176:179]
mf v[180:183],a[252:255],a[180:183],v[52:55]
v_exp_f32 v27,v255
mf v[180:183],a[248:251],a[164:167],v[180:183]
cvt v126,v24,v25
cvt v127,v26,v27
mf v[180:183],a[244:247],a[148:151],v[180:183]
mf v[180:183],a[240:243],a[132:135],v[180:183]
mf v[20:23],v[36:39],v[124:127],v[20:23]
mf v[184:187],a[240:243],a[136:139],v[184:187]
mf v[184:187],a[244:247],a[152:155],v[184:187]
buffer_load_dwordx4 v0,s[16:19],s40 offen offset:3072 sc1 lds
s_add_u32 s40,s40,32768
mf v[184:187],a[248:251],a[168:171],v[184:187]
s_xor_b32 s42,s42,0x10000
mf v[184:187],a[252:255],a[184:187],v[184:187]
mf v[188:191],a[252:255],a[188:191],v[60:63]
mf v[188:191],a[248:251],a[172:175],v[188:191]
v_max3_f32 v44,v8,v12,v16
mf v[188:191],a[244:247],a[156:159],v[188:191]
v_max_f32 v44,v44,v20
v_cmp_lt_f32 vcc,s62,v44
mf v[188:191],a[240:243],a[140:143],v[188:191]
s_waitcnt lgkmcnt(0)
s_cbranch_vccnz LDM0_rare
LDM0_post:
LDM1:
mf a[0:3],a[192:195],v[96:99],a[0:3]
v_add_f32 v40,v40,v8
v_add_f32 v41,v41,v12
mf a[0:3],a[196:199],v[112:115],a[0:3]
ds_read_b128 a[224:227],v4 offset:4096
s_add_u32 m0,s43,0
mf a[16:19],a[204:207],v[112:115],a[16:19]
v_cmp_le_i32 s[64:65],0,v5
v_cmp_le_i32 s[66:67],1,v5
mf a[16:19],a[200:203],v[96:99],a[16:19]
v_exp_f32 v24,v128
mf a[20:23],a[200:203],v[100:103],a[20:23]
ds_read_b128 a[228:231],v4 offset:12288
buffer_load_dwordx4 v2,s[16:19],s40 offen sc1 lds
mf a[20:23],a[204:207],v[116:119],a[20:23]
v_exp_f32 v25,v129
mf a[4:7],a[196:199],v[116:119],a[4:7]
v_exp_f32 v26,v130
mf a[4:7],a[192:195],v[100:103],a[4:7]
v_add_f32 v42,v42,v16
v_add_f32 v43,v43,v20
mf a[8:11],a[192:195],v[104:107],a[8:11]
v_exp_f32 v27,v131
v_cmp_le_i32 s[68:69],2,v5
v_cmp_le_i32 s[70:71],3,v5
mf a[8:11],a[196:199],v[120:123],a[8:11]
cvt v64,v24,v25
cvt v65,v26,v27
mf a[24:27],a[204:207],v[120:123],a[24:27]
v_exp_f32 v28,v144
mf a[24:27],a[200:203],v[104:107],a[24:27]
v_exp_f32 v29,v145
mf a[28:31],a[200:203],v[108:111],a[28:31]
v_cndmask_b32 v204,v7,v60,s[64:65]
v_cmp_le_i32 s[72:73],16,v5
mf a[28:31],a[204:207],v[124:127],a[28:31]
v_exp_f32 v30,v146
mf a[12:15],a[196:199],v[124:127],a[12:15]
v_cndmask_b32 v205,v7,v60,s[66:67]
v_cmp_le_i32 s[74:75],17,v5
mf a[12:15],a[192:195],v[108:111],a[12:15]
v_exp_f32 v31,v147
mf a[44:47],a[208:211],v[108:111],a[44:47]
cvt v66,v28,v29
cvt v67,v30,v31
mf a[44:47],a[212:215],v[124:127],a[44:47]
v_exp_f32 v32,v160
mf a[60:63],a[220:223],v[124:127],a[60:63]
v_exp_f32 v33,v161
mf a[60:63],a[216:219],v[108:111],a[60:63]
ds_read_b128 a[232:235],v4 offset:5120
buffer_load_dwordx4 v2,s[16:19],s40 offen offset:1024 sc1 lds
mf v[8:11],v[36:39],v[64:67],0
v_exp_f32 v34,v162
v_cndmask_b32 v206,v7,v60,s[68:69]
v_cmp_le_i32 s[76:77],18,v5
mf a[56:59],a[216:219],v[104:107],a[56:59]
v_cndmask_b32 v207,v7,v60,s[70:71]
v_cmp_le_i32 s[78:79],19,v5
mf a[56:59],a[220:223],v[120:123],a[56:59]
v_exp_f32 v35,v163
mf a[40:43],a[212:215],v[120:123],a[40:43]
v_exp_f32 v24,v176
mf a[40:43],a[208:211],v[104:107],a[40:43]
cvt v80,v32,v33
cvt v81,v34,v35
mf a[36:39],a[208:211],v[100:103],a[36:39]
ds_read_b128 a[240:243],v4 offset:6144
ds_read_b128 a[236:239],v4 offset:13312
mf a[36:39],a[212:215],v[116:119],a[36:39]
ds_read_b128 a[248:251],v4 offset:7168
ds_read_b128 a[244:247],v4 offset:14336
mf a[52:55],a[220:223],v[116:119],a[52:55]
v_cndmask_b32 v220,v7,v60,s[72:73]
v_cmp_le_i32 s[64:65],32,v5
mf a[52:55],a[216:219],v[100:103],a[52:55]
ds_read_b128 a[252:255],v4 offset:15360
v_exp_f32 v25,v177
mf a[48:51],a[216:219],v[96:99],a[48:51]
v_exp_f32 v26,v178
mf a[48:51],a[220:223],v[112:115],a[48:51]
v_exp_f32 v27,v179
mf a[32:35],a[212:215],v[112:115],a[32:35]
v_exp_f32 v28,v132
v_cndmask_b32 v221,v7,v60,s[74:75]
v_cmp_le_i32 s[66:67],33,v5
mf a[32:35],a[208:211],v[96:99],a[32:35]
v_exp_f32 v29,v133
s_waitcnt lgkmcnt(0)
mf a[64:67],a[224:227],v[96:99],a[64:67]
cvt v82,v24,v25
cvt v83,v26,v27
mf a[64:67],a[228:231],v[112:115],a[64:67]
v_exp_f32 v30,v134
mf a[80:83],a[236:239],v[112:115],a[80:83]
v_exp_f32 v31,v135
v_cndmask_b32 v222,v7,v60,s[76:77]
v_cmp_le_i32 s[68:69],34,v5
mf a[80:83],a[232:235],v[96:99],a[80:83]
cvt v68,v28,v29
cvt v69,v30,v31
mf v[8:11],v[36:39],v[80:83],v[8:11]
v_exp_f32 v32,v148
mf a[84:87],a[232:235],v[100:103],a[84:87]
ds_read_b128 a[192:195],v4 offset:16384
buffer_load_dwordx4 v2,s[16:19],s40 offen offset:2048 sc1 lds
mf a[84:87],a[236:239],v[116:119],a[84:87]
v_exp_f32 v33,v149
v_cndmask_b32 v223,v7,v60,s[78:79]
v_cmp_le_i32 s[70:71],35,v5
mf a[68:71],a[228:231],v[116:119],a[68:71]
v_exp_f32 v34,v150
mf a[68:71],a[224:227],v[100:103],a[68:71]
v_cndmask_b32 v236,v7,v60,s[64:65]
v_cmp_le_i32 s[72:73],48,v5
mf a[72:75],a[224:227],v[104:107],a[72:75]
v_exp_f32 v35,v151
mf a[72:75],a[228:231],v[120:123],a[72:75]
cvt v70,v32,v33
cvt v71,v34,v35
mf a[88:91],a[236:239],v[120:123],a[88:91]
v_exp_f32 v24,v164
mf a[88:91],a[232:235],v[104:107],a[88:91]
v_exp_f32 v25,v165
mf v[12:15],v[36:39],v[68:71],0
v_cndmask_b32 v237,v7,v60,s[66:67]
v_cmp_le_i32 s[74:75],49,v5
mf a[92:95],a[232:235],v[108:111],a[92:95]
v_exp_f32 v26,v166
mf a[92:95],a[236:239],v[124:127],a[92:95]
v_cndmask_b32 v238,v7,v60,s[68:69]
v_cmp_le_i32 s[76:77],50,v5
mf a[76:79],a[228:231],v[124:127],a[76:79]
v_exp_f32 v27,v167
mf a[76:79],a[224:227],v[108:111],a[76:79]
cvt v84,v24,v25
cvt v85,v26,v27
mf a[108:111],a[240:243],v[108:111],a[108:111]
v_exp_f32 v28,v180
mf a[108:111],a[244:247],v[124:127],a[108:111]
v_exp_f32 v29,v181
mf a[124:127],a[252:255],v[124:127],a[124:127]
ds_read_b128 a[196:199],v4 offset:17408
buffer_load_dwordx4 v2,s[16:19],s40 offen offset:3072 sc1 lds
mf a[124:127],a[248:251],v[108:111],a[124:127]
v_exp_f32 v30,v182
v_cndmask_b32 v239,v7,v60,s[70:71]
v_cmp_le_i32 s[78:79],51,v5
mf a[120:123],a[248:251],v[104:107],a[120:123]
v_cndmask_b32 v252,v7,v60,s[72:73]
v_cndmask_b32 v253,v7,v60,s[74:75]
mf a[120:123],a[252:255],v[120:123],a[120:123]
v_exp_f32 v31,v183
mf a[104:107],a[244:247],v[120:123],a[104:107]
v_exp_f32 v32,v136
mf a[104:107],a[240:243],v[104:107],a[104:107]
cvt v86,v28,v29
cvt v87,v30,v31
mf a[100:103],a[240:243],v[100:103],a[100:103]
ds_read_b128 a[204:207],v4 offset:19456
ds_read_b128 a[200:203],v4 offset:18432
mf a[100:103],a[244:247],v[116:119],a[100:103]
v_cndmask_b32 v254,v7,v60,s[76:77]
v_cndmask_b32 v255,v7,v60,s[78:79]
mf v[12:15],v[36:39],v[84:87],v[12:15]
ds_read_b128 a[212:215],v4 offset:21504
ds_read_b128 a[208:211],v4 offset:20480
mf a[116:119],a[252:255],v[116:119],a[116:119]
ds_read_b128 a[220:223],v4 offset:23552
ds_read_b128 a[216:219],v4 offset:22528
mf a[116:119],a[248:251],v[100:103],a[116:119]
v_exp_f32 v33,v137
mf a[112:115],a[248:251],v[96:99],a[112:115]
v_exp_f32 v34,v138
mf a[112:115],a[252:255],v[112:115],a[112:115]
v_exp_f32 v35,v139
mf a[96:99],a[244:247],v[112:115],a[96:99]
v_exp_f32 v24,v152
mf a[96:99],a[240:243],v[96:99],a[96:99]
v_exp_f32 v25,v153
s_add_u32 m0,s43,16384
s_waitcnt lgkmcnt(0)
mf v[204:207],a[192:195],a[140:143],v[204:207]
v_exp_f32 v26,v154
mf v[204:207],a[196:199],a[156:159],v[204:207]
v_exp_f32 v27,v155
mf v[204:207],a[200:203],a[172:175],v[204:207]
cvt v72,v32,v33
cvt v73,v34,v35
buffer_load_dwordx4 v0,s[16:19],s40 offen sc1 lds
mf v[204:207],a[204:207],a[188:191],v[204:207]
v_exp_f32 v28,v168
mf v[196:199],a[204:207],a[180:183],v[52:55]
cvt v74,v24,v25
cvt v75,v26,v27
mf v[196:199],a[200:203],a[164:167],v[196:199]
v_exp_f32 v29,v169
mf v[196:199],a[196:199],a[148:151],v[196:199]
v_exp_f32 v30,v170
mf v[196:199],a[192:195],a[132:135],v[196:199]
ds_read_b128 a[228:231],v4 offset:25600
ds_read_b128 a[224:227],v4 offset:24576
mf v[16:19],v[36:39],v[72:75],0
v_exp_f32 v31,v171
mf v[192:195],a[192:195],a[128:131],v[48:51]
cvt v88,v28,v29
cvt v89,v30,v31
mf v[192:195],a[196:199],a[144:147],v[192:195]
v_exp_f32 v32,v184
mf v[192:195],a[200:203],a[160:163],v[192:195]
ds_read_b128 a[236:239],v4 offset:27648
ds_read_b128 a[232:235],v4 offset:26624
mf v[192:195],a[204:207],a[176:179],v[192:195]
v_exp_f32 v33,v185
mf v[208:211],a[220:223],a[176:179],v[48:51]
v_exp_f32 v34,v186
mf v[208:211],a[216:219],a[160:163],v[208:211]
ds_read_b128 a[240:243],v4 offset:28672
buffer_load_dwordx4 v0,s[16:19],s40 offen offset:1024 sc1 lds
mf v[208:211],a[212:215],a[144:147],v[208:211]
v_exp_f32 v35,v187
mf v[208:211],a[208:211],a[128:131],v[208:211]
cvt v90,v32,v33
cvt v91,v34,v35
mf v[212:215],a[208:211],a[132:135],v[52:55]
v_exp_f32 v24,v140
mf v[212:215],a[212:215],a[148:151],v[212:215]
ds_read_b128 a[248:251],v4 offset:30720
ds_read_b128 a[244:247],v4 offset:29696
mf v[212:215],a[216:219],a[164:167],v[212:215]
ds_read_b128 a[252:255],v4 offset:31744
mf v[212:215],a[220:223],a[180:183],v[212:215]
v_exp_f32 v25,v141
mf v[16:19],v[36:39],v[88:91],v[16:19]
v_exp_f32 v26,v142
mf v[220:223],a[220:223],a[188:191],v[220:223]
v_exp_f32 v27,v143
mf v[220:223],a[216:219],a[172:175],v[220:223]
v_exp_f32 v28,v156
mf v[220:223],a[212:215],a[156:159],v[220:223]
cvt v76,v24,v25
cvt v77,v26,v27
mf v[220:223],a[208:211],a[140:143],v[220:223]
v_exp_f32 v29,v157
s_waitcnt lgkmcnt(0)
mf v[236:239],a[224:227],a[140:143],v[236:239]
s_waitcnt vmcnt(14)
s_barrier
mf v[236:239],a[228:231],a[156:159],v[236:239]
v_exp_f32 v30,v158
mf v[236:239],a[232:235],a[172:175],v[236:239]
ds_read_b128 a[196:199],v3 offset:8192
ds_read_b128 a[192:195],v3 offset:0
mf v[236:239],a[236:239],a[188:191],v[236:239]
v_exp_f32 v31,v159
mf v[228:231],a[236:239],a[180:183],v[52:55]
v_exp_f32 v32,v172
mf v[228:231],a[232:235],a[164:167],v[228:231]
cvt v78,v28,v29
cvt v79,v30,v31
mf v[228:231],a[228:231],a[148:151],v[228:231]
v_exp_f32 v33,v173
mf v[228:231],a[224:227],a[132:135],v[228:231]
ds_read_b128 a[200:203],v3 offset:1024
buffer_load_dwordx4 v0,s[16:19],s40 offen offset:2048 sc1 lds
mf v[20:23],v[36:39],v[76:79],0
v_exp_f32 v34,v174
mf v[224:227],a[224:227],a[128:131],v[48:51]
v_exp_f32 v35,v175
mf v[224:227],a[228:231],a[144:147],v[224:227]
cvt v92,v32,v33
cvt v93,v34,v35
mf v[224:227],a[232:235],a[160:163],v[224:227]
v_exp_f32 v24,v188
mf v[224:227],a[236:239],a[176:179],v[224:227]
ds_read_b128 a[208:211],v3 offset:2048
ds_read_b128 a[204:207],v3 offset:9216
mf v[240:243],a[252:255],a[176:179],v[48:51]
v_exp_f32 v25,v189
mf v[240:243],a[248:251],a[160:163],v[240:243]
v_exp_f32 v26,v190
mf v[240:243],a[244:247],a[144:147],v[240:243]
v_exp_f32 v27,v191
mf v[240:243],a[240:243],a[128:131],v[240:243]
cvt v94,v24,v25
cvt v95,v26,v27
mf v[244:247],a[240:243],a[132:135],v[52:55]
ds_read_b128 a[216:219],v3 offset:3072
ds_read_b128 a[212:215],v3 offset:10240
mf v[244:247],a[244:247],a[148:151],v[244:247]
ds_read_b128 a[220:223],v3 offset:11264
v_xor_b32 v4,0x10000,v4
mf v[244:247],a[248:251],a[164:167],v[244:247]
buffer_load_dwordx4 v0,s[16:19],s40 offen offset:3072 sc1 lds
s_add_u32 s40,s40,32768
mf v[20:23],v[36:39],v[92:95],v[20:23]
s_xor_b32 s43,s43,0x10000
mf v[244:247],a[252:255],a[180:183],v[244:247]
mf v[252:255],a[252:255],a[188:191],v[252:255]
mf v[252:255],a[248:251],a[172:175],v[252:255]
v_max3_f32 v44,v8,v12,v16
mf v[252:255],a[244:247],a[156:159],v[252:255]
s_nop 1
v_max_f32 v44,v44,v20
v_cmp_lt_f32 vcc,s62,v44
mf v[252:255],a[240:243],a[140:143],v[252:255]
s_waitcnt lgkmcnt(0)
s_cbranch_vccnz LDM1_rare
LDM1_post:
LT1:
mf a[0:3],a[192:195],v[64:67],a[0:3]
v_add_f32 v40,v40,v8
v_add_f32 v41,v41,v12
mf a[0:3],a[196:199],v[80:83],a[0:3]
s_waitcnt vmcnt(8)
ds_read_b64_tr_b16 v[136:137],v46
mf a[16:19],a[204:207],v[80:83],a[16:19]
ds_read_b64_tr_b16 v[138:139],v46 offset:4096
v_xor_b32 v46,32,v46
mf a[16:19],a[200:203],v[64:67],a[16:19]
v_exp_f32 v24,v192
mf a[20:23],a[200:203],v[68:71],a[20:23]
ds_read_b128 a[224:227],v3 offset:4096
ds_read_b64_tr_b16 v[152:153],v46
mf a[20:23],a[204:207],v[84:87],a[20:23]
v_exp_f32 v25,v193
mf a[4:7],a[196:199],v[84:87],a[4:7]
v_add_f32 v42,v42,v16
v_add_f32 v43,v43,v20
mf a[4:7],a[192:195],v[68:71],a[4:7]
v_exp_f32 v26,v194
mf a[8:11],a[192:195],v[72:75],a[8:11]
ds_read_b64_tr_b16 v[154:155],v46 offset:4096
v_xor_b32 v46,96,v46
mf a[8:11],a[196:199],v[88:91],a[8:11]
v_exp_f32 v27,v195
mf a[24:27],a[204:207],v[88:91],a[24:27]
cvt v96,v24,v25
cvt v97,v26,v27
ds_read_b64_tr_b16 v[168:169],v46
mf a[24:27],a[200:203],v[72:75],a[24:27]
v_exp_f32 v28,v208
ds_read_b64_tr_b16 v[170:171],v46 offset:4096
v_xor_b32 v46,32,v46
mf a[28:31],a[200:203],v[76:79],a[28:31]
ds_read_b128 a[228:231],v3 offset:12288
ds_read_b64_tr_b16 v[184:185],v46
mf a[28:31],a[204:207],v[92:95],a[28:31]
v_exp_f32 v29,v209
ds_read_b64_tr_b16 v[186:187],v46 offset:4096
v_xor_b32 v46,224,v46
mf a[12:15],a[196:199],v[92:95],a[12:15]
ds_read_b128 a[232:235],v3 offset:5120
ds_read_b64_tr_b16 v[200:201],v46
mf a[12:15],a[192:195],v[76:79],a[12:15]
v_exp_f32 v30,v210
ds_read_b64_tr_b16 v[202:203],v46 offset:4096
v_xor_b32 v46,32,v46
mf a[44:47],a[208:211],v[76:79],a[44:47]
ds_read_b128 a[236:239],v3 offset:13312
ds_read_b64_tr_b16 v[216:217],v46
mf a[44:47],a[212:215],v[92:95],a[44:47]
v_exp_f32 v31,v211
ds_read_b64_tr_b16 v[218:219],v46 offset:4096
v_xor_b32 v46,96,v46
mf a[60:63],a[220:223],v[92:95],a[60:63]
v_exp_f32 v32,v224
ds_read_b64_tr_b16 v[232:233],v46
mf a[60:63],a[216:219],v[76:79],a[60:63]
cvt v98,v28,v29
cvt v99,v30,v31
ds_read_b64_tr_b16 v[234:235],v46 offset:4096
v_xor_b32 v46,32,v46
ds_read_b64_tr_b16 v[248:249],v46
ds_read_b64_tr_b16 v[250:251],v46 offset:4096
v_lshrrev_b32 v45,3,v1
v_mul_u32_u24 v45,3456,v45
v_lshrrev_b32 v6,3,v1
v_and_b32 v6,6,v6
v_xor_b32 v6,v6,v1
v_and_b32 v6,7,v6
v_lshl_add_u32 v45,v6,4,v45
mf a[56:59],a[216:219],v[72:75],a[56:59]
v_exp_f32 v33,v225
mf a[56:59],a[220:223],v[88:91],a[56:59]
ds_read_b128 a[244:247],v3 offset:14336
ds_read_b128 a[240:243],v3 offset:6144
mf v[8:11],v[36:39],v[96:99],0
v_exp_f32 v34,v226
mf a[40:43],a[212:215],v[88:91],a[40:43]
ds_read_b128 a[248:251],v3 offset:7168
s_waitcnt lgkmcnt(14)
buffer_store_dwordx4 v[136:139],v2,s[36:39],s55 offen sc1
mf a[40:43],a[208:211],v[72:75],a[40:43]
v_exp_f32 v35,v227
mf a[36:39],a[208:211],v[68:71],a[36:39]
cvt v112,v32,v33
cvt v113,v34,v35
mf a[36:39],a[212:215],v[84:87],a[36:39]
v_exp_f32 v24,v240
mf a[52:55],a[220:223],v[84:87],a[52:55]
ds_read_b128 a[252:255],v3 offset:15360
mf a[52:55],a[216:219],v[68:71],a[52:55]
v_exp_f32 v25,v241
mf a[48:51],a[216:219],v[64:67],a[48:51]
s_waitcnt lgkmcnt(0)
mf a[48:51],a[220:223],v[80:83],a[48:51]
v_exp_f32 v26,v242
mf a[32:35],a[212:215],v[80:83],a[32:35]
s_waitcnt lgkmcnt(0)
mf a[32:35],a[208:211],v[64:67],a[32:35]
v_exp_f32 v27,v243
mf a[64:67],a[224:227],v[64:67],a[64:67]
cvt v114,v24,v25
cvt v115,v26,v27
s_add_u32 m0,s12,0
s_nop 0
buffer_load_dwordx4 v45,s[32:35],s6 offen lds
mf a[64:67],a[228:231],v[80:83],a[64:67]
v_exp_f32 v28,v196
mf a[80:83],a[236:239],v[80:83],a[80:83]
ds_read_b128 a[196:199],v3 offset:17408
ds_read_b128 a[192:195],v3 offset:16384
mf a[80:83],a[232:235],v[64:67],a[80:83]
v_exp_f32 v29,v197
mf v[8:11],v[36:39],v[112:115],v[8:11]
v_exp_f32 v30,v198
s_add_u32 m0,s12,1024
s_add_u32 s6,s6,27648
buffer_load_dwordx4 v45,s[32:35],s6 offen lds
mf a[84:87],a[232:235],v[68:71],a[84:87]
ds_read_b128 a[204:207],v3 offset:19456
ds_read_b128 a[200:203],v3 offset:18432
mf a[84:87],a[236:239],v[84:87],a[84:87]
v_exp_f32 v31,v199
mf a[68:71],a[228:231],v[84:87],a[68:71]
cvt v100,v28,v29
cvt v101,v30,v31
buffer_store_dwordx4 v[152:155],v2,s[36:39],s55 offen offset:1024 sc1
mf a[68:71],a[224:227],v[68:71],a[68:71]
v_exp_f32 v32,v212
mf a[72:75],a[224:227],v[72:75],a[72:75]
ds_read_b128 a[212:215],v3 offset:21504
ds_read_b128 a[208:211],v3 offset:20480
mf a[72:75],a[228:231],v[88:91],a[72:75]
v_exp_f32 v33,v213
s_add_u32 m0,s12,2048
s_add_u32 s6,s6,27648
buffer_load_dwordx4 v45,s[32:35],s6 offen lds
mf a[88:91],a[236:239],v[88:91],a[88:91]
ds_read_b128 a[220:223],v3 offset:23552
ds_read_b128 a[216:219],v3 offset:22528
mf a[88:91],a[232:235],v[72:75],a[88:91]
v_exp_f32 v34,v214
mf a[92:95],a[232:235],v[76:79],a[92:95]
s_add_u32 m0,s12,3072
s_add_u32 s6,s6,27648
buffer_load_dwordx4 v45,s[32:35],s6 offen lds
mf a[92:95],a[236:239],v[92:95],a[92:95]
v_exp_f32 v35,v215
mf a[76:79],a[228:231],v[92:95],a[76:79]
cvt v102,v32,v33
cvt v103,v34,v35
mf a[76:79],a[224:227],v[76:79],a[76:79]
v_exp_f32 v24,v228
buffer_store_dwordx4 v[168:171],v2,s[36:39],s55 offen offset:2048 sc1
mf a[108:111],a[240:243],v[76:79],a[108:111]
mf a[108:111],a[244:247],v[92:95],a[108:111]
v_exp_f32 v25,v229
mf v[12:15],v[36:39],v[100:103],0
s_add_u32 m0,s12,4096
s_add_u32 s6,s6,27648
buffer_load_dwordx4 v45,s[32:35],s6 offen lds
mf a[124:127],a[252:255],v[92:95],a[124:127]
v_exp_f32 v26,v230
mf a[124:127],a[248:251],v[76:79],a[124:127]
v_exp_f32 v27,v231
mf a[120:123],a[248:251],v[72:75],a[120:123]
cvt v116,v24,v25
cvt v117,v26,v27
s_add_u32 m0,s12,5120
s_add_u32 s6,s6,27648
buffer_load_dwordx4 v45,s[32:35],s6 offen lds
mf a[120:123],a[252:255],v[88:91],a[120:123]
v_exp_f32 v28,v244
mf a[104:107],a[244:247],v[88:91],a[104:107]
mf a[104:107],a[240:243],v[72:75],a[104:107]
v_exp_f32 v29,v245
buffer_store_dwordx4 v[184:187],v2,s[36:39],s55 offen offset:3072 sc1
s_add_u32 s55,s55,4096
mf a[100:103],a[240:243],v[68:71],a[100:103]
mf a[100:103],a[244:247],v[84:87],a[100:103]
v_exp_f32 v30,v246
mf a[116:119],a[252:255],v[84:87],a[116:119]
s_add_u32 m0,s12,6144
s_add_u32 s6,s6,27648
buffer_load_dwordx4 v45,s[32:35],s6 offen lds
mf a[116:119],a[248:251],v[68:71],a[116:119]
v_exp_f32 v31,v247
s_add_u32 m0,s12,7168
s_add_u32 s6,s6,27648
buffer_load_dwordx4 v45,s[32:35],s6 offen lds
mf a[112:115],a[248:251],v[64:67],a[112:115]
cvt v118,v28,v29
cvt v119,v30,v31
mf a[112:115],a[252:255],v[80:83],a[112:115]
v_exp_f32 v32,v204
mf a[96:99],a[244:247],v[80:83],a[96:99]
s_add_u32 m0,s42,0
buffer_store_dwordx4 v[200:203],v2,s[36:39],s55 offen sc1
mf a[96:99],a[240:243],v[64:67],a[96:99]
v_exp_f32 v33,v205
s_waitcnt lgkmcnt(0)
mf v[12:15],v[36:39],v[116:119],v[12:15]
mf v[132:135],a[192:195],a[132:135],v[52:55]
v_exp_f32 v34,v206
mf v[132:135],a[196:199],a[148:151],v[132:135]
ds_read_b128 a[224:227],v3 offset:24576
buffer_load_dwordx4 v2,s[16:19],s40 offen sc1 lds
mf v[132:135],a[200:203],a[164:167],v[132:135]
v_exp_f32 v35,v207
mf v[132:135],a[204:207],a[180:183],v[132:135]
cvt v108,v32,v33
cvt v109,v34,v35
mf v[128:131],a[204:207],a[176:179],v[48:51]
v_exp_f32 v24,v220
mf v[128:131],a[200:203],a[160:163],v[128:131]
v_exp_f32 v25,v221
mf v[128:131],a[196:199],a[144:147],v[128:131]
ds_read_b128 a[228:231],v3 offset:25600
buffer_load_dwordx4 v2,s[16:19],s40 offen offset:1024 sc1 lds
mf v[128:131],a[192:195],a[128:131],v[128:131]
v_exp_f32 v26,v222
mf v[144:147],a[208:211],a[128:131],v[48:51]
ds_read_b128 a[236:239],v3 offset:27648
ds_read_b128 a[232:235],v3 offset:26624
mf v[144:147],a[212:215],a[144:147],v[144:147]
ds_read_b128 a[240:243],v3 offset:28672
buffer_store_dwordx4 v[216:219],v2,s[36:39],s55 offen offset:1024 sc1
mf v[144:147],a[216:219],a[160:163],v[144:147]
ds_read_b128 a[248:251],v3 offset:30720
ds_read_b128 a[244:247],v3 offset:29696
mf v[144:147],a[220:223],a[176:179],v[144:147]
ds_read_b128 a[252:255],v3 offset:31744
mf v[148:151],a[220:223],a[180:183],v[52:55]
v_exp_f32 v27,v223
buffer_load_dwordx4 v2,s[16:19],s40 offen offset:2048 sc1 lds
mf v[148:151],a[216:219],a[164:167],v[148:151]
v_exp_f32 v28,v236
mf v[148:151],a[212:215],a[148:151],v[148:151]
v_exp_f32 v29,v237
mf v[148:151],a[208:211],a[132:135],v[148:151]
v_exp_f32 v30,v238
buffer_load_dwordx4 v2,s[16:19],s40 offen offset:3072 sc1 lds
s_waitcnt lgkmcnt(0)
mf v[164:167],a[224:227],a[132:135],v[52:55]
s_barrier
s_add_u32 m0,s42,16384
mf v[164:167],a[228:231],a[148:151],v[164:167]
v_exp_f32 v31,v239
mf v[164:167],a[232:235],a[164:167],v[164:167]
cvt v110,v24,v25
cvt v111,v26,v27
mf v[164:167],a[236:239],a[180:183],v[164:167]
v_exp_f32 v32,v252
buffer_load_dwordx4 v0,s[16:19],s40 offen sc1 lds
mf v[160:163],a[236:239],a[176:179],v[48:51]
cvt v124,v28,v29
cvt v125,v30,v31
mf v[160:163],a[232:235],a[160:163],v[160:163]
v_exp_f32 v33,v253
mf v[160:163],a[228:231],a[144:147],v[160:163]
v_exp_f32 v34,v254
buffer_store_dwordx4 v[232:235],v2,s[36:39],s55 offen offset:2048 sc1
mf v[160:163],a[224:227],a[128:131],v[160:163]
v_exp_f32 v35,v255
mf v[20:23],v[36:39],v[108:111],0
cvt v126,v32,v33
cvt v127,v34,v35
mf v[176:179],a[240:243],a[128:131],v[48:51]
ds_read_b128 a[192:195],v4 offset:0
buffer_load_dwordx4 v0,s[16:19],s40 offen offset:1024 sc1 lds
mf v[176:179],a[244:247],a[144:147],v[176:179]
ds_read_b128 a[200:203],v4 offset:1024
ds_read_b128 a[196:199],v4 offset:8192
mf v[176:179],a[248:251],a[160:163],v[176:179]
ds_read_b128 a[208:211],v4 offset:2048
ds_read_b128 a[204:207],v4 offset:9216
mf v[20:23],v[36:39],v[124:127],v[20:23]
ds_read_b128 a[212:215],v4 offset:10240
buffer_load_dwordx4 v0,s[16:19],s40 offen offset:2048 sc1 lds
mf v[176:179],a[252:255],a[176:179],v[176:179]
ds_read_b128 a[220:223],v4 offset:11264
ds_read_b128 a[216:219],v4 offset:3072
mf v[180:183],a[252:255],a[180:183],v[52:55]
v_xor_b32 v3,0x10000,v3
mf v[180:183],a[248:251],a[164:167],v[180:183]
buffer_load_dwordx4 v0,s[16:19],s40 offen offset:3072 sc1 lds
s_add_u32 s40,s40,32768
s_xor_b32 s42,s42,0x10000
mf v[180:183],a[244:247],a[148:151],v[180:183]
v_max3_f32 v44,v8,v12,v20
v_cmp_lt_f32 vcc,s62,v44
mf v[180:183],a[240:243],a[132:135],v[180:183]
buffer_store_dwordx4 v[248:251],v2,s[36:39],s55 offen offset:3072 sc1
s_waitcnt lgkmcnt(0)
s_cbranch_vccnz LT1_rare
LT1_post:
s_cmp_eq_u32 s15,7
s_cbranch_scc1 Lt1m
Lt1c:
LT2:
mf a[0:3],a[192:195],v[96:99],a[0:3]
v_add_f32 v40,v40,v8
v_add_f32 v41,v41,v12
mf a[0:3],a[196:199],v[112:115],a[0:3]
ds_read_b128 a[224:227],v4 offset:4096
s_add_u32 m0,s43,0
mf a[16:19],a[204:207],v[112:115],a[16:19]
ds_read_b128 a[232:235],v4 offset:5120
ds_read_b128 a[228:231],v4 offset:12288
mf a[16:19],a[200:203],v[96:99],a[16:19]
ds_read_b128 a[236:239],v4 offset:13312
buffer_load_dwordx4 v2,s[16:19],s40 offen sc1 lds
mf a[20:23],a[200:203],v[100:103],a[20:23]
v_exp_f32 v24,v128
mf a[20:23],a[204:207],v[116:119],a[20:23]
s_waitcnt vmcnt(13)
ds_read_b64_tr_b16 v[136:137],v47 offset:0
mf a[4:7],a[196:199],v[116:119],a[4:7]
v_exp_f32 v25,v129
mf a[4:7],a[192:195],v[100:103],a[4:7]
v_add_f32 v43,v43,v20
ds_read_b64_tr_b16 v[138:139],v47 offset:2048
mf a[12:15],a[192:195],v[108:111],a[12:15]
ds_read_b128 a[240:243],v4 offset:6144
ds_read_b64_tr_b16 v[200:201],v47 offset:4096
mf a[12:15],a[196:199],v[124:127],a[12:15]
v_exp_f32 v26,v130
mf a[28:31],a[204:207],v[124:127],a[28:31]
ds_read_b64_tr_b16 v[202:203],v47 offset:6144
v_xor_b32 v47,32,v47
mf a[28:31],a[200:203],v[108:111],a[28:31]
v_exp_f32 v27,v131
mf a[44:47],a[208:211],v[108:111],a[44:47]
cvt v64,v24,v25
cvt v65,v26,v27
mf a[44:47],a[212:215],v[124:127],a[44:47]
v_exp_f32 v28,v144
mf a[60:63],a[220:223],v[124:127],a[60:63]
buffer_load_dwordx4 v2,s[16:19],s40 offen offset:1024 sc1 lds
ds_read_b64_tr_b16 v[152:153],v47 offset:0
mf a[60:63],a[216:219],v[108:111],a[60:63]
v_exp_f32 v29,v145
mf a[52:55],a[216:219],v[100:103],a[52:55]
ds_read_b64_tr_b16 v[154:155],v47 offset:2048
ds_read_b64_tr_b16 v[216:217],v47 offset:4096
mf a[52:55],a[220:223],v[116:119],a[52:55]
ds_read_b128 a[248:251],v4 offset:7168
ds_read_b128 a[244:247],v4 offset:14336
mf a[36:39],a[212:215],v[116:119],a[36:39]
ds_read_b64_tr_b16 v[218:219],v47 offset:6144
v_xor_b32 v47,96,v47
mf a[36:39],a[208:211],v[100:103],a[36:39]
ds_read_b128 a[252:255],v4 offset:15360
mf a[32:35],a[208:211],v[96:99],a[32:35]
v_exp_f32 v30,v146
ds_read_b64_tr_b16 v[168:169],v47 offset:0
mf a[32:35],a[212:215],v[112:115],a[32:35]
v_exp_f32 v31,v147
ds_read_b64_tr_b16 v[170:171],v47 offset:2048
mf a[48:51],a[220:223],v[112:115],a[48:51]
v_exp_f32 v32,v160
ds_read_b64_tr_b16 v[232:233],v47 offset:4096
mf a[48:51],a[216:219],v[96:99],a[48:51]
cvt v66,v28,v29
cvt v67,v30,v31
ds_read_b64_tr_b16 v[234:235],v47 offset:6144
v_xor_b32 v47,32,v47
s_waitcnt lgkmcnt(0)
mf a[64:67],a[224:227],v[96:99],a[64:67]
buffer_load_dwordx4 v2,s[16:19],s40 offen offset:2048 sc1 lds
ds_read_b64_tr_b16 v[184:185],v47 offset:0
ds_read_b64_tr_b16 v[186:187],v47 offset:2048
ds_read_b64_tr_b16 v[248:249],v47 offset:4096
ds_read_b64_tr_b16 v[250:251],v47 offset:6144
mf a[64:67],a[228:231],v[112:115],a[64:67]
v_exp_f32 v33,v161
mf v[8:11],v[36:39],v[64:67],0
ds_read_b128 a[196:199],v4 offset:17408
ds_read_b128 a[192:195],v4 offset:16384
mf a[80:83],a[236:239],v[112:115],a[80:83]
v_exp_f32 v34,v162
mf a[80:83],a[232:235],v[96:99],a[80:83]
ds_read_b128 a[200:203],v4 offset:18432
buffer_store_dwordx4 v[136:139],v2,s[36:39],s7 offen sc1
mf a[84:87],a[232:235],v[100:103],a[84:87]
v_exp_f32 v35,v163
mf a[84:87],a[236:239],v[116:119],a[84:87]
cvt v80,v32,v33
cvt v81,v34,v35
mf a[68:71],a[228:231],v[116:119],a[68:71]
v_exp_f32 v24,v176
mf a[68:71],a[224:227],v[100:103],a[68:71]
ds_read_b128 a[208:211],v4 offset:20480
ds_read_b128 a[204:207],v4 offset:19456
mf a[76:79],a[224:227],v[108:111],a[76:79]
ds_read_b128 a[216:219],v4 offset:22528
ds_read_b128 a[212:215],v4 offset:21504
mf a[76:79],a[228:231],v[124:127],a[76:79]
v_exp_f32 v25,v177
mf a[92:95],a[236:239],v[124:127],a[92:95]
ds_read_b128 a[220:223],v4 offset:23552
buffer_load_dwordx4 v2,s[16:19],s40 offen offset:3072 sc1 lds
mf a[92:95],a[232:235],v[108:111],a[92:95]
v_exp_f32 v26,v178
mf a[108:111],a[240:243],v[108:111],a[108:111]
mf a[108:111],a[244:247],v[124:127],a[108:111]
v_exp_f32 v27,v179
mf a[124:127],a[252:255],v[124:127],a[124:127]
cvt v82,v24,v25
cvt v83,v26,v27
buffer_store_dwordx4 v[152:155],v2,s[36:39],s7 offen offset:1024 sc1
mf a[124:127],a[248:251],v[108:111],a[124:127]
v_exp_f32 v28,v132
mf a[116:119],a[248:251],v[100:103],a[116:119]
mf a[116:119],a[252:255],v[116:119],a[116:119]
s_add_u32 m0,s43,16384
buffer_store_dwordx4 v[168:171],v2,s[36:39],s7 offen offset:2048 sc1
mf v[8:11],v[36:39],v[80:83],v[8:11]
v_exp_f32 v29,v133
mf a[100:103],a[244:247],v[116:119],a[100:103]
v_exp_f32 v30,v134
mf a[100:103],a[240:243],v[100:103],a[100:103]
buffer_load_dwordx4 v0,s[16:19],s40 offen sc1 lds
mf a[96:99],a[240:243],v[96:99],a[96:99]
v_exp_f32 v31,v135
mf a[96:99],a[244:247],v[112:115],a[96:99]
cvt v68,v28,v29
cvt v69,v30,v31
mf a[112:115],a[252:255],v[112:115],a[112:115]
s_waitcnt lgkmcnt(10)
buffer_store_dwordx4 v[184:187],v2,s[36:39],s7 offen offset:3072 sc1
s_add_u32 s7,s7,8192
mf a[112:115],a[248:251],v[96:99],a[112:115]
s_waitcnt lgkmcnt(0)
mf v[196:199],a[192:195],a[132:135],v[52:55]
v_exp_f32 v32,v148
mf v[196:199],a[196:199],a[148:151],v[196:199]
ds_read_b128 a[228:231],v4 offset:25600
ds_read_b128 a[224:227],v4 offset:24576
mf v[196:199],a[200:203],a[164:167],v[196:199]
v_exp_f32 v33,v149
mf v[196:199],a[204:207],a[180:183],v[196:199]
ds_read_b128 a[236:239],v4 offset:27648
ds_read_b128 a[232:235],v4 offset:26624
mf v[192:195],a[204:207],a[176:179],v[48:51]
v_exp_f32 v34,v150
mf v[192:195],a[200:203],a[160:163],v[192:195]
ds_read_b128 a[240:243],v4 offset:28672
buffer_load_dwordx4 v0,s[16:19],s40 offen offset:1024 sc1 lds
mf v[192:195],a[196:199],a[144:147],v[192:195]
ds_read_b128 a[248:251],v4 offset:30720
ds_read_b128 a[244:247],v4 offset:29696
mf v[192:195],a[192:195],a[128:131],v[192:195]
v_exp_f32 v35,v151
mf v[208:211],a[208:211],a[128:131],v[48:51]
cvt v70,v32,v33
cvt v71,v34,v35
mf v[208:211],a[212:215],a[144:147],v[208:211]
v_exp_f32 v24,v164
mf v[208:211],a[216:219],a[160:163],v[208:211]
ds_read_b128 a[252:255],v4 offset:31744
buffer_store_dwordx4 v[200:203],v2,s[36:39],s7 offen sc1
mf v[208:211],a[220:223],a[176:179],v[208:211]
v_exp_f32 v25,v165
mf v[12:15],v[36:39],v[68:71],0
mf v[212:215],a[220:223],a[180:183],v[52:55]
v_exp_f32 v26,v166
mf v[212:215],a[216:219],a[164:167],v[212:215]
buffer_store_dwordx4 v[216:219],v2,s[36:39],s7 offen offset:1024 sc1
s_waitcnt lgkmcnt(0)
mf v[212:215],a[212:215],a[148:151],v[212:215]
v_exp_f32 v27,v167
mf v[212:215],a[208:211],a[132:135],v[212:215]
cvt v84,v24,v25
cvt v85,v26,v27
mf v[228:231],a[224:227],a[132:135],v[52:55]
s_barrier
mf v[228:231],a[228:231],a[148:151],v[228:231]
v_exp_f32 v28,v180
mf v[228:231],a[232:235],a[164:167],v[228:231]
ds_read_b128 a[192:195],v3 offset:0
buffer_load_dwordx4 v0,s[16:19],s40 offen offset:2048 sc1 lds
mf v[228:231],a[236:239],a[180:183],v[228:231]
v_exp_f32 v29,v181
mf v[224:227],a[236:239],a[176:179],v[48:51]
ds_read_b128 a[200:203],v3 offset:1024
ds_read_b128 a[196:199],v3 offset:8192
mf v[224:227],a[232:235],a[160:163],v[224:227]
v_exp_f32 v30,v182
mf v[224:227],a[228:231],a[144:147],v[224:227]
v_exp_f32 v31,v183
mf v[224:227],a[224:227],a[128:131],v[224:227]
cvt v86,v28,v29
cvt v87,v30,v31
buffer_store_dwordx4 v[232:235],v2,s[36:39],s7 offen offset:2048 sc1
mf v[240:243],a[240:243],a[128:131],v[48:51]
ds_read_b128 a[208:211],v3 offset:2048
ds_read_b128 a[204:207],v3 offset:9216
mf v[240:243],a[244:247],a[144:147],v[240:243]
ds_read_b128 a[216:219],v3 offset:3072
ds_read_b128 a[212:215],v3 offset:10240
mf v[240:243],a[248:251],a[160:163],v[240:243]
buffer_load_dwordx4 v0,s[16:19],s40 offen offset:3072 sc1 lds
s_add_u32 s40,s40,32768
mf v[12:15],v[36:39],v[84:87],v[12:15]
ds_read_b128 a[220:223],v3 offset:11264
s_xor_b32 s43,s43,0x10000
mf v[240:243],a[252:255],a[176:179],v[240:243]
v_xor_b32 v4,0x10000,v4
mf v[244:247],a[252:255],a[180:183],v[52:55]
buffer_store_dwordx4 v[248:251],v2,s[36:39],s7 offen offset:3072 sc1
mf v[244:247],a[248:251],a[164:167],v[244:247]
mf v[244:247],a[244:247],a[148:151],v[244:247]
v_max_f32 v44,v8,v12
v_cmp_lt_f32 vcc,s62,v44
mf v[244:247],a[240:243],a[132:135],v[244:247]
s_waitcnt lgkmcnt(0)
s_cbranch_vccnz LT2_rare
LT2_post:
v_rcp_f32 v24,v42
v_rcp_f32 v26,v43
v_mov_b32 v25,v24
v_mov_b32 v27,v26
s_add_u32 s59,s61,0
ard v72,a8
ard v73,a9
ard v74,a10
ard v75,a11
ard v76,a24
ard v77,a25
ard v78,a26
ard v79,a27
v_pk_mul_f32 v[72:73],v[72:73],v[24:25]
v_pk_mul_f32 v[74:75],v[74:75],v[24:25]
v_pk_mul_f32 v[76:77],v[76:77],v[24:25]
v_pk_mul_f32 v[78:79],v[78:79],v[24:25]
cvt v88,v72,v73
cvt v89,v74,v75
cvt v90,v76,v77
cvt v91,v78,v79
buffer_store_dwordx4 v[88:91],v2,s[28:31],s59 offen sc1
ard v104,a12
ard v105,a13
ard v106,a14
ard v107,a15
ard v108,a28
ard v109,a29
ard v110,a30
ard v111,a31
v_pk_mul_f32 v[104:105],v[104:105],v[26:27]
v_pk_mul_f32 v[106:107],v[106:107],v[26:27]
v_pk_mul_f32 v[108:109],v[108:109],v[26:27]
v_pk_mul_f32 v[110:111],v[110:111],v[26:27]
cvt v120,v104,v105
cvt v121,v106,v107
cvt v122,v108,v109
cvt v123,v110,v111
buffer_store_dwordx4 v[120:123],v2,s[28:31],s59 offen offset:1024 sc1
s_add_u32 s59,s61,4096
ard v72,a40
ard v73,a41
ard v74,a42
ard v75,a43
ard v76,a56
ard v77,a57
ard v78,a58
ard v79,a59
v_pk_mul_f32 v[72:73],v[72:73],v[24:25]
v_pk_mul_f32 v[74:75],v[74:75],v[24:25]
v_pk_mul_f32 v[76:77],v[76:77],v[24:25]
v_pk_mul_f32 v[78:79],v[78:79],v[24:25]
cvt v92,v72,v73
cvt v93,v74,v75
cvt v94,v76,v77
cvt v95,v78,v79
buffer_store_dwordx4 v[92:95],v2,s[28:31],s59 offen sc1
ard v104,a44
ard v105,a45
ard v106,a46
ard v107,a47
ard v108,a60
ard v109,a61
ard v110,a62
ard v111,a63
v_pk_mul_f32 v[104:105],v[104:105],v[26:27]
v_pk_mul_f32 v[106:107],v[106:107],v[26:27]
v_pk_mul_f32 v[108:109],v[108:109],v[26:27]
v_pk_mul_f32 v[110:111],v[110:111],v[26:27]
cvt v124,v104,v105
cvt v125,v106,v107
cvt v126,v108,v109
cvt v127,v110,v111
buffer_store_dwordx4 v[124:127],v2,s[28:31],s59 offen offset:1024 sc1
s_add_u32 s59,s61,8192
ard v72,a72
ard v73,a73
ard v74,a74
ard v75,a75
ard v76,a88
ard v77,a89
ard v78,a90
ard v79,a91
v_pk_mul_f32 v[72:73],v[72:73],v[24:25]
v_pk_mul_f32 v[74:75],v[74:75],v[24:25]
v_pk_mul_f32 v[76:77],v[76:77],v[24:25]
v_pk_mul_f32 v[78:79],v[78:79],v[24:25]
cvt v88,v72,v73
cvt v89,v74,v75
cvt v90,v76,v77
cvt v91,v78,v79
buffer_store_dwordx4 v[88:91],v2,s[28:31],s59 offen sc1
ard v104,a76
ard v105,a77
ard v106,a78
ard v107,a79
ard v108,a92
ard v109,a93
ard v110,a94
ard v111,a95
v_pk_mul_f32 v[104:105],v[104:105],v[26:27]
v_pk_mul_f32 v[106:107],v[106:107],v[26:27]
v_pk_mul_f32 v[108:109],v[108:109],v[26:27]
v_pk_mul_f32 v[110:111],v[110:111],v[26:27]
cvt v120,v104,v105
cvt v121,v106,v107
cvt v122,v108,v109
cvt v123,v110,v111
buffer_store_dwordx4 v[120:123],v2,s[28:31],s59 offen offset:1024 sc1
s_add_u32 s59,s61,12288
ard v72,a104
ard v73,a105
ard v74,a106
ard v75,a107
ard v76,a120
ard v77,a121
ard v78,a122
ard v79,a123
v_pk_mul_f32 v[72:73],v[72:73],v[24:25]
v_pk_mul_f32 v[74:75],v[74:75],v[24:25]
v_pk_mul_f32 v[76:77],v[76:77],v[24:25]
v_pk_mul_f32 v[78:79],v[78:79],v[24:25]
cvt v92,v72,v73
cvt v93,v74,v75
cvt v94,v76,v77
cvt v95,v78,v79
buffer_store_dwordx4 v[92:95],v2,s[28:31],s59 offen sc1
ard v104,a108
ard v105,a109
ard v106,a110
ard v107,a111
ard v108,a124
ard v109,a125
ard v110,a126
ard v111,a127
v_pk_mul_f32 v[104:105],v[104:105],v[26:27]
v_pk_mul_f32 v[106:107],v[106:107],v[26:27]
v_pk_mul_f32 v[108:109],v[108:109],v[26:27]
v_pk_mul_f32 v[110:111],v[110:111],v[26:27]
cvt v124,v104,v105
cvt v125,v106,v107
cvt v126,v108,v109
cvt v127,v110,v111
buffer_store_dwordx4 v[124:127],v2,s[28:31],s59 offen offset:1024 sc1
s_lshl_b32 s44,s15,1
s_sub_u32 s44,13,s44
v_mov_b32 v220,1
v_lshlrev_b32 v221,20,v1
v_and_b32 v205,3,v1
v_lshlrev_b32 v205,12,v205
v_add_u32 v45,4096,v2
v_and_b32 v222,7,v1
v_lshlrev_b32 v222,7,v222
s_cmp_eq_u32 s15,7
s_cbranch_scc1 Lt2m
LSA0:
mf a[0:3],a[192:195],v[64:67],a[0:3]
v_add_f32 v40,v40,v8
v_add_f32 v41,v41,v12
mf a[0:3],a[196:199],v[80:83],a[0:3]
ds_read_b128 a[224:227],v3 offset:4096
s_add_u32 m0,s42,0
mf a[16:19],a[204:207],v[80:83],a[16:19]
ds_read_b128 a[232:235],v3 offset:5120
ds_read_b128 a[228:231],v3 offset:12288
mf a[16:19],a[200:203],v[64:67],a[16:19]
v_exp_f32 v24,v192
mf a[20:23],a[200:203],v[68:71],a[20:23]
ds_read_b128 a[236:239],v3 offset:13312
buffer_load_dwordx4 v2,s[16:19],s40 offen sc1 lds
mf a[20:23],a[204:207],v[84:87],a[20:23]
v_exp_f32 v25,v193
mf a[4:7],a[196:199],v[84:87],a[4:7]
ds_read_b128 a[244:247],v3 offset:14336
ds_read_b128 a[240:243],v3 offset:6144
mf a[4:7],a[192:195],v[68:71],a[4:7]
v_exp_f32 v26,v194
mf a[36:39],a[208:211],v[68:71],a[36:39]
v_exp_f32 v27,v195
mf a[36:39],a[212:215],v[84:87],a[36:39]
cvt v96,v24,v25
cvt v97,v26,v27
mf a[52:55],a[220:223],v[84:87],a[52:55]
ds_read_b128 a[252:255],v3 offset:15360
ds_read_b128 a[248:251],v3 offset:7168
mf a[52:55],a[216:219],v[68:71],a[52:55]
v_exp_f32 v28,v208
mf a[48:51],a[216:219],v[64:67],a[48:51]
v_exp_f32 v29,v209
mf a[48:51],a[220:223],v[80:83],a[48:51]
buffer_load_dwordx4 v2,s[16:19],s40 offen offset:1024 sc1 lds
s_waitcnt lgkmcnt(0)
mf a[32:35],a[212:215],v[80:83],a[32:35]
v_exp_f32 v30,v210
mf a[32:35],a[208:211],v[64:67],a[32:35]
v_exp_f32 v31,v211
mf a[64:67],a[224:227],v[64:67],a[64:67]
cvt v98,v28,v29
cvt v99,v30,v31
mf a[64:67],a[228:231],v[80:83],a[64:67]
v_exp_f32 v32,v224
mf a[80:83],a[236:239],v[80:83],a[80:83]
ds_read_b128 a[196:199],v3 offset:17408
ds_read_b128 a[192:195],v3 offset:16384
mf a[80:83],a[232:235],v[64:67],a[80:83]
v_exp_f32 v33,v225
mf v[8:11],v[36:39],v[96:99],0
ds_read_b128 a[200:203],v3 offset:18432
buffer_load_dwordx4 v2,s[16:19],s40 offen offset:2048 sc1 lds
mf a[84:87],a[232:235],v[68:71],a[84:87]
v_exp_f32 v34,v226
mf a[84:87],a[236:239],v[84:87],a[84:87]
ds_read_b128 a[208:211],v3 offset:20480
ds_read_b128 a[204:207],v3 offset:19456
mf a[68:71],a[228:231],v[84:87],a[68:71]
v_exp_f32 v35,v227
mf a[68:71],a[224:227],v[68:71],a[68:71]
v_exp_f32 v24,v240
mf a[100:103],a[240:243],v[68:71],a[100:103]
cvt v112,v32,v33
cvt v113,v34,v35
mf a[100:103],a[244:247],v[84:87],a[100:103]
ds_read_b128 a[216:219],v3 offset:22528
ds_read_b128 a[212:215],v3 offset:21504
mf a[116:119],a[252:255],v[84:87],a[116:119]
ds_read_b128 a[220:223],v3 offset:23552
mf a[116:119],a[248:251],v[68:71],a[116:119]
v_exp_f32 v25,v241
mf a[112:115],a[248:251],v[64:67],a[112:115]
v_exp_f32 v26,v242
mf a[112:115],a[252:255],v[80:83],a[112:115]
v_exp_f32 v27,v243
mf a[96:99],a[244:247],v[80:83],a[96:99]
cvt v114,v24,v25
cvt v115,v26,v27
mf a[96:99],a[240:243],v[64:67],a[96:99]
v_exp_f32 v28,v196
buffer_load_dwordx4 v2,s[16:19],s40 offen offset:3072 sc1 lds
s_waitcnt lgkmcnt(0)
mf v[132:135],a[192:195],a[132:135],v[52:55]
v_exp_f32 v29,v197
mf v[132:135],a[196:199],a[148:151],v[132:135]
ds_read_b128 a[224:227],v3 offset:24576
s_add_u32 m0,s42,16384
mf v[132:135],a[200:203],a[164:167],v[132:135]
v_exp_f32 v30,v198
mf v[132:135],a[204:207],a[180:183],v[132:135]
ds_read_b128 a[228:231],v3 offset:25600
buffer_load_dwordx4 v0,s[16:19],s40 offen sc1 lds
mf v[8:11],v[36:39],v[112:115],v[8:11]
v_exp_f32 v31,v199
mf v[128:131],a[204:207],a[176:179],v[48:51]
cvt v100,v28,v29
cvt v101,v30,v31
mf v[128:131],a[200:203],a[160:163],v[128:131]
v_exp_f32 v32,v212
mf v[128:131],a[196:199],a[144:147],v[128:131]
v_exp_f32 v33,v213
mf v[128:131],a[192:195],a[128:131],v[128:131]
ds_read_b128 a[236:239],v3 offset:27648
ds_read_b128 a[232:235],v3 offset:26624
mf v[144:147],a[208:211],a[128:131],v[48:51]
v_exp_f32 v34,v214
mf v[144:147],a[212:215],a[144:147],v[144:147]
ds_read_b128 a[244:247],v3 offset:29696
ds_read_b128 a[240:243],v3 offset:28672
mf v[144:147],a[216:219],a[160:163],v[144:147]
ds_read_b128 a[252:255],v3 offset:31744
ds_read_b128 a[248:251],v3 offset:30720
mf v[144:147],a[220:223],a[176:179],v[144:147]
v_exp_f32 v35,v215
mf v[148:151],a[220:223],a[180:183],v[52:55]
v_exp_f32 v24,v228
mf v[148:151],a[216:219],a[164:167],v[148:151]
cvt v102,v32,v33
cvt v103,v34,v35
mf v[148:151],a[212:215],a[148:151],v[148:151]
v_exp_f32 v25,v229
mf v[148:151],a[208:211],a[132:135],v[148:151]
v_exp_f32 v26,v230
buffer_load_dwordx4 v0,s[16:19],s40 offen offset:1024 sc1 lds
s_waitcnt lgkmcnt(0)
mf v[12:15],v[36:39],v[100:103],0
v_exp_f32 v27,v231
mf v[164:167],a[224:227],a[132:135],v[52:55]
s_waitcnt vmcnt(31)
s_barrier
mf v[164:167],a[228:231],a[148:151],v[164:167]
cvt v116,v24,v25
cvt v117,v26,v27
mf v[164:167],a[232:235],a[164:167],v[164:167]
v_exp_f32 v28,v244
mf v[164:167],a[236:239],a[180:183],v[164:167]
ds_read_b128 a[192:195],v4 offset:0
buffer_load_dwordx4 v0,s[16:19],s40 offen offset:2048 sc1 lds
mf v[160:163],a[236:239],a[176:179],v[48:51]
v_exp_f32 v29,v245
mf v[160:163],a[232:235],a[160:163],v[160:163]
v_exp_f32 v30,v246
mf v[160:163],a[228:231],a[144:147],v[160:163]
v_exp_f32 v31,v247
mf v[160:163],a[224:227],a[128:131],v[160:163]
cvt v118,v28,v29
cvt v119,v30,v31
mf v[176:179],a[240:243],a[128:131],v[48:51]
ds_read_b128 a[200:203],v4 offset:1024
ds_read_b128 a[196:199],v4 offset:8192
mf v[176:179],a[244:247],a[144:147],v[176:179]
ds_read_b128 a[208:211],v4 offset:2048
ds_read_b128 a[204:207],v4 offset:9216
mf v[176:179],a[248:251],a[160:163],v[176:179]
buffer_load_dwordx4 v0,s[16:19],s40 offen offset:3072 sc1 lds
s_add_u32 s40,s40,32768
mf v[12:15],v[36:39],v[116:119],v[12:15]
ds_read_b128 a[216:219],v4 offset:3072
ds_read_b128 a[212:215],v4 offset:10240
mf v[176:179],a[252:255],a[176:179],v[176:179]
ds_read_b128 a[220:223],v4 offset:11264
v_xor_b32 v3,0x10000,v3
mf v[180:183],a[252:255],a[180:183],v[52:55]
s_xor_b32 s42,s42,0x10000
mf v[180:183],a[248:251],a[164:167],v[180:183]
mf v[180:183],a[244:247],a[148:151],v[180:183]
v_max_f32 v44,v8,v12
v_cmp_lt_f32 vcc,s62,v44
mf v[180:183],a[240:243],a[132:135],v[180:183]
s_waitcnt lgkmcnt(0)
s_cbranch_vccnz LSA0_rare
LSA0_post:
LSA1:
mf a[0:3],a[192:195],v[96:99],a[0:3]
v_add_f32 v40,v40,v8
v_add_f32 v41,v41,v12
mf a[0:3],a[196:199],v[112:115],a[0:3]
ds_read_b128 a[224:227],v4 offset:4096
s_add_u32 m0,s43,0
mf a[16:19],a[204:207],v[112:115],a[16:19]
ds_read_b128 a[232:235],v4 offset:5120
ds_read_b128 a[228:231],v4 offset:12288
mf a[16:19],a[200:203],v[96:99],a[16:19]
v_exp_f32 v24,v128
mf a[20:23],a[200:203],v[100:103],a[20:23]
ds_read_b128 a[236:239],v4 offset:13312
buffer_load_dwordx4 v2,s[16:19],s40 offen sc1 lds
mf a[20:23],a[204:207],v[116:119],a[20:23]
v_exp_f32 v25,v129
mf a[4:7],a[196:199],v[116:119],a[4:7]
ds_read_b128 a[244:247],v4 offset:14336
ds_read_b128 a[240:243],v4 offset:6144
mf a[4:7],a[192:195],v[100:103],a[4:7]
v_exp_f32 v26,v130
mf a[36:39],a[208:211],v[100:103],a[36:39]
v_exp_f32 v27,v131
mf a[36:39],a[212:215],v[116:119],a[36:39]
cvt v64,v24,v25
cvt v65,v26,v27
mf a[52:55],a[220:223],v[116:119],a[52:55]
ds_read_b128 a[252:255],v4 offset:15360
ds_read_b128 a[248:251],v4 offset:7168
mf a[52:55],a[216:219],v[100:103],a[52:55]
v_exp_f32 v28,v144
mf a[48:51],a[216:219],v[96:99],a[48:51]
v_exp_f32 v29,v145
mf a[48:51],a[220:223],v[112:115],a[48:51]
buffer_load_dwordx4 v2,s[16:19],s40 offen offset:1024 sc1 lds
s_waitcnt lgkmcnt(0)
mf a[32:35],a[212:215],v[112:115],a[32:35]
v_exp_f32 v30,v146
mf a[32:35],a[208:211],v[96:99],a[32:35]
v_exp_f32 v31,v147
mf a[64:67],a[224:227],v[96:99],a[64:67]
cvt v66,v28,v29
cvt v67,v30,v31
mf a[64:67],a[228:231],v[112:115],a[64:67]
v_exp_f32 v32,v160
mf a[80:83],a[236:239],v[112:115],a[80:83]
ds_read_b128 a[196:199],v4 offset:17408
ds_read_b128 a[192:195],v4 offset:16384
mf a[80:83],a[232:235],v[96:99],a[80:83]
v_exp_f32 v33,v161
mf v[8:11],v[36:39],v[64:67],0
ds_read_b128 a[200:203],v4 offset:18432
buffer_load_dwordx4 v2,s[16:19],s40 offen offset:2048 sc1 lds
mf a[84:87],a[232:235],v[100:103],a[84:87]
v_exp_f32 v34,v162
mf a[84:87],a[236:239],v[116:119],a[84:87]
ds_read_b128 a[208:211],v4 offset:20480
ds_read_b128 a[204:207],v4 offset:19456
mf a[68:71],a[228:231],v[116:119],a[68:71]
v_exp_f32 v35,v163
mf a[68:71],a[224:227],v[100:103],a[68:71]
v_exp_f32 v24,v176
mf a[100:103],a[240:243],v[100:103],a[100:103]
cvt v80,v32,v33
cvt v81,v34,v35
mf a[100:103],a[244:247],v[116:119],a[100:103]
ds_read_b128 a[216:219],v4 offset:22528
ds_read_b128 a[212:215],v4 offset:21504
mf a[116:119],a[252:255],v[116:119],a[116:119]
ds_read_b128 a[220:223],v4 offset:23552
mf a[116:119],a[248:251],v[100:103],a[116:119]
v_exp_f32 v25,v177
mf a[112:115],a[248:251],v[96:99],a[112:115]
v_exp_f32 v26,v178
mf a[112:115],a[252:255],v[112:115],a[112:115]
v_exp_f32 v27,v179
mf a[96:99],a[244:247],v[112:115],a[96:99]
cvt v82,v24,v25
cvt v83,v26,v27
mf a[96:99],a[240:243],v[96:99],a[96:99]
v_exp_f32 v28,v132
buffer_load_dwordx4 v2,s[16:19],s40 offen offset:3072 sc1 lds
s_waitcnt lgkmcnt(0)
mf v[196:199],a[192:195],a[132:135],v[52:55]
v_exp_f32 v29,v133
mf v[196:199],a[196:199],a[148:151],v[196:199]
ds_read_b128 a[224:227],v4 offset:24576
s_add_u32 m0,s43,16384
mf v[196:199],a[200:203],a[164:167],v[196:199]
v_exp_f32 v30,v134
mf v[196:199],a[204:207],a[180:183],v[196:199]
ds_read_b128 a[228:231],v4 offset:25600
buffer_load_dwordx4 v0,s[16:19],s40 offen sc1 lds
mf v[8:11],v[36:39],v[80:83],v[8:11]
v_exp_f32 v31,v135
mf v[192:195],a[204:207],a[176:179],v[48:51]
cvt v68,v28,v29
cvt v69,v30,v31
mf v[192:195],a[200:203],a[160:163],v[192:195]
v_exp_f32 v32,v148
mf v[192:195],a[196:199],a[144:147],v[192:195]
v_exp_f32 v33,v149
mf v[192:195],a[192:195],a[128:131],v[192:195]
ds_read_b128 a[236:239],v4 offset:27648
ds_read_b128 a[232:235],v4 offset:26624
mf v[208:211],a[208:211],a[128:131],v[48:51]
v_exp_f32 v34,v150
mf v[208:211],a[212:215],a[144:147],v[208:211]
ds_read_b128 a[244:247],v4 offset:29696
ds_read_b128 a[240:243],v4 offset:28672
mf v[208:211],a[216:219],a[160:163],v[208:211]
ds_read_b128 a[252:255],v4 offset:31744
ds_read_b128 a[248:251],v4 offset:30720
mf v[208:211],a[220:223],a[176:179],v[208:211]
v_exp_f32 v35,v151
mf v[212:215],a[220:223],a[180:183],v[52:55]
v_exp_f32 v24,v164
mf v[212:215],a[216:219],a[164:167],v[212:215]
cvt v70,v32,v33
cvt v71,v34,v35
mf v[212:215],a[212:215],a[148:151],v[212:215]
v_exp_f32 v25,v165
mf v[212:215],a[208:211],a[132:135],v[212:215]
v_exp_f32 v26,v166
buffer_load_dwordx4 v0,s[16:19],s40 offen offset:1024 sc1 lds
s_waitcnt lgkmcnt(0)
mf v[12:15],v[36:39],v[68:71],0
v_exp_f32 v27,v167
mf v[228:231],a[224:227],a[132:135],v[52:55]
s_waitcnt vmcnt(23)
s_barrier
mf v[228:231],a[228:231],a[148:151],v[228:231]
cvt v84,v24,v25
cvt v85,v26,v27
mf v[228:231],a[232:235],a[164:167],v[228:231]
v_exp_f32 v28,v180
mf v[228:231],a[236:239],a[180:183],v[228:231]
ds_read_b128 a[192:195],v3 offset:0
buffer_load_dwordx4 v0,s[16:19],s40 offen offset:2048 sc1 lds
mf v[224:227],a[236:239],a[176:179],v[48:51]
v_exp_f32 v29,v181
mf v[224:227],a[232:235],a[160:163],v[224:227]
v_exp_f32 v30,v182
mf v[224:227],a[228:231],a[144:147],v[224:227]
v_exp_f32 v31,v183
mf v[224:227],a[224:227],a[128:131],v[224:227]
cvt v86,v28,v29
cvt v87,v30,v31
mf v[240:243],a[240:243],a[128:131],v[48:51]
s_waitcnt vmcnt(15)
buffer_store_dword v220,v221,s[8:11],s24 offen sc1
mf v[240:243],a[244:247],a[144:147],v[240:243]
ds_read_b128 a[200:203],v3 offset:1024
ds_read_b128 a[196:199],v3 offset:8192
mf v[240:243],a[248:251],a[160:163],v[240:243]
ds_read_b128 a[208:211],v3 offset:2048
ds_read_b128 a[204:207],v3 offset:9216
mf v[12:15],v[36:39],v[84:87],v[12:15]
ds_read_b128 a[216:219],v3 offset:3072
ds_read_b128 a[212:215],v3 offset:10240
mf v[240:243],a[252:255],a[176:179],v[240:243]
ds_read_b128 a[220:223],v3 offset:11264
v_xor_b32 v4,0x10000,v4
mf v[244:247],a[252:255],a[180:183],v[52:55]
buffer_load_dwordx4 v0,s[16:19],s40 offen offset:3072 sc1 lds
s_add_u32 s40,s40,32768
buffer_atomic_add v220,v221,s[8:11],s25 offen sc1
s_mov_b64 s[24:25],s[26:27]
mf v[244:247],a[248:251],a[164:167],v[244:247]
s_xor_b32 s43,s43,0x10000
s_sub_u32 s44,s44,1
s_cmp_lg_u32 s44,0
mf v[244:247],a[244:247],a[148:151],v[244:247]
v_max_f32 v44,v8,v12
v_cmp_lt_f32 vcc,s62,v44
mf v[244:247],a[240:243],a[132:135],v[244:247]
s_waitcnt lgkmcnt(0)
s_cbranch_vccnz LSA1_rare
LSA1_post:
s_cbranch_scc0 LSM0
.p2align 6
LSF0:
mf a[0:3],a[192:195],v[64:67],a[0:3]
v_add_f32 v40,v40,v8
v_add_f32 v41,v41,v12
mf a[0:3],a[196:199],v[80:83],a[0:3]
ds_read_b128 a[224:227],v3 offset:4096
s_add_u32 m0,s42,0
mf a[16:19],a[204:207],v[80:83],a[16:19]
ds_read_b128 a[232:235],v3 offset:5120
ds_read_b128 a[228:231],v3 offset:12288
mf a[16:19],a[200:203],v[64:67],a[16:19]
v_exp_f32 v24,v192
mf a[20:23],a[200:203],v[68:71],a[20:23]
ds_read_b128 a[236:239],v3 offset:13312
buffer_load_dwordx4 v2,s[16:19],s40 offen sc1 lds
mf a[20:23],a[204:207],v[84:87],a[20:23]
v_exp_f32 v25,v193
mf a[4:7],a[196:199],v[84:87],a[4:7]
ds_read_b128 a[244:247],v3 offset:14336
ds_read_b128 a[240:243],v3 offset:6144
mf a[4:7],a[192:195],v[68:71],a[4:7]
v_exp_f32 v26,v194
mf a[36:39],a[208:211],v[68:71],a[36:39]
v_exp_f32 v27,v195
mf a[36:39],a[212:215],v[84:87],a[36:39]
cvt v96,v24,v25
cvt v97,v26,v27
mf a[52:55],a[220:223],v[84:87],a[52:55]
ds_read_b128 a[252:255],v3 offset:15360
ds_read_b128 a[248:251],v3 offset:7168
mf a[52:55],a[216:219],v[68:71],a[52:55]
v_exp_f32 v28,v208
mf a[48:51],a[216:219],v[64:67],a[48:51]
v_exp_f32 v29,v209
mf a[48:51],a[220:223],v[80:83],a[48:51]
buffer_load_dwordx4 v2,s[16:19],s40 offen offset:1024 sc1 lds
s_waitcnt lgkmcnt(0)
mf a[32:35],a[212:215],v[80:83],a[32:35]
v_exp_f32 v30,v210
mf a[32:35],a[208:211],v[64:67],a[32:35]
v_exp_f32 v31,v211
mf a[64:67],a[224:227],v[64:67],a[64:67]
cvt v98,v28,v29
cvt v99,v30,v31
mf a[64:67],a[228:231],v[80:83],a[64:67]
v_exp_f32 v32,v224
mf a[80:83],a[236:239],v[80:83],a[80:83]
ds_read_b128 a[196:199],v3 offset:17408
ds_read_b128 a[192:195],v3 offset:16384
mf a[80:83],a[232:235],v[64:67],a[80:83]
v_exp_f32 v33,v225
mf v[8:11],v[36:39],v[96:99],0
ds_read_b128 a[200:203],v3 offset:18432
buffer_load_dwordx4 v2,s[16:19],s40 offen offset:2048 sc1 lds
mf a[84:87],a[232:235],v[68:71],a[84:87]
v_exp_f32 v34,v226
mf a[84:87],a[236:239],v[84:87],a[84:87]
ds_read_b128 a[208:211],v3 offset:20480
ds_read_b128 a[204:207],v3 offset:19456
mf a[68:71],a[228:231],v[84:87],a[68:71]
v_exp_f32 v35,v227
mf a[68:71],a[224:227],v[68:71],a[68:71]
v_exp_f32 v24,v240
mf a[100:103],a[240:243],v[68:71],a[100:103]
cvt v112,v32,v33
cvt v113,v34,v35
mf a[100:103],a[244:247],v[84:87],a[100:103]
ds_read_b128 a[216:219],v3 offset:22528
ds_read_b128 a[212:215],v3 offset:21504
mf a[116:119],a[252:255],v[84:87],a[116:119]
ds_read_b128 a[220:223],v3 offset:23552
mf a[116:119],a[248:251],v[68:71],a[116:119]
v_exp_f32 v25,v241
mf a[112:115],a[248:251],v[64:67],a[112:115]
v_exp_f32 v26,v242
mf a[112:115],a[252:255],v[80:83],a[112:115]
v_exp_f32 v27,v243
mf a[96:99],a[244:247],v[80:83],a[96:99]
cvt v114,v24,v25
cvt v115,v26,v27
mf a[96:99],a[240:243],v[64:67],a[96:99]
v_exp_f32 v28,v196
buffer_load_dwordx4 v2,s[16:19],s40 offen offset:3072 sc1 lds
s_waitcnt lgkmcnt(0)
mf v[132:135],a[192:195],a[132:135],v[52:55]
v_exp_f32 v29,v197
mf v[132:135],a[196:199],a[148:151],v[132:135]
ds_read_b128 a[224:227],v3 offset:24576
s_add_u32 m0,s42,16384
mf v[132:135],a[200:203],a[164:167],v[132:135]
v_exp_f32 v30,v198
mf v[132:135],a[204:207],a[180:183],v[132:135]
ds_read_b128 a[228:231],v3 offset:25600
buffer_load_dwordx4 v0,s[16:19],s40 offen sc1 lds
mf v[8:11],v[36:39],v[112:115],v[8:11]
v_exp_f32 v31,v199
mf v[128:131],a[204:207],a[176:179],v[48:51]
cvt v100,v28,v29
cvt v101,v30,v31
mf v[128:131],a[200:203],a[160:163],v[128:131]
v_exp_f32 v32,v212
mf v[128:131],a[196:199],a[144:147],v[128:131]
v_exp_f32 v33,v213
mf v[128:131],a[192:195],a[128:131],v[128:131]
ds_read_b128 a[236:239],v3 offset:27648
ds_read_b128 a[232:235],v3 offset:26624
mf v[144:147],a[208:211],a[128:131],v[48:51]
v_exp_f32 v34,v214
mf v[144:147],a[212:215],a[144:147],v[144:147]
ds_read_b128 a[244:247],v3 offset:29696
ds_read_b128 a[240:243],v3 offset:28672
mf v[144:147],a[216:219],a[160:163],v[144:147]
ds_read_b128 a[252:255],v3 offset:31744
ds_read_b128 a[248:251],v3 offset:30720
mf v[144:147],a[220:223],a[176:179],v[144:147]
v_exp_f32 v35,v215
mf v[148:151],a[220:223],a[180:183],v[52:55]
v_exp_f32 v24,v228
mf v[148:151],a[216:219],a[164:167],v[148:151]
cvt v102,v32,v33
cvt v103,v34,v35
mf v[148:151],a[212:215],a[148:151],v[148:151]
v_exp_f32 v25,v229
mf v[148:151],a[208:211],a[132:135],v[148:151]
v_exp_f32 v26,v230
buffer_load_dwordx4 v0,s[16:19],s40 offen offset:1024 sc1 lds
s_waitcnt lgkmcnt(0)
mf v[12:15],v[36:39],v[100:103],0
v_exp_f32 v27,v231
mf v[164:167],a[224:227],a[132:135],v[52:55]
s_waitcnt vmcnt(14)
s_barrier
mf v[164:167],a[228:231],a[148:151],v[164:167]
cvt v116,v24,v25
cvt v117,v26,v27
mf v[164:167],a[232:235],a[164:167],v[164:167]
v_exp_f32 v28,v244
mf v[164:167],a[236:239],a[180:183],v[164:167]
ds_read_b128 a[192:195],v4 offset:0
buffer_load_dwordx4 v0,s[16:19],s40 offen offset:2048 sc1 lds
mf v[160:163],a[236:239],a[176:179],v[48:51]
v_exp_f32 v29,v245
mf v[160:163],a[232:235],a[160:163],v[160:163]
v_exp_f32 v30,v246
mf v[160:163],a[228:231],a[144:147],v[160:163]
v_exp_f32 v31,v247
mf v[160:163],a[224:227],a[128:131],v[160:163]
cvt v118,v28,v29
cvt v119,v30,v31
mf v[176:179],a[240:243],a[128:131],v[48:51]
ds_read_b128 a[200:203],v4 offset:1024
ds_read_b128 a[196:199],v4 offset:8192
mf v[176:179],a[244:247],a[144:147],v[176:179]
ds_read_b128 a[208:211],v4 offset:2048
ds_read_b128 a[204:207],v4 offset:9216
mf v[176:179],a[248:251],a[160:163],v[176:179]
buffer_load_dwordx4 v0,s[16:19],s40 offen offset:3072 sc1 lds
s_add_u32 s40,s40,32768
mf v[12:15],v[36:39],v[116:119],v[12:15]
ds_read_b128 a[216:219],v4 offset:3072
ds_read_b128 a[212:215],v4 offset:10240
mf v[176:179],a[252:255],a[176:179],v[176:179]
ds_read_b128 a[220:223],v4 offset:11264
v_xor_b32 v3,0x10000,v3
mf v[180:183],a[252:255],a[180:183],v[52:55]
s_xor_b32 s42,s42,0x10000
mf v[180:183],a[248:251],a[164:167],v[180:183]
mf v[180:183],a[244:247],a[148:151],v[180:183]
v_max_f32 v44,v8,v12
v_cmp_lt_f32 vcc,s62,v44
mf v[180:183],a[240:243],a[132:135],v[180:183]
s_waitcnt lgkmcnt(0)
s_cbranch_vccnz LSF0_rare
LSF0_post:
LSF1:
mf a[0:3],a[192:195],v[96:99],a[0:3]
v_add_f32 v40,v40,v8
v_add_f32 v41,v41,v12
mf a[0:3],a[196:199],v[112:115],a[0:3]
ds_read_b128 a[224:227],v4 offset:4096
s_add_u32 m0,s43,0
mf a[16:19],a[204:207],v[112:115],a[16:19]
ds_read_b128 a[232:235],v4 offset:5120
ds_read_b128 a[228:231],v4 offset:12288
mf a[16:19],a[200:203],v[96:99],a[16:19]
v_exp_f32 v24,v128
mf a[20:23],a[200:203],v[100:103],a[20:23]
ds_read_b128 a[236:239],v4 offset:13312
buffer_load_dwordx4 v2,s[16:19],s40 offen sc1 lds
mf a[20:23],a[204:207],v[116:119],a[20:23]
v_exp_f32 v25,v129
mf a[4:7],a[196:199],v[116:119],a[4:7]
ds_read_b128 a[244:247],v4 offset:14336
ds_read_b128 a[240:243],v4 offset:6144
mf a[4:7],a[192:195],v[100:103],a[4:7]
v_exp_f32 v26,v130
mf a[36:39],a[208:211],v[100:103],a[36:39]
v_exp_f32 v27,v131
mf a[36:39],a[212:215],v[116:119],a[36:39]
cvt v64,v24,v25
cvt v65,v26,v27
mf a[52:55],a[220:223],v[116:119],a[52:55]
ds_read_b128 a[252:255],v4 offset:15360
ds_read_b128 a[248:251],v4 offset:7168
mf a[52:55],a[216:219],v[100:103],a[52:55]
v_exp_f32 v28,v144
mf a[48:51],a[216:219],v[96:99],a[48:51]
v_exp_f32 v29,v145
mf a[48:51],a[220:223],v[112:115],a[48:51]
buffer_load_dwordx4 v2,s[16:19],s40 offen offset:1024 sc1 lds
s_waitcnt lgkmcnt(0)
mf a[32:35],a[212:215],v[112:115],a[32:35]
v_exp_f32 v30,v146
mf a[32:35],a[208:211],v[96:99],a[32:35]
v_exp_f32 v31,v147
mf a[64:67],a[224:227],v[96:99],a[64:67]
cvt v66,v28,v29
cvt v67,v30,v31
mf a[64:67],a[228:231],v[112:115],a[64:67]
v_exp_f32 v32,v160
mf a[80:83],a[236:239],v[112:115],a[80:83]
ds_read_b128 a[196:199],v4 offset:17408
ds_read_b128 a[192:195],v4 offset:16384
mf a[80:83],a[232:235],v[96:99],a[80:83]
v_exp_f32 v33,v161
mf v[8:11],v[36:39],v[64:67],0
ds_read_b128 a[200:203],v4 offset:18432
buffer_load_dwordx4 v2,s[16:19],s40 offen offset:2048 sc1 lds
mf a[84:87],a[232:235],v[100:103],a[84:87]
v_exp_f32 v34,v162
mf a[84:87],a[236:239],v[116:119],a[84:87]
ds_read_b128 a[208:211],v4 offset:20480
ds_read_b128 a[204:207],v4 offset:19456
mf a[68:71],a[228:231],v[116:119],a[68:71]
v_exp_f32 v35,v163
mf a[68:71],a[224:227],v[100:103],a[68:71]
v_exp_f32 v24,v176
mf a[100:103],a[240:243],v[100:103],a[100:103]
cvt v80,v32,v33
cvt v81,v34,v35
mf a[100:103],a[244:247],v[116:119],a[100:103]
ds_read_b128 a[216:219],v4 offset:22528
ds_read_b128 a[212:215],v4 offset:21504
mf a[116:119],a[252:255],v[116:119],a[116:119]
ds_read_b128 a[220:223],v4 offset:23552
mf a[116:119],a[248:251],v[100:103],a[116:119]
v_exp_f32 v25,v177
mf a[112:115],a[248:251],v[96:99],a[112:115]
v_exp_f32 v26,v178
mf a[112:115],a[252:255],v[112:115],a[112:115]
v_exp_f32 v27,v179
mf a[96:99],a[244:247],v[112:115],a[96:99]
cvt v82,v24,v25
cvt v83,v26,v27
mf a[96:99],a[240:243],v[96:99],a[96:99]
v_exp_f32 v28,v132
buffer_load_dwordx4 v2,s[16:19],s40 offen offset:3072 sc1 lds
s_waitcnt lgkmcnt(0)
mf v[196:199],a[192:195],a[132:135],v[52:55]
v_exp_f32 v29,v133
mf v[196:199],a[196:199],a[148:151],v[196:199]
ds_read_b128 a[224:227],v4 offset:24576
s_add_u32 m0,s43,16384
mf v[196:199],a[200:203],a[164:167],v[196:199]
v_exp_f32 v30,v134
mf v[196:199],a[204:207],a[180:183],v[196:199]
ds_read_b128 a[228:231],v4 offset:25600
buffer_load_dwordx4 v0,s[16:19],s40 offen sc1 lds
mf v[8:11],v[36:39],v[80:83],v[8:11]
v_exp_f32 v31,v135
mf v[192:195],a[204:207],a[176:179],v[48:51]
cvt v68,v28,v29
cvt v69,v30,v31
mf v[192:195],a[200:203],a[160:163],v[192:195]
v_exp_f32 v32,v148
mf v[192:195],a[196:199],a[144:147],v[192:195]
v_exp_f32 v33,v149
mf v[192:195],a[192:195],a[128:131],v[192:195]
ds_read_b128 a[236:239],v4 offset:27648
ds_read_b128 a[232:235],v4 offset:26624
mf v[208:211],a[208:211],a[128:131],v[48:51]
v_exp_f32 v34,v150
mf v[208:211],a[212:215],a[144:147],v[208:211]
ds_read_b128 a[244:247],v4 offset:29696
ds_read_b128 a[240:243],v4 offset:28672
mf v[208:211],a[216:219],a[160:163],v[208:211]
ds_read_b128 a[252:255],v4 offset:31744
ds_read_b128 a[248:251],v4 offset:30720
mf v[208:211],a[220:223],a[176:179],v[208:211]
v_exp_f32 v35,v151
mf v[212:215],a[220:223],a[180:183],v[52:55]
v_exp_f32 v24,v164
mf v[212:215],a[216:219],a[164:167],v[212:215]
cvt v70,v32,v33
cvt v71,v34,v35
mf v[212:215],a[212:215],a[148:151],v[212:215]
v_exp_f32 v25,v165
mf v[212:215],a[208:211],a[132:135],v[212:215]
v_exp_f32 v26,v166
buffer_load_dwordx4 v0,s[16:19],s40 offen offset:1024 sc1 lds
s_waitcnt lgkmcnt(0)
mf v[12:15],v[36:39],v[68:71],0
v_exp_f32 v27,v167
mf v[228:231],a[224:227],a[132:135],v[52:55]
s_waitcnt vmcnt(14)
s_barrier
mf v[228:231],a[228:231],a[148:151],v[228:231]
cvt v84,v24,v25
cvt v85,v26,v27
mf v[228:231],a[232:235],a[164:167],v[228:231]
v_exp_f32 v28,v180
mf v[228:231],a[236:239],a[180:183],v[228:231]
ds_read_b128 a[192:195],v3 offset:0
buffer_load_dwordx4 v0,s[16:19],s40 offen offset:2048 sc1 lds
mf v[224:227],a[236:239],a[176:179],v[48:51]
v_exp_f32 v29,v181
mf v[224:227],a[232:235],a[160:163],v[224:227]
v_exp_f32 v30,v182
mf v[224:227],a[228:231],a[144:147],v[224:227]
v_exp_f32 v31,v183
mf v[224:227],a[224:227],a[128:131],v[224:227]
cvt v86,v28,v29
cvt v87,v30,v31
mf v[240:243],a[240:243],a[128:131],v[48:51]
ds_read_b128 a[200:203],v3 offset:1024
ds_read_b128 a[196:199],v3 offset:8192
mf v[240:243],a[244:247],a[144:147],v[240:243]
ds_read_b128 a[208:211],v3 offset:2048
ds_read_b128 a[204:207],v3 offset:9216
mf v[240:243],a[248:251],a[160:163],v[240:243]
buffer_load_dwordx4 v0,s[16:19],s40 offen offset:3072 sc1 lds
s_add_u32 s40,s40,32768
mf v[12:15],v[36:39],v[84:87],v[12:15]
ds_read_b128 a[216:219],v3 offset:3072
ds_read_b128 a[212:215],v3 offset:10240
mf v[240:243],a[252:255],a[176:179],v[240:243]
ds_read_b128 a[220:223],v3 offset:11264
v_xor_b32 v4,0x10000,v4
mf v[244:247],a[252:255],a[180:183],v[52:55]
s_xor_b32 s43,s43,0x10000
s_sub_u32 s44,s44,1
mf v[244:247],a[248:251],a[164:167],v[244:247]
s_cmp_lg_u32 s44,0
mf v[244:247],a[244:247],a[148:151],v[244:247]
v_max_f32 v44,v8,v12
v_cmp_lt_f32 vcc,s62,v44
mf v[244:247],a[240:243],a[132:135],v[244:247]
s_waitcnt lgkmcnt(0)
s_cbranch_vccnz LSF1_rare
LSF1_post:
s_cbranch_scc1 LSF0
LSM0:
mf a[0:3],a[192:195],v[64:67],a[0:3]
v_add_f32 v40,v40,v8
v_add_f32 v41,v41,v12
mf a[0:3],a[196:199],v[80:83],a[0:3]
ds_read_b128 a[224:227],v3 offset:4096
s_add_u32 m0,s42,0
mf a[16:19],a[204:207],v[80:83],a[16:19]
v_cmp_le_i32 s[64:65],0,v5
v_cmp_le_i32 s[66:67],1,v5
mf a[16:19],a[200:203],v[64:67],a[16:19]
v_exp_f32 v24,v192
mf a[20:23],a[200:203],v[68:71],a[20:23]
ds_read_b128 a[228:231],v3 offset:12288
buffer_load_dwordx4 v2,s[16:19],s40 offen sc1 lds
mf a[20:23],a[204:207],v[84:87],a[20:23]
v_exp_f32 v25,v193
mf a[4:7],a[196:199],v[84:87],a[4:7]
v_cmp_le_i32 s[68:69],2,v5
v_cmp_le_i32 s[70:71],3,v5
mf a[4:7],a[192:195],v[68:71],a[4:7]
v_exp_f32 v26,v194
mf a[36:39],a[208:211],v[68:71],a[36:39]
v_cndmask_b32 v128,v7,v48,s[64:65]
v_cmp_le_i32 s[72:73],16,v5
mf a[36:39],a[212:215],v[84:87],a[36:39]
ds_read_b128 a[236:239],v3 offset:13312
ds_read_b128 a[232:235],v3 offset:5120
mf a[52:55],a[220:223],v[84:87],a[52:55]
ds_read_b128 a[244:247],v3 offset:14336
ds_read_b128 a[240:243],v3 offset:6144
v_cndmask_b32 v129,v7,v48,s[66:67]
v_cmp_le_i32 s[74:75],17,v5
mf a[52:55],a[216:219],v[68:71],a[52:55]
ds_read_b128 a[252:255],v3 offset:15360
ds_read_b128 a[248:251],v3 offset:7168
mf a[48:51],a[216:219],v[64:67],a[48:51]
v_exp_f32 v27,v195
v_cndmask_b32 v130,v7,v48,s[68:69]
v_cmp_le_i32 s[76:77],18,v5
mf a[48:51],a[220:223],v[80:83],a[48:51]
v_exp_f32 v28,v208
mf a[32:35],a[212:215],v[80:83],a[32:35]
v_exp_f32 v29,v209
v_cndmask_b32 v131,v7,v48,s[70:71]
v_cmp_le_i32 s[78:79],19,v5
mf a[32:35],a[208:211],v[64:67],a[32:35]
v_exp_f32 v30,v210
s_waitcnt lgkmcnt(0)
mf a[64:67],a[224:227],v[64:67],a[64:67]
v_exp_f32 v31,v211
v_cndmask_b32 v144,v7,v48,s[72:73]
v_cmp_le_i32 s[64:65],32,v5
mf a[64:67],a[228:231],v[80:83],a[64:67]
v_exp_f32 v32,v224
mf a[80:83],a[236:239],v[80:83],a[80:83]
cvt v96,v24,v25
cvt v97,v26,v27
v_cndmask_b32 v145,v7,v48,s[74:75]
v_cmp_le_i32 s[66:67],33,v5
mf a[80:83],a[232:235],v[64:67],a[80:83]
v_exp_f32 v33,v225
mf a[84:87],a[232:235],v[68:71],a[84:87]
cvt v98,v28,v29
cvt v99,v30,v31
v_cndmask_b32 v146,v7,v48,s[76:77]
v_cmp_le_i32 s[68:69],34,v5
mf a[84:87],a[236:239],v[84:87],a[84:87]
v_exp_f32 v34,v226
v_cndmask_b32 v147,v7,v48,s[78:79]
v_cmp_le_i32 s[70:71],35,v5
mf a[68:71],a[228:231],v[84:87],a[68:71]
ds_read_b128 a[192:195],v3 offset:16384
buffer_load_dwordx4 v2,s[16:19],s40 offen offset:1024 sc1 lds
mf a[68:71],a[224:227],v[68:71],a[68:71]
v_cndmask_b32 v160,v7,v48,s[64:65]
v_cmp_le_i32 s[72:73],48,v5
mf v[8:11],v[36:39],v[96:99],0
ds_read_b128 a[200:203],v3 offset:18432
ds_read_b128 a[196:199],v3 offset:17408
mf a[100:103],a[240:243],v[68:71],a[100:103]
v_cndmask_b32 v161,v7,v48,s[66:67]
v_cmp_le_i32 s[74:75],49,v5
mf a[100:103],a[244:247],v[84:87],a[100:103]
ds_read_b128 a[204:207],v3 offset:19456
v_exp_f32 v35,v227
mf a[116:119],a[252:255],v[84:87],a[116:119]
ds_read_b128 a[212:215],v3 offset:21504
ds_read_b128 a[208:211],v3 offset:20480
v_cndmask_b32 v162,v7,v48,s[68:69]
v_cmp_le_i32 s[76:77],50,v5
mf a[116:119],a[248:251],v[68:71],a[116:119]
ds_read_b128 a[220:223],v3 offset:23552
ds_read_b128 a[216:219],v3 offset:22528
v_exp_f32 v24,v240
mf a[112:115],a[248:251],v[64:67],a[112:115]
v_exp_f32 v25,v241
v_cndmask_b32 v163,v7,v48,s[70:71]
v_cmp_le_i32 s[78:79],51,v5
v_cndmask_b32 v176,v7,v48,s[72:73]
v_cndmask_b32 v177,v7,v48,s[74:75]
v_cndmask_b32 v178,v7,v48,s[76:77]
v_cndmask_b32 v179,v7,v48,s[78:79]
mf a[112:115],a[252:255],v[80:83],a[112:115]
v_exp_f32 v26,v242
mf a[96:99],a[244:247],v[80:83],a[96:99]
v_exp_f32 v27,v243
mf a[96:99],a[240:243],v[64:67],a[96:99]
v_exp_f32 v28,v196
s_waitcnt lgkmcnt(0)
mf v[132:135],a[192:195],a[132:135],v[52:55]
v_exp_f32 v29,v197
mf v[132:135],a[196:199],a[148:151],v[132:135]
cvt v112,v32,v33
cvt v113,v34,v35
mf v[132:135],a[200:203],a[164:167],v[132:135]
v_exp_f32 v30,v198
mf v[132:135],a[204:207],a[180:183],v[132:135]
cvt v114,v24,v25
cvt v115,v26,v27
mf v[128:131],a[204:207],a[176:179],v[128:131]
v_exp_f32 v31,v199
mf v[128:131],a[200:203],a[160:163],v[128:131]
cvt v100,v28,v29
cvt v101,v30,v31
mf v[128:131],a[196:199],a[144:147],v[128:131]
v_exp_f32 v32,v212
mf v[128:131],a[192:195],a[128:131],v[128:131]
ds_read_b128 a[228:231],v3 offset:25600
ds_read_b128 a[224:227],v3 offset:24576
mf v[8:11],v[36:39],v[112:115],v[8:11]
v_exp_f32 v33,v213
mf v[144:147],a[208:211],a[128:131],v[144:147]
ds_read_b128 a[236:239],v3 offset:27648
ds_read_b128 a[232:235],v3 offset:26624
mf v[144:147],a[212:215],a[144:147],v[144:147]
ds_read_b128 a[244:247],v3 offset:29696
ds_read_b128 a[240:243],v3 offset:28672
mf v[144:147],a[216:219],a[160:163],v[144:147]
ds_read_b128 a[252:255],v3 offset:31744
ds_read_b128 a[248:251],v3 offset:30720
mf v[144:147],a[220:223],a[176:179],v[144:147]
v_exp_f32 v34,v214
mf v[148:151],a[220:223],a[180:183],v[52:55]
v_exp_f32 v35,v215
buffer_load_dwordx4 v2,s[16:19],s40 offen offset:2048 sc1 lds
mf v[148:151],a[216:219],a[164:167],v[148:151]
v_exp_f32 v24,v228
mf v[148:151],a[212:215],a[148:151],v[148:151]
v_exp_f32 v25,v229
mf v[148:151],a[208:211],a[132:135],v[148:151]
v_exp_f32 v26,v230
s_waitcnt lgkmcnt(0)
mf v[164:167],a[224:227],a[132:135],v[52:55]
s_waitcnt vmcnt(11)
s_barrier
mf v[164:167],a[228:231],a[148:151],v[164:167]
v_exp_f32 v27,v231
mf v[164:167],a[232:235],a[164:167],v[164:167]
cvt v102,v32,v33
cvt v103,v34,v35
mf v[164:167],a[236:239],a[180:183],v[164:167]
v_exp_f32 v28,v244
mf v[160:163],a[236:239],a[176:179],v[160:163]
cvt v116,v24,v25
cvt v117,v26,v27
mf v[160:163],a[232:235],a[160:163],v[160:163]
v_exp_f32 v29,v245
mf v[160:163],a[228:231],a[144:147],v[160:163]
v_exp_f32 v30,v246
mf v[160:163],a[224:227],a[128:131],v[160:163]
v_exp_f32 v31,v247
mf v[12:15],v[36:39],v[100:103],0
cvt v118,v28,v29
cvt v119,v30,v31
mf v[176:179],a[240:243],a[128:131],v[176:179]
ds_read_b128 a[196:199],v4 offset:8192
ds_read_b128 a[192:195],v4 offset:0
mf v[176:179],a[244:247],a[144:147],v[176:179]
ds_read_b128 a[204:207],v4 offset:9216
ds_read_b128 a[200:203],v4 offset:1024
mf v[176:179],a[248:251],a[160:163],v[176:179]
ds_read_b128 a[212:215],v4 offset:10240
ds_read_b128 a[208:211],v4 offset:2048
mf v[12:15],v[36:39],v[116:119],v[12:15]
ds_read_b128 a[220:223],v4 offset:11264
ds_read_b128 a[216:219],v4 offset:3072
mf v[176:179],a[252:255],a[176:179],v[176:179]
buffer_load_dwordx4 v2,s[16:19],s40 offen offset:3072 sc1 lds
s_add_u32 s40,s40,32768
mf v[180:183],a[252:255],a[180:183],v[52:55]
s_xor_b32 s42,s42,0x10000
v_xor_b32 v3,0x10000,v3
mf v[180:183],a[248:251],a[164:167],v[180:183]
mf v[180:183],a[244:247],a[148:151],v[180:183]
v_max_f32 v44,v8,v12
v_cmp_lt_f32 vcc,s62,v44
mf v[180:183],a[240:243],a[132:135],v[180:183]
s_waitcnt lgkmcnt(0)
s_cbranch_vccnz LSM0_rare
LSM0_post:
LSM1:
mf a[0:3],a[192:195],v[96:99],a[0:3]
v_add_f32 v40,v40,v8
v_add_f32 v41,v41,v12
mf a[0:3],a[196:199],v[112:115],a[0:3]
v_cmp_le_i32 s[64:65],0,v5
v_cmp_le_i32 s[66:67],1,v5
mf a[16:19],a[204:207],v[112:115],a[16:19]
v_exp_f32 v24,v128
mf a[16:19],a[200:203],v[96:99],a[16:19]
v_exp_f32 v25,v129
mf a[20:23],a[200:203],v[100:103],a[20:23]
v_cmp_le_i32 s[68:69],2,v5
v_cmp_le_i32 s[70:71],3,v5
mf a[20:23],a[204:207],v[116:119],a[20:23]
v_exp_f32 v26,v130
buffer_load_dword v223,v222,s[8:11],s47 offen sc1
mf a[4:7],a[196:199],v[116:119],a[4:7]
v_exp_f32 v27,v131
mf a[4:7],a[192:195],v[100:103],a[4:7]
v_exp_f32 v28,v144
mf a[36:39],a[208:211],v[100:103],a[36:39]
ds_read_b128 a[228:231],v4 offset:12288
ds_read_b128 a[224:227],v4 offset:4096
v_exp_f32 v29,v145
v_cndmask_b32 v196,v7,v52,s[64:65]
v_cmp_le_i32 s[72:73],16,v5
mf a[36:39],a[212:215],v[116:119],a[36:39]
ds_read_b128 a[236:239],v4 offset:13312
ds_read_b128 a[232:235],v4 offset:5120
cvt v64,v24,v25
cvt v65,v26,v27
mf a[52:55],a[220:223],v[116:119],a[52:55]
ds_read_b128 a[244:247],v4 offset:14336
ds_read_b128 a[240:243],v4 offset:6144
v_exp_f32 v30,v146
v_cndmask_b32 v197,v7,v52,s[66:67]
v_cmp_le_i32 s[74:75],17,v5
mf a[52:55],a[216:219],v[100:103],a[52:55]
ds_read_b128 a[252:255],v4 offset:15360
ds_read_b128 a[248:251],v4 offset:7168
v_exp_f32 v31,v147
mf a[48:51],a[216:219],v[96:99],a[48:51]
v_exp_f32 v32,v160
v_cndmask_b32 v198,v7,v52,s[68:69]
v_cmp_le_i32 s[76:77],18,v5
mf a[48:51],a[220:223],v[112:115],a[48:51]
cvt v66,v28,v29
cvt v67,v30,v31
mf a[32:35],a[212:215],v[112:115],a[32:35]
v_exp_f32 v33,v161
v_cndmask_b32 v199,v7,v52,s[70:71]
v_cmp_le_i32 s[78:79],19,v5
mf a[32:35],a[208:211],v[96:99],a[32:35]
v_exp_f32 v34,v162
s_waitcnt lgkmcnt(0)
mf v[8:11],v[36:39],v[64:67],0
v_exp_f32 v35,v163
v_cndmask_b32 v212,v7,v52,s[72:73]
v_cmp_le_i32 s[64:65],32,v5
mf a[64:67],a[224:227],v[96:99],a[64:67]
v_exp_f32 v24,v176
mf a[64:67],a[228:231],v[112:115],a[64:67]
cvt v80,v32,v33
cvt v81,v34,v35
v_cndmask_b32 v213,v7,v52,s[74:75]
v_cmp_le_i32 s[66:67],33,v5
mf a[80:83],a[236:239],v[112:115],a[80:83]
v_exp_f32 v25,v177
mf a[80:83],a[232:235],v[96:99],a[80:83]
v_exp_f32 v26,v178
v_cndmask_b32 v214,v7,v52,s[76:77]
v_cmp_le_i32 s[68:69],34,v5
s_getpc_b64 s[16:17]
ct3:
s_add_u32 s16,s16,LE2-ct3
s_addc_u32 s17,s17,0
mf a[84:87],a[232:235],v[100:103],a[84:87]
v_exp_f32 v27,v179
mf a[84:87],a[236:239],v[116:119],a[84:87]
cvt v82,v24,v25
cvt v83,v26,v27
v_cndmask_b32 v215,v7,v52,s[78:79]
v_cmp_le_i32 s[70:71],35,v5
mf a[68:71],a[228:231],v[116:119],a[68:71]
v_exp_f32 v28,v132
mf a[68:71],a[224:227],v[100:103],a[68:71]
v_exp_f32 v29,v133
v_cndmask_b32 v228,v7,v52,s[64:65]
v_cmp_le_i32 s[72:73],48,v5
mf v[8:11],v[36:39],v[80:83],v[8:11]
v_exp_f32 v30,v134
s_mov_b32 s18,code_end-LE2
s_mov_b32 s19,0x20000
mf a[100:103],a[240:243],v[100:103],a[100:103]
ds_read_b128 a[196:199],v4 offset:17408
ds_read_b128 a[192:195],v4 offset:16384
v_exp_f32 v31,v135
v_cndmask_b32 v229,v7,v52,s[66:67]
v_cmp_le_i32 s[74:75],49,v5
mf a[100:103],a[244:247],v[116:119],a[100:103]
ds_read_b128 a[204:207],v4 offset:19456
ds_read_b128 a[200:203],v4 offset:18432
cvt v68,v28,v29
cvt v69,v30,v31
mf a[116:119],a[252:255],v[116:119],a[116:119]
ds_read_b128 a[212:215],v4 offset:21504
ds_read_b128 a[208:211],v4 offset:20480
v_exp_f32 v32,v148
v_cndmask_b32 v230,v7,v52,s[68:69]
v_cmp_le_i32 s[76:77],50,v5
mf a[116:119],a[248:251],v[100:103],a[116:119]
ds_read_b128 a[220:223],v4 offset:23552
ds_read_b128 a[216:219],v4 offset:22528
v_exp_f32 v33,v149
mf a[112:115],a[248:251],v[96:99],a[112:115]
v_exp_f32 v34,v150
v_cndmask_b32 v231,v7,v52,s[70:71]
v_cmp_le_i32 s[78:79],51,v5
v_cndmask_b32 v244,v7,v52,s[72:73]
v_cndmask_b32 v245,v7,v52,s[74:75]
v_cndmask_b32 v246,v7,v52,s[76:77]
v_cndmask_b32 v247,v7,v52,s[78:79]
s_bfe_u32 s20,s2,0x50003
s_lshl_b32 s20,s20,2
mf a[112:115],a[252:255],v[112:115],a[112:115]
v_exp_f32 v35,v151
mf a[96:99],a[244:247],v[112:115],a[96:99]
cvt v70,v32,v33
cvt v71,v34,v35
mf a[96:99],a[240:243],v[96:99],a[96:99]
v_exp_f32 v24,v164
s_waitcnt lgkmcnt(0)
mf v[196:199],a[192:195],a[132:135],v[196:199]
ds_read_b128 a[228:231],v4 offset:25600
ds_read_b128 a[224:227],v4 offset:24576
v_exp_f32 v25,v165
mf v[196:199],a[196:199],a[148:151],v[196:199]
ds_read_b128 a[236:239],v4 offset:27648
ds_read_b128 a[232:235],v4 offset:26624
v_exp_f32 v26,v166
s_add_u32 s20,s20,s3
s_lshl_b32 s20,s20,7
mf v[196:199],a[200:203],a[164:167],v[196:199]
ds_read_b128 a[244:247],v4 offset:29696
ds_read_b128 a[240:243],v4 offset:28672
v_exp_f32 v27,v167
mf v[196:199],a[204:207],a[180:183],v[196:199]
ds_read_b128 a[252:255],v4 offset:31744
ds_read_b128 a[248:251],v4 offset:30720
cvt v84,v24,v25
cvt v85,v26,v27
mf v[12:15],v[36:39],v[68:71],0
v_exp_f32 v28,v180
mf v[212:215],a[220:223],a[180:183],v[212:215]
v_exp_f32 v29,v181
mf v[212:215],a[216:219],a[164:167],v[212:215]
v_exp_f32 v30,v182
v_lshlrev_b32 v46,14,v1
mf v[212:215],a[212:215],a[148:151],v[212:215]
v_exp_f32 v31,v183
mf v[212:215],a[208:211],a[132:135],v[212:215]
cvt v86,v28,v29
cvt v87,v30,v31
s_waitcnt lgkmcnt(0)
mf v[228:231],a[224:227],a[132:135],v[228:231]
s_waitcnt vmcnt(5)
s_barrier
mf v[228:231],a[228:231],a[148:151],v[228:231]
ds_read_b128 a[196:199],v3 offset:8192
ds_read_b128 a[192:195],v3 offset:0
mf v[228:231],a[232:235],a[164:167],v[228:231]
ds_read_b128 a[204:207],v3 offset:9216
ds_read_b128 a[200:203],v3 offset:1024
buffer_load_dword v46,v46,s[16:19],s20 offen
mf v[12:15],v[36:39],v[84:87],v[12:15]
ds_read_b128 a[212:215],v3 offset:10240
ds_read_b128 a[208:211],v3 offset:2048
mf v[228:231],a[236:239],a[180:183],v[228:231]
ds_read_b128 a[220:223],v3 offset:11264
ds_read_b128 a[216:219],v3 offset:3072
mf v[244:247],a[252:255],a[180:183],v[244:247]
v_xor_b32 v4,0x10000,v4
mf v[244:247],a[248:251],a[164:167],v[244:247]
mf v[244:247],a[244:247],a[148:151],v[244:247]
v_max_f32 v44,v8,v12
v_cmp_lt_f32 vcc,s62,v44
mf v[244:247],a[240:243],a[132:135],v[244:247]
s_waitcnt lgkmcnt(0)
s_cbranch_vccnz LSM1_rare
LSM1_post:
Lr_chk:
s_waitcnt vmcnt(1)
v_cmp_ne_u32 vcc,80,v223
s_nop 0
s_cbranch_vccnz Lr_spin
LE1:
mf a[0:3],a[192:195],v[64:67],a[0:3]
v_add_f32 v40,v40,v8
v_add_f32 v41,v41,v12
mf a[0:3],a[196:199],v[80:83],a[0:3]
ds_read_b128 a[224:227],v3 offset:4096
buffer_load_dword v204,v205,s[8:11],s63 offen sc1
mf a[16:19],a[204:207],v[80:83],a[16:19]
ds_read_b128 a[228:231],v3 offset:12288
s_add_u32 m0,s52,143360
mf a[16:19],a[200:203],v[64:67],a[16:19]
v_exp_f32 v24,v196
mf a[20:23],a[200:203],v[68:71],a[20:23]
v_exp_f32 v25,v197
mf a[20:23],a[204:207],v[84:87],a[20:23]
ds_read_b128 a[232:235],v3 offset:5120
buffer_load_dwordx4 v2,s[36:39],s51 offen sc1 lds
mf a[4:7],a[196:199],v[84:87],a[4:7]
v_exp_f32 v26,v198
mf a[4:7],a[192:195],v[68:71],a[4:7]
ds_read_b128 a[236:239],v3 offset:13312
buffer_load_dwordx4 v2,s[36:39],s51 offen offset:1024 sc1 lds
mf a[36:39],a[208:211],v[68:71],a[36:39]
v_exp_f32 v27,v199
mf a[36:39],a[212:215],v[84:87],a[36:39]
ds_read_b128 a[244:247],v3 offset:14336
ds_read_b128 a[240:243],v3 offset:6144
mf a[52:55],a[220:223],v[84:87],a[52:55]
ds_read_b128 a[252:255],v3 offset:15360
ds_read_b128 a[248:251],v3 offset:7168
mf a[52:55],a[216:219],v[68:71],a[52:55]
v_exp_f32 v28,v212
mf a[48:51],a[216:219],v[64:67],a[48:51]
v_exp_f32 v29,v213
mf a[48:51],a[220:223],v[80:83],a[48:51]
v_exp_f32 v30,v214
buffer_load_dwordx4 v2,s[36:39],s51 offen offset:2048 sc1 lds
mf a[32:35],a[212:215],v[80:83],a[32:35]
v_exp_f32 v31,v215
mf a[32:35],a[208:211],v[64:67],a[32:35]
cvt v100,v24,v25
cvt v101,v26,v27
buffer_load_dwordx4 v2,s[36:39],s51 offen offset:3072 sc1 lds
s_waitcnt lgkmcnt(0)
mf a[64:67],a[224:227],v[64:67],a[64:67]
s_barrier
s_add_u32 m0,s52,147456
s_nop 0
buffer_load_dwordx4 v45,s[36:39],s51 offen sc1 lds
s_add_u32 s51,s51,81920
mf a[64:67],a[228:231],v[80:83],a[64:67]
v_exp_f32 v32,v228
mf a[80:83],a[236:239],v[80:83],a[80:83]
v_exp_f32 v33,v229
mf a[80:83],a[232:235],v[64:67],a[80:83]
v_exp_f32 v34,v230
mf a[84:87],a[232:235],v[68:71],a[84:87]
cvt v102,v28,v29
cvt v103,v30,v31
mf a[84:87],a[236:239],v[84:87],a[84:87]
v_exp_f32 v35,v231
mf a[68:71],a[228:231],v[84:87],a[68:71]
v_exp_f32 v24,v244
mf a[68:71],a[224:227],v[68:71],a[68:71]
cvt v116,v32,v33
cvt v117,v34,v35
mf v[12:15],v[36:39],v[100:103],0
v_exp_f32 v25,v245
mf a[100:103],a[240:243],v[68:71],a[100:103]
v_exp_f32 v26,v246
mf a[100:103],a[244:247],v[84:87],a[100:103]
ds_read_b128 a[196:199],v4 offset:8192
ds_read_b128 a[192:195],v4 offset:0
v_exp_f32 v27,v247
s_add_u32 m0,s52,0
mf a[116:119],a[252:255],v[84:87],a[116:119]
ds_read_b128 a[204:207],v4 offset:9216
ds_read_b128 a[200:203],v4 offset:1024
cvt v118,v24,v25
cvt v119,v26,v27
buffer_load_dwordx4 v2,s[36:39],s51 offen sc1 lds
mf a[116:119],a[248:251],v[68:71],a[116:119]
ds_read_b128 a[212:215],v4 offset:10240
ds_read_b128 a[208:211],v4 offset:2048
mf a[112:115],a[248:251],v[64:67],a[112:115]
ds_read_b128 a[220:223],v4 offset:11264
ds_read_b128 a[216:219],v4 offset:3072
buffer_load_dwordx4 v2,s[36:39],s51 offen offset:1024 sc1 lds
mf v[12:15],v[36:39],v[116:119],v[12:15]
v_xor_b32 v3,0x10000,v3
mf a[112:115],a[252:255],v[80:83],a[112:115]
buffer_load_dwordx4 v2,s[36:39],s51 offen offset:2048 sc1 lds
buffer_load_dwordx4 v2,s[36:39],s51 offen offset:3072 sc1 lds
s_add_u32 m0,s52,4096
s_nop 0
buffer_load_dwordx4 v45,s[36:39],s51 offen sc1 lds
s_add_u32 s51,s51,81920
buffer_store_dword v220,v221,s[8:11],s24 offen sc1
buffer_atomic_add v220,v221,s[8:11],s25 offen sc1
mf a[96:99],a[244:247],v[80:83],a[96:99]
v_cmp_lt_f32 vcc,s62,v12
mf a[96:99],a[240:243],v[64:67],a[96:99]
s_waitcnt lgkmcnt(0)
s_cbranch_vccnz LE1_rare
LE1_post:
LE2:
mf a[4:7],a[192:195],v[100:103],a[4:7]
ds_read_b128 a[228:231],v4 offset:12288
ds_read_b128 a[224:227],v4 offset:4096
mf a[4:7],a[196:199],v[116:119],a[4:7]
ds_read_b128 a[236:239],v4 offset:13312
ds_read_b128 a[232:235],v4 offset:5120
mf a[20:23],a[204:207],v[116:119],a[20:23]
ds_read_b128 a[244:247],v4 offset:14336
ds_read_b128 a[240:243],v4 offset:6144
mf a[20:23],a[200:203],v[100:103],a[20:23]
ds_read_b128 a[252:255],v4 offset:15360
ds_read_b128 a[248:251],v4 offset:7168
mf a[36:39],a[208:211],v[100:103],a[36:39]
v_add_f32 v41,v41,v12
mf a[36:39],a[212:215],v[116:119],a[36:39]
s_waitcnt vmcnt(12)
v_cmp_ne_u32 vcc,1,v204
s_mov_b32 s62,s50
mf a[52:55],a[220:223],v[116:119],a[52:55]
s_cmp_eq_u64 vcc,0
s_cselect_b32 s50,s50,0x8000000
mf a[52:55],a[216:219],v[100:103],a[52:55]
buffer_load_dwordx4 a[128:131],v2,s[28:31],s50 offen sc1
s_waitcnt lgkmcnt(0)
mf a[68:71],a[224:227],v[100:103],a[68:71]
mf a[68:71],a[228:231],v[116:119],a[68:71]
buffer_load_dwordx4 a[132:135],v2,s[28:31],s50 offen offset:1024 sc1
s_add_u32 s50,s50,4096
mf a[84:87],a[236:239],v[116:119],a[84:87]
mf a[84:87],a[232:235],v[100:103],a[84:87]
buffer_load_dwordx4 a[136:139],v2,s[28:31],s50 offen sc1
mf a[100:103],a[240:243],v[100:103],a[100:103]
mf a[100:103],a[244:247],v[116:119],a[100:103]
buffer_load_dwordx4 a[140:143],v2,s[28:31],s50 offen offset:1024 sc1
s_add_u32 s50,s50,4096
mf a[116:119],a[252:255],v[116:119],a[116:119]
buffer_load_dwordx4 a[144:147],v2,s[28:31],s50 offen sc1
buffer_load_dwordx4 a[148:151],v2,s[28:31],s50 offen offset:1024 sc1
s_add_u32 s50,s50,4096
mf a[116:119],a[248:251],v[100:103],a[116:119]
LE2_post:
v_rcp_f32 v24,v40
v_rcp_f32 v26,v41
v_mov_b32 v25,v24
v_mov_b32 v27,v26
s_add_u32 s59,s60,0
ard v72,a0
ard v73,a1
ard v74,a2
ard v75,a3
ard v76,a16
ard v77,a17
ard v78,a18
ard v79,a19
v_pk_mul_f32 v[72:73],v[72:73],v[24:25]
v_pk_mul_f32 v[74:75],v[74:75],v[24:25]
v_pk_mul_f32 v[76:77],v[76:77],v[24:25]
v_pk_mul_f32 v[78:79],v[78:79],v[24:25]
cvt v88,v72,v73
cvt v89,v74,v75
cvt v90,v76,v77
cvt v91,v78,v79
buffer_store_dwordx4 v[88:91],v2,s[28:31],s59 offen sc1
ard v104,a4
ard v105,a5
ard v106,a6
ard v107,a7
ard v108,a20
ard v109,a21
ard v110,a22
ard v111,a23
v_pk_mul_f32 v[104:105],v[104:105],v[26:27]
v_pk_mul_f32 v[106:107],v[106:107],v[26:27]
v_pk_mul_f32 v[108:109],v[108:109],v[26:27]
v_pk_mul_f32 v[110:111],v[110:111],v[26:27]
cvt v120,v104,v105
cvt v121,v106,v107
cvt v122,v108,v109
cvt v123,v110,v111
buffer_store_dwordx4 v[120:123],v2,s[28:31],s59 offen offset:1024 sc1
s_add_u32 s59,s60,4096
ard v72,a32
ard v73,a33
ard v74,a34
ard v75,a35
ard v76,a48
ard v77,a49
ard v78,a50
ard v79,a51
v_pk_mul_f32 v[72:73],v[72:73],v[24:25]
v_pk_mul_f32 v[74:75],v[74:75],v[24:25]
v_pk_mul_f32 v[76:77],v[76:77],v[24:25]
v_pk_mul_f32 v[78:79],v[78:79],v[24:25]
cvt v92,v72,v73
cvt v93,v74,v75
cvt v94,v76,v77
cvt v95,v78,v79
buffer_store_dwordx4 v[92:95],v2,s[28:31],s59 offen sc1
ard v104,a36
ard v105,a37
ard v106,a38
ard v107,a39
ard v108,a52
ard v109,a53
ard v110,a54
ard v111,a55
v_pk_mul_f32 v[104:105],v[104:105],v[26:27]
v_pk_mul_f32 v[106:107],v[106:107],v[26:27]
v_pk_mul_f32 v[108:109],v[108:109],v[26:27]
v_pk_mul_f32 v[110:111],v[110:111],v[26:27]
cvt v124,v104,v105
cvt v125,v106,v107
cvt v126,v108,v109
cvt v127,v110,v111
buffer_store_dwordx4 v[124:127],v2,s[28:31],s59 offen offset:1024 sc1
s_add_u32 s59,s60,8192
ard v72,a64
ard v73,a65
ard v74,a66
ard v75,a67
ard v76,a80
ard v77,a81
ard v78,a82
ard v79,a83
v_pk_mul_f32 v[72:73],v[72:73],v[24:25]
v_pk_mul_f32 v[74:75],v[74:75],v[24:25]
v_pk_mul_f32 v[76:77],v[76:77],v[24:25]
v_pk_mul_f32 v[78:79],v[78:79],v[24:25]
cvt v88,v72,v73
cvt v89,v74,v75
cvt v90,v76,v77
cvt v91,v78,v79
buffer_store_dwordx4 v[88:91],v2,s[28:31],s59 offen sc1
ard v104,a68
ard v105,a69
ard v106,a70
ard v107,a71
ard v108,a84
ard v109,a85
ard v110,a86
ard v111,a87
v_pk_mul_f32 v[104:105],v[104:105],v[26:27]
v_pk_mul_f32 v[106:107],v[106:107],v[26:27]
v_pk_mul_f32 v[108:109],v[108:109],v[26:27]
v_pk_mul_f32 v[110:111],v[110:111],v[26:27]
cvt v120,v104,v105
cvt v121,v106,v107
cvt v122,v108,v109
cvt v123,v110,v111
buffer_store_dwordx4 v[120:123],v2,s[28:31],s59 offen offset:1024 sc1
s_add_u32 s59,s60,12288
ard v72,a96
ard v73,a97
ard v74,a98
ard v75,a99
ard v76,a112
ard v77,a113
ard v78,a114
ard v79,a115
v_pk_mul_f32 v[72:73],v[72:73],v[24:25]
v_pk_mul_f32 v[74:75],v[74:75],v[24:25]
v_pk_mul_f32 v[76:77],v[76:77],v[24:25]
v_pk_mul_f32 v[78:79],v[78:79],v[24:25]
cvt v92,v72,v73
cvt v93,v74,v75
cvt v94,v76,v77
cvt v95,v78,v79
buffer_store_dwordx4 v[92:95],v2,s[28:31],s59 offen sc1
ard v104,a100
ard v105,a101
ard v106,a102
ard v107,a103
ard v108,a116
ard v109,a117
ard v110,a118
ard v111,a119
v_pk_mul_f32 v[104:105],v[104:105],v[26:27]
v_pk_mul_f32 v[106:107],v[106:107],v[26:27]
v_pk_mul_f32 v[108:109],v[108:109],v[26:27]
v_pk_mul_f32 v[110:111],v[110:111],v[26:27]
cvt v124,v104,v105
cvt v125,v106,v107
cvt v126,v108,v109
cvt v127,v110,v111
buffer_store_dwordx4 v[124:127],v2,s[28:31],s59 offen offset:1024 sc1
s_mov_b32 s40,s50
s_mov_b32 s41,s51
s_mov_b32 s43,s52
v_mov_b32 v3,v45
s_add_u32 s20,s4,36372480
s_addc_u32 s21,s5,0
s_mov_b32 s22,16777216
s_mov_b32 s23,0x20000
s_add_u32 s24,s4,53149696
s_addc_u32 s25,s5,0
s_mov_b32 s26,5242880
s_mov_b32 s27,0x20000
v_add_u32 v4,61440,v2
v_add_u32 v122,122880,v2
v_lshlrev_b32 v6,20,v1
s_waitcnt vmcnt(16)
s_barrier
v_cmp_ne_u32 vcc,1,v204
s_nop 0
s_cbranch_vccnz Lwc_slow
Lwc_go:
buffer_load_dwordx4 a[152:155],v2,s[20:23],s40 offen sc1
buffer_load_dwordx4 a[156:159],v2,s[20:23],s40 offen offset:1024 sc1
s_add_u32 s40,s40,4096
ds_read_b128 a[0:3],v122 offset:20480
ds_read_b128 a[4:7],v122 offset:21504
ds_read_b128 a[8:11],v122 offset:22528
ds_read_b128 a[12:15],v122 offset:23552
ds_read_b128 a[16:19],v122 offset:24576
ds_read_b128 a[20:23],v122 offset:30720
ds_read_b128 a[24:27],v122 offset:31744
ds_read_b128 a[28:31],v122 offset:32768
ds_read_b128 a[32:35],v122 offset:33792
ds_read_b128 a[36:39],v122 offset:34816
buffer_load_dwordx4 a[160:163],v2,s[20:23],s40 offen sc1
buffer_load_dwordx4 a[164:167],v2,s[20:23],s40 offen offset:1024 sc1
s_add_u32 s40,s40,4096
s_waitcnt vmcnt(17) lgkmcnt(9)
mf v[16:19],a[0:3],a[128:131],0
ds_read_b128 a[40:43],v122 offset:25600
ds_read_b128 a[44:47],v122 offset:26624
s_waitcnt vmcnt(15) lgkmcnt(6)
mf v[16:19],a[20:23],a[136:139],v[16:19]
ds_read_b128 a[48:51],v122 offset:27648
ds_read_b128 a[52:55],v122 offset:28672
s_waitcnt lgkmcnt(7)
mf v[20:23],a[24:27],a[136:139],0
ds_read_b128 a[56:59],v122 offset:29696
ds_read_b128 a[60:63],v122 offset:35840
mf v[20:23],a[4:7],a[128:131],v[20:23]
ds_read_b128 a[64:67],v122 offset:36864
ds_read_b128 a[68:71],v122 offset:37888
mf v[24:27],a[8:11],a[128:131],0
ds_read_b128 a[72:75],v122 offset:38912
ds_read_b128 a[76:79],v122 offset:39936
s_waitcnt lgkmcnt(12)
mf v[24:27],a[28:31],a[136:139],v[24:27]
s_waitcnt lgkmcnt(11)
mf v[28:31],a[32:35],a[136:139],0
s_add_u32 m0,s43,20480
mf v[28:31],a[12:15],a[128:131],v[28:31]
buffer_load_dwordx4 v2,s[24:27],s41 offen sc1 lds
mf v[32:35],a[16:19],a[128:131],0
s_waitcnt lgkmcnt(10)
mf v[32:35],a[36:39],a[136:139],v[32:35]
buffer_load_dwordx4 v2,s[24:27],s41 offen offset:1024 sc1 lds
s_waitcnt vmcnt(16)
mf v[72:75],a[36:39],a[140:143],0
mf v[72:75],a[16:19],a[132:135],v[72:75]
buffer_load_dwordx4 v2,s[24:27],s41 offen offset:2048 sc1 lds
mf v[68:71],a[12:15],a[132:135],0
mf v[68:71],a[32:35],a[140:143],v[68:71]
buffer_load_dwordx4 v2,s[24:27],s41 offen offset:3072 sc1 lds
mf v[64:67],a[28:31],a[140:143],0
mf v[64:67],a[8:11],a[132:135],v[64:67]
buffer_load_dwordx4 a[168:171],v2,s[20:23],s40 offen sc1
mf v[60:63],a[4:7],a[132:135],0
mf v[60:63],a[24:27],a[140:143],v[60:63]
buffer_load_dwordx4 a[172:175],v2,s[20:23],s40 offen offset:1024 sc1
s_add_u32 s40,s40,4096
mf v[56:59],a[20:23],a[140:143],0
mf v[56:59],a[0:3],a[132:135],v[56:59]
s_waitcnt lgkmcnt(0)
mf v[36:39],a[40:43],a[128:131],0
ds_read_b128 a[0:3],v2 offset:0
ds_read_b128 a[4:7],v2 offset:1024
mf v[36:39],a[60:63],a[136:139],v[36:39]
ds_read_b128 a[8:11],v2 offset:2048
ds_read_b128 a[12:15],v2 offset:3072
mf v[40:43],a[64:67],a[136:139],0
ds_read_b128 a[16:19],v2 offset:4096
ds_read_b128 a[20:23],v2 offset:10240
mf v[40:43],a[44:47],a[128:131],v[40:43]
ds_read_b128 a[24:27],v2 offset:11264
ds_read_b128 a[28:31],v2 offset:12288
mf v[44:47],a[48:51],a[128:131],0
ds_read_b128 a[32:35],v2 offset:13312
ds_read_b128 a[36:39],v2 offset:14336
mf v[44:47],a[68:71],a[136:139],v[44:47]
mf v[48:51],a[72:75],a[136:139],0
s_add_u32 m0,s43,24576
mf v[48:51],a[52:55],a[128:131],v[48:51]
buffer_load_dwordx4 v3,s[24:27],s41 offen sc1 lds
s_add_u32 s41,s41,81920
mf v[52:55],a[56:59],a[128:131],0
s_waitcnt vmcnt(11)
buffer_store_dword v220,v221,s[8:11],s49 offen sc1
mf v[52:55],a[76:79],a[136:139],v[52:55]
s_add_u32 m0,s43,40960
mf v[92:95],a[76:79],a[140:143],0
mf v[92:95],a[56:59],a[132:135],v[92:95]
buffer_load_dwordx4 v2,s[24:27],s41 offen sc1 lds
mf v[88:91],a[52:55],a[132:135],0
mf v[88:91],a[72:75],a[140:143],v[88:91]
buffer_load_dwordx4 v2,s[24:27],s41 offen offset:1024 sc1 lds
mf v[84:87],a[68:71],a[140:143],0
mf v[84:87],a[48:51],a[132:135],v[84:87]
buffer_load_dwordx4 a[176:179],v2,s[20:23],s40 offen sc1
mf v[80:83],a[44:47],a[132:135],0
mf v[80:83],a[64:67],a[140:143],v[80:83]
buffer_load_dwordx4 a[180:183],v2,s[20:23],s40 offen offset:1024 sc1
s_add_u32 s40,s40,4096
mf v[76:79],a[60:63],a[140:143],0
mf v[76:79],a[40:43],a[132:135],v[76:79]
s_waitcnt lgkmcnt(0)
mf v[16:19],a[0:3],a[144:147],v[16:19]
ds_read_b128 a[40:43],v2 offset:5120
ds_read_b128 a[44:47],v2 offset:6144
s_waitcnt vmcnt(15)
mf v[16:19],a[20:23],a[152:155],v[16:19]
ds_read_b128 a[48:51],v2 offset:7168
ds_read_b128 a[52:55],v2 offset:8192
mf v[20:23],a[24:27],a[152:155],v[20:23]
ds_read_b128 a[56:59],v2 offset:9216
ds_read_b128 a[60:63],v2 offset:15360
mf v[20:23],a[4:7],a[144:147],v[20:23]
ds_read_b128 a[64:67],v2 offset:16384
ds_read_b128 a[68:71],v2 offset:17408
mf v[24:27],a[8:11],a[144:147],v[24:27]
ds_read_b128 a[72:75],v2 offset:18432
ds_read_b128 a[76:79],v2 offset:19456
mf v[24:27],a[28:31],a[152:155],v[24:27]
mf v[28:31],a[32:35],a[152:155],v[28:31]
buffer_load_dwordx4 v2,s[24:27],s41 offen offset:2048 sc1 lds
mf v[28:31],a[12:15],a[144:147],v[28:31]
mf v[32:35],a[16:19],a[144:147],v[32:35]
buffer_load_dwordx4 v2,s[24:27],s41 offen offset:3072 sc1 lds
mf v[32:35],a[36:39],a[152:155],v[32:35]
s_waitcnt vmcnt(16)
mf v[72:75],a[36:39],a[156:159],v[72:75]
s_add_u32 m0,s43,45056
mf v[72:75],a[16:19],a[148:151],v[72:75]
mf v[68:71],a[12:15],a[148:151],v[68:71]
buffer_load_dwordx4 v3,s[24:27],s41 offen sc1 lds
s_add_u32 s41,s41,81920
mf v[68:71],a[32:35],a[156:159],v[68:71]
mf v[64:67],a[28:31],a[156:159],v[64:67]
buffer_load_dwordx4 a[128:131],v2,s[20:23],s40 offen sc1
mf v[64:67],a[8:11],a[148:151],v[64:67]
mf v[60:63],a[4:7],a[148:151],v[60:63]
buffer_load_dwordx4 a[132:135],v2,s[20:23],s40 offen offset:1024 sc1
s_add_u32 s40,s40,4096
mf v[60:63],a[24:27],a[156:159],v[60:63]
mf v[56:59],a[20:23],a[156:159],v[56:59]
mf v[56:59],a[0:3],a[148:151],v[56:59]
s_waitcnt lgkmcnt(0)
mf v[36:39],a[40:43],a[144:147],v[36:39]
s_waitcnt vmcnt(10)
s_barrier
mf v[36:39],a[60:63],a[152:155],v[36:39]
ds_read_b128 a[0:3],v2 offset:20480
ds_read_b128 a[4:7],v2 offset:21504
mf v[40:43],a[64:67],a[152:155],v[40:43]
ds_read_b128 a[8:11],v2 offset:22528
ds_read_b128 a[12:15],v2 offset:23552
mf v[40:43],a[44:47],a[144:147],v[40:43]
ds_read_b128 a[16:19],v2 offset:24576
ds_read_b128 a[20:23],v2 offset:30720
mf v[44:47],a[48:51],a[144:147],v[44:47]
ds_read_b128 a[24:27],v2 offset:31744
ds_read_b128 a[28:31],v2 offset:32768
mf v[44:47],a[68:71],a[152:155],v[44:47]
ds_read_b128 a[32:35],v2 offset:33792
ds_read_b128 a[36:39],v2 offset:34816
mf v[48:51],a[72:75],a[152:155],v[48:51]
s_add_u32 m0,s43,61440
mf v[48:51],a[52:55],a[144:147],v[48:51]
mf v[52:55],a[56:59],a[144:147],v[52:55]
buffer_load_dwordx4 v2,s[24:27],s41 offen sc1 lds
mf v[52:55],a[76:79],a[152:155],v[52:55]
mf v[92:95],a[76:79],a[156:159],v[92:95]
mf v[92:95],a[56:59],a[148:151],v[92:95]
buffer_load_dwordx4 v2,s[24:27],s41 offen offset:1024 sc1 lds
mf v[88:91],a[52:55],a[148:151],v[88:91]
mf v[88:91],a[72:75],a[156:159],v[88:91]
buffer_load_dwordx4 a[136:139],v2,s[20:23],s40 offen sc1
mf v[84:87],a[68:71],a[156:159],v[84:87]
mf v[84:87],a[48:51],a[148:151],v[84:87]
mf v[80:83],a[44:47],a[148:151],v[80:83]
buffer_load_dwordx4 a[140:143],v2,s[20:23],s40 offen offset:1024 sc1
s_add_u32 s40,s40,4096
mf v[80:83],a[64:67],a[156:159],v[80:83]
mf v[76:79],a[60:63],a[156:159],v[76:79]
mf v[76:79],a[40:43],a[148:151],v[76:79]
s_waitcnt lgkmcnt(0)
mf v[16:19],a[0:3],a[160:163],v[16:19]
ds_read_b128 a[40:43],v2 offset:25600
ds_read_b128 a[44:47],v2 offset:26624
mf v[16:19],a[20:23],a[168:171],v[16:19]
ds_read_b128 a[48:51],v2 offset:27648
ds_read_b128 a[52:55],v2 offset:28672
mf v[20:23],a[24:27],a[168:171],v[20:23]
ds_read_b128 a[56:59],v2 offset:29696
ds_read_b128 a[60:63],v2 offset:35840
mf v[20:23],a[4:7],a[160:163],v[20:23]
ds_read_b128 a[64:67],v2 offset:36864
ds_read_b128 a[68:71],v2 offset:37888
mf v[24:27],a[8:11],a[160:163],v[24:27]
ds_read_b128 a[72:75],v2 offset:38912
ds_read_b128 a[76:79],v2 offset:39936
mf v[24:27],a[28:31],a[168:171],v[24:27]
mf v[28:31],a[32:35],a[168:171],v[28:31]
buffer_load_dwordx4 v2,s[24:27],s41 offen offset:2048 sc1 lds
mf v[28:31],a[12:15],a[160:163],v[28:31]
mf v[32:35],a[16:19],a[160:163],v[32:35]
buffer_load_dwordx4 v2,s[24:27],s41 offen offset:3072 sc1 lds
mf v[32:35],a[36:39],a[168:171],v[32:35]
mf v[72:75],a[36:39],a[172:175],v[72:75]
s_add_u32 m0,s43,65536
mf v[72:75],a[16:19],a[164:167],v[72:75]
mf v[68:71],a[12:15],a[164:167],v[68:71]
buffer_load_dwordx4 v3,s[24:27],s41 offen sc1 lds
s_add_u32 s41,s41,81920
mf v[68:71],a[32:35],a[172:175],v[68:71]
mf v[64:67],a[28:31],a[172:175],v[64:67]
buffer_load_dwordx4 a[144:147],v2,s[20:23],s40 offen sc1
mf v[64:67],a[8:11],a[164:167],v[64:67]
mf v[60:63],a[4:7],a[164:167],v[60:63]
buffer_load_dwordx4 a[148:151],v2,s[20:23],s40 offen offset:1024 sc1
s_add_u32 s40,s40,4096
mf v[60:63],a[24:27],a[172:175],v[60:63]
mf v[56:59],a[20:23],a[172:175],v[56:59]
mf v[56:59],a[0:3],a[164:167],v[56:59]
s_waitcnt lgkmcnt(0)
mf v[36:39],a[40:43],a[160:163],v[36:39]
s_waitcnt vmcnt(11)
s_barrier
mf v[36:39],a[60:63],a[168:171],v[36:39]
ds_read_b128 a[0:3],v2 offset:40960
ds_read_b128 a[4:7],v2 offset:41984
mf v[40:43],a[64:67],a[168:171],v[40:43]
ds_read_b128 a[8:11],v2 offset:43008
ds_read_b128 a[12:15],v2 offset:44032
mf v[40:43],a[44:47],a[160:163],v[40:43]
ds_read_b128 a[16:19],v2 offset:45056
ds_read_b128 a[20:23],v2 offset:51200
mf v[44:47],a[48:51],a[160:163],v[44:47]
ds_read_b128 a[24:27],v2 offset:52224
ds_read_b128 a[28:31],v2 offset:53248
mf v[44:47],a[68:71],a[168:171],v[44:47]
ds_read_b128 a[32:35],v2 offset:54272
ds_read_b128 a[36:39],v2 offset:55296
mf v[48:51],a[72:75],a[168:171],v[48:51]
s_add_u32 m0,s43,81920
mf v[48:51],a[52:55],a[160:163],v[48:51]
mf v[52:55],a[56:59],a[160:163],v[52:55]
buffer_load_dwordx4 v2,s[24:27],s41 offen sc1 lds
mf v[52:55],a[76:79],a[168:171],v[52:55]
mf v[92:95],a[76:79],a[172:175],v[92:95]
mf v[92:95],a[56:59],a[164:167],v[92:95]
buffer_load_dwordx4 v2,s[24:27],s41 offen offset:1024 sc1 lds
mf v[88:91],a[52:55],a[164:167],v[88:91]
mf v[88:91],a[72:75],a[172:175],v[88:91]
buffer_load_dwordx4 a[152:155],v2,s[20:23],s40 offen sc1
mf v[84:87],a[68:71],a[172:175],v[84:87]
mf v[84:87],a[48:51],a[164:167],v[84:87]
mf v[80:83],a[44:47],a[164:167],v[80:83]
buffer_load_dwordx4 a[156:159],v2,s[20:23],s40 offen offset:1024 sc1
s_add_u32 s40,s40,4096
mf v[80:83],a[64:67],a[172:175],v[80:83]
mf v[76:79],a[60:63],a[172:175],v[76:79]
mf v[76:79],a[40:43],a[164:167],v[76:79]
s_waitcnt lgkmcnt(0)
mf v[16:19],a[0:3],a[176:179],v[16:19]
ds_read_b128 a[40:43],v2 offset:46080
ds_read_b128 a[44:47],v2 offset:47104
s_waitcnt vmcnt(14)
mf v[16:19],a[20:23],a[128:131],v[16:19]
ds_read_b128 a[48:51],v2 offset:48128
ds_read_b128 a[52:55],v2 offset:49152
mf v[20:23],a[24:27],a[128:131],v[20:23]
ds_read_b128 a[56:59],v2 offset:50176
ds_read_b128 a[60:63],v2 offset:56320
mf v[20:23],a[4:7],a[176:179],v[20:23]
ds_read_b128 a[64:67],v2 offset:57344
ds_read_b128 a[68:71],v2 offset:58368
mf v[24:27],a[8:11],a[176:179],v[24:27]
ds_read_b128 a[72:75],v2 offset:59392
ds_read_b128 a[76:79],v2 offset:60416
mf v[24:27],a[28:31],a[128:131],v[24:27]
mf v[28:31],a[32:35],a[128:131],v[28:31]
buffer_load_dwordx4 v2,s[24:27],s41 offen offset:2048 sc1 lds
mf v[28:31],a[12:15],a[176:179],v[28:31]
s_bfe_u32 s50,s2,0x20001
s_mul_i32 s50,s50,27
mf v[32:35],a[16:19],a[176:179],v[32:35]
buffer_load_dwordx4 v2,s[24:27],s41 offen offset:3072 sc1 lds
mf v[32:35],a[36:39],a[128:131],v[32:35]
s_waitcnt vmcnt(15)
mf v[72:75],a[36:39],a[132:135],v[72:75]
s_add_u32 m0,s43,86016
mf v[72:75],a[16:19],a[180:183],v[72:75]
s_lshr_b32 s51,s2,3
s_add_u32 s50,s50,s51
mf v[68:71],a[12:15],a[180:183],v[68:71]
buffer_load_dwordx4 v3,s[24:27],s41 offen sc1 lds
s_add_u32 s41,s41,81920
mf v[68:71],a[32:35],a[132:135],v[68:71]
s_and_b32 s51,s2,1
s_lshl_b32 s51,s51,2
mf v[64:67],a[28:31],a[132:135],v[64:67]
buffer_load_dwordx4 a[160:163],v2,s[20:23],s40 offen sc1
mf v[64:67],a[8:11],a[180:183],v[64:67]
s_and_b32 s52,s50,3
s_add_u32 s51,s51,s52
mf v[60:63],a[4:7],a[180:183],v[60:63]
buffer_load_dwordx4 a[164:167],v2,s[20:23],s40 offen offset:1024 sc1
s_add_u32 s40,s40,4096
mf v[60:63],a[24:27],a[132:135],v[60:63]
mf v[56:59],a[20:23],a[132:135],v[56:59]
mf v[56:59],a[0:3],a[180:183],v[56:59]
s_waitcnt lgkmcnt(0)
mf v[36:39],a[40:43],a[176:179],v[36:39]
s_waitcnt vmcnt(11)
s_barrier
mf v[36:39],a[60:63],a[128:131],v[36:39]
ds_read_b128 a[0:3],v4 offset:0
ds_read_b128 a[4:7],v4 offset:1024
mf v[40:43],a[64:67],a[128:131],v[40:43]
ds_read_b128 a[8:11],v4 offset:2048
ds_read_b128 a[12:15],v4 offset:3072
mf v[40:43],a[44:47],a[176:179],v[40:43]
ds_read_b128 a[16:19],v4 offset:4096
ds_read_b128 a[20:23],v4 offset:10240
mf v[44:47],a[48:51],a[176:179],v[44:47]
ds_read_b128 a[24:27],v4 offset:11264
ds_read_b128 a[28:31],v4 offset:12288
mf v[44:47],a[68:71],a[128:131],v[44:47]
ds_read_b128 a[32:35],v4 offset:13312
ds_read_b128 a[36:39],v4 offset:14336
mf v[48:51],a[72:75],a[128:131],v[48:51]
s_add_u32 m0,s43,102400
mf v[48:51],a[52:55],a[176:179],v[48:51]
s_lshr_b32 s50,s50,2
s_lshl_b32 s51,s51,2
mf v[52:55],a[56:59],a[176:179],v[52:55]
buffer_load_dwordx4 v2,s[24:27],s41 offen sc1 lds
mf v[52:55],a[76:79],a[128:131],v[52:55]
mf v[92:95],a[76:79],a[132:135],v[92:95]
s_add_u32 s51,s51,s3
s_mul_i32 s52,s50,163840
mf v[92:95],a[56:59],a[180:183],v[92:95]
buffer_load_dwordx4 v2,s[24:27],s41 offen offset:1024 sc1 lds
mf v[88:91],a[52:55],a[180:183],v[88:91]
s_lshl_b32 s53,s3,13
s_add_u32 s52,s52,s53
mf v[88:91],a[72:75],a[132:135],v[88:91]
buffer_load_dwordx4 a[168:171],v2,s[20:23],s40 offen sc1
mf v[84:87],a[68:71],a[132:135],v[84:87]
s_add_u32 s56,s4,58392576
s_addc_u32 s57,s5,0
mf v[84:87],a[48:51],a[180:183],v[84:87]
s_cmp_lt_u32 s2,216
s_cselect_b32 s58,4423680,0
mf v[80:83],a[44:47],a[180:183],v[80:83]
buffer_load_dwordx4 a[172:175],v2,s[20:23],s40 offen offset:1024 sc1
s_add_u32 s40,s40,4096
mf v[80:83],a[64:67],a[132:135],v[80:83]
s_mov_b32 s59,0x20000
mf v[76:79],a[60:63],a[132:135],v[76:79]
mf v[76:79],a[40:43],a[180:183],v[76:79]
s_waitcnt lgkmcnt(0)
mf v[16:19],a[0:3],a[136:139],v[16:19]
ds_read_b128 a[40:43],v4 offset:5120
ds_read_b128 a[44:47],v4 offset:6144
s_waitcnt vmcnt(14)
mf v[16:19],a[20:23],a[144:147],v[16:19]
ds_read_b128 a[48:51],v4 offset:7168
ds_read_b128 a[52:55],v4 offset:8192
mf v[20:23],a[24:27],a[144:147],v[20:23]
ds_read_b128 a[56:59],v4 offset:9216
ds_read_b128 a[60:63],v4 offset:15360
mf v[20:23],a[4:7],a[136:139],v[20:23]
ds_read_b128 a[64:67],v4 offset:16384
ds_read_b128 a[68:71],v4 offset:17408
mf v[24:27],a[8:11],a[136:139],v[24:27]
ds_read_b128 a[72:75],v4 offset:18432
ds_read_b128 a[76:79],v4 offset:19456
mf v[24:27],a[28:31],a[144:147],v[24:27]
mf v[28:31],a[32:35],a[144:147],v[28:31]
buffer_load_dwordx4 v2,s[24:27],s41 offen offset:2048 sc1 lds
mf v[28:31],a[12:15],a[136:139],v[28:31]
mf v[32:35],a[16:19],a[136:139],v[32:35]
buffer_load_dwordx4 v2,s[24:27],s41 offen offset:3072 sc1 lds
mf v[32:35],a[36:39],a[144:147],v[32:35]
s_waitcnt vmcnt(15)
mf v[72:75],a[36:39],a[148:151],v[72:75]
s_add_u32 m0,s43,106496
mf v[72:75],a[16:19],a[140:143],v[72:75]
s_load_dwordx2 s[6:7],s[0:1],0
s_load_dwordx2 s[12:13],s[0:1],96
mf v[68:71],a[12:15],a[140:143],v[68:71]
buffer_load_dwordx4 v3,s[24:27],s41 offen sc1 lds
s_add_u32 s41,s41,81920
mf v[68:71],a[32:35],a[148:151],v[68:71]
s_add_u32 s63,s63,512
buffer_load_dword v204,v205,s[8:11],s63 offen sc1
mf v[64:67],a[28:31],a[148:151],v[64:67]
buffer_load_dwordx4 a[176:179],v2,s[20:23],s40 offen sc1
mf v[64:67],a[8:11],a[140:143],v[64:67]
mf v[60:63],a[4:7],a[140:143],v[60:63]
buffer_load_dwordx4 a[180:183],v2,s[20:23],s40 offen offset:1024 sc1
s_add_u32 s40,s40,4096
mf v[60:63],a[24:27],a[148:151],v[60:63]
mf v[56:59],a[20:23],a[148:151],v[56:59]
mf v[56:59],a[0:3],a[140:143],v[56:59]
s_waitcnt lgkmcnt(0)
mf v[36:39],a[40:43],a[136:139],v[36:39]
s_waitcnt vmcnt(12)
s_barrier
mf v[36:39],a[60:63],a[144:147],v[36:39]
ds_read_b128 a[0:3],v4 offset:20480
ds_read_b128 a[4:7],v4 offset:21504
mf v[40:43],a[64:67],a[144:147],v[40:43]
ds_read_b128 a[8:11],v4 offset:22528
ds_read_b128 a[12:15],v4 offset:23552
mf v[40:43],a[44:47],a[136:139],v[40:43]
ds_read_b128 a[16:19],v4 offset:24576
ds_read_b128 a[20:23],v4 offset:30720
mf v[44:47],a[48:51],a[136:139],v[44:47]
ds_read_b128 a[24:27],v4 offset:31744
ds_read_b128 a[28:31],v4 offset:32768
mf v[44:47],a[68:71],a[144:147],v[44:47]
ds_read_b128 a[32:35],v4 offset:33792
ds_read_b128 a[36:39],v4 offset:34816
mf v[48:51],a[72:75],a[144:147],v[48:51]
s_add_u32 m0,s43,122880
mf v[48:51],a[52:55],a[136:139],v[48:51]
s_bfe_u32 s14,s2,0x20001
s_and_b32 s15,s2,1
mf v[52:55],a[56:59],a[136:139],v[52:55]
buffer_load_dwordx4 v2,s[24:27],s41 offen sc1 lds
mf v[52:55],a[76:79],a[144:147],v[52:55]
mf v[92:95],a[76:79],a[148:151],v[92:95]
s_lshl_b32 s15,s15,3
s_lshr_b32 s16,s2,5
mf v[92:95],a[56:59],a[140:143],v[92:95]
buffer_load_dwordx4 v2,s[24:27],s41 offen offset:1024 sc1 lds
mf v[88:91],a[52:55],a[140:143],v[88:91]
s_add_u32 s15,s15,s16
s_bfe_u32 s16,s2,0x20003
mf v[88:91],a[72:75],a[148:151],v[88:91]
buffer_load_dwordx4 a[128:131],v2,s[20:23],s40 offen sc1
mf v[84:87],a[68:71],a[148:151],v[84:87]
s_lshr_b32 s17,s3,1
s_and_b32 s18,s3,1
mf v[84:87],a[48:51],a[140:143],v[84:87]
s_lshl_b32 s19,s15,1
s_add_u32 s19,s19,s17
mf v[80:83],a[44:47],a[140:143],v[80:83]
buffer_load_dwordx4 a[132:135],v2,s[20:23],s40 offen offset:1024 sc1
s_add_u32 s40,s40,4096
mf v[80:83],a[64:67],a[148:151],v[80:83]
v_mov_b32 v5,1
s_lshl_b32 s45,s3,6
mf v[76:79],a[60:63],a[148:151],v[76:79]
mf v[76:79],a[40:43],a[140:143],v[76:79]
s_waitcnt lgkmcnt(0)
mf v[16:19],a[0:3],a[152:155],v[16:19]
ds_read_b128 a[40:43],v4 offset:25600
ds_read_b128 a[44:47],v4 offset:26624
s_waitcnt vmcnt(15)
mf v[16:19],a[20:23],a[160:163],v[16:19]
ds_read_b128 a[48:51],v4 offset:27648
ds_read_b128 a[52:55],v4 offset:28672
mf v[20:23],a[24:27],a[160:163],v[20:23]
ds_read_b128 a[56:59],v4 offset:29696
ds_read_b128 a[60:63],v4 offset:35840
mf v[20:23],a[4:7],a[152:155],v[20:23]
ds_read_b128 a[64:67],v4 offset:36864
ds_read_b128 a[68:71],v4 offset:37888
mf v[24:27],a[8:11],a[152:155],v[24:27]
ds_read_b128 a[72:75],v4 offset:38912
ds_read_b128 a[76:79],v4 offset:39936
mf v[24:27],a[28:31],a[160:163],v[24:27]
mf v[28:31],a[32:35],a[160:163],v[28:31]
buffer_load_dwordx4 v2,s[24:27],s41 offen offset:2048 sc1 lds
v_add_u32 v0,s45,v1
mf v[28:31],a[12:15],a[152:155],v[28:31]
s_add_u32 s28,s4,77398016
s_addc_u32 s29,s5,0
mf v[32:35],a[16:19],a[152:155],v[32:35]
buffer_load_dwordx4 v2,s[24:27],s41 offen offset:3072 sc1 lds
mf v[32:35],a[36:39],a[160:163],v[32:35]
s_waitcnt vmcnt(16)
mf v[72:75],a[36:39],a[164:167],v[72:75]
s_add_u32 m0,s43,126976
mf v[72:75],a[16:19],a[156:159],v[72:75]
s_mov_b32 s30,10485760
s_mov_b32 s31,0x20000
mf v[68:71],a[12:15],a[156:159],v[68:71]
buffer_load_dwordx4 v3,s[24:27],s41 offen sc1 lds
s_add_u32 s41,s41,81920
mf v[68:71],a[32:35],a[164:167],v[68:71]
s_mul_i32 s44,s14,2621440
s_mul_i32 s45,s19,20
mf v[64:67],a[28:31],a[164:167],v[64:67]
buffer_load_dwordx4 a[136:139],v2,s[20:23],s40 offen sc1
mf v[64:67],a[8:11],a[156:159],v[64:67]
s_mul_i32 s46,s16,5
s_add_u32 s45,s45,s46
mf v[60:63],a[4:7],a[156:159],v[60:63]
buffer_load_dwordx4 a[140:143],v2,s[20:23],s40 offen offset:1024 sc1
s_add_u32 s40,s40,4096
mf v[60:63],a[24:27],a[164:167],v[60:63]
s_lshl_b32 s45,s45,12
s_add_u32 s44,s44,s45
mf v[56:59],a[20:23],a[164:167],v[56:59]
s_lshl_b32 s45,s18,11
s_add_u32 s44,s44,s45
mf v[56:59],a[0:3],a[156:159],v[56:59]
s_waitcnt lgkmcnt(0)
s_waitcnt vmcnt(11)
v_cmp_ne_u32 vcc,1,v204
s_nop 0
s_cbranch_vccnz Lwd_slow
Lwd_go:
mf v[36:39],a[40:43],a[152:155],v[36:39]
s_barrier
mf v[36:39],a[60:63],a[160:163],v[36:39]
ds_read_b128 a[0:3],v4 offset:40960
ds_read_b128 a[4:7],v4 offset:41984
mf v[40:43],a[64:67],a[160:163],v[40:43]
ds_read_b128 a[8:11],v4 offset:43008
ds_read_b128 a[12:15],v4 offset:44032
mf v[40:43],a[44:47],a[152:155],v[40:43]
ds_read_b128 a[16:19],v4 offset:45056
ds_read_b128 a[20:23],v4 offset:51200
mf v[44:47],a[48:51],a[152:155],v[44:47]
ds_read_b128 a[24:27],v4 offset:52224
ds_read_b128 a[28:31],v4 offset:53248
mf v[44:47],a[68:71],a[160:163],v[44:47]
ds_read_b128 a[32:35],v4 offset:54272
ds_read_b128 a[36:39],v4 offset:55296
mf v[48:51],a[72:75],a[160:163],v[48:51]
s_add_u32 m0,s43,143360
mf v[48:51],a[52:55],a[152:155],v[48:51]
s_lshl_b32 s47,s16,2
s_add_u32 s47,s47,s14
mf v[52:55],a[56:59],a[152:155],v[52:55]
buffer_load_dwordx4 v2,s[24:27],s41 offen sc1 lds
mf v[52:55],a[76:79],a[160:163],v[52:55]
mf v[92:95],a[76:79],a[164:167],v[92:95]
s_lshl_b32 s48,s15,4
s_add_u32 s48,s48,s47
mf v[92:95],a[56:59],a[156:159],v[92:95]
buffer_load_dwordx4 v2,s[24:27],s41 offen offset:1024 sc1 lds
mf v[88:91],a[52:55],a[156:159],v[88:91]
v_and_b32 v8,7,v1
v_bfe_u32 v9,v1,3,2
mf v[88:91],a[72:75],a[164:167],v[88:91]
buffer_load_dwordx4 a[144:147],v2,s[20:23],s40 offen sc1
mf v[84:87],a[68:71],a[164:167],v[84:87]
v_lshrrev_b32 v10,5,v1
s_lshr_b32 s45,s48,3
mf v[84:87],a[48:51],a[156:159],v[84:87]
s_mul_i32 s45,s45,20
s_mul_i32 s46,s3,5
mf v[80:83],a[44:47],a[156:159],v[80:83]
buffer_load_dwordx4 a[148:151],v2,s[20:23],s40 offen offset:1024 sc1
s_add_u32 s40,s40,4096
mf v[80:83],a[64:67],a[164:167],v[80:83]
s_add_u32 s45,s45,s46
s_lshl_b32 s45,s45,2
mf v[76:79],a[60:63],a[164:167],v[76:79]
mf v[76:79],a[40:43],a[156:159],v[76:79]
s_waitcnt lgkmcnt(0)
mf v[16:19],a[0:3],a[168:171],v[16:19]
ds_read_b128 a[40:43],v4 offset:46080
ds_read_b128 a[44:47],v4 offset:47104
s_waitcnt vmcnt(14)
mf v[16:19],a[20:23],a[176:179],v[16:19]
ds_read_b128 a[48:51],v4 offset:48128
ds_read_b128 a[52:55],v4 offset:49152
mf v[20:23],a[24:27],a[176:179],v[20:23]
ds_read_b128 a[56:59],v4 offset:50176
ds_read_b128 a[60:63],v4 offset:56320
mf v[20:23],a[4:7],a[168:171],v[20:23]
ds_read_b128 a[64:67],v4 offset:57344
ds_read_b128 a[68:71],v4 offset:58368
mf v[24:27],a[8:11],a[168:171],v[24:27]
ds_read_b128 a[72:75],v4 offset:59392
ds_read_b128 a[76:79],v4 offset:60416
mf v[24:27],a[28:31],a[176:179],v[24:27]
mf v[28:31],a[32:35],a[176:179],v[28:31]
buffer_load_dwordx4 v2,s[24:27],s41 offen offset:2048 sc1 lds
mf v[28:31],a[12:15],a[168:171],v[28:31]
s_bfe_u32 s55,s48,0x20001
s_add_u32 s45,s45,s55
mf v[32:35],a[16:19],a[168:171],v[32:35]
buffer_load_dwordx4 v2,s[24:27],s41 offen offset:3072 sc1 lds
mf v[32:35],a[36:39],a[176:179],v[32:35]
s_waitcnt vmcnt(15)
mf v[72:75],a[36:39],a[180:183],v[72:75]
s_add_u32 m0,s43,147456
mf v[72:75],a[16:19],a[172:175],v[72:75]
s_lshl_b32 s45,s45,10
s_and_b32 s55,s48,1
mf v[68:71],a[12:15],a[172:175],v[68:71]
buffer_load_dwordx4 v3,s[24:27],s41 offen sc1 lds
s_add_u32 s41,s41,81920
mf v[68:71],a[32:35],a[180:183],v[68:71]
s_lshl_b32 s55,s55,7
s_add_u32 s45,s45,s55
mf v[64:67],a[28:31],a[180:183],v[64:67]
buffer_load_dwordx4 a[152:155],v2,s[20:23],s40 offen sc1
mf v[64:67],a[8:11],a[172:175],v[64:67]
v_lshlrev_b32 v11,8,v9
v_lshl_add_u32 v11,v8,4,v11
mf v[60:63],a[4:7],a[172:175],v[60:63]
buffer_load_dwordx4 a[156:159],v2,s[20:23],s40 offen offset:1024 sc1
s_add_u32 s40,s40,4096
mf v[60:63],a[24:27],a[180:183],v[60:63]
v_add_u32 v11,s45,v11
v_mul_u32_u24 v12,5242880,v10
mf v[56:59],a[20:23],a[180:183],v[56:59]
v_add_u32 v12,v12,v11
v_mul_u32_u24 v13,2621440,v10
mf v[56:59],a[0:3],a[172:175],v[56:59]
s_waitcnt lgkmcnt(0)
mf v[36:39],a[40:43],a[168:171],v[36:39]
s_waitcnt vmcnt(11)
s_barrier
mf v[36:39],a[60:63],a[176:179],v[36:39]
ds_read_b128 a[0:3],v122 offset:0
ds_read_b128 a[4:7],v122 offset:1024
mf v[40:43],a[64:67],a[176:179],v[40:43]
ds_read_b128 a[8:11],v122 offset:2048
ds_read_b128 a[12:15],v122 offset:3072
mf v[40:43],a[44:47],a[168:171],v[40:43]
ds_read_b128 a[16:19],v122 offset:4096
ds_read_b128 a[20:23],v122 offset:10240
mf v[44:47],a[48:51],a[168:171],v[44:47]
ds_read_b128 a[24:27],v122 offset:11264
ds_read_b128 a[28:31],v122 offset:12288
mf v[44:47],a[68:71],a[176:179],v[44:47]
ds_read_b128 a[32:35],v122 offset:13312
ds_read_b128 a[36:39],v122 offset:14336
mf v[48:51],a[72:75],a[176:179],v[48:51]
s_add_u32 m0,s43,0
mf v[48:51],a[52:55],a[168:171],v[48:51]
v_add_u32 v13,v13,v11
s_lshl_b32 s46,s46,5
mf v[52:55],a[56:59],a[168:171],v[52:55]
buffer_load_dwordx4 v2,s[24:27],s41 offen sc1 lds
mf v[52:55],a[76:79],a[176:179],v[52:55]
mf v[92:95],a[76:79],a[180:183],v[92:95]
v_lshlrev_b32 v14,4,v10
v_lshl_add_u32 v14,v9,2,v14
mf v[92:95],a[56:59],a[172:175],v[92:95]
buffer_load_dwordx4 v2,s[24:27],s41 offen offset:1024 sc1 lds
mf v[88:91],a[52:55],a[172:175],v[88:91]
v_add_u32 v14,s46,v14
s_and_b32 s55,s48,0xf1
mf v[88:91],a[72:75],a[180:183],v[88:91]
buffer_load_dwordx4 a[160:163],v2,s[20:23],s40 offen sc1
mf v[84:87],a[68:71],a[180:183],v[84:87]
s_bfe_u32 s45,s48,0x20002
s_lshl_b32 s45,s45,1
mf v[84:87],a[48:51],a[172:175],v[84:87]
s_add_u32 s55,s55,s45
s_bfe_u32 s45,s48,0x10001
mf v[80:83],a[44:47],a[172:175],v[80:83]
buffer_load_dwordx4 a[164:167],v2,s[20:23],s40 offen offset:1024 sc1
s_add_u32 s40,s40,4096
mf v[80:83],a[64:67],a[180:183],v[80:83]
s_lshl_b32 s45,s45,3
s_add_u32 s55,s55,s45
mf v[76:79],a[60:63],a[180:183],v[76:79]
mf v[76:79],a[40:43],a[172:175],v[76:79]
s_waitcnt lgkmcnt(0)
mf v[16:19],a[0:3],a[128:131],v[16:19]
ds_read_b128 a[40:43],v122 offset:5120
ds_read_b128 a[44:47],v122 offset:6144
s_waitcnt vmcnt(14)
mf v[16:19],a[20:23],a[136:139],v[16:19]
ds_read_b128 a[48:51],v122 offset:7168
ds_read_b128 a[52:55],v122 offset:8192
mf v[20:23],a[24:27],a[136:139],v[20:23]
ds_read_b128 a[56:59],v122 offset:9216
ds_read_b128 a[60:63],v122 offset:15360
mf v[20:23],a[4:7],a[128:131],v[20:23]
ds_read_b128 a[64:67],v122 offset:16384
ds_read_b128 a[68:71],v122 offset:17408
mf v[24:27],a[8:11],a[128:131],v[24:27]
ds_read_b128 a[72:75],v122 offset:18432
ds_read_b128 a[76:79],v122 offset:19456
mf v[24:27],a[28:31],a[136:139],v[24:27]
mf v[28:31],a[32:35],a[136:139],v[28:31]
buffer_load_dwordx4 v2,s[24:27],s41 offen offset:2048 sc1 lds
mf v[28:31],a[12:15],a[128:131],v[28:31]
s_lshl_b32 s55,s55,3
v_add_u32 v15,s55,v8
mf v[32:35],a[16:19],a[128:131],v[32:35]
buffer_load_dwordx4 v2,s[24:27],s41 offen offset:3072 sc1 lds
mf v[32:35],a[36:39],a[136:139],v[32:35]
s_waitcnt vmcnt(15)
mf v[72:75],a[36:39],a[140:143],v[72:75]
s_add_u32 m0,s43,4096
mf v[72:75],a[16:19],a[132:135],v[72:75]
v_mul_u32_u24 v15,1280,v15
v_lshl_add_u32 v15,v14,1,v15
mf v[68:71],a[12:15],a[132:135],v[68:71]
buffer_load_dwordx4 v3,s[24:27],s41 offen sc1 lds
s_add_u32 s41,s41,81920
mf v[68:71],a[32:35],a[140:143],v[68:71]
v_lshlrev_b32 v14,2,v14
s_mov_b32 s32,s6
mf v[64:67],a[28:31],a[140:143],v[64:67]
buffer_load_dwordx4 a[168:171],v2,s[20:23],s40 offen sc1
mf v[64:67],a[8:11],a[132:135],v[64:67]
s_mov_b32 s33,s7
s_mov_b32 s34,2621440
mf v[60:63],a[4:7],a[132:135],v[60:63]
buffer_load_dwordx4 a[172:175],v2,s[20:23],s40 offen offset:1024 sc1
s_add_u32 s40,s40,4096
mf v[60:63],a[24:27],a[140:143],v[60:63]
s_mov_b32 s35,0x20000
mf v[56:59],a[20:23],a[140:143],v[56:59]
s_add_u32 s36,s4,65536
s_addc_u32 s37,s5,0
s_mov_b32 s38,15360
s_mov_b32 s39,0x20000
mf v[56:59],a[0:3],a[132:135],v[56:59]
s_waitcnt lgkmcnt(0)
mf v[36:39],a[40:43],a[128:131],v[36:39]
s_waitcnt vmcnt(11)
s_barrier
mf v[36:39],a[60:63],a[136:139],v[36:39]
ds_read_b128 a[0:3],v122 offset:20480
ds_read_b128 a[4:7],v122 offset:21504
mf v[40:43],a[64:67],a[136:139],v[40:43]
ds_read_b128 a[8:11],v122 offset:22528
ds_read_b128 a[12:15],v122 offset:23552
mf v[40:43],a[44:47],a[128:131],v[40:43]
ds_read_b128 a[16:19],v122 offset:24576
ds_read_b128 a[20:23],v122 offset:30720
mf v[44:47],a[48:51],a[128:131],v[44:47]
ds_read_b128 a[24:27],v122 offset:31744
ds_read_b128 a[28:31],v122 offset:32768
mf v[44:47],a[68:71],a[136:139],v[44:47]
ds_read_b128 a[32:35],v122 offset:33792
ds_read_b128 a[36:39],v122 offset:34816
mf v[48:51],a[72:75],a[136:139],v[48:51]
s_add_u32 m0,s43,20480
mf v[48:51],a[52:55],a[128:131],v[48:51]
mf v[52:55],a[56:59],a[128:131],v[52:55]
buffer_load_dwordx4 v2,s[24:27],s41 offen sc1 lds
mf v[52:55],a[76:79],a[136:139],v[52:55]
mf v[92:95],a[76:79],a[140:143],v[92:95]
mf v[92:95],a[56:59],a[132:135],v[92:95]
buffer_load_dwordx4 v2,s[24:27],s41 offen offset:1024 sc1 lds
mf v[88:91],a[52:55],a[132:135],v[88:91]
mf v[88:91],a[72:75],a[140:143],v[88:91]
buffer_load_dwordx4 a[176:179],v2,s[20:23],s40 offen sc1
mf v[84:87],a[68:71],a[140:143],v[84:87]
mf v[84:87],a[48:51],a[132:135],v[84:87]
mf v[80:83],a[44:47],a[132:135],v[80:83]
buffer_load_dwordx4 a[180:183],v2,s[20:23],s40 offen offset:1024 sc1
s_add_u32 s40,s40,4096
mf v[80:83],a[64:67],a[140:143],v[80:83]
mf v[76:79],a[60:63],a[140:143],v[76:79]
mf v[76:79],a[40:43],a[132:135],v[76:79]
s_waitcnt lgkmcnt(0)
mf v[16:19],a[0:3],a[144:147],v[16:19]
ds_read_b128 a[40:43],v122 offset:25600
ds_read_b128 a[44:47],v122 offset:26624
s_waitcnt vmcnt(14)
mf v[16:19],a[20:23],a[152:155],v[16:19]
ds_read_b128 a[48:51],v122 offset:27648
ds_read_b128 a[52:55],v122 offset:28672
mf v[20:23],a[24:27],a[152:155],v[20:23]
ds_read_b128 a[56:59],v122 offset:29696
ds_read_b128 a[60:63],v122 offset:35840
mf v[20:23],a[4:7],a[144:147],v[20:23]
ds_read_b128 a[64:67],v122 offset:36864
ds_read_b128 a[68:71],v122 offset:37888
mf v[24:27],a[8:11],a[144:147],v[24:27]
ds_read_b128 a[72:75],v122 offset:38912
ds_read_b128 a[76:79],v122 offset:39936
mf v[24:27],a[28:31],a[152:155],v[24:27]
mf v[28:31],a[32:35],a[152:155],v[28:31]
buffer_load_dwordx4 v2,s[24:27],s41 offen offset:2048 sc1 lds
mf v[28:31],a[12:15],a[144:147],v[28:31]
s_lshl_b32 s64,s3,11
s_add_u32 s64,s64,154624
mf v[32:35],a[16:19],a[144:147],v[32:35]
buffer_load_dwordx4 v2,s[24:27],s41 offen offset:3072 sc1 lds
mf v[32:35],a[36:39],a[152:155],v[32:35]
s_waitcnt vmcnt(15)
mf v[72:75],a[36:39],a[156:159],v[72:75]
s_add_u32 m0,s43,24576
mf v[72:75],a[16:19],a[148:151],v[72:75]
s_mul_i32 s65,s3,640
s_add_u32 s66,s65,5120
mf v[68:71],a[12:15],a[148:151],v[68:71]
buffer_load_dwordx4 v3,s[24:27],s41 offen sc1 lds
s_add_u32 s41,s41,81920
mf v[68:71],a[32:35],a[156:159],v[68:71]
v_subrev_u32 v14,s65,v14
v_add_u32 v14,s64,v14
mf v[64:67],a[28:31],a[156:159],v[64:67]
buffer_load_dwordx4 a[128:131],v2,s[20:23],s40 offen sc1
mf v[64:67],a[8:11],a[148:151],v[64:67]
v_add_u32 v200,0,v1
v_mul_u32_u24 v202,26215,v200
mf v[60:63],a[4:7],a[148:151],v[60:63]
buffer_load_dwordx4 a[132:135],v2,s[20:23],s40 offen offset:1024 sc1
s_add_u32 s40,s40,4096
mf v[60:63],a[24:27],a[156:159],v[60:63]
v_lshrrev_b32 v202,20,v202
v_mul_u32_u24 v202,1920,v202
mf v[56:59],a[20:23],a[156:159],v[56:59]
v_lshl_add_u32 v200,v200,4,v202
v_add_u32 v201,64,v1
v_mul_u32_u24 v202,26215,v201
v_lshrrev_b32 v202,20,v202
v_mul_u32_u24 v202,1920,v202
v_lshl_add_u32 v201,v201,4,v202
mf v[56:59],a[0:3],a[148:151],v[56:59]
s_waitcnt lgkmcnt(0)
mf v[36:39],a[40:43],a[144:147],v[36:39]
s_waitcnt vmcnt(11)
s_barrier
mf v[36:39],a[60:63],a[152:155],v[36:39]
ds_read_b128 a[0:3],v2 offset:0
ds_read_b128 a[4:7],v2 offset:1024
mf v[40:43],a[64:67],a[152:155],v[40:43]
ds_read_b128 a[8:11],v2 offset:2048
ds_read_b128 a[12:15],v2 offset:3072
mf v[40:43],a[44:47],a[144:147],v[40:43]
ds_read_b128 a[16:19],v2 offset:4096
ds_read_b128 a[20:23],v2 offset:10240
mf v[44:47],a[48:51],a[144:147],v[44:47]
ds_read_b128 a[24:27],v2 offset:11264
ds_read_b128 a[28:31],v2 offset:12288
mf v[44:47],a[68:71],a[152:155],v[44:47]
ds_read_b128 a[32:35],v2 offset:13312
ds_read_b128 a[36:39],v2 offset:14336
mf v[48:51],a[72:75],a[152:155],v[48:51]
s_add_u32 m0,s43,40960
mf v[48:51],a[52:55],a[144:147],v[48:51]
mf v[52:55],a[56:59],a[144:147],v[52:55]
buffer_load_dwordx4 v2,s[24:27],s41 offen sc1 lds
mf v[52:55],a[76:79],a[152:155],v[52:55]
mf v[92:95],a[76:79],a[156:159],v[92:95]
mf v[92:95],a[56:59],a[148:151],v[92:95]
buffer_load_dwordx4 v2,s[24:27],s41 offen offset:1024 sc1 lds
mf v[88:91],a[52:55],a[148:151],v[88:91]
mf v[88:91],a[72:75],a[156:159],v[88:91]
buffer_load_dwordx4 a[136:139],v2,s[20:23],s40 offen sc1
mf v[84:87],a[68:71],a[156:159],v[84:87]
mf v[84:87],a[48:51],a[148:151],v[84:87]
mf v[80:83],a[44:47],a[148:151],v[80:83]
buffer_load_dwordx4 a[140:143],v2,s[20:23],s40 offen offset:1024 sc1
s_add_u32 s40,s40,4096
mf v[80:83],a[64:67],a[156:159],v[80:83]
mf v[76:79],a[60:63],a[156:159],v[76:79]
mf v[76:79],a[40:43],a[148:151],v[76:79]
s_waitcnt lgkmcnt(0)
mf v[16:19],a[0:3],a[160:163],v[16:19]
ds_read_b128 a[40:43],v2 offset:5120
ds_read_b128 a[44:47],v2 offset:6144
s_waitcnt vmcnt(14)
mf v[16:19],a[20:23],a[168:171],v[16:19]
ds_read_b128 a[48:51],v2 offset:7168
ds_read_b128 a[52:55],v2 offset:8192
mf v[20:23],a[24:27],a[168:171],v[20:23]
ds_read_b128 a[56:59],v2 offset:9216
ds_read_b128 a[60:63],v2 offset:15360
mf v[20:23],a[4:7],a[160:163],v[20:23]
ds_read_b128 a[64:67],v2 offset:16384
ds_read_b128 a[68:71],v2 offset:17408
mf v[24:27],a[8:11],a[160:163],v[24:27]
ds_read_b128 a[72:75],v2 offset:18432
ds_read_b128 a[76:79],v2 offset:19456
mf v[24:27],a[28:31],a[168:171],v[24:27]
mf v[28:31],a[32:35],a[168:171],v[28:31]
buffer_load_dwordx4 v2,s[24:27],s41 offen offset:2048 sc1 lds
mf v[28:31],a[12:15],a[160:163],v[28:31]
mf v[32:35],a[16:19],a[160:163],v[32:35]
buffer_load_dwordx4 v2,s[24:27],s41 offen offset:3072 sc1 lds
mf v[32:35],a[36:39],a[168:171],v[32:35]
s_waitcnt vmcnt(15)
mf v[72:75],a[36:39],a[172:175],v[72:75]
s_add_u32 m0,s43,45056
mf v[72:75],a[16:19],a[164:167],v[72:75]
mf v[68:71],a[12:15],a[164:167],v[68:71]
buffer_load_dwordx4 v3,s[24:27],s41 offen sc1 lds
s_add_u32 s41,s41,81920
mf v[68:71],a[32:35],a[172:175],v[68:71]
mf v[64:67],a[28:31],a[172:175],v[64:67]
buffer_load_dwordx4 a[144:147],v2,s[20:23],s40 offen sc1
mf v[64:67],a[8:11],a[164:167],v[64:67]
mf v[60:63],a[4:7],a[164:167],v[60:63]
buffer_load_dwordx4 a[148:151],v2,s[20:23],s40 offen offset:1024 sc1
s_add_u32 s40,s40,4096
mf v[60:63],a[24:27],a[172:175],v[60:63]
mf v[56:59],a[20:23],a[172:175],v[56:59]
mf v[56:59],a[0:3],a[164:167],v[56:59]
s_waitcnt lgkmcnt(0)
mf v[36:39],a[40:43],a[160:163],v[36:39]
s_waitcnt vmcnt(11)
s_barrier
mf v[36:39],a[60:63],a[168:171],v[36:39]
ds_read_b128 a[0:3],v2 offset:20480
ds_read_b128 a[4:7],v2 offset:21504
mf v[40:43],a[64:67],a[168:171],v[40:43]
ds_read_b128 a[8:11],v2 offset:22528
ds_read_b128 a[12:15],v2 offset:23552
mf v[40:43],a[44:47],a[160:163],v[40:43]
ds_read_b128 a[16:19],v2 offset:24576
ds_read_b128 a[20:23],v2 offset:30720
mf v[44:47],a[48:51],a[160:163],v[44:47]
ds_read_b128 a[24:27],v2 offset:31744
ds_read_b128 a[28:31],v2 offset:32768
mf v[44:47],a[68:71],a[168:171],v[44:47]
ds_read_b128 a[32:35],v2 offset:33792
ds_read_b128 a[36:39],v2 offset:34816
mf v[48:51],a[72:75],a[168:171],v[48:51]
s_add_u32 m0,s43,61440
mf v[48:51],a[52:55],a[160:163],v[48:51]
mf v[52:55],a[56:59],a[160:163],v[52:55]
buffer_load_dwordx4 v2,s[24:27],s41 offen sc1 lds
mf v[52:55],a[76:79],a[168:171],v[52:55]
mf v[92:95],a[76:79],a[172:175],v[92:95]
mf v[92:95],a[56:59],a[164:167],v[92:95]
buffer_load_dwordx4 v2,s[24:27],s41 offen offset:1024 sc1 lds
mf v[88:91],a[52:55],a[164:167],v[88:91]
mf v[88:91],a[72:75],a[172:175],v[88:91]
buffer_load_dwordx4 a[152:155],v2,s[20:23],s40 offen sc1
mf v[84:87],a[68:71],a[172:175],v[84:87]
mf v[84:87],a[48:51],a[164:167],v[84:87]
mf v[80:83],a[44:47],a[164:167],v[80:83]
buffer_load_dwordx4 a[156:159],v2,s[20:23],s40 offen offset:1024 sc1
s_add_u32 s40,s40,4096
mf v[80:83],a[64:67],a[172:175],v[80:83]
mf v[76:79],a[60:63],a[172:175],v[76:79]
mf v[76:79],a[40:43],a[164:167],v[76:79]
s_waitcnt lgkmcnt(0)
mf v[16:19],a[0:3],a[176:179],v[16:19]
ds_read_b128 a[40:43],v2 offset:25600
ds_read_b128 a[44:47],v2 offset:26624
s_waitcnt vmcnt(14)
mf v[16:19],a[20:23],a[128:131],v[16:19]
ds_read_b128 a[48:51],v2 offset:27648
ds_read_b128 a[52:55],v2 offset:28672
mf v[20:23],a[24:27],a[128:131],v[20:23]
ds_read_b128 a[56:59],v2 offset:29696
ds_read_b128 a[60:63],v2 offset:35840
mf v[20:23],a[4:7],a[176:179],v[20:23]
ds_read_b128 a[64:67],v2 offset:36864
ds_read_b128 a[68:71],v2 offset:37888
mf v[24:27],a[8:11],a[176:179],v[24:27]
ds_read_b128 a[72:75],v2 offset:38912
ds_read_b128 a[76:79],v2 offset:39936
mf v[24:27],a[28:31],a[128:131],v[24:27]
mf v[28:31],a[32:35],a[128:131],v[28:31]
buffer_load_dwordx4 v2,s[24:27],s41 offen offset:2048 sc1 lds
mf v[28:31],a[12:15],a[176:179],v[28:31]
mf v[32:35],a[16:19],a[176:179],v[32:35]
buffer_load_dwordx4 v2,s[24:27],s41 offen offset:3072 sc1 lds
mf v[32:35],a[36:39],a[128:131],v[32:35]
s_waitcnt vmcnt(15)
mf v[72:75],a[36:39],a[132:135],v[72:75]
s_add_u32 m0,s43,65536
mf v[72:75],a[16:19],a[180:183],v[72:75]
mf v[68:71],a[12:15],a[180:183],v[68:71]
buffer_load_dwordx4 v3,s[24:27],s41 offen sc1 lds
s_add_u32 s41,s41,81920
mf v[68:71],a[32:35],a[132:135],v[68:71]
mf v[64:67],a[28:31],a[132:135],v[64:67]
buffer_load_dwordx4 a[160:163],v2,s[20:23],s40 offen sc1
mf v[64:67],a[8:11],a[180:183],v[64:67]
mf v[60:63],a[4:7],a[180:183],v[60:63]
buffer_load_dwordx4 a[164:167],v2,s[20:23],s40 offen offset:1024 sc1
s_add_u32 s40,s40,4096
mf v[60:63],a[24:27],a[132:135],v[60:63]
mf v[56:59],a[20:23],a[132:135],v[56:59]
mf v[56:59],a[0:3],a[180:183],v[56:59]
s_waitcnt lgkmcnt(0)
mf v[36:39],a[40:43],a[176:179],v[36:39]
s_waitcnt vmcnt(11)
s_barrier
mf v[36:39],a[60:63],a[128:131],v[36:39]
ds_read_b128 a[0:3],v2 offset:40960
ds_read_b128 a[4:7],v2 offset:41984
mf v[40:43],a[64:67],a[128:131],v[40:43]
ds_read_b128 a[8:11],v2 offset:43008
ds_read_b128 a[12:15],v2 offset:44032
mf v[40:43],a[44:47],a[176:179],v[40:43]
ds_read_b128 a[16:19],v2 offset:45056
ds_read_b128 a[20:23],v2 offset:51200
mf v[44:47],a[48:51],a[176:179],v[44:47]
ds_read_b128 a[24:27],v2 offset:52224
ds_read_b128 a[28:31],v2 offset:53248
mf v[44:47],a[68:71],a[128:131],v[44:47]
ds_read_b128 a[32:35],v2 offset:54272
ds_read_b128 a[36:39],v2 offset:55296
mf v[48:51],a[72:75],a[128:131],v[48:51]
s_add_u32 m0,s43,81920
mf v[48:51],a[52:55],a[176:179],v[48:51]
v_and_b32 v120,7,v1
v_lshlrev_b32 v120,7,v120
mf v[52:55],a[56:59],a[176:179],v[52:55]
buffer_load_dwordx4 v2,s[24:27],s41 offen sc1 lds
mf v[52:55],a[76:79],a[128:131],v[52:55]
mf v[92:95],a[76:79],a[132:135],v[92:95]
mf v[92:95],a[56:59],a[180:183],v[92:95]
buffer_load_dwordx4 v2,s[24:27],s41 offen offset:1024 sc1 lds
mf v[88:91],a[52:55],a[180:183],v[88:91]
s_mov_b32 s54,25600
buffer_load_dword v121,v120,s[8:11],s54 offen sc1
mf v[88:91],a[72:75],a[132:135],v[88:91]
buffer_load_dwordx4 a[168:171],v2,s[20:23],s40 offen sc1
mf v[84:87],a[68:71],a[132:135],v[84:87]
mf v[84:87],a[48:51],a[180:183],v[84:87]
mf v[80:83],a[44:47],a[180:183],v[80:83]
buffer_load_dwordx4 a[172:175],v2,s[20:23],s40 offen offset:1024 sc1
s_add_u32 s40,s40,4096
mf v[80:83],a[64:67],a[132:135],v[80:83]
mf v[76:79],a[60:63],a[132:135],v[76:79]
mf v[76:79],a[40:43],a[180:183],v[76:79]
s_waitcnt lgkmcnt(0)
mf v[16:19],a[0:3],a[136:139],v[16:19]
ds_read_b128 a[40:43],v2 offset:46080
ds_read_b128 a[44:47],v2 offset:47104
s_waitcnt vmcnt(15)
mf v[16:19],a[20:23],a[144:147],v[16:19]
ds_read_b128 a[48:51],v2 offset:48128
ds_read_b128 a[52:55],v2 offset:49152
mf v[20:23],a[24:27],a[144:147],v[20:23]
ds_read_b128 a[56:59],v2 offset:50176
ds_read_b128 a[60:63],v2 offset:56320
mf v[20:23],a[4:7],a[136:139],v[20:23]
ds_read_b128 a[64:67],v2 offset:57344
ds_read_b128 a[68:71],v2 offset:58368
mf v[24:27],a[8:11],a[136:139],v[24:27]
ds_read_b128 a[72:75],v2 offset:59392
ds_read_b128 a[76:79],v2 offset:60416
mf v[24:27],a[28:31],a[144:147],v[24:27]
mf v[28:31],a[32:35],a[144:147],v[28:31]
buffer_load_dwordx4 v2,s[24:27],s41 offen offset:2048 sc1 lds
mf v[28:31],a[12:15],a[136:139],v[28:31]
mf v[32:35],a[16:19],a[136:139],v[32:35]
buffer_load_dwordx4 v2,s[24:27],s41 offen offset:3072 sc1 lds
mf v[32:35],a[36:39],a[144:147],v[32:35]
s_waitcnt vmcnt(16)
mf v[72:75],a[36:39],a[148:151],v[72:75]
s_add_u32 m0,s43,86016
mf v[72:75],a[16:19],a[140:143],v[72:75]
mf v[68:71],a[12:15],a[140:143],v[68:71]
buffer_load_dwordx4 v3,s[24:27],s41 offen sc1 lds
s_add_u32 s41,s41,81920
mf v[68:71],a[32:35],a[148:151],v[68:71]
mf v[64:67],a[28:31],a[148:151],v[64:67]
buffer_load_dwordx4 a[176:179],v2,s[20:23],s40 offen sc1
mf v[64:67],a[8:11],a[140:143],v[64:67]
mf v[60:63],a[4:7],a[140:143],v[60:63]
buffer_load_dwordx4 a[180:183],v2,s[20:23],s40 offen offset:1024 sc1
s_add_u32 s40,s40,4096
mf v[60:63],a[24:27],a[148:151],v[60:63]
mf v[56:59],a[20:23],a[148:151],v[56:59]
mf v[56:59],a[0:3],a[140:143],v[56:59]
s_waitcnt lgkmcnt(0)
mf v[36:39],a[40:43],a[136:139],v[36:39]
s_waitcnt vmcnt(12)
s_barrier
mf v[36:39],a[60:63],a[144:147],v[36:39]
ds_read_b128 a[0:3],v4 offset:0
ds_read_b128 a[4:7],v4 offset:1024
mf v[40:43],a[64:67],a[144:147],v[40:43]
ds_read_b128 a[8:11],v4 offset:2048
ds_read_b128 a[12:15],v4 offset:3072
mf v[40:43],a[44:47],a[136:139],v[40:43]
ds_read_b128 a[16:19],v4 offset:4096
ds_read_b128 a[20:23],v4 offset:10240
mf v[44:47],a[48:51],a[136:139],v[44:47]
ds_read_b128 a[24:27],v4 offset:11264
ds_read_b128 a[28:31],v4 offset:12288
mf v[44:47],a[68:71],a[144:147],v[44:47]
ds_read_b128 a[32:35],v4 offset:13312
ds_read_b128 a[36:39],v4 offset:14336
mf v[48:51],a[72:75],a[144:147],v[48:51]
s_add_u32 m0,s43,102400
mf v[48:51],a[52:55],a[136:139],v[48:51]
mf v[52:55],a[56:59],a[136:139],v[52:55]
buffer_load_dwordx4 v2,s[24:27],s41 offen sc1 lds
mf v[52:55],a[76:79],a[144:147],v[52:55]
mf v[92:95],a[76:79],a[148:151],v[92:95]
mf v[92:95],a[56:59],a[140:143],v[92:95]
buffer_load_dwordx4 v2,s[24:27],s41 offen offset:1024 sc1 lds
mf v[88:91],a[52:55],a[140:143],v[88:91]
mf v[88:91],a[72:75],a[148:151],v[88:91]
buffer_load_dwordx4 a[128:131],v2,s[20:23],s40 offen sc1
mf v[84:87],a[68:71],a[148:151],v[84:87]
mf v[84:87],a[48:51],a[140:143],v[84:87]
mf v[80:83],a[44:47],a[140:143],v[80:83]
buffer_load_dwordx4 a[132:135],v2,s[20:23],s40 offen offset:1024 sc1
s_add_u32 s40,s40,4096
mf v[80:83],a[64:67],a[148:151],v[80:83]
mf v[76:79],a[60:63],a[148:151],v[76:79]
mf v[76:79],a[40:43],a[140:143],v[76:79]
s_waitcnt lgkmcnt(0)
mf v[16:19],a[0:3],a[152:155],v[16:19]
ds_read_b128 a[40:43],v4 offset:5120
ds_read_b128 a[44:47],v4 offset:6144
s_waitcnt vmcnt(15)
mf v[16:19],a[20:23],a[160:163],v[16:19]
ds_read_b128 a[48:51],v4 offset:7168
ds_read_b128 a[52:55],v4 offset:8192
mf v[20:23],a[24:27],a[160:163],v[20:23]
ds_read_b128 a[56:59],v4 offset:9216
ds_read_b128 a[60:63],v4 offset:15360
mf v[20:23],a[4:7],a[152:155],v[20:23]
ds_read_b128 a[64:67],v4 offset:16384
ds_read_b128 a[68:71],v4 offset:17408
mf v[24:27],a[8:11],a[152:155],v[24:27]
ds_read_b128 a[72:75],v4 offset:18432
ds_read_b128 a[76:79],v4 offset:19456
mf v[24:27],a[28:31],a[160:163],v[24:27]
mf v[28:31],a[32:35],a[160:163],v[28:31]
buffer_load_dwordx4 v2,s[24:27],s41 offen offset:2048 sc1 lds
mf v[28:31],a[12:15],a[152:155],v[28:31]
mf v[32:35],a[16:19],a[152:155],v[32:35]
buffer_load_dwordx4 v2,s[24:27],s41 offen offset:3072 sc1 lds
mf v[32:35],a[36:39],a[160:163],v[32:35]
s_waitcnt vmcnt(16)
mf v[72:75],a[36:39],a[164:167],v[72:75]
s_add_u32 m0,s43,106496
mf v[72:75],a[16:19],a[156:159],v[72:75]
mf v[68:71],a[12:15],a[156:159],v[68:71]
buffer_load_dwordx4 v3,s[24:27],s41 offen sc1 lds
s_add_u32 s41,s41,81920
mf v[68:71],a[32:35],a[164:167],v[68:71]
mf v[64:67],a[28:31],a[164:167],v[64:67]
buffer_load_dwordx4 a[136:139],v2,s[20:23],s40 offen sc1
mf v[64:67],a[8:11],a[156:159],v[64:67]
mf v[60:63],a[4:7],a[156:159],v[60:63]
buffer_load_dwordx4 a[140:143],v2,s[20:23],s40 offen offset:1024 sc1
s_add_u32 s40,s40,4096
mf v[60:63],a[24:27],a[164:167],v[60:63]
mf v[56:59],a[20:23],a[164:167],v[56:59]
mf v[56:59],a[0:3],a[156:159],v[56:59]
s_waitcnt lgkmcnt(0)
mf v[36:39],a[40:43],a[152:155],v[36:39]
s_waitcnt vmcnt(11)
s_barrier
mf v[36:39],a[60:63],a[160:163],v[36:39]
ds_read_b128 a[0:3],v4 offset:20480
ds_read_b128 a[4:7],v4 offset:21504
mf v[40:43],a[64:67],a[160:163],v[40:43]
ds_read_b128 a[8:11],v4 offset:22528
ds_read_b128 a[12:15],v4 offset:23552
mf v[40:43],a[44:47],a[152:155],v[40:43]
ds_read_b128 a[16:19],v4 offset:24576
ds_read_b128 a[20:23],v4 offset:30720
mf v[44:47],a[48:51],a[152:155],v[44:47]
ds_read_b128 a[24:27],v4 offset:31744
ds_read_b128 a[28:31],v4 offset:32768
mf v[44:47],a[68:71],a[160:163],v[44:47]
ds_read_b128 a[32:35],v4 offset:33792
ds_read_b128 a[36:39],v4 offset:34816
mf v[48:51],a[72:75],a[160:163],v[48:51]
s_add_u32 m0,s43,122880
mf v[48:51],a[52:55],a[152:155],v[48:51]
mf v[52:55],a[56:59],a[152:155],v[52:55]
buffer_load_dwordx4 v2,s[24:27],s41 offen sc1 lds
mf v[52:55],a[76:79],a[160:163],v[52:55]
mf v[92:95],a[76:79],a[164:167],v[92:95]
mf v[92:95],a[56:59],a[156:159],v[92:95]
buffer_load_dwordx4 v2,s[24:27],s41 offen offset:1024 sc1 lds
mf v[88:91],a[52:55],a[156:159],v[88:91]
mf v[88:91],a[72:75],a[164:167],v[88:91]
buffer_load_dwordx4 a[144:147],v2,s[20:23],s40 offen sc1
mf v[84:87],a[68:71],a[164:167],v[84:87]
mf v[84:87],a[48:51],a[156:159],v[84:87]
mf v[80:83],a[44:47],a[156:159],v[80:83]
buffer_load_dwordx4 a[148:151],v2,s[20:23],s40 offen offset:1024 sc1
s_add_u32 s40,s40,4096
mf v[80:83],a[64:67],a[164:167],v[80:83]
mf v[76:79],a[60:63],a[164:167],v[76:79]
mf v[76:79],a[40:43],a[156:159],v[76:79]
s_waitcnt lgkmcnt(0)
Le_chk:
v_cmp_ne_u32 vcc,48,v121
s_nop 0
s_cbranch_vccnz Le_spin
mf v[16:19],a[0:3],a[168:171],v[16:19]
ds_read_b128 a[40:43],v4 offset:25600
ds_read_b128 a[44:47],v4 offset:26624
s_waitcnt vmcnt(14)
mf v[16:19],a[20:23],a[176:179],v[16:19]
ds_read_b128 a[48:51],v4 offset:27648
ds_read_b128 a[52:55],v4 offset:28672
mf v[20:23],a[24:27],a[176:179],v[20:23]
ds_read_b128 a[56:59],v4 offset:29696
ds_read_b128 a[60:63],v4 offset:35840
mf v[20:23],a[4:7],a[168:171],v[20:23]
ds_read_b128 a[64:67],v4 offset:36864
ds_read_b128 a[68:71],v4 offset:37888
mf v[24:27],a[8:11],a[168:171],v[24:27]
ds_read_b128 a[72:75],v4 offset:38912
ds_read_b128 a[76:79],v4 offset:39936
mf v[24:27],a[28:31],a[176:179],v[24:27]
mf v[28:31],a[32:35],a[176:179],v[28:31]
buffer_load_dwordx4 v2,s[24:27],s41 offen offset:2048 sc1 lds
mf v[28:31],a[12:15],a[168:171],v[28:31]
buffer_load_dwordx4 v2,s[24:27],s41 offen offset:3072 sc1 lds
mf v[32:35],a[16:19],a[168:171],v[32:35]
mf v[32:35],a[36:39],a[176:179],v[32:35]
s_add_u32 m0,s43,126976
s_waitcnt vmcnt(15)
mf v[72:75],a[36:39],a[180:183],v[72:75]
buffer_load_dwordx4 v3,s[24:27],s41 offen sc1 lds
s_add_u32 s41,s41,81920
mf v[72:75],a[16:19],a[172:175],v[72:75]
mf v[68:71],a[12:15],a[172:175],v[68:71]
buffer_load_dwordx4 a[152:155],v2,s[20:23],s40 offen sc1
mf v[68:71],a[32:35],a[180:183],v[68:71]
mf v[64:67],a[28:31],a[180:183],v[64:67]
buffer_load_dwordx4 a[156:159],v2,s[20:23],s40 offen offset:1024 sc1
s_add_u32 s40,s40,4096
mf v[64:67],a[8:11],a[172:175],v[64:67]
s_mov_b32 m0,s64
mf v[60:63],a[4:7],a[172:175],v[60:63]
mf v[60:63],a[24:27],a[180:183],v[60:63]
buffer_load_dwordx4 v200,s[36:39],s66 offen sc1 lds
s_add_u32 m0,s64,1024
mf v[56:59],a[20:23],a[180:183],v[56:59]
mf v[56:59],a[0:3],a[172:175],v[56:59]
s_waitcnt lgkmcnt(0)
mf v[36:39],a[40:43],a[168:171],v[36:39]
s_waitcnt vmcnt(12)
s_barrier
mf v[36:39],a[60:63],a[176:179],v[36:39]
ds_read_b128 a[0:3],v4 offset:40960
ds_read_b128 a[4:7],v4 offset:41984
mf v[40:43],a[64:67],a[176:179],v[40:43]
ds_read_b128 a[8:11],v4 offset:43008
ds_read_b128 a[12:15],v4 offset:44032
mf v[40:43],a[44:47],a[168:171],v[40:43]
ds_read_b128 a[16:19],v4 offset:45056
ds_read_b128 a[20:23],v4 offset:51200
mf v[44:47],a[48:51],a[168:171],v[44:47]
ds_read_b128 a[24:27],v4 offset:52224
ds_read_b128 a[28:31],v4 offset:53248
mf v[44:47],a[68:71],a[176:179],v[44:47]
ds_read_b128 a[32:35],v4 offset:54272
ds_read_b128 a[36:39],v4 offset:55296
mf v[48:51],a[72:75],a[176:179],v[48:51]
buffer_load_dwordx4 v201,s[36:39],s66 offen sc1 lds
mf v[48:51],a[52:55],a[168:171],v[48:51]
mf v[52:55],a[56:59],a[168:171],v[52:55]
mf v[52:55],a[76:79],a[176:179],v[52:55]
mf v[92:95],a[76:79],a[180:183],v[92:95]
buffer_load_dwordx2 v[128:129],v15,s[32:35],0 offen offset:0
mf v[92:95],a[56:59],a[172:175],v[92:95]
mf v[88:91],a[52:55],a[172:175],v[88:91]
mf v[88:91],a[72:75],a[180:183],v[88:91]
mf v[84:87],a[68:71],a[180:183],v[84:87]
buffer_load_dwordx2 v[130:131],v15,s[32:35],0 offen offset:64
mf v[84:87],a[48:51],a[172:175],v[84:87]
mf v[80:83],a[44:47],a[172:175],v[80:83]
mf v[80:83],a[64:67],a[180:183],v[80:83]
mf v[76:79],a[60:63],a[180:183],v[76:79]
mf v[76:79],a[40:43],a[172:175],v[76:79]
s_waitcnt lgkmcnt(0)
mf v[16:19],a[0:3],a[128:131],v[16:19]
ds_read_b128 a[40:43],v4 offset:46080
ds_read_b128 a[44:47],v4 offset:47104
s_waitcnt vmcnt(14)
mf v[16:19],a[20:23],a[136:139],v[16:19]
ds_read_b128 a[48:51],v4 offset:48128
ds_read_b128 a[52:55],v4 offset:49152
mf v[20:23],a[24:27],a[136:139],v[20:23]
ds_read_b128 a[56:59],v4 offset:50176
ds_read_b128 a[60:63],v4 offset:56320
mf v[20:23],a[4:7],a[128:131],v[20:23]
ds_read_b128 a[64:67],v4 offset:57344
ds_read_b128 a[68:71],v4 offset:58368
mf v[24:27],a[8:11],a[128:131],v[24:27]
ds_read_b128 a[72:75],v4 offset:59392
ds_read_b128 a[76:79],v4 offset:60416
mf v[24:27],a[28:31],a[136:139],v[24:27]
mf v[28:31],a[32:35],a[136:139],v[28:31]
buffer_load_dwordx2 v[132:133],v15,s[32:35],0 offen offset:128
mf v[28:31],a[12:15],a[128:131],v[28:31]
mf v[32:35],a[16:19],a[128:131],v[32:35]
mf v[32:35],a[36:39],a[136:139],v[32:35]
s_waitcnt vmcnt(14)
mf v[72:75],a[36:39],a[140:143],v[72:75]
buffer_load_dwordx2 v[134:135],v15,s[32:35],0 offen offset:192
mf v[72:75],a[16:19],a[132:135],v[72:75]
mf v[68:71],a[12:15],a[132:135],v[68:71]
mf v[68:71],a[32:35],a[140:143],v[68:71]
mf v[64:67],a[28:31],a[140:143],v[64:67]
buffer_load_dwordx2 v[136:137],v15,s[32:35],0 offen offset:256
mf v[64:67],a[8:11],a[132:135],v[64:67]
mf v[60:63],a[4:7],a[132:135],v[60:63]
mf v[60:63],a[24:27],a[140:143],v[60:63]
mf v[56:59],a[20:23],a[140:143],v[56:59]
mf v[56:59],a[0:3],a[132:135],v[56:59]
s_waitcnt lgkmcnt(0)
mf v[36:39],a[40:43],a[128:131],v[36:39]
s_waitcnt vmcnt(9)
s_barrier
mf v[36:39],a[60:63],a[136:139],v[36:39]
ds_read_b128 a[0:3],v122 offset:0
ds_read_b128 a[4:7],v122 offset:1024
mf v[40:43],a[64:67],a[136:139],v[40:43]
ds_read_b128 a[8:11],v122 offset:2048
ds_read_b128 a[12:15],v122 offset:3072
mf v[40:43],a[44:47],a[128:131],v[40:43]
ds_read_b128 a[16:19],v122 offset:4096
ds_read_b128 a[20:23],v122 offset:5120
mf v[44:47],a[48:51],a[128:131],v[44:47]
ds_read_b128 a[24:27],v122 offset:6144
ds_read_b128 a[28:31],v122 offset:7168
mf v[44:47],a[68:71],a[136:139],v[44:47]
ds_read_b128 a[32:35],v122 offset:8192
ds_read_b128 a[36:39],v122 offset:9216
mf v[48:51],a[72:75],a[136:139],v[48:51]
ds_read_b128 a[80:83],v122 offset:10240
ds_read_b128 a[84:87],v122 offset:11264
mf v[48:51],a[52:55],a[128:131],v[48:51]
ds_read_b128 a[88:91],v122 offset:12288
ds_read_b128 a[92:95],v122 offset:13312
mf v[52:55],a[56:59],a[128:131],v[52:55]
ds_read_b128 a[96:99],v122 offset:14336
ds_read_b128 a[100:103],v122 offset:15360
mf v[52:55],a[76:79],a[136:139],v[52:55]
mf v[92:95],a[76:79],a[140:143],v[92:95]
ds_read_b128 a[104:107],v122 offset:16384
ds_read_b128 a[108:111],v122 offset:17408
mf v[92:95],a[56:59],a[132:135],v[92:95]
ds_read_b128 a[112:115],v122 offset:18432
ds_read_b128 a[116:119],v122 offset:19456
mf v[88:91],a[52:55],a[132:135],v[88:91]
mf v[88:91],a[72:75],a[140:143],v[88:91]
mf v[84:87],a[68:71],a[140:143],v[84:87]
mf v[84:87],a[48:51],a[132:135],v[84:87]
mf v[80:83],a[44:47],a[132:135],v[80:83]
mf v[80:83],a[64:67],a[140:143],v[80:83]
mf v[76:79],a[60:63],a[140:143],v[76:79]
mf v[76:79],a[40:43],a[132:135],v[76:79]
s_waitcnt lgkmcnt(0)
mf v[16:19],a[0:3],a[144:147],v[16:19]
s_barrier
s_waitcnt vmcnt(8)
mf v[16:19],a[80:83],a[152:155],v[16:19]
mf v[20:23],a[84:87],a[152:155],v[20:23]
mf v[20:23],a[4:7],a[144:147],v[20:23]
mf v[56:59],a[0:3],a[148:151],v[56:59]
s_waitcnt vmcnt(7)
mf v[56:59],a[80:83],a[156:159],v[56:59]
mf v[60:63],a[84:87],a[156:159],v[60:63]
mf v[60:63],a[4:7],a[148:151],v[60:63]
s_nop 0
cvt v96,v16,v17
cvt v97,v18,v19
mf v[24:27],a[8:11],a[144:147],v[24:27]
cvt v98,v20,v21
cvt v99,v22,v23
mf v[24:27],a[88:91],a[152:155],v[24:27]
s_add_u32 s45,s44,0
buffer_store_dwordx4 v[96:99],v2,s[28:31],s45 offen sc1
mf v[28:31],a[92:95],a[152:155],v[28:31]
mf v[28:31],a[12:15],a[144:147],v[28:31]
mf v[64:67],a[8:11],a[148:151],v[64:67]
mf v[64:67],a[88:91],a[156:159],v[64:67]
cvt v100,v56,v57
cvt v101,v58,v59
mf v[68:71],a[92:95],a[156:159],v[68:71]
cvt v102,v60,v61
cvt v103,v62,v63
mf v[68:71],a[12:15],a[148:151],v[68:71]
s_add_u32 s45,s44,0
buffer_store_dwordx4 v[100:103],v2,s[28:31],s45 offen offset:1024 sc1
mf v[32:35],a[16:19],a[144:147],v[32:35]
mf v[32:35],a[96:99],a[152:155],v[32:35]
mf v[36:39],a[100:103],a[152:155],v[36:39]
mf v[36:39],a[20:23],a[144:147],v[36:39]
mf v[72:75],a[16:19],a[148:151],v[72:75]
cvt v104,v24,v25
cvt v105,v26,v27
mf v[72:75],a[96:99],a[156:159],v[72:75]
cvt v106,v28,v29
cvt v107,v30,v31
mf v[76:79],a[100:103],a[156:159],v[76:79]
s_add_u32 s45,s44,4096
buffer_store_dwordx4 v[104:107],v2,s[28:31],s45 offen sc1
mf v[76:79],a[20:23],a[148:151],v[76:79]
mf v[40:43],a[24:27],a[144:147],v[40:43]
mf v[40:43],a[104:107],a[152:155],v[40:43]
mf v[44:47],a[108:111],a[152:155],v[44:47]
cvt v108,v64,v65
cvt v109,v66,v67
mf v[44:47],a[28:31],a[144:147],v[44:47]
cvt v110,v68,v69
cvt v111,v70,v71
mf v[80:83],a[24:27],a[148:151],v[80:83]
s_add_u32 s45,s44,4096
buffer_store_dwordx4 v[108:111],v2,s[28:31],s45 offen offset:1024 sc1
mf v[80:83],a[104:107],a[156:159],v[80:83]
mf v[84:87],a[108:111],a[156:159],v[84:87]
mf v[84:87],a[28:31],a[148:151],v[84:87]
mf v[48:51],a[32:35],a[144:147],v[48:51]
mf v[48:51],a[112:115],a[152:155],v[48:51]
cvt v112,v32,v33
cvt v113,v34,v35
mf v[52:55],a[116:119],a[152:155],v[52:55]
cvt v114,v36,v37
cvt v115,v38,v39
mf v[52:55],a[36:39],a[144:147],v[52:55]
s_add_u32 s45,s44,8192
buffer_store_dwordx4 v[112:115],v2,s[28:31],s45 offen sc1
mf v[88:91],a[32:35],a[148:151],v[88:91]
mf v[88:91],a[112:115],a[156:159],v[88:91]
mf v[92:95],a[116:119],a[156:159],v[92:95]
mf v[92:95],a[36:39],a[148:151],v[92:95]
cvt v116,v72,v73
cvt v117,v74,v75
cvt v118,v76,v77
cvt v119,v78,v79
s_add_u32 s45,s44,8192
buffer_store_dwordx4 v[116:119],v2,s[28:31],s45 offen offset:1024 sc1
cvt v96,v40,v41
cvt v97,v42,v43
cvt v98,v44,v45
cvt v99,v46,v47
s_add_u32 s45,s44,12288
buffer_store_dwordx4 v[96:99],v2,s[28:31],s45 offen sc1
cvt v100,v80,v81
cvt v101,v82,v83
cvt v102,v84,v85
cvt v103,v86,v87
s_add_u32 s45,s44,12288
buffer_store_dwordx4 v[100:103],v2,s[28:31],s45 offen offset:1024 sc1
cvt v104,v48,v49
cvt v105,v50,v51
cvt v106,v52,v53
cvt v107,v54,v55
s_add_u32 s45,s44,16384
buffer_store_dwordx4 v[104:107],v2,s[28:31],s45 offen sc1
cvt v108,v88,v89
cvt v109,v90,v91
cvt v110,v92,v93
cvt v111,v94,v95
s_add_u32 s45,s44,16384
buffer_store_dwordx4 v[108:111],v2,s[28:31],s45 offen offset:1024 sc1
s_add_u32 m0,s53,0
s_nop 0
buffer_load_dwordx4 v2,s[56:59],s52 offen sc1 lds
buffer_load_dwordx4 v2,s[56:59],s52 offen offset:1024 sc1 lds
buffer_load_dwordx4 v2,s[56:59],s52 offen offset:2048 sc1 lds
buffer_load_dwordx4 v2,s[56:59],s52 offen offset:3072 sc1 lds
s_add_u32 s52,s52,4096
s_add_u32 m0,s53,4096
s_nop 0
buffer_load_dwordx4 v2,s[56:59],s52 offen sc1 lds
buffer_load_dwordx4 v2,s[56:59],s52 offen offset:1024 sc1 lds
buffer_load_dwordx4 v2,s[56:59],s52 offen offset:2048 sc1 lds
buffer_load_dwordx4 v2,s[56:59],s52 offen offset:3072 sc1 lds
s_add_u32 s52,s52,28672
s_lshl_b32 s47,s2,2
s_add_u32 s47,s47,s3
s_lshl_b32 s47,s47,7
s_add_u32 s47,s47,81928
s_and_b32 s45,s2,0xe1
s_lshl_b32 s45,s45,2
s_add_u32 s45,s45,s16
s_lshl_b32 s45,s45,7
s_add_u32 s45,s45,81928
v_and_b32 v120,15,v1
v_lshlrev_b32 v120,10,v120
s_waitcnt vmcnt(8)
buffer_store_dword v5,v6,s[8:11],s47 offen sc1
s_add_u32 m0,s53,32768
s_nop 0
buffer_load_dwordx4 v2,s[56:59],s52 offen sc1 lds
buffer_load_dwordx4 v2,s[56:59],s52 offen offset:1024 sc1 lds
buffer_load_dwordx4 v2,s[56:59],s52 offen offset:2048 sc1 lds
buffer_load_dwordx4 v2,s[56:59],s52 offen offset:3072 sc1 lds
s_add_u32 s52,s52,4096
s_add_u32 m0,s53,36864
s_nop 0
buffer_load_dwordx4 v2,s[56:59],s52 offen sc1 lds
buffer_load_dwordx4 v2,s[56:59],s52 offen offset:1024 sc1 lds
buffer_load_dwordx4 v2,s[56:59],s52 offen offset:2048 sc1 lds
buffer_load_dwordx4 v2,s[56:59],s52 offen offset:3072 sc1 lds
s_add_u32 s52,s52,28672
s_add_u32 m0,s53,65536
s_nop 0
buffer_load_dwordx4 v2,s[56:59],s52 offen sc1 lds
buffer_load_dwordx4 v2,s[56:59],s52 offen offset:1024 sc1 lds
buffer_load_dwordx4 v2,s[56:59],s52 offen offset:2048 sc1 lds
buffer_load_dwordx4 v2,s[56:59],s52 offen offset:3072 sc1 lds
s_add_u32 s52,s52,4096
s_add_u32 m0,s53,69632
s_nop 0
buffer_load_dwordx4 v2,s[56:59],s52 offen sc1 lds
buffer_load_dwordx4 v2,s[56:59],s52 offen offset:1024 sc1 lds
buffer_load_dwordx4 v2,s[56:59],s52 offen offset:2048 sc1 lds
buffer_load_dwordx4 v2,s[56:59],s52 offen offset:3072 sc1 lds
s_add_u32 s52,s52,28672
s_add_u32 m0,s53,98304
s_nop 0
buffer_load_dwordx4 v2,s[56:59],s52 offen sc1 lds
buffer_load_dwordx4 v2,s[56:59],s52 offen offset:1024 sc1 lds
buffer_load_dwordx4 v2,s[56:59],s52 offen offset:2048 sc1 lds
buffer_load_dwordx4 v2,s[56:59],s52 offen offset:3072 sc1 lds
s_add_u32 s52,s52,4096
s_add_u32 m0,s53,102400
s_nop 0
buffer_load_dwordx4 v2,s[56:59],s52 offen sc1 lds
buffer_load_dwordx4 v2,s[56:59],s52 offen offset:1024 sc1 lds
buffer_load_dwordx4 v2,s[56:59],s52 offen offset:2048 sc1 lds
buffer_load_dwordx4 v2,s[56:59],s52 offen offset:3072 sc1 lds
s_add_u32 s52,s52,28672
buffer_load_dword v16,v120,s[8:11],s45 offen sc1
Lwp_chk:
s_waitcnt vmcnt(0)
v_cmp_ne_u32 vcc,1,v16
s_nop 0
s_cbranch_vccnz Lwp_spin
s_mov_b32 s46,0
buffer_load_dwordx4 v[16:19],v12,s[28:31],s46 offen sc1
s_mov_b32 s46,2621440
buffer_load_dwordx4 v[20:23],v12,s[28:31],s46 offen sc1
s_mov_b32 s46,4096
buffer_load_dwordx4 v[24:27],v12,s[28:31],s46 offen sc1
s_mov_b32 s46,2625536
buffer_load_dwordx4 v[28:31],v12,s[28:31],s46 offen sc1
s_mov_b32 s46,8192
buffer_load_dwordx4 v[32:35],v12,s[28:31],s46 offen sc1
s_mov_b32 s46,2629632
buffer_load_dwordx4 v[36:39],v12,s[28:31],s46 offen sc1
s_mov_b32 s46,12288
buffer_load_dwordx4 v[40:43],v12,s[28:31],s46 offen sc1
s_mov_b32 s46,2633728
buffer_load_dwordx4 v[44:47],v12,s[28:31],s46 offen sc1
s_mov_b32 s46,16384
buffer_load_dwordx4 v[48:51],v12,s[28:31],s46 offen sc1
s_mov_b32 s46,2637824
buffer_load_dwordx4 v[52:55],v12,s[28:31],s46 offen sc1
ds_read_b128 v[140:143],v14 offset:0
ds_read_b128 v[144:147],v14 offset:128
ds_read_b128 v[148:151],v14 offset:256
ds_read_b128 v[152:155],v14 offset:384
ds_read_b128 v[156:159],v14 offset:512
ds_read_b128 v[180:183],v14 offset:640
ds_read_b128 v[184:187],v14 offset:768
ds_read_b128 v[188:191],v14 offset:896
ds_read_b128 v[192:195],v14 offset:1024
ds_read_b128 v[196:199],v14 offset:1152
ds_read_b128 v[160:163],v14 offset:1280
ds_read_b128 v[164:167],v14 offset:1408
ds_read_b128 v[168:171],v14 offset:1536
ds_read_b128 v[172:175],v14 offset:1664
ds_read_b128 v[176:179],v14 offset:1792
s_add_u32 s20,s4,65077248
s_addc_u32 s21,s5,0
s_mov_b32 s22,5242880
s_mov_b32 s23,0x20000
v_lshlrev_b32 v8,4,v8
v_add_u32 v8,162816,v8
s_lshl_b32 s46,s3,2
v_add_u32 v9,s46,v8
s_waitcnt vmcnt(9)
v_lshlrev_b32 v64,16,v16
v_and_b32 v65,0xffff0000,v16
s_waitcnt vmcnt(8)
v_lshlrev_b32 v56,16,v20
v_and_b32 v57,0xffff0000,v20
v_pk_add_f32 v[64:65],v[64:65],v[56:57]
v_lshlrev_b32 v66,16,v17
v_and_b32 v67,0xffff0000,v17
v_lshlrev_b32 v56,16,v21
v_and_b32 v57,0xffff0000,v21
v_pk_add_f32 v[66:67],v[66:67],v[56:57]
v_lshlrev_b32 v68,16,v18
v_and_b32 v69,0xffff0000,v18
v_lshlrev_b32 v56,16,v22
v_and_b32 v57,0xffff0000,v22
v_pk_add_f32 v[68:69],v[68:69],v[56:57]
v_lshlrev_b32 v70,16,v19
v_and_b32 v71,0xffff0000,v19
v_lshlrev_b32 v56,16,v23
v_and_b32 v57,0xffff0000,v23
v_pk_add_f32 v[70:71],v[70:71],v[56:57]
v_permlane32_swap_b32 v64,v68
v_permlane32_swap_b32 v65,v69
v_permlane32_swap_b32 v66,v70
v_permlane32_swap_b32 v67,v71
v_pk_add_f32 v[64:65],v[64:65],v[68:69]
v_pk_add_f32 v[66:67],v[66:67],v[70:71]
v_lshlrev_b32 v68,16,v128
v_and_b32 v69,0xffff0000,v128
v_lshlrev_b32 v70,16,v129
v_and_b32 v71,0xffff0000,v129
s_waitcnt lgkmcnt(14)
v_pk_fma_f32 v[64:65],v[64:65],v[140:141],v[68:69]
v_pk_fma_f32 v[66:67],v[66:67],v[142:143],v[70:71]
cvt v104,v64,v65
cvt v105,v66,v67
v_lshlrev_b32 v64,16,v104
v_and_b32 v65,0xffff0000,v104
v_lshlrev_b32 v66,16,v105
v_and_b32 v67,0xffff0000,v105
v_pk_add_f32 v[58:59],v[64:65],v[66:67]
v_pk_mul_f32 v[60:61],v[64:65],v[64:65]
v_pk_fma_f32 v[60:61],v[66:67],v[66:67],v[60:61]
s_waitcnt vmcnt(7)
v_lshlrev_b32 v72,16,v24
v_and_b32 v73,0xffff0000,v24
s_waitcnt vmcnt(6)
v_lshlrev_b32 v56,16,v28
v_and_b32 v57,0xffff0000,v28
v_pk_add_f32 v[72:73],v[72:73],v[56:57]
v_lshlrev_b32 v74,16,v25
v_and_b32 v75,0xffff0000,v25
v_lshlrev_b32 v56,16,v29
v_and_b32 v57,0xffff0000,v29
v_pk_add_f32 v[74:75],v[74:75],v[56:57]
v_lshlrev_b32 v76,16,v26
v_and_b32 v77,0xffff0000,v26
v_lshlrev_b32 v56,16,v30
v_and_b32 v57,0xffff0000,v30
v_pk_add_f32 v[76:77],v[76:77],v[56:57]
v_lshlrev_b32 v78,16,v27
v_and_b32 v79,0xffff0000,v27
v_lshlrev_b32 v56,16,v31
v_and_b32 v57,0xffff0000,v31
v_pk_add_f32 v[78:79],v[78:79],v[56:57]
v_permlane32_swap_b32 v72,v76
v_permlane32_swap_b32 v73,v77
v_permlane32_swap_b32 v74,v78
v_permlane32_swap_b32 v75,v79
v_pk_add_f32 v[72:73],v[72:73],v[76:77]
v_pk_add_f32 v[74:75],v[74:75],v[78:79]
v_lshlrev_b32 v76,16,v130
v_and_b32 v77,0xffff0000,v130
v_lshlrev_b32 v78,16,v131
v_and_b32 v79,0xffff0000,v131
s_waitcnt lgkmcnt(13)
v_pk_fma_f32 v[72:73],v[72:73],v[144:145],v[76:77]
v_pk_fma_f32 v[74:75],v[74:75],v[146:147],v[78:79]
cvt v108,v72,v73
cvt v109,v74,v75
v_lshlrev_b32 v72,16,v108
v_and_b32 v73,0xffff0000,v108
v_lshlrev_b32 v74,16,v109
v_and_b32 v75,0xffff0000,v109
v_pk_add_f32 v[58:59],v[72:73],v[58:59]
v_pk_fma_f32 v[60:61],v[72:73],v[72:73],v[60:61]
v_pk_add_f32 v[58:59],v[74:75],v[58:59]
v_pk_fma_f32 v[60:61],v[74:75],v[74:75],v[60:61]
s_waitcnt vmcnt(5)
v_lshlrev_b32 v80,16,v32
v_and_b32 v81,0xffff0000,v32
s_waitcnt vmcnt(4)
v_lshlrev_b32 v56,16,v36
v_and_b32 v57,0xffff0000,v36
v_pk_add_f32 v[80:81],v[80:81],v[56:57]
v_lshlrev_b32 v82,16,v33
v_and_b32 v83,0xffff0000,v33
v_lshlrev_b32 v56,16,v37
v_and_b32 v57,0xffff0000,v37
v_pk_add_f32 v[82:83],v[82:83],v[56:57]
v_lshlrev_b32 v84,16,v34
v_and_b32 v85,0xffff0000,v34
v_lshlrev_b32 v56,16,v38
v_and_b32 v57,0xffff0000,v38
v_pk_add_f32 v[84:85],v[84:85],v[56:57]
v_lshlrev_b32 v86,16,v35
v_and_b32 v87,0xffff0000,v35
v_lshlrev_b32 v56,16,v39
v_and_b32 v57,0xffff0000,v39
v_pk_add_f32 v[86:87],v[86:87],v[56:57]
v_permlane32_swap_b32 v80,v84
v_permlane32_swap_b32 v81,v85
v_permlane32_swap_b32 v82,v86
v_permlane32_swap_b32 v83,v87
v_pk_add_f32 v[80:81],v[80:81],v[84:85]
v_pk_add_f32 v[82:83],v[82:83],v[86:87]
v_lshlrev_b32 v84,16,v132
v_and_b32 v85,0xffff0000,v132
v_lshlrev_b32 v86,16,v133
v_and_b32 v87,0xffff0000,v133
s_waitcnt lgkmcnt(12)
v_pk_fma_f32 v[80:81],v[80:81],v[148:149],v[84:85]
v_pk_fma_f32 v[82:83],v[82:83],v[150:151],v[86:87]
cvt v112,v80,v81
cvt v113,v82,v83
v_lshlrev_b32 v80,16,v112
v_and_b32 v81,0xffff0000,v112
v_lshlrev_b32 v82,16,v113
v_and_b32 v83,0xffff0000,v113
v_pk_add_f32 v[58:59],v[80:81],v[58:59]
v_pk_fma_f32 v[60:61],v[80:81],v[80:81],v[60:61]
v_pk_add_f32 v[58:59],v[82:83],v[58:59]
v_pk_fma_f32 v[60:61],v[82:83],v[82:83],v[60:61]
s_waitcnt vmcnt(3)
v_lshlrev_b32 v88,16,v40
v_and_b32 v89,0xffff0000,v40
s_waitcnt vmcnt(2)
v_lshlrev_b32 v56,16,v44
v_and_b32 v57,0xffff0000,v44
v_pk_add_f32 v[88:89],v[88:89],v[56:57]
v_lshlrev_b32 v90,16,v41
v_and_b32 v91,0xffff0000,v41
v_lshlrev_b32 v56,16,v45
v_and_b32 v57,0xffff0000,v45
v_pk_add_f32 v[90:91],v[90:91],v[56:57]
v_lshlrev_b32 v92,16,v42
v_and_b32 v93,0xffff0000,v42
v_lshlrev_b32 v56,16,v46
v_and_b32 v57,0xffff0000,v46
v_pk_add_f32 v[92:93],v[92:93],v[56:57]
v_lshlrev_b32 v94,16,v43
v_and_b32 v95,0xffff0000,v43
v_lshlrev_b32 v56,16,v47
v_and_b32 v57,0xffff0000,v47
v_pk_add_f32 v[94:95],v[94:95],v[56:57]
v_permlane32_swap_b32 v88,v92
v_permlane32_swap_b32 v89,v93
v_permlane32_swap_b32 v90,v94
v_permlane32_swap_b32 v91,v95
v_pk_add_f32 v[88:89],v[88:89],v[92:93]
v_pk_add_f32 v[90:91],v[90:91],v[94:95]
v_lshlrev_b32 v92,16,v134
v_and_b32 v93,0xffff0000,v134
v_lshlrev_b32 v94,16,v135
v_and_b32 v95,0xffff0000,v135
s_waitcnt lgkmcnt(11)
v_pk_fma_f32 v[88:89],v[88:89],v[152:153],v[92:93]
v_pk_fma_f32 v[90:91],v[90:91],v[154:155],v[94:95]
cvt v116,v88,v89
cvt v117,v90,v91
v_lshlrev_b32 v88,16,v116
v_and_b32 v89,0xffff0000,v116
v_lshlrev_b32 v90,16,v117
v_and_b32 v91,0xffff0000,v117
v_pk_add_f32 v[58:59],v[88:89],v[58:59]
v_pk_fma_f32 v[60:61],v[88:89],v[88:89],v[60:61]
v_pk_add_f32 v[58:59],v[90:91],v[58:59]
v_pk_fma_f32 v[60:61],v[90:91],v[90:91],v[60:61]
s_lshl_b32 s55,s51,12
s_add_u32 s55,s55,81932
v_and_b32 v124,12,v1
v_and_b32 v15,15,v1
v_add_u32 v124,v124,v15
v_lshlrev_b32 v124,7,v124
buffer_load_dword v15,v124,s[8:11],s55 offen sc1
s_waitcnt vmcnt(2)
v_lshlrev_b32 v96,16,v48
v_and_b32 v97,0xffff0000,v48
s_waitcnt vmcnt(1)
v_lshlrev_b32 v56,16,v52
v_and_b32 v57,0xffff0000,v52
v_pk_add_f32 v[96:97],v[96:97],v[56:57]
v_lshlrev_b32 v98,16,v49
v_and_b32 v99,0xffff0000,v49
v_lshlrev_b32 v56,16,v53
v_and_b32 v57,0xffff0000,v53
v_pk_add_f32 v[98:99],v[98:99],v[56:57]
v_lshlrev_b32 v100,16,v50
v_and_b32 v101,0xffff0000,v50
v_lshlrev_b32 v56,16,v54
v_and_b32 v57,0xffff0000,v54
v_pk_add_f32 v[100:101],v[100:101],v[56:57]
v_lshlrev_b32 v102,16,v51
v_and_b32 v103,0xffff0000,v51
v_lshlrev_b32 v56,16,v55
v_and_b32 v57,0xffff0000,v55
v_pk_add_f32 v[102:103],v[102:103],v[56:57]
v_permlane32_swap_b32 v96,v100
v_permlane32_swap_b32 v97,v101
v_permlane32_swap_b32 v98,v102
v_permlane32_swap_b32 v99,v103
v_pk_add_f32 v[96:97],v[96:97],v[100:101]
v_pk_add_f32 v[98:99],v[98:99],v[102:103]
v_lshlrev_b32 v100,16,v136
v_and_b32 v101,0xffff0000,v136
v_lshlrev_b32 v102,16,v137
v_and_b32 v103,0xffff0000,v137
s_waitcnt lgkmcnt(10)
v_pk_fma_f32 v[96:97],v[96:97],v[156:157],v[100:101]
v_pk_fma_f32 v[98:99],v[98:99],v[158:159],v[102:103]
cvt v120,v96,v97
cvt v121,v98,v99
v_lshlrev_b32 v96,16,v120
v_and_b32 v97,0xffff0000,v120
v_lshlrev_b32 v98,16,v121
v_and_b32 v99,0xffff0000,v121
v_pk_add_f32 v[58:59],v[96:97],v[58:59]
v_pk_fma_f32 v[60:61],v[96:97],v[96:97],v[60:61]
v_pk_add_f32 v[58:59],v[98:99],v[58:59]
v_pk_fma_f32 v[60:61],v[98:99],v[98:99],v[60:61]
v_add_f32 v58,v58,v59
v_add_f32 v59,v60,v61
s_nop 1
v_permlane32_swap_b32 v58,v59
v_add_f32 v58,v58,v59
s_nop 1
v_add_f32_dpp v58,v58,v58 row_ror:8 row_mask:0xf bank_mask:0xf
v_mov_b32 v59,v58
s_nop 1
v_permlane16_swap_b32 v58,v59
v_add_f32 v58,v58,v59
v_lshl_add_u32 v9,v10,8,v9
ds_write_b32 v9,v58
s_lshr_b32 s42,s51,1
s_and_b32 s43,s51,1
s_lshl_b32 s43,s43,11
s_mul_i32 s40,s42,81920
s_add_u32 s40,s40,s43
s_add_u32 s32,s4,67698688
s_addc_u32 s33,s5,0
s_mov_b32 s34,2621440
s_mov_b32 s35,0x20000
s_waitcnt lgkmcnt(0)
s_barrier
ds_read_b128 v[60:63],v8
ds_read_b128 v[56:59],v8 offset:256
s_waitcnt lgkmcnt(1)
v_pk_add_f32 v[60:61],v[60:61],v[62:63]
s_waitcnt lgkmcnt(0)
v_pk_add_f32 v[56:57],v[56:57],v[58:59]
v_add_f32 v60,v60,v61
v_add_f32 v56,v56,v57
v_mul_f32 v60,0xbacccccd,v60
v_mul_f32 v56,0x3acccccd,v56
v_mov_b32 v61,v60
v_fma_f32 v56,-v60,v60,v56
v_max_f32 v56,0,v56
v_add_f32 v56,0x3727c5ac,v56
v_rsq_f32 v56,v56
v_pk_add_f32 v[64:65],v[64:65],v[60:61]
v_pk_add_f32 v[66:67],v[66:67],v[60:61]
v_pk_add_f32 v[72:73],v[72:73],v[60:61]
v_pk_add_f32 v[74:75],v[74:75],v[60:61]
v_pk_add_f32 v[80:81],v[80:81],v[60:61]
v_pk_add_f32 v[82:83],v[82:83],v[60:61]
v_pk_add_f32 v[88:89],v[88:89],v[60:61]
v_pk_add_f32 v[90:91],v[90:91],v[60:61]
v_pk_add_f32 v[96:97],v[96:97],v[60:61]
v_pk_add_f32 v[98:99],v[98:99],v[60:61]
v_mov_b32 v57,v56
v_pk_mul_f32 v[64:65],v[64:65],v[160:161]
v_pk_mul_f32 v[66:67],v[66:67],v[162:163]
v_pk_mul_f32 v[72:73],v[72:73],v[164:165]
v_pk_mul_f32 v[74:75],v[74:75],v[166:167]
v_pk_mul_f32 v[80:81],v[80:81],v[168:169]
v_pk_mul_f32 v[82:83],v[82:83],v[170:171]
v_pk_mul_f32 v[88:89],v[88:89],v[172:173]
v_pk_mul_f32 v[90:91],v[90:91],v[174:175]
v_pk_mul_f32 v[96:97],v[96:97],v[176:177]
v_pk_mul_f32 v[98:99],v[98:99],v[178:179]
v_pk_fma_f32 v[64:65],v[64:65],v[56:57],v[180:181]
v_pk_fma_f32 v[66:67],v[66:67],v[56:57],v[182:183]
v_pk_fma_f32 v[72:73],v[72:73],v[56:57],v[184:185]
v_pk_fma_f32 v[74:75],v[74:75],v[56:57],v[186:187]
v_pk_fma_f32 v[80:81],v[80:81],v[56:57],v[188:189]
v_pk_fma_f32 v[82:83],v[82:83],v[56:57],v[190:191]
v_pk_fma_f32 v[88:89],v[88:89],v[56:57],v[192:193]
v_pk_fma_f32 v[90:91],v[90:91],v[56:57],v[194:195]
v_pk_fma_f32 v[96:97],v[96:97],v[56:57],v[196:197]
v_pk_fma_f32 v[98:99],v[98:99],v[56:57],v[198:199]
s_waitcnt vmcnt(0)
v_cmp_ne_u32 vcc,1,v15
s_mov_b32 s62,s40
s_cmp_eq_u64 vcc,0
s_cselect_b32 s40,s40,0x8000000
buffer_load_dwordx4 a[64:67],v2,s[32:35],s40 offen sc1
buffer_load_dwordx4 a[68:71],v2,s[32:35],s40 offen offset:1024 sc1
s_add_u32 s40,s40,4096
buffer_load_dwordx4 a[72:75],v2,s[32:35],s40 offen sc1
buffer_load_dwordx4 a[76:79],v2,s[32:35],s40 offen offset:1024 sc1
s_add_u32 s40,s40,4096
buffer_load_dwordx4 a[80:83],v2,s[32:35],s40 offen sc1
buffer_load_dwordx4 a[84:87],v2,s[32:35],s40 offen offset:1024 sc1
s_add_u32 s40,s40,4096
buffer_load_dwordx4 a[88:91],v2,s[32:35],s40 offen sc1
buffer_load_dwordx4 a[92:95],v2,s[32:35],s40 offen offset:1024 sc1
s_add_u32 s40,s40,4096
cvt v106,v64,v65
cvt v107,v66,v67
cvt v110,v72,v73
cvt v111,v74,v75
cvt v114,v80,v81
cvt v115,v82,v83
cvt v118,v88,v89
cvt v119,v90,v91
cvt v122,v96,v97
cvt v123,v98,v99
v_permlane32_swap_b32 v104,v106
v_permlane32_swap_b32 v105,v107
s_mov_b32 s46,0
buffer_store_dwordx4 v[104:107],v13,s[20:23],s46 offen sc1
v_permlane32_swap_b32 v108,v110
v_permlane32_swap_b32 v109,v111
s_mov_b32 s46,4096
buffer_store_dwordx4 v[108:111],v13,s[20:23],s46 offen sc1
v_permlane32_swap_b32 v112,v114
v_permlane32_swap_b32 v113,v115
s_mov_b32 s46,8192
buffer_store_dwordx4 v[112:115],v13,s[20:23],s46 offen sc1
v_permlane32_swap_b32 v116,v118
v_permlane32_swap_b32 v117,v119
s_mov_b32 s46,12288
buffer_store_dwordx4 v[116:119],v13,s[20:23],s46 offen sc1
v_permlane32_swap_b32 v120,v122
v_permlane32_swap_b32 v121,v123
s_mov_b32 s46,16384
buffer_store_dwordx4 v[120:123],v13,s[20:23],s46 offen sc1
s_lshl_b32 s54,s2,2
s_add_u32 s54,s54,s3
s_lshl_b32 s54,s54,7
s_add_u32 s54,s54,81932
s_bfe_u32 s14,s2,0x20001
s_lshl_b32 s14,s14,3
s_lshr_b32 s15,s2,5
s_add_u32 s14,s14,s15
s_and_b32 s15,s2,1
s_lshl_b32 s15,s15,2
s_bfe_u32 s16,s2,0x20003
s_add_u32 s15,s15,s16
v_add_u32 v14,4096,v2
s_lshl_b32 s41,s3,3
s_add_u32 s41,s41,s15
s_mul_i32 s41,s41,5120
s_add_u32 s24,s4,62849024
s_addc_u32 s25,s5,0
s_mov_b32 s26,2211840
s_mov_b32 s27,0x20000
v_min_u32 v7,26,v1
s_bfe_u32 s17,s14,0x20002
v_lshl_add_u32 v7,v7,2,s17
v_mul_u32_u24 v13,38837,v7
v_lshrrev_b32 v13,20,v13
v_lshlrev_b32 v7,3,v7
v_mul_u32_u24 v13,214,v13
v_sub_u32 v7,v7,v13
v_lshlrev_b32 v7,9,v7
s_lshr_b32 s17,s14,4
s_lshl_b32 s17,s17,2
s_and_b32 s18,s14,3
s_add_u32 s17,s17,s18
s_lshl_b32 s17,s17,7
s_add_u32 s17,s17,81936
s_mov_b32 s47,0x100000
s_cmp_ge_u32 s2,216
s_cbranch_scc1 Lidle
s_add_u32 s28,s4,70320128
s_addc_u32 s29,s5,0
s_mov_b32 s30,7077888
s_mov_b32 s31,0x20000
v_add_u32 v3,0x10000,v2
v_add_u32 v4,0x20000,v2
s_mul_i32 s44,s42,54
s_lshl_b32 s45,s50,1
s_add_u32 s44,s44,s45
s_lshl_b32 s44,s44,12
s_add_u32 s44,s44,s43
s_add_u32 s45,s44,4096
s_lshl_b32 s46,s2,2
s_add_u32 s46,s46,s3
s_lshl_b32 s46,s46,7
s_add_u32 s46,s46,81936
s_add_u32 s47,s46,4
v_mov_b32 v8,0xc0135761
v_mov_b32 v9,v8
v_mov_b32 v10,1.0
v_mov_b32 v11,1.0
s_mov_b32 s48,0xbdd2d3e8
s_mov_b32 s49,s48
ds_read_b128 a[0:3],v2 offset:0
ds_read_b128 a[4:7],v2 offset:1024
ds_read_b128 a[8:11],v2 offset:2048
ds_read_b128 a[12:15],v2 offset:3072
ds_read_b128 a[16:19],v2 offset:8192
ds_read_b128 a[20:23],v2 offset:9216
ds_read_b128 a[24:27],v2 offset:10240
ds_read_b128 a[28:31],v2 offset:11264
v_cmp_ne_u32 vcc,1,v15
s_nop 0
s_cbranch_vccnz Lha_slow
Lha_go:
s_waitcnt vmcnt(12) lgkmcnt(7)
mf v[128:131],a[0:3],a[64:67],0
ds_read_b128 a[32:35],v2 offset:4096
ds_read_b128 a[36:39],v2 offset:5120
s_waitcnt vmcnt(10) lgkmcnt(5)
mf v[128:131],a[16:19],a[72:75],v[128:131]
ds_read_b128 a[40:43],v2 offset:6144
ds_read_b128 a[44:47],v2 offset:7168
s_waitcnt lgkmcnt(6)
mf v[132:135],a[20:23],a[72:75],0
ds_read_b128 a[48:51],v2 offset:12288
ds_read_b128 a[52:55],v2 offset:13312
mf v[132:135],a[4:7],a[64:67],v[132:135]
ds_read_b128 a[56:59],v2 offset:14336
ds_read_b128 a[60:63],v2 offset:15360
mf v[136:139],a[8:11],a[64:67],0
s_waitcnt lgkmcnt(9)
mf v[136:139],a[24:27],a[72:75],v[136:139]
buffer_load_dwordx4 a[96:99],v2,s[32:35],s40 offen sc1
s_waitcnt lgkmcnt(8)
mf v[140:143],a[28:31],a[72:75],0
mf v[140:143],a[12:15],a[64:67],v[140:143]
buffer_load_dwordx4 a[100:103],v2,s[32:35],s40 offen offset:1024 sc1
s_add_u32 s40,s40,4096
mf v[172:175],a[12:15],a[68:71],0
s_waitcnt vmcnt(11)
mf v[172:175],a[28:31],a[76:79],v[172:175]
mf v[168:171],a[24:27],a[76:79],0
buffer_load_dwordx4 a[104:107],v2,s[32:35],s40 offen sc1
mf v[168:171],a[8:11],a[68:71],v[168:171]
mf v[164:167],a[4:7],a[68:71],0
buffer_load_dwordx4 a[108:111],v2,s[32:35],s40 offen offset:1024 sc1
s_add_u32 s40,s40,4096
mf v[164:167],a[20:23],a[76:79],v[164:167]
mf v[160:163],a[16:19],a[76:79],0
mf v[160:163],a[0:3],a[68:71],v[160:163]
s_waitcnt lgkmcnt(0)
mf v[144:147],a[32:35],a[64:67],0
ds_read_b128 a[0:3],v2 offset:16384
ds_read_b128 a[4:7],v2 offset:17408
mf v[144:147],a[48:51],a[72:75],v[144:147]
ds_read_b128 a[8:11],v2 offset:18432
ds_read_b128 a[12:15],v2 offset:19456
mf v[148:151],a[52:55],a[72:75],0
ds_read_b128 a[16:19],v2 offset:24576
ds_read_b128 a[20:23],v2 offset:25600
mf v[148:151],a[36:39],a[64:67],v[148:151]
ds_read_b128 a[24:27],v2 offset:26624
ds_read_b128 a[28:31],v2 offset:27648
mf v[152:155],a[40:43],a[64:67],0
mf v[152:155],a[56:59],a[72:75],v[152:155]
buffer_load_dwordx4 a[112:115],v2,s[32:35],s40 offen sc1
mf v[156:159],a[60:63],a[72:75],0
mf v[156:159],a[44:47],a[64:67],v[156:159]
buffer_load_dwordx4 a[116:119],v2,s[32:35],s40 offen offset:1024 sc1
s_add_u32 s40,s40,4096
mf v[188:191],a[44:47],a[68:71],0
mf v[188:191],a[60:63],a[76:79],v[188:191]
mf v[184:187],a[56:59],a[76:79],0
buffer_load_dwordx4 a[120:123],v2,s[32:35],s40 offen sc1
mf v[184:187],a[40:43],a[68:71],v[184:187]
mf v[180:183],a[36:39],a[68:71],0
buffer_load_dwordx4 a[124:127],v2,s[32:35],s40 offen offset:1024 sc1
s_add_u32 s40,s40,4096
mf v[180:183],a[52:55],a[76:79],v[180:183]
mf v[176:179],a[48:51],a[76:79],0
mf v[176:179],a[32:35],a[68:71],v[176:179]
s_waitcnt lgkmcnt(0)
s_waitcnt vmcnt(16)
mf v[128:131],a[0:3],a[80:83],v[128:131]
ds_read_b128 a[32:35],v2 offset:20480
ds_read_b128 a[36:39],v2 offset:21504
s_waitcnt vmcnt(14)
mf v[128:131],a[16:19],a[88:91],v[128:131]
ds_read_b128 a[40:43],v2 offset:22528
ds_read_b128 a[44:47],v2 offset:23552
mf v[132:135],a[20:23],a[88:91],v[132:135]
ds_read_b128 a[48:51],v2 offset:28672
ds_read_b128 a[52:55],v2 offset:29696
mf v[132:135],a[4:7],a[80:83],v[132:135]
ds_read_b128 a[56:59],v2 offset:30720
ds_read_b128 a[60:63],v2 offset:31744
mf v[136:139],a[8:11],a[80:83],v[136:139]
mf v[136:139],a[24:27],a[88:91],v[136:139]
buffer_load_dwordx4 a[64:67],v2,s[32:35],s40 offen sc1
mf v[140:143],a[28:31],a[88:91],v[140:143]
mf v[140:143],a[12:15],a[80:83],v[140:143]
mf v[172:175],a[12:15],a[84:87],v[172:175]
buffer_load_dwordx4 a[68:71],v2,s[32:35],s40 offen offset:1024 sc1
s_add_u32 s40,s40,4096
s_waitcnt vmcnt(15)
mf v[172:175],a[28:31],a[92:95],v[172:175]
mf v[168:171],a[24:27],a[92:95],v[168:171]
mf v[168:171],a[8:11],a[84:87],v[168:171]
s_waitcnt vmcnt(10)
buffer_store_dword v5,v6,s[8:11],s54 offen sc1
mf v[164:167],a[4:7],a[84:87],v[164:167]
mf v[164:167],a[20:23],a[92:95],v[164:167]
mf v[160:163],a[16:19],a[92:95],v[160:163]
mf v[160:163],a[0:3],a[84:87],v[160:163]
s_waitcnt lgkmcnt(0)
mf v[144:147],a[32:35],a[80:83],v[144:147]
s_barrier
mf v[144:147],a[48:51],a[88:91],v[144:147]
ds_read_b128 a[0:3],v2 offset:32768
ds_read_b128 a[4:7],v2 offset:33792
mf v[148:151],a[52:55],a[88:91],v[148:151]
ds_read_b128 a[8:11],v2 offset:34816
ds_read_b128 a[12:15],v2 offset:35840
mf v[148:151],a[36:39],a[80:83],v[148:151]
ds_read_b128 a[16:19],v2 offset:40960
ds_read_b128 a[20:23],v2 offset:41984
mf v[152:155],a[40:43],a[80:83],v[152:155]
ds_read_b128 a[24:27],v2 offset:43008
ds_read_b128 a[28:31],v2 offset:44032
mf v[152:155],a[56:59],a[88:91],v[152:155]
buffer_load_dwordx4 a[72:75],v2,s[32:35],s40 offen sc1
mf v[156:159],a[60:63],a[88:91],v[156:159]
mf v[156:159],a[44:47],a[80:83],v[156:159]
mf v[188:191],a[44:47],a[84:87],v[188:191]
mf v[188:191],a[60:63],a[92:95],v[188:191]
mf v[184:187],a[56:59],a[92:95],v[184:187]
buffer_load_dwordx4 a[76:79],v2,s[32:35],s40 offen offset:1024 sc1
s_add_u32 s40,s40,4096
mf v[184:187],a[40:43],a[84:87],v[184:187]
mf v[180:183],a[36:39],a[84:87],v[180:183]
mf v[180:183],a[52:55],a[92:95],v[180:183]
mf v[176:179],a[48:51],a[92:95],v[176:179]
mf v[176:179],a[32:35],a[84:87],v[176:179]
s_waitcnt lgkmcnt(0)
s_waitcnt vmcnt(12)
mf v[128:131],a[0:3],a[96:99],v[128:131]
ds_read_b128 a[32:35],v2 offset:36864
ds_read_b128 a[36:39],v2 offset:37888
s_waitcnt vmcnt(10)
mf v[128:131],a[16:19],a[104:107],v[128:131]
ds_read_b128 a[40:43],v2 offset:38912
ds_read_b128 a[44:47],v2 offset:39936
mf v[132:135],a[20:23],a[104:107],v[132:135]
ds_read_b128 a[48:51],v2 offset:45056
ds_read_b128 a[52:55],v2 offset:46080
mf v[132:135],a[4:7],a[96:99],v[132:135]
ds_read_b128 a[56:59],v2 offset:47104
ds_read_b128 a[60:63],v2 offset:48128
mf v[136:139],a[8:11],a[96:99],v[136:139]
mf v[136:139],a[24:27],a[104:107],v[136:139]
buffer_load_dwordx4 a[80:83],v2,s[32:35],s40 offen sc1
mf v[140:143],a[28:31],a[104:107],v[140:143]
mf v[140:143],a[12:15],a[96:99],v[140:143]
buffer_load_dwordx4 a[84:87],v2,s[32:35],s40 offen offset:1024 sc1
s_add_u32 s40,s40,4096
mf v[172:175],a[12:15],a[100:103],v[172:175]
s_waitcnt vmcnt(11)
mf v[172:175],a[28:31],a[108:111],v[172:175]
mf v[168:171],a[24:27],a[108:111],v[168:171]
s_add_u32 m0,s53,131072
mf v[168:171],a[8:11],a[100:103],v[168:171]
mf v[164:167],a[4:7],a[100:103],v[164:167]
buffer_load_dwordx4 v2,s[56:59],s52 offen sc1 lds
mf v[164:167],a[20:23],a[108:111],v[164:167]
mf v[160:163],a[16:19],a[108:111],v[160:163]
mf v[160:163],a[0:3],a[100:103],v[160:163]
s_waitcnt lgkmcnt(0)
mf v[144:147],a[32:35],a[96:99],v[144:147]
ds_read_b128 a[0:3],v2 offset:49152
ds_read_b128 a[4:7],v2 offset:50176
mf v[144:147],a[48:51],a[104:107],v[144:147]
ds_read_b128 a[8:11],v2 offset:51200
ds_read_b128 a[12:15],v2 offset:52224
mf v[148:151],a[52:55],a[104:107],v[148:151]
ds_read_b128 a[16:19],v2 offset:57344
ds_read_b128 a[20:23],v2 offset:58368
mf v[148:151],a[36:39],a[96:99],v[148:151]
ds_read_b128 a[24:27],v2 offset:59392
ds_read_b128 a[28:31],v2 offset:60416
mf v[152:155],a[40:43],a[96:99],v[152:155]
mf v[152:155],a[56:59],a[104:107],v[152:155]
buffer_load_dwordx4 a[88:91],v2,s[32:35],s40 offen sc1
mf v[156:159],a[60:63],a[104:107],v[156:159]
mf v[156:159],a[44:47],a[96:99],v[156:159]
buffer_load_dwordx4 a[92:95],v2,s[32:35],s40 offen offset:1024 sc1
s_add_u32 s40,s40,4096
mf v[188:191],a[44:47],a[100:103],v[188:191]
mf v[188:191],a[60:63],a[108:111],v[188:191]
mf v[184:187],a[56:59],a[108:111],v[184:187]
buffer_load_dwordx4 v2,s[56:59],s52 offen offset:1024 sc1 lds
mf v[184:187],a[40:43],a[100:103],v[184:187]
mf v[180:183],a[36:39],a[100:103],v[180:183]
buffer_load_dwordx4 v2,s[56:59],s52 offen offset:2048 sc1 lds
mf v[180:183],a[52:55],a[108:111],v[180:183]
mf v[176:179],a[48:51],a[108:111],v[176:179]
mf v[176:179],a[32:35],a[100:103],v[176:179]
s_waitcnt lgkmcnt(0)
s_waitcnt vmcnt(15)
mf v[128:131],a[0:3],a[112:115],v[128:131]
ds_read_b128 a[32:35],v2 offset:53248
ds_read_b128 a[36:39],v2 offset:54272
s_waitcnt vmcnt(13)
mf v[128:131],a[16:19],a[120:123],v[128:131]
ds_read_b128 a[40:43],v2 offset:55296
ds_read_b128 a[44:47],v2 offset:56320
mf v[132:135],a[20:23],a[120:123],v[132:135]
ds_read_b128 a[48:51],v2 offset:61440
ds_read_b128 a[52:55],v2 offset:62464
mf v[132:135],a[4:7],a[112:115],v[132:135]
ds_read_b128 a[56:59],v2 offset:63488
ds_read_b128 a[60:63],v2 offset:64512
mf v[136:139],a[8:11],a[112:115],v[136:139]
mf v[136:139],a[24:27],a[120:123],v[136:139]
buffer_load_dwordx4 a[96:99],v2,s[32:35],s40 offen sc1
mf v[140:143],a[28:31],a[120:123],v[140:143]
mf v[140:143],a[12:15],a[112:115],v[140:143]
buffer_load_dwordx4 a[100:103],v2,s[32:35],s40 offen offset:1024 sc1
s_add_u32 s40,s40,4096
mf v[172:175],a[12:15],a[116:119],v[172:175]
s_waitcnt vmcnt(14)
mf v[172:175],a[28:31],a[124:127],v[172:175]
mf v[168:171],a[24:27],a[124:127],v[168:171]
buffer_load_dwordx4 v2,s[56:59],s52 offen offset:3072 sc1 lds
s_add_u32 s52,s52,4096
mf v[168:171],a[8:11],a[116:119],v[168:171]
mf v[164:167],a[4:7],a[116:119],v[164:167]
s_add_u32 m0,s53,135168
mf v[164:167],a[20:23],a[124:127],v[164:167]
mf v[160:163],a[16:19],a[124:127],v[160:163]
mf v[160:163],a[0:3],a[116:119],v[160:163]
s_waitcnt lgkmcnt(0)
mf v[144:147],a[32:35],a[112:115],v[144:147]
ds_read_b128 a[0:3],v3 offset:0
ds_read_b128 a[4:7],v3 offset:1024
mf v[144:147],a[48:51],a[120:123],v[144:147]
ds_read_b128 a[8:11],v3 offset:2048
ds_read_b128 a[12:15],v3 offset:3072
mf v[148:151],a[52:55],a[120:123],v[148:151]
ds_read_b128 a[16:19],v3 offset:8192
ds_read_b128 a[20:23],v3 offset:9216
mf v[148:151],a[36:39],a[112:115],v[148:151]
ds_read_b128 a[24:27],v3 offset:10240
ds_read_b128 a[28:31],v3 offset:11264
mf v[152:155],a[40:43],a[112:115],v[152:155]
mf v[152:155],a[56:59],a[120:123],v[152:155]
buffer_load_dwordx4 a[104:107],v2,s[32:35],s40 offen sc1
mf v[156:159],a[60:63],a[120:123],v[156:159]
mf v[156:159],a[44:47],a[112:115],v[156:159]
buffer_load_dwordx4 a[108:111],v2,s[32:35],s40 offen offset:1024 sc1
s_add_u32 s40,s40,4096
mf v[188:191],a[44:47],a[116:119],v[188:191]
mf v[188:191],a[60:63],a[124:127],v[188:191]
mf v[184:187],a[56:59],a[124:127],v[184:187]
buffer_load_dwordx4 v2,s[56:59],s52 offen sc1 lds
mf v[184:187],a[40:43],a[116:119],v[184:187]
mf v[180:183],a[36:39],a[116:119],v[180:183]
buffer_load_dwordx4 v2,s[56:59],s52 offen offset:1024 sc1 lds
mf v[180:183],a[52:55],a[124:127],v[180:183]
mf v[176:179],a[48:51],a[124:127],v[176:179]
mf v[176:179],a[32:35],a[116:119],v[176:179]
s_waitcnt lgkmcnt(0)
s_waitcnt vmcnt(18)
mf v[128:131],a[0:3],a[64:67],v[128:131]
ds_read_b128 a[32:35],v3 offset:4096
ds_read_b128 a[36:39],v3 offset:5120
s_waitcnt vmcnt(15)
mf v[128:131],a[16:19],a[72:75],v[128:131]
ds_read_b128 a[40:43],v3 offset:6144
ds_read_b128 a[44:47],v3 offset:7168
mf v[132:135],a[20:23],a[72:75],v[132:135]
ds_read_b128 a[48:51],v3 offset:12288
ds_read_b128 a[52:55],v3 offset:13312
mf v[132:135],a[4:7],a[64:67],v[132:135]
ds_read_b128 a[56:59],v3 offset:14336
ds_read_b128 a[60:63],v3 offset:15360
mf v[136:139],a[8:11],a[64:67],v[136:139]
mf v[136:139],a[24:27],a[72:75],v[136:139]
buffer_load_dwordx4 a[112:115],v2,s[32:35],s40 offen sc1
mf v[140:143],a[28:31],a[72:75],v[140:143]
mf v[140:143],a[12:15],a[64:67],v[140:143]
buffer_load_dwordx4 a[116:119],v2,s[32:35],s40 offen offset:1024 sc1
s_add_u32 s40,s40,4096
mf v[172:175],a[12:15],a[68:71],v[172:175]
s_waitcnt vmcnt(16)
mf v[172:175],a[28:31],a[76:79],v[172:175]
mf v[168:171],a[24:27],a[76:79],v[168:171]
buffer_load_dwordx4 v2,s[56:59],s52 offen offset:2048 sc1 lds
mf v[168:171],a[8:11],a[68:71],v[168:171]
mf v[164:167],a[4:7],a[68:71],v[164:167]
buffer_load_dwordx4 v2,s[56:59],s52 offen offset:3072 sc1 lds
s_add_u32 s52,s52,28672
mf v[164:167],a[20:23],a[76:79],v[164:167]
mf v[160:163],a[16:19],a[76:79],v[160:163]
mf v[160:163],a[0:3],a[68:71],v[160:163]
s_waitcnt lgkmcnt(0)
mf v[144:147],a[32:35],a[64:67],v[144:147]
ds_read_b128 a[0:3],v3 offset:16384
ds_read_b128 a[4:7],v3 offset:17408
mf v[144:147],a[48:51],a[72:75],v[144:147]
ds_read_b128 a[8:11],v3 offset:18432
ds_read_b128 a[12:15],v3 offset:19456
mf v[148:151],a[52:55],a[72:75],v[148:151]
ds_read_b128 a[16:19],v3 offset:24576
ds_read_b128 a[20:23],v3 offset:25600
mf v[148:151],a[36:39],a[64:67],v[148:151]
ds_read_b128 a[24:27],v3 offset:26624
ds_read_b128 a[28:31],v3 offset:27648
mf v[152:155],a[40:43],a[64:67],v[152:155]
mf v[152:155],a[56:59],a[72:75],v[152:155]
buffer_load_dwordx4 a[120:123],v2,s[32:35],s40 offen sc1
mf v[156:159],a[60:63],a[72:75],v[156:159]
mf v[156:159],a[44:47],a[64:67],v[156:159]
mf v[188:191],a[44:47],a[68:71],v[188:191]
mf v[188:191],a[60:63],a[76:79],v[188:191]
mf v[184:187],a[56:59],a[76:79],v[184:187]
buffer_load_dwordx4 a[124:127],v2,s[32:35],s40 offen offset:1024 sc1
s_add_u32 s40,s40,4096
mf v[184:187],a[40:43],a[68:71],v[184:187]
mf v[180:183],a[36:39],a[68:71],v[180:183]
mf v[180:183],a[52:55],a[76:79],v[180:183]
mf v[176:179],a[48:51],a[76:79],v[176:179]
mf v[176:179],a[32:35],a[68:71],v[176:179]
s_waitcnt lgkmcnt(0)
s_waitcnt vmcnt(19)
mf v[128:131],a[0:3],a[80:83],v[128:131]
ds_read_b128 a[32:35],v3 offset:20480
ds_read_b128 a[36:39],v3 offset:21504
s_waitcnt vmcnt(16)
mf v[128:131],a[16:19],a[88:91],v[128:131]
ds_read_b128 a[40:43],v3 offset:22528
ds_read_b128 a[44:47],v3 offset:23552
mf v[132:135],a[20:23],a[88:91],v[132:135]
ds_read_b128 a[48:51],v3 offset:28672
ds_read_b128 a[52:55],v3 offset:29696
mf v[132:135],a[4:7],a[80:83],v[132:135]
ds_read_b128 a[56:59],v3 offset:30720
ds_read_b128 a[60:63],v3 offset:31744
mf v[136:139],a[8:11],a[80:83],v[136:139]
mf v[136:139],a[24:27],a[88:91],v[136:139]
buffer_load_dwordx4 a[64:67],v2,s[32:35],s40 offen sc1
mf v[140:143],a[28:31],a[88:91],v[140:143]
mf v[140:143],a[12:15],a[80:83],v[140:143]
buffer_load_dwordx4 a[68:71],v2,s[32:35],s40 offen offset:1024 sc1
s_add_u32 s40,s40,4096
mf v[172:175],a[12:15],a[84:87],v[172:175]
s_waitcnt vmcnt(17)
mf v[172:175],a[28:31],a[92:95],v[172:175]
mf v[168:171],a[24:27],a[92:95],v[168:171]
buffer_load_dwordx4 a[128:131],v2,s[24:27],s41 offen sc1
mf v[168:171],a[8:11],a[84:87],v[168:171]
mf v[164:167],a[4:7],a[84:87],v[164:167]
s_add_u32 s55,s55,512
buffer_load_dword v15,v124,s[8:11],s55 offen sc1
mf v[164:167],a[20:23],a[92:95],v[164:167]
mf v[160:163],a[16:19],a[92:95],v[160:163]
mf v[160:163],a[0:3],a[84:87],v[160:163]
s_waitcnt lgkmcnt(0)
mf v[144:147],a[32:35],a[80:83],v[144:147]
ds_read_b128 a[0:3],v3 offset:32768
ds_read_b128 a[4:7],v3 offset:33792
mf v[144:147],a[48:51],a[88:91],v[144:147]
ds_read_b128 a[8:11],v3 offset:34816
ds_read_b128 a[12:15],v3 offset:35840
mf v[148:151],a[52:55],a[88:91],v[148:151]
ds_read_b128 a[16:19],v3 offset:40960
ds_read_b128 a[20:23],v3 offset:41984
mf v[148:151],a[36:39],a[80:83],v[148:151]
ds_read_b128 a[24:27],v3 offset:43008
ds_read_b128 a[28:31],v3 offset:44032
mf v[152:155],a[40:43],a[80:83],v[152:155]
mf v[152:155],a[56:59],a[88:91],v[152:155]
buffer_load_dwordx4 a[72:75],v2,s[32:35],s40 offen sc1
mf v[156:159],a[60:63],a[88:91],v[156:159]
mf v[156:159],a[44:47],a[80:83],v[156:159]
mf v[188:191],a[44:47],a[84:87],v[188:191]
buffer_load_dwordx4 a[76:79],v2,s[32:35],s40 offen offset:1024 sc1
s_add_u32 s40,s40,4096
mf v[188:191],a[60:63],a[92:95],v[188:191]
mf v[184:187],a[56:59],a[92:95],v[184:187]
mf v[184:187],a[40:43],a[84:87],v[184:187]
buffer_load_dwordx4 a[132:135],v2,s[24:27],s41 offen offset:1024 sc1
mf v[180:183],a[36:39],a[84:87],v[180:183]
mf v[180:183],a[52:55],a[92:95],v[180:183]
mf v[176:179],a[48:51],a[92:95],v[176:179]
mf v[176:179],a[32:35],a[84:87],v[176:179]
s_waitcnt lgkmcnt(0)
s_waitcnt vmcnt(19)
mf v[128:131],a[0:3],a[96:99],v[128:131]
ds_read_b128 a[32:35],v3 offset:36864
ds_read_b128 a[36:39],v3 offset:37888
s_waitcnt vmcnt(16)
mf v[128:131],a[16:19],a[104:107],v[128:131]
ds_read_b128 a[40:43],v3 offset:38912
ds_read_b128 a[44:47],v3 offset:39936
mf v[132:135],a[20:23],a[104:107],v[132:135]
ds_read_b128 a[48:51],v3 offset:45056
ds_read_b128 a[52:55],v3 offset:46080
mf v[132:135],a[4:7],a[96:99],v[132:135]
ds_read_b128 a[56:59],v3 offset:47104
ds_read_b128 a[60:63],v3 offset:48128
mf v[136:139],a[8:11],a[96:99],v[136:139]
mf v[136:139],a[24:27],a[104:107],v[136:139]
buffer_load_dwordx4 a[80:83],v2,s[32:35],s40 offen sc1
mf v[140:143],a[28:31],a[104:107],v[140:143]
mf v[140:143],a[12:15],a[96:99],v[140:143]
mf v[172:175],a[12:15],a[100:103],v[172:175]
buffer_load_dwordx4 a[84:87],v2,s[32:35],s40 offen offset:1024 sc1
s_add_u32 s40,s40,4096
s_waitcnt vmcnt(17)
mf v[172:175],a[28:31],a[108:111],v[172:175]
mf v[168:171],a[24:27],a[108:111],v[168:171]
mf v[168:171],a[8:11],a[100:103],v[168:171]
buffer_load_dwordx4 a[136:139],v2,s[24:27],s41 offen offset:2048 sc1
mf v[164:167],a[4:7],a[100:103],v[164:167]
mf v[164:167],a[20:23],a[108:111],v[164:167]
mf v[160:163],a[16:19],a[108:111],v[160:163]
mf v[160:163],a[0:3],a[100:103],v[160:163]
s_waitcnt lgkmcnt(0)
s_waitcnt vmcnt(6)
v_cmp_ne_u32 vcc,1,v15
s_nop 0
s_cbranch_vccnz Lhb_slow
Lhb_go:
mf v[144:147],a[32:35],a[96:99],v[144:147]
ds_read_b128 a[0:3],v3 offset:49152
ds_read_b128 a[4:7],v3 offset:50176
mf v[144:147],a[48:51],a[104:107],v[144:147]
ds_read_b128 a[8:11],v3 offset:51200
ds_read_b128 a[12:15],v3 offset:52224
mf v[148:151],a[52:55],a[104:107],v[148:151]
ds_read_b128 a[16:19],v3 offset:57344
ds_read_b128 a[20:23],v3 offset:58368
mf v[148:151],a[36:39],a[96:99],v[148:151]
ds_read_b128 a[24:27],v3 offset:59392
ds_read_b128 a[28:31],v3 offset:60416
mf v[152:155],a[40:43],a[96:99],v[152:155]
mf v[152:155],a[56:59],a[104:107],v[152:155]
buffer_load_dwordx4 a[88:91],v2,s[32:35],s40 offen sc1
mf v[156:159],a[60:63],a[104:107],v[156:159]
mf v[156:159],a[44:47],a[96:99],v[156:159]
mf v[188:191],a[44:47],a[100:103],v[188:191]
buffer_load_dwordx4 a[92:95],v2,s[32:35],s40 offen offset:1024 sc1
s_add_u32 s40,s40,1232896
mf v[188:191],a[60:63],a[108:111],v[188:191]
mf v[184:187],a[56:59],a[108:111],v[184:187]
mf v[184:187],a[40:43],a[100:103],v[184:187]
buffer_load_dwordx4 a[140:143],v2,s[24:27],s41 offen offset:3072 sc1
mf v[180:183],a[36:39],a[100:103],v[180:183]
mf v[180:183],a[52:55],a[108:111],v[180:183]
mf v[176:179],a[48:51],a[108:111],v[176:179]
mf v[176:179],a[32:35],a[100:103],v[176:179]
s_waitcnt lgkmcnt(0)
mf v[128:131],a[0:3],a[112:115],v[128:131]
ds_read_b128 a[32:35],v3 offset:53248
ds_read_b128 a[36:39],v3 offset:54272
mf v[128:131],a[16:19],a[120:123],v[128:131]
ds_read_b128 a[40:43],v3 offset:55296
ds_read_b128 a[44:47],v3 offset:56320
mf v[132:135],a[20:23],a[120:123],v[132:135]
ds_read_b128 a[48:51],v3 offset:61440
ds_read_b128 a[52:55],v3 offset:62464
mf v[132:135],a[4:7],a[112:115],v[132:135]
ds_read_b128 a[56:59],v3 offset:63488
ds_read_b128 a[60:63],v3 offset:64512
mf v[136:139],a[8:11],a[112:115],v[136:139]
mf v[136:139],a[24:27],a[120:123],v[136:139]
buffer_load_dwordx4 a[96:99],v2,s[32:35],s40 offen sc1
mf v[140:143],a[28:31],a[120:123],v[140:143]
mf v[140:143],a[12:15],a[112:115],v[140:143]
mf v[172:175],a[12:15],a[116:119],v[172:175]
buffer_load_dwordx4 a[100:103],v2,s[32:35],s40 offen offset:1024 sc1
s_add_u32 s40,s40,4096
mf v[172:175],a[28:31],a[124:127],v[172:175]
mf v[168:171],a[24:27],a[124:127],v[168:171]
mf v[168:171],a[8:11],a[116:119],v[168:171]
buffer_load_dwordx4 a[144:147],v14,s[24:27],s41 offen sc1
s_add_u32 s41,s41,163840
mf v[164:167],a[4:7],a[116:119],v[164:167]
mf v[164:167],a[20:23],a[124:127],v[164:167]
mf v[160:163],a[16:19],a[124:127],v[160:163]
mf v[160:163],a[0:3],a[116:119],v[160:163]
s_waitcnt lgkmcnt(0)
mf v[144:147],a[32:35],a[112:115],v[144:147]
s_barrier
mf v[144:147],a[48:51],a[120:123],v[144:147]
ds_read_b128 a[0:3],v4 offset:0
ds_read_b128 a[4:7],v4 offset:1024
mf v[148:151],a[52:55],a[120:123],v[148:151]
ds_read_b128 a[8:11],v4 offset:2048
ds_read_b128 a[12:15],v4 offset:3072
mf v[148:151],a[36:39],a[112:115],v[148:151]
ds_read_b128 a[16:19],v4 offset:8192
ds_read_b128 a[20:23],v4 offset:9216
mf v[152:155],a[40:43],a[112:115],v[152:155]
ds_read_b128 a[24:27],v4 offset:10240
ds_read_b128 a[28:31],v4 offset:11264
mf v[152:155],a[56:59],a[120:123],v[152:155]
buffer_load_dwordx4 a[104:107],v2,s[32:35],s40 offen sc1
mf v[156:159],a[60:63],a[120:123],v[156:159]
mf v[156:159],a[44:47],a[112:115],v[156:159]
mf v[188:191],a[44:47],a[116:119],v[188:191]
buffer_load_dwordx4 a[108:111],v2,s[32:35],s40 offen offset:1024 sc1
s_add_u32 s40,s40,4096
mf v[188:191],a[60:63],a[124:127],v[188:191]
mf v[184:187],a[56:59],a[124:127],v[184:187]
mf v[184:187],a[40:43],a[116:119],v[184:187]
buffer_load_dwordx4 a[148:151],v2,s[24:27],s41 offen sc1
mf v[180:183],a[36:39],a[116:119],v[180:183]
mf v[180:183],a[52:55],a[124:127],v[180:183]
mf v[176:179],a[48:51],a[124:127],v[176:179]
mf v[176:179],a[32:35],a[116:119],v[176:179]
s_waitcnt lgkmcnt(0)
mf v[128:131],a[0:3],a[64:67],v[128:131]
ds_read_b128 a[32:35],v4 offset:4096
ds_read_b128 a[36:39],v4 offset:5120
s_waitcnt vmcnt(14)
mf v[128:131],a[16:19],a[72:75],v[128:131]
ds_read_b128 a[40:43],v4 offset:6144
ds_read_b128 a[44:47],v4 offset:7168
mf v[132:135],a[20:23],a[72:75],v[132:135]
ds_read_b128 a[48:51],v4 offset:12288
ds_read_b128 a[52:55],v4 offset:13312
mf v[132:135],a[4:7],a[64:67],v[132:135]
ds_read_b128 a[56:59],v4 offset:14336
ds_read_b128 a[60:63],v4 offset:15360
mf v[136:139],a[8:11],a[64:67],v[136:139]
mf v[136:139],a[24:27],a[72:75],v[136:139]
buffer_load_dwordx4 a[112:115],v2,s[32:35],s40 offen sc1
mf v[140:143],a[28:31],a[72:75],v[140:143]
mf v[140:143],a[12:15],a[64:67],v[140:143]
mf v[172:175],a[12:15],a[68:71],v[172:175]
buffer_load_dwordx4 a[116:119],v2,s[32:35],s40 offen offset:1024 sc1
s_add_u32 s40,s40,4096
s_waitcnt vmcnt(15)
mf v[172:175],a[28:31],a[76:79],v[172:175]
mf v[168:171],a[24:27],a[76:79],v[168:171]
mf v[168:171],a[8:11],a[68:71],v[168:171]
buffer_load_dwordx4 a[152:155],v2,s[24:27],s41 offen offset:1024 sc1
mf v[164:167],a[4:7],a[68:71],v[164:167]
mf v[164:167],a[20:23],a[76:79],v[164:167]
mf v[160:163],a[16:19],a[76:79],v[160:163]
mf v[160:163],a[0:3],a[68:71],v[160:163]
s_waitcnt lgkmcnt(0)
mf v[144:147],a[32:35],a[64:67],v[144:147]
ds_read_b128 a[0:3],v4 offset:16384
ds_read_b128 a[4:7],v4 offset:17408
mf v[144:147],a[48:51],a[72:75],v[144:147]
ds_read_b128 a[8:11],v4 offset:18432
ds_read_b128 a[12:15],v4 offset:19456
mf v[148:151],a[52:55],a[72:75],v[148:151]
ds_read_b128 a[16:19],v4 offset:24576
ds_read_b128 a[20:23],v4 offset:25600
mf v[148:151],a[36:39],a[64:67],v[148:151]
ds_read_b128 a[24:27],v4 offset:26624
ds_read_b128 a[28:31],v4 offset:27648
mf v[152:155],a[40:43],a[64:67],v[152:155]
mf v[152:155],a[56:59],a[72:75],v[152:155]
buffer_load_dwordx4 a[120:123],v2,s[32:35],s40 offen sc1
mf v[156:159],a[60:63],a[72:75],v[156:159]
mf v[156:159],a[44:47],a[64:67],v[156:159]
mf v[188:191],a[44:47],a[68:71],v[188:191]
buffer_load_dwordx4 a[124:127],v2,s[32:35],s40 offen offset:1024 sc1
s_add_u32 s40,s40,4096
mf v[188:191],a[60:63],a[76:79],v[188:191]
mf v[184:187],a[56:59],a[76:79],v[184:187]
mf v[184:187],a[40:43],a[68:71],v[184:187]
buffer_load_dwordx4 a[156:159],v2,s[24:27],s41 offen offset:2048 sc1
mf v[180:183],a[36:39],a[68:71],v[180:183]
mf v[180:183],a[52:55],a[76:79],v[180:183]
mf v[176:179],a[48:51],a[76:79],v[176:179]
mf v[176:179],a[32:35],a[68:71],v[176:179]
s_waitcnt lgkmcnt(0)
s_waitcnt vmcnt(17)
mf v[128:131],a[0:3],a[80:83],v[128:131]
ds_read_b128 a[32:35],v4 offset:20480
ds_read_b128 a[36:39],v4 offset:21504
s_waitcnt vmcnt(14)
mf v[128:131],a[16:19],a[88:91],v[128:131]
ds_read_b128 a[40:43],v4 offset:22528
ds_read_b128 a[44:47],v4 offset:23552
mf v[132:135],a[20:23],a[88:91],v[132:135]
ds_read_b128 a[48:51],v4 offset:28672
ds_read_b128 a[52:55],v4 offset:29696
mf v[132:135],a[4:7],a[80:83],v[132:135]
ds_read_b128 a[56:59],v4 offset:30720
ds_read_b128 a[60:63],v4 offset:31744
mf v[136:139],a[8:11],a[80:83],v[136:139]
mf v[136:139],a[24:27],a[88:91],v[136:139]
buffer_load_dwordx4 a[64:67],v2,s[32:35],s40 offen sc1
mf v[140:143],a[28:31],a[88:91],v[140:143]
mf v[140:143],a[12:15],a[80:83],v[140:143]
mf v[172:175],a[12:15],a[84:87],v[172:175]
buffer_load_dwordx4 a[68:71],v2,s[32:35],s40 offen offset:1024 sc1
s_add_u32 s40,s40,4096
s_waitcnt vmcnt(15)
mf v[172:175],a[28:31],a[92:95],v[172:175]
mf v[168:171],a[24:27],a[92:95],v[168:171]
mf v[168:171],a[8:11],a[84:87],v[168:171]
buffer_load_dwordx4 a[160:163],v2,s[24:27],s41 offen offset:3072 sc1
mf v[164:167],a[4:7],a[84:87],v[164:167]
mf v[164:167],a[20:23],a[92:95],v[164:167]
mf v[160:163],a[16:19],a[92:95],v[160:163]
mf v[160:163],a[0:3],a[84:87],v[160:163]
s_waitcnt lgkmcnt(0)
mf v[144:147],a[32:35],a[80:83],v[144:147]
ds_read_b128 a[0:3],v2 offset:0
ds_read_b128 a[4:7],v2 offset:1024
mf v[144:147],a[48:51],a[88:91],v[144:147]
ds_read_b128 a[8:11],v2 offset:2048
ds_read_b128 a[12:15],v2 offset:3072
mf v[148:151],a[52:55],a[88:91],v[148:151]
ds_read_b128 a[16:19],v2 offset:8192
ds_read_b128 a[20:23],v2 offset:9216
mf v[148:151],a[36:39],a[80:83],v[148:151]
ds_read_b128 a[24:27],v2 offset:10240
ds_read_b128 a[28:31],v2 offset:11264
mf v[152:155],a[40:43],a[80:83],v[152:155]
mf v[152:155],a[56:59],a[88:91],v[152:155]
buffer_load_dwordx4 a[72:75],v2,s[32:35],s40 offen sc1
mf v[156:159],a[60:63],a[88:91],v[156:159]
mf v[156:159],a[44:47],a[80:83],v[156:159]
mf v[188:191],a[44:47],a[84:87],v[188:191]
buffer_load_dwordx4 a[76:79],v2,s[32:35],s40 offen offset:1024 sc1
s_add_u32 s40,s40,4096
mf v[188:191],a[60:63],a[92:95],v[188:191]
mf v[184:187],a[56:59],a[92:95],v[184:187]
mf v[184:187],a[40:43],a[84:87],v[184:187]
buffer_load_dwordx4 a[164:167],v14,s[24:27],s41 offen sc1
s_add_u32 s41,s41,163840
mf v[180:183],a[36:39],a[84:87],v[180:183]
mf v[180:183],a[52:55],a[92:95],v[180:183]
mf v[176:179],a[48:51],a[92:95],v[176:179]
mf v[176:179],a[32:35],a[84:87],v[176:179]
s_waitcnt lgkmcnt(0)
s_waitcnt vmcnt(17)
mf v[192:195],a[0:3],a[96:99],0
ds_read_b128 a[32:35],v2 offset:4096
ds_read_b128 a[36:39],v2 offset:5120
s_waitcnt vmcnt(14)
mf v[192:195],a[16:19],a[104:107],v[192:195]
ds_read_b128 a[40:43],v2 offset:6144
ds_read_b128 a[44:47],v2 offset:7168
mf v[196:199],a[20:23],a[104:107],0
ds_read_b128 a[48:51],v2 offset:12288
ds_read_b128 a[52:55],v2 offset:13312
mf v[196:199],a[4:7],a[96:99],v[196:199]
ds_read_b128 a[56:59],v2 offset:14336
ds_read_b128 a[60:63],v2 offset:15360
mf v[200:203],a[8:11],a[96:99],0
mf v[200:203],a[24:27],a[104:107],v[200:203]
buffer_load_dwordx4 a[80:83],v2,s[32:35],s40 offen sc1
mf v[204:207],a[28:31],a[104:107],0
v_mul_f32 v20,v128,v128
v_mul_f32 v21,v129,v129
mf v[204:207],a[12:15],a[96:99],v[204:207]
v_mul_f32 v22,v130,v130
v_mul_f32 v23,v131,v131
mf v[236:239],a[12:15],a[100:103],0
buffer_load_dwordx4 a[84:87],v2,s[32:35],s40 offen offset:1024 sc1
s_add_u32 s40,s40,4096
s_waitcnt vmcnt(15)
mf v[236:239],a[28:31],a[108:111],v[236:239]
v_mul_f32 v24,v132,v132
v_mul_f32 v25,v133,v133
mf v[232:235],a[24:27],a[108:111],0
v_mul_f32 v26,v134,v134
v_mul_f32 v27,v135,v135
mf v[232:235],a[8:11],a[100:103],v[232:235]
buffer_load_dwordx4 a[168:171],v2,s[24:27],s41 offen sc1
mf v[228:231],a[4:7],a[100:103],0
v_fma_f32 v20,v20,s48,v8
v_fma_f32 v21,v21,s48,v8
mf v[228:231],a[20:23],a[108:111],v[228:231]
v_fma_f32 v22,v22,s48,v8
v_fma_f32 v23,v23,s48,v8
mf v[224:227],a[16:19],a[108:111],0
v_fma_f32 v24,v24,s48,v8
v_fma_f32 v25,v25,s48,v8
v_fma_f32 v26,v26,s48,v8
v_fma_f32 v27,v27,s48,v8
mf v[224:227],a[0:3],a[100:103],v[224:227]
s_waitcnt lgkmcnt(0)
v_mul_f32 v20,v20,v128
v_mul_f32 v21,v21,v129
v_mul_f32 v22,v22,v130
v_mul_f32 v23,v23,v131
v_mul_f32 v24,v24,v132
v_mul_f32 v25,v25,v133
v_mul_f32 v26,v26,v134
v_mul_f32 v27,v27,v135
v_exp_f32 v20,v20
v_exp_f32 v21,v21
v_exp_f32 v22,v22
mf v[208:211],a[32:35],a[96:99],0
ds_read_b128 a[0:3],v2 offset:16384
ds_read_b128 a[4:7],v2 offset:17408
mf v[208:211],a[48:51],a[104:107],v[208:211]
ds_read_b128 a[8:11],v2 offset:18432
ds_read_b128 a[12:15],v2 offset:19456
mf v[212:215],a[52:55],a[104:107],0
ds_read_b128 a[16:19],v2 offset:24576
ds_read_b128 a[20:23],v2 offset:25600
mf v[212:215],a[36:39],a[96:99],v[212:215]
ds_read_b128 a[24:27],v2 offset:26624
ds_read_b128 a[28:31],v2 offset:27648
mf v[216:219],a[40:43],a[96:99],0
v_exp_f32 v23,v23
mf v[216:219],a[56:59],a[104:107],v[216:219]
buffer_load_dwordx4 a[88:91],v2,s[32:35],s40 offen sc1
mf v[220:223],a[60:63],a[104:107],0
v_exp_f32 v24,v24
mf v[220:223],a[44:47],a[96:99],v[220:223]
v_exp_f32 v25,v25
mf v[252:255],a[44:47],a[100:103],0
buffer_load_dwordx4 a[92:95],v2,s[32:35],s40 offen offset:1024 sc1
s_add_u32 s40,s40,4096
mf v[252:255],a[60:63],a[108:111],v[252:255]
v_exp_f32 v26,v26
mf v[248:251],a[56:59],a[108:111],0
v_exp_f32 v27,v27
mf v[248:251],a[40:43],a[100:103],v[248:251]
buffer_load_dwordx4 a[172:175],v2,s[24:27],s41 offen offset:1024 sc1
mf v[244:247],a[36:39],a[100:103],0
v_mul_f32 v28,v128,v144
v_mul_f32 v29,v129,v145
mf v[244:247],a[52:55],a[108:111],v[244:247]
v_mul_f32 v30,v130,v146
v_mul_f32 v31,v131,v147
mf v[240:243],a[48:51],a[108:111],0
v_mul_f32 v32,v132,v148
v_mul_f32 v33,v133,v149
v_mul_f32 v34,v134,v150
v_mul_f32 v35,v135,v151
mf v[240:243],a[32:35],a[100:103],v[240:243]
s_waitcnt lgkmcnt(0)
v_add_f32 v20,1.0,v20
v_add_f32 v21,1.0,v21
v_add_f32 v22,1.0,v22
v_add_f32 v23,1.0,v23
v_add_f32 v24,1.0,v24
v_add_f32 v25,1.0,v25
v_add_f32 v26,1.0,v26
v_add_f32 v27,1.0,v27
v_rcp_f32 v20,v20
s_waitcnt vmcnt(17)
mf v[192:195],a[0:3],a[112:115],v[192:195]
ds_read_b128 a[32:35],v2 offset:20480
ds_read_b128 a[36:39],v2 offset:21504
s_waitcnt vmcnt(14)
mf v[192:195],a[16:19],a[120:123],v[192:195]
ds_read_b128 a[40:43],v2 offset:22528
ds_read_b128 a[44:47],v2 offset:23552
mf v[196:199],a[20:23],a[120:123],v[196:199]
ds_read_b128 a[48:51],v2 offset:28672
ds_read_b128 a[52:55],v2 offset:29696
mf v[196:199],a[4:7],a[112:115],v[196:199]
ds_read_b128 a[56:59],v2 offset:30720
ds_read_b128 a[60:63],v2 offset:31744
mf v[200:203],a[8:11],a[112:115],v[200:203]
v_rcp_f32 v21,v21
mf v[200:203],a[24:27],a[120:123],v[200:203]
buffer_load_dwordx4 a[96:99],v2,s[32:35],s40 offen sc1
mf v[204:207],a[28:31],a[120:123],v[204:207]
v_rcp_f32 v22,v22
mf v[204:207],a[12:15],a[112:115],v[204:207]
v_rcp_f32 v23,v23
mf v[236:239],a[12:15],a[116:119],v[236:239]
buffer_load_dwordx4 a[100:103],v2,s[32:35],s40 offen offset:1024 sc1
s_add_u32 s40,s40,4096
s_waitcnt vmcnt(15)
mf v[236:239],a[28:31],a[124:127],v[236:239]
v_rcp_f32 v24,v24
mf v[232:235],a[24:27],a[124:127],v[232:235]
v_rcp_f32 v25,v25
mf v[232:235],a[8:11],a[116:119],v[232:235]
buffer_load_dwordx4 a[176:179],v2,s[24:27],s41 offen offset:2048 sc1
mf v[228:231],a[4:7],a[116:119],v[228:231]
v_rcp_f32 v26,v26
mf v[228:231],a[20:23],a[124:127],v[228:231]
v_rcp_f32 v27,v27
mf v[224:227],a[16:19],a[124:127],v[224:227]
v_mul_f32 v28,v28,v20
v_mul_f32 v29,v29,v21
v_mul_f32 v30,v30,v22
v_mul_f32 v31,v31,v23
mf v[224:227],a[0:3],a[116:119],v[224:227]
s_waitcnt lgkmcnt(0)
v_mul_f32 v32,v32,v24
v_mul_f32 v33,v33,v25
v_mul_f32 v34,v34,v26
v_mul_f32 v35,v35,v27
cvt v16,v28,v29
cvt v17,v30,v31
cvt v18,v32,v33
cvt v19,v34,v35
buffer_store_dwordx4 v[16:19],v2,s[28:31],s44 offen sc1
mf v[208:211],a[32:35],a[112:115],v[208:211]
ds_read_b128 a[0:3],v2 offset:32768
ds_read_b128 a[4:7],v2 offset:33792
mf v[208:211],a[48:51],a[120:123],v[208:211]
ds_read_b128 a[8:11],v2 offset:34816
ds_read_b128 a[12:15],v2 offset:35840
mf v[212:215],a[52:55],a[120:123],v[212:215]
ds_read_b128 a[16:19],v2 offset:40960
ds_read_b128 a[20:23],v2 offset:41984
mf v[212:215],a[36:39],a[112:115],v[212:215]
ds_read_b128 a[24:27],v2 offset:43008
ds_read_b128 a[28:31],v2 offset:44032
mf v[216:219],a[40:43],a[112:115],v[216:219]
v_mul_f32 v40,v136,v136
v_mul_f32 v41,v137,v137
mf v[216:219],a[56:59],a[120:123],v[216:219]
buffer_load_dwordx4 a[104:107],v2,s[32:35],s40 offen sc1
mf v[220:223],a[60:63],a[120:123],v[220:223]
v_mul_f32 v42,v138,v138
v_mul_f32 v43,v139,v139
mf v[220:223],a[44:47],a[112:115],v[220:223]
v_mul_f32 v44,v140,v140
v_mul_f32 v45,v141,v141
mf v[252:255],a[44:47],a[116:119],v[252:255]
buffer_load_dwordx4 a[108:111],v2,s[32:35],s40 offen offset:1024 sc1
s_add_u32 s40,s40,4096
mf v[252:255],a[60:63],a[124:127],v[252:255]
v_mul_f32 v46,v142,v142
v_mul_f32 v47,v143,v143
mf v[248:251],a[56:59],a[124:127],v[248:251]
v_fma_f32 v40,v40,s48,v8
v_fma_f32 v41,v41,s48,v8
mf v[248:251],a[40:43],a[116:119],v[248:251]
buffer_load_dwordx4 a[180:183],v2,s[24:27],s41 offen offset:3072 sc1
mf v[244:247],a[36:39],a[116:119],v[244:247]
v_fma_f32 v42,v42,s48,v8
v_fma_f32 v43,v43,s48,v8
mf v[244:247],a[52:55],a[124:127],v[244:247]
v_fma_f32 v44,v44,s48,v8
v_fma_f32 v45,v45,s48,v8
mf v[240:243],a[48:51],a[124:127],v[240:243]
v_fma_f32 v46,v46,s48,v8
v_fma_f32 v47,v47,s48,v8
v_mul_f32 v40,v40,v136
v_mul_f32 v41,v41,v137
mf v[240:243],a[32:35],a[116:119],v[240:243]
s_waitcnt lgkmcnt(0)
v_mul_f32 v42,v42,v138
v_mul_f32 v43,v43,v139
v_mul_f32 v44,v44,v140
v_mul_f32 v45,v45,v141
v_mul_f32 v46,v46,v142
v_mul_f32 v47,v47,v143
v_exp_f32 v40,v40
v_exp_f32 v41,v41
v_exp_f32 v42,v42
s_waitcnt vmcnt(18)
mf v[192:195],a[0:3],a[64:67],v[192:195]
ds_read_b128 a[32:35],v2 offset:36864
ds_read_b128 a[36:39],v2 offset:37888
s_waitcnt vmcnt(15)
mf v[192:195],a[16:19],a[72:75],v[192:195]
ds_read_b128 a[40:43],v2 offset:38912
ds_read_b128 a[44:47],v2 offset:39936
mf v[196:199],a[20:23],a[72:75],v[196:199]
ds_read_b128 a[48:51],v2 offset:45056
ds_read_b128 a[52:55],v2 offset:46080
mf v[196:199],a[4:7],a[64:67],v[196:199]
ds_read_b128 a[56:59],v2 offset:47104
ds_read_b128 a[60:63],v2 offset:48128
mf v[200:203],a[8:11],a[64:67],v[200:203]
v_exp_f32 v43,v43
mf v[200:203],a[24:27],a[72:75],v[200:203]
buffer_load_dwordx4 a[112:115],v2,s[32:35],s40 offen sc1
mf v[204:207],a[28:31],a[72:75],v[204:207]
v_exp_f32 v44,v44
mf v[204:207],a[12:15],a[64:67],v[204:207]
v_exp_f32 v45,v45
mf v[236:239],a[12:15],a[68:71],v[236:239]
buffer_load_dwordx4 a[116:119],v2,s[32:35],s40 offen offset:1024 sc1
s_add_u32 s40,s40,4096
s_waitcnt vmcnt(16)
mf v[236:239],a[28:31],a[76:79],v[236:239]
v_exp_f32 v46,v46
mf v[232:235],a[24:27],a[76:79],v[232:235]
v_exp_f32 v47,v47
mf v[232:235],a[8:11],a[68:71],v[232:235]
buffer_load_dwordx4 a[184:187],v14,s[24:27],s41 offen sc1
s_add_u32 s41,s41,163840
mf v[228:231],a[4:7],a[68:71],v[228:231]
v_mul_f32 v48,v136,v152
v_mul_f32 v49,v137,v153
mf v[228:231],a[20:23],a[76:79],v[228:231]
v_mul_f32 v50,v138,v154
v_mul_f32 v51,v139,v155
mf v[224:227],a[16:19],a[76:79],v[224:227]
v_mul_f32 v52,v140,v156
v_mul_f32 v53,v141,v157
v_mul_f32 v54,v142,v158
v_mul_f32 v55,v143,v159
mf v[224:227],a[0:3],a[68:71],v[224:227]
s_waitcnt lgkmcnt(0)
v_add_f32 v40,1.0,v40
v_add_f32 v41,1.0,v41
v_add_f32 v42,1.0,v42
v_add_f32 v43,1.0,v43
v_add_f32 v44,1.0,v44
v_add_f32 v45,1.0,v45
v_add_f32 v46,1.0,v46
v_add_f32 v47,1.0,v47
v_rcp_f32 v40,v40
mf v[208:211],a[32:35],a[64:67],v[208:211]
ds_read_b128 a[0:3],v2 offset:49152
ds_read_b128 a[4:7],v2 offset:50176
mf v[208:211],a[48:51],a[72:75],v[208:211]
ds_read_b128 a[8:11],v2 offset:51200
ds_read_b128 a[12:15],v2 offset:52224
mf v[212:215],a[52:55],a[72:75],v[212:215]
ds_read_b128 a[16:19],v2 offset:57344
ds_read_b128 a[20:23],v2 offset:58368
mf v[212:215],a[36:39],a[64:67],v[212:215]
ds_read_b128 a[24:27],v2 offset:59392
ds_read_b128 a[28:31],v2 offset:60416
mf v[216:219],a[40:43],a[64:67],v[216:219]
v_rcp_f32 v41,v41
mf v[216:219],a[56:59],a[72:75],v[216:219]
buffer_load_dwordx4 a[120:123],v2,s[32:35],s40 offen sc1
mf v[220:223],a[60:63],a[72:75],v[220:223]
v_rcp_f32 v42,v42
mf v[220:223],a[44:47],a[64:67],v[220:223]
v_rcp_f32 v43,v43
mf v[252:255],a[44:47],a[68:71],v[252:255]
buffer_load_dwordx4 a[124:127],v2,s[32:35],s40 offen offset:1024 sc1
s_add_u32 s40,s40,4096
mf v[252:255],a[60:63],a[76:79],v[252:255]
v_rcp_f32 v44,v44
mf v[248:251],a[56:59],a[76:79],v[248:251]
v_rcp_f32 v45,v45
mf v[248:251],a[40:43],a[68:71],v[248:251]
buffer_load_dwordx4 a[188:191],v2,s[24:27],s41 offen sc1
mf v[244:247],a[36:39],a[68:71],v[244:247]
v_rcp_f32 v46,v46
mf v[244:247],a[52:55],a[76:79],v[244:247]
v_rcp_f32 v47,v47
mf v[240:243],a[48:51],a[76:79],v[240:243]
v_mul_f32 v48,v48,v40
v_mul_f32 v49,v49,v41
v_mul_f32 v50,v50,v42
v_mul_f32 v51,v51,v43
mf v[240:243],a[32:35],a[68:71],v[240:243]
s_waitcnt lgkmcnt(0)
v_mul_f32 v52,v52,v44
v_mul_f32 v53,v53,v45
v_mul_f32 v54,v54,v46
v_mul_f32 v55,v55,v47
cvt v36,v48,v49
cvt v37,v50,v51
cvt v38,v52,v53
cvt v39,v54,v55
buffer_store_dwordx4 v[36:39],v2,s[28:31],s45 offen sc1
s_waitcnt vmcnt(19)
mf v[192:195],a[0:3],a[80:83],v[192:195]
ds_read_b128 a[32:35],v2 offset:53248
ds_read_b128 a[36:39],v2 offset:54272
s_waitcnt vmcnt(16)
mf v[192:195],a[16:19],a[88:91],v[192:195]
ds_read_b128 a[40:43],v2 offset:55296
ds_read_b128 a[44:47],v2 offset:56320
mf v[196:199],a[20:23],a[88:91],v[196:199]
ds_read_b128 a[48:51],v2 offset:61440
ds_read_b128 a[52:55],v2 offset:62464
mf v[196:199],a[4:7],a[80:83],v[196:199]
ds_read_b128 a[56:59],v2 offset:63488
ds_read_b128 a[60:63],v2 offset:64512
mf v[200:203],a[8:11],a[80:83],v[200:203]
v_mul_f32 v60,v160,v160
v_mul_f32 v61,v161,v161
mf v[200:203],a[24:27],a[88:91],v[200:203]
buffer_load_dwordx4 a[64:67],v2,s[32:35],s40 offen sc1
mf v[204:207],a[28:31],a[88:91],v[204:207]
v_mul_f32 v62,v162,v162
v_mul_f32 v63,v163,v163
mf v[204:207],a[12:15],a[80:83],v[204:207]
v_mul_f32 v64,v164,v164
v_mul_f32 v65,v165,v165
mf v[236:239],a[12:15],a[84:87],v[236:239]
buffer_load_dwordx4 a[68:71],v2,s[32:35],s40 offen offset:1024 sc1
s_add_u32 s40,s40,4096
s_waitcnt vmcnt(17)
mf v[236:239],a[28:31],a[92:95],v[236:239]
v_mul_f32 v66,v166,v166
v_mul_f32 v67,v167,v167
mf v[232:235],a[24:27],a[92:95],v[232:235]
v_fma_f32 v60,v60,s48,v8
v_fma_f32 v61,v61,s48,v8
mf v[232:235],a[8:11],a[84:87],v[232:235]
buffer_load_dwordx4 a[192:195],v2,s[24:27],s41 offen offset:1024 sc1
mf v[228:231],a[4:7],a[84:87],v[228:231]
v_fma_f32 v62,v62,s48,v8
v_fma_f32 v63,v63,s48,v8
mf v[228:231],a[20:23],a[92:95],v[228:231]
v_fma_f32 v64,v64,s48,v8
v_fma_f32 v65,v65,s48,v8
mf v[224:227],a[16:19],a[92:95],v[224:227]
v_fma_f32 v66,v66,s48,v8
v_fma_f32 v67,v67,s48,v8
v_mul_f32 v60,v60,v160
v_mul_f32 v61,v61,v161
mf v[224:227],a[0:3],a[84:87],v[224:227]
s_waitcnt lgkmcnt(0)
v_mul_f32 v62,v62,v162
v_mul_f32 v63,v63,v163
v_mul_f32 v64,v64,v164
v_mul_f32 v65,v65,v165
v_mul_f32 v66,v66,v166
v_mul_f32 v67,v67,v167
v_exp_f32 v60,v60
v_exp_f32 v61,v61
v_exp_f32 v62,v62
mf v[208:211],a[32:35],a[80:83],v[208:211]
ds_read_b128 a[0:3],v3 offset:0
ds_read_b128 a[4:7],v3 offset:1024
mf v[208:211],a[48:51],a[88:91],v[208:211]
ds_read_b128 a[8:11],v3 offset:2048
ds_read_b128 a[12:15],v3 offset:3072
mf v[212:215],a[52:55],a[88:91],v[212:215]
ds_read_b128 a[16:19],v3 offset:8192
ds_read_b128 a[20:23],v3 offset:9216
mf v[212:215],a[36:39],a[80:83],v[212:215]
ds_read_b128 a[24:27],v3 offset:10240
ds_read_b128 a[28:31],v3 offset:11264
mf v[216:219],a[40:43],a[80:83],v[216:219]
v_exp_f32 v63,v63
mf v[216:219],a[56:59],a[88:91],v[216:219]
buffer_load_dwordx4 a[72:75],v2,s[32:35],s40 offen sc1
mf v[220:223],a[60:63],a[88:91],v[220:223]
v_exp_f32 v64,v64
mf v[220:223],a[44:47],a[80:83],v[220:223]
v_exp_f32 v65,v65
mf v[252:255],a[44:47],a[84:87],v[252:255]
buffer_load_dwordx4 a[76:79],v2,s[32:35],s40 offen offset:1024 sc1
s_add_u32 s40,s40,4096
mf v[252:255],a[60:63],a[92:95],v[252:255]
v_exp_f32 v66,v66
mf v[248:251],a[56:59],a[92:95],v[248:251]
v_exp_f32 v67,v67
mf v[248:251],a[40:43],a[84:87],v[248:251]
buffer_load_dwordx4 a[196:199],v2,s[24:27],s41 offen offset:2048 sc1
mf v[244:247],a[36:39],a[84:87],v[244:247]
v_mul_f32 v68,v160,v176
v_mul_f32 v69,v161,v177
mf v[244:247],a[52:55],a[92:95],v[244:247]
v_mul_f32 v70,v162,v178
v_mul_f32 v71,v163,v179
mf v[240:243],a[48:51],a[92:95],v[240:243]
v_mul_f32 v72,v164,v180
v_mul_f32 v73,v165,v181
v_mul_f32 v74,v166,v182
v_mul_f32 v75,v167,v183
mf v[240:243],a[32:35],a[84:87],v[240:243]
s_waitcnt lgkmcnt(0)
v_add_f32 v60,1.0,v60
v_add_f32 v61,1.0,v61
v_add_f32 v62,1.0,v62
v_add_f32 v63,1.0,v63
v_add_f32 v64,1.0,v64
v_add_f32 v65,1.0,v65
v_add_f32 v66,1.0,v66
v_add_f32 v67,1.0,v67
v_rcp_f32 v60,v60
s_waitcnt vmcnt(19)
mf v[192:195],a[0:3],a[96:99],v[192:195]
ds_read_b128 a[32:35],v3 offset:4096
ds_read_b128 a[36:39],v3 offset:5120
s_waitcnt vmcnt(15)
mf v[192:195],a[16:19],a[104:107],v[192:195]
ds_read_b128 a[40:43],v3 offset:6144
ds_read_b128 a[44:47],v3 offset:7168
mf v[196:199],a[20:23],a[104:107],v[196:199]
ds_read_b128 a[48:51],v3 offset:12288
ds_read_b128 a[52:55],v3 offset:13312
mf v[196:199],a[4:7],a[96:99],v[196:199]
ds_read_b128 a[56:59],v3 offset:14336
ds_read_b128 a[60:63],v3 offset:15360
mf v[200:203],a[8:11],a[96:99],v[200:203]
v_rcp_f32 v61,v61
mf v[200:203],a[24:27],a[104:107],v[200:203]
buffer_load_dwordx4 a[80:83],v2,s[32:35],s40 offen sc1
mf v[204:207],a[28:31],a[104:107],v[204:207]
v_rcp_f32 v62,v62
mf v[204:207],a[12:15],a[96:99],v[204:207]
v_rcp_f32 v63,v63
mf v[236:239],a[12:15],a[100:103],v[236:239]
buffer_load_dwordx4 a[84:87],v2,s[32:35],s40 offen offset:1024 sc1
s_add_u32 s40,s40,4096
s_waitcnt vmcnt(16)
mf v[236:239],a[28:31],a[108:111],v[236:239]
v_rcp_f32 v64,v64
mf v[232:235],a[24:27],a[108:111],v[232:235]
v_rcp_f32 v65,v65
mf v[232:235],a[8:11],a[100:103],v[232:235]
buffer_load_dwordx4 a[200:203],v2,s[24:27],s41 offen offset:3072 sc1
mf v[228:231],a[4:7],a[100:103],v[228:231]
v_rcp_f32 v66,v66
mf v[228:231],a[20:23],a[108:111],v[228:231]
v_rcp_f32 v67,v67
mf v[224:227],a[16:19],a[108:111],v[224:227]
v_mul_f32 v68,v68,v60
v_mul_f32 v69,v69,v61
v_mul_f32 v70,v70,v62
v_mul_f32 v71,v71,v63
mf v[224:227],a[0:3],a[100:103],v[224:227]
s_waitcnt lgkmcnt(0)
v_mul_f32 v72,v72,v64
v_mul_f32 v73,v73,v65
v_mul_f32 v74,v74,v66
v_mul_f32 v75,v75,v67
cvt v56,v68,v69
cvt v57,v70,v71
cvt v58,v72,v73
cvt v59,v74,v75
buffer_store_dwordx4 v[56:59],v2,s[28:31],s44 offen offset:1024 sc1
mf v[208:211],a[32:35],a[96:99],v[208:211]
ds_read_b128 a[0:3],v3 offset:16384
ds_read_b128 a[4:7],v3 offset:17408
mf v[208:211],a[48:51],a[104:107],v[208:211]
ds_read_b128 a[8:11],v3 offset:18432
ds_read_b128 a[12:15],v3 offset:19456
mf v[212:215],a[52:55],a[104:107],v[212:215]
ds_read_b128 a[16:19],v3 offset:24576
ds_read_b128 a[20:23],v3 offset:25600
mf v[212:215],a[36:39],a[96:99],v[212:215]
ds_read_b128 a[24:27],v3 offset:26624
ds_read_b128 a[28:31],v3 offset:27648
mf v[216:219],a[40:43],a[96:99],v[216:219]
v_mul_f32 v80,v168,v168
v_mul_f32 v81,v169,v169
mf v[216:219],a[56:59],a[104:107],v[216:219]
buffer_load_dwordx4 a[88:91],v2,s[32:35],s40 offen sc1
mf v[220:223],a[60:63],a[104:107],v[220:223]
v_mul_f32 v82,v170,v170
v_mul_f32 v83,v171,v171
mf v[220:223],a[44:47],a[96:99],v[220:223]
v_mul_f32 v84,v172,v172
v_mul_f32 v85,v173,v173
mf v[252:255],a[44:47],a[100:103],v[252:255]
buffer_load_dwordx4 a[92:95],v2,s[32:35],s40 offen offset:1024 sc1
s_add_u32 s40,s40,4096
mf v[252:255],a[60:63],a[108:111],v[252:255]
v_mul_f32 v86,v174,v174
v_mul_f32 v87,v175,v175
mf v[248:251],a[56:59],a[108:111],v[248:251]
v_fma_f32 v80,v80,s48,v8
v_fma_f32 v81,v81,s48,v8
mf v[248:251],a[40:43],a[100:103],v[248:251]
buffer_load_dwordx4 a[204:207],v14,s[24:27],s41 offen sc1
s_add_u32 s41,s41,163840
mf v[244:247],a[36:39],a[100:103],v[244:247]
v_fma_f32 v82,v82,s48,v8
v_fma_f32 v83,v83,s48,v8
mf v[244:247],a[52:55],a[108:111],v[244:247]
v_fma_f32 v84,v84,s48,v8
v_fma_f32 v85,v85,s48,v8
mf v[240:243],a[48:51],a[108:111],v[240:243]
v_fma_f32 v86,v86,s48,v8
v_fma_f32 v87,v87,s48,v8
v_mul_f32 v80,v80,v168
v_mul_f32 v81,v81,v169
mf v[240:243],a[32:35],a[100:103],v[240:243]
s_waitcnt lgkmcnt(0)
v_mul_f32 v82,v82,v170
v_mul_f32 v83,v83,v171
v_mul_f32 v84,v84,v172
v_mul_f32 v85,v85,v173
v_mul_f32 v86,v86,v174
v_mul_f32 v87,v87,v175
v_exp_f32 v80,v80
v_exp_f32 v81,v81
v_exp_f32 v82,v82
s_waitcnt vmcnt(19)
mf v[192:195],a[0:3],a[112:115],v[192:195]
ds_read_b128 a[32:35],v3 offset:20480
ds_read_b128 a[36:39],v3 offset:21504
s_waitcnt vmcnt(16)
mf v[192:195],a[16:19],a[120:123],v[192:195]
ds_read_b128 a[40:43],v3 offset:22528
ds_read_b128 a[44:47],v3 offset:23552
mf v[196:199],a[20:23],a[120:123],v[196:199]
ds_read_b128 a[48:51],v3 offset:28672
ds_read_b128 a[52:55],v3 offset:29696
mf v[196:199],a[4:7],a[112:115],v[196:199]
ds_read_b128 a[56:59],v3 offset:30720
ds_read_b128 a[60:63],v3 offset:31744
mf v[200:203],a[8:11],a[112:115],v[200:203]
v_exp_f32 v83,v83
mf v[200:203],a[24:27],a[120:123],v[200:203]
buffer_load_dwordx4 a[96:99],v2,s[32:35],s40 offen sc1
mf v[204:207],a[28:31],a[120:123],v[204:207]
v_exp_f32 v84,v84
mf v[204:207],a[12:15],a[112:115],v[204:207]
v_exp_f32 v85,v85
mf v[236:239],a[12:15],a[116:119],v[236:239]
buffer_load_dwordx4 a[100:103],v2,s[32:35],s40 offen offset:1024 sc1
s_add_u32 s40,s40,4096
s_waitcnt vmcnt(17)
mf v[236:239],a[28:31],a[124:127],v[236:239]
v_exp_f32 v86,v86
mf v[232:235],a[24:27],a[124:127],v[232:235]
v_exp_f32 v87,v87
mf v[232:235],a[8:11],a[116:119],v[232:235]
buffer_load_dwordx4 a[208:211],v2,s[24:27],s41 offen sc1
mf v[228:231],a[4:7],a[116:119],v[228:231]
v_mul_f32 v88,v168,v184
v_mul_f32 v89,v169,v185
mf v[228:231],a[20:23],a[124:127],v[228:231]
v_mul_f32 v90,v170,v186
v_mul_f32 v91,v171,v187
mf v[224:227],a[16:19],a[124:127],v[224:227]
v_mul_f32 v92,v172,v188
v_mul_f32 v93,v173,v189
v_mul_f32 v94,v174,v190
v_mul_f32 v95,v175,v191
mf v[224:227],a[0:3],a[116:119],v[224:227]
s_waitcnt lgkmcnt(0)
v_add_f32 v80,1.0,v80
v_add_f32 v81,1.0,v81
v_add_f32 v82,1.0,v82
v_add_f32 v83,1.0,v83
v_add_f32 v84,1.0,v84
v_add_f32 v85,1.0,v85
v_add_f32 v86,1.0,v86
v_add_f32 v87,1.0,v87
v_rcp_f32 v80,v80
mf v[208:211],a[32:35],a[112:115],v[208:211]
ds_read_b128 a[0:3],v3 offset:32768
ds_read_b128 a[4:7],v3 offset:33792
mf v[208:211],a[48:51],a[120:123],v[208:211]
ds_read_b128 a[8:11],v3 offset:34816
ds_read_b128 a[12:15],v3 offset:35840
mf v[212:215],a[52:55],a[120:123],v[212:215]
ds_read_b128 a[16:19],v3 offset:40960
ds_read_b128 a[20:23],v3 offset:41984
mf v[212:215],a[36:39],a[112:115],v[212:215]
ds_read_b128 a[24:27],v3 offset:43008
ds_read_b128 a[28:31],v3 offset:44032
mf v[216:219],a[40:43],a[112:115],v[216:219]
v_rcp_f32 v81,v81
mf v[216:219],a[56:59],a[120:123],v[216:219]
buffer_load_dwordx4 a[104:107],v2,s[32:35],s40 offen sc1
mf v[220:223],a[60:63],a[120:123],v[220:223]
v_rcp_f32 v82,v82
mf v[220:223],a[44:47],a[112:115],v[220:223]
v_rcp_f32 v83,v83
mf v[252:255],a[44:47],a[116:119],v[252:255]
buffer_load_dwordx4 a[108:111],v2,s[32:35],s40 offen offset:1024 sc1
s_add_u32 s40,s40,4096
mf v[252:255],a[60:63],a[124:127],v[252:255]
v_rcp_f32 v84,v84
mf v[248:251],a[56:59],a[124:127],v[248:251]
v_rcp_f32 v85,v85
mf v[248:251],a[40:43],a[116:119],v[248:251]
buffer_load_dwordx4 a[212:215],v2,s[24:27],s41 offen offset:1024 sc1
mf v[244:247],a[36:39],a[116:119],v[244:247]
v_rcp_f32 v86,v86
mf v[244:247],a[52:55],a[124:127],v[244:247]
v_rcp_f32 v87,v87
mf v[240:243],a[48:51],a[124:127],v[240:243]
v_mul_f32 v88,v88,v80
v_mul_f32 v89,v89,v81
v_mul_f32 v90,v90,v82
v_mul_f32 v91,v91,v83
mf v[240:243],a[32:35],a[116:119],v[240:243]
s_waitcnt lgkmcnt(0)
v_mul_f32 v92,v92,v84
v_mul_f32 v93,v93,v85
v_mul_f32 v94,v94,v86
v_mul_f32 v95,v95,v87
cvt v76,v88,v89
cvt v77,v90,v91
cvt v78,v92,v93
cvt v79,v94,v95
buffer_store_dwordx4 v[76:79],v2,s[28:31],s45 offen offset:1024 sc1
s_waitcnt vmcnt(19)
mf v[192:195],a[0:3],a[64:67],v[192:195]
ds_read_b128 a[32:35],v3 offset:36864
ds_read_b128 a[36:39],v3 offset:37888
s_waitcnt vmcnt(16)
mf v[192:195],a[16:19],a[72:75],v[192:195]
ds_read_b128 a[40:43],v3 offset:38912
ds_read_b128 a[44:47],v3 offset:39936
mf v[196:199],a[20:23],a[72:75],v[196:199]
ds_read_b128 a[48:51],v3 offset:45056
ds_read_b128 a[52:55],v3 offset:46080
mf v[196:199],a[4:7],a[64:67],v[196:199]
ds_read_b128 a[56:59],v3 offset:47104
ds_read_b128 a[60:63],v3 offset:48128
mf v[200:203],a[8:11],a[64:67],v[200:203]
mf v[200:203],a[24:27],a[72:75],v[200:203]
buffer_load_dwordx4 a[112:115],v2,s[32:35],s40 offen sc1
mf v[204:207],a[28:31],a[72:75],v[204:207]
mf v[204:207],a[12:15],a[64:67],v[204:207]
mf v[236:239],a[12:15],a[68:71],v[236:239]
buffer_load_dwordx4 a[116:119],v2,s[32:35],s40 offen offset:1024 sc1
s_add_u32 s40,s40,4096
s_waitcnt vmcnt(17)
mf v[236:239],a[28:31],a[76:79],v[236:239]
mf v[232:235],a[24:27],a[76:79],v[232:235]
mf v[232:235],a[8:11],a[68:71],v[232:235]
buffer_load_dwordx4 a[216:219],v2,s[24:27],s41 offen offset:2048 sc1
mf v[228:231],a[4:7],a[68:71],v[228:231]
mf v[228:231],a[20:23],a[76:79],v[228:231]
mf v[224:227],a[16:19],a[76:79],v[224:227]
mf v[224:227],a[0:3],a[68:71],v[224:227]
s_waitcnt lgkmcnt(0)
mf v[208:211],a[32:35],a[64:67],v[208:211]
ds_read_b128 a[0:3],v3 offset:49152
ds_read_b128 a[4:7],v3 offset:50176
mf v[208:211],a[48:51],a[72:75],v[208:211]
ds_read_b128 a[8:11],v3 offset:51200
ds_read_b128 a[12:15],v3 offset:52224
mf v[212:215],a[52:55],a[72:75],v[212:215]
ds_read_b128 a[16:19],v3 offset:57344
ds_read_b128 a[20:23],v3 offset:58368
mf v[212:215],a[36:39],a[64:67],v[212:215]
ds_read_b128 a[24:27],v3 offset:59392
ds_read_b128 a[28:31],v3 offset:60416
mf v[216:219],a[40:43],a[64:67],v[216:219]
mf v[216:219],a[56:59],a[72:75],v[216:219]
buffer_load_dwordx4 a[120:123],v2,s[32:35],s40 offen sc1
mf v[220:223],a[60:63],a[72:75],v[220:223]
mf v[220:223],a[44:47],a[64:67],v[220:223]
mf v[252:255],a[44:47],a[68:71],v[252:255]
buffer_load_dwordx4 a[124:127],v2,s[32:35],s40 offen offset:1024 sc1
s_add_u32 s40,s40,4096
mf v[252:255],a[60:63],a[76:79],v[252:255]
mf v[248:251],a[56:59],a[76:79],v[248:251]
mf v[248:251],a[40:43],a[68:71],v[248:251]
buffer_load_dwordx4 a[220:223],v2,s[24:27],s41 offen offset:3072 sc1
mf v[244:247],a[36:39],a[68:71],v[244:247]
mf v[244:247],a[52:55],a[76:79],v[244:247]
mf v[240:243],a[48:51],a[76:79],v[240:243]
mf v[240:243],a[32:35],a[68:71],v[240:243]
s_waitcnt lgkmcnt(0)
s_waitcnt vmcnt(19)
mf v[192:195],a[0:3],a[80:83],v[192:195]
ds_read_b128 a[32:35],v3 offset:53248
ds_read_b128 a[36:39],v3 offset:54272
s_waitcnt vmcnt(15)
mf v[192:195],a[16:19],a[88:91],v[192:195]
ds_read_b128 a[40:43],v3 offset:55296
ds_read_b128 a[44:47],v3 offset:56320
mf v[196:199],a[20:23],a[88:91],v[196:199]
ds_read_b128 a[48:51],v3 offset:61440
ds_read_b128 a[52:55],v3 offset:62464
mf v[196:199],a[4:7],a[80:83],v[196:199]
ds_read_b128 a[56:59],v3 offset:63488
ds_read_b128 a[60:63],v3 offset:64512
mf v[200:203],a[8:11],a[80:83],v[200:203]
mf v[200:203],a[24:27],a[88:91],v[200:203]
buffer_load_dwordx4 a[224:227],v14,s[24:27],s41 offen sc1
s_add_u32 s41,s41,163840
mf v[204:207],a[28:31],a[88:91],v[204:207]
mf v[204:207],a[12:15],a[80:83],v[204:207]
mf v[236:239],a[12:15],a[84:87],v[236:239]
s_waitcnt vmcnt(15)
mf v[236:239],a[28:31],a[92:95],v[236:239]
mf v[232:235],a[24:27],a[92:95],v[232:235]
mf v[232:235],a[8:11],a[84:87],v[232:235]
mf v[228:231],a[4:7],a[84:87],v[228:231]
mf v[228:231],a[20:23],a[92:95],v[228:231]
mf v[224:227],a[16:19],a[92:95],v[224:227]
mf v[224:227],a[0:3],a[84:87],v[224:227]
s_waitcnt lgkmcnt(0)
mf v[208:211],a[32:35],a[80:83],v[208:211]
ds_read_b128 a[0:3],v4 offset:0
ds_read_b128 a[4:7],v4 offset:1024
mf v[208:211],a[48:51],a[88:91],v[208:211]
ds_read_b128 a[8:11],v4 offset:2048
ds_read_b128 a[12:15],v4 offset:3072
mf v[212:215],a[52:55],a[88:91],v[212:215]
ds_read_b128 a[16:19],v4 offset:8192
ds_read_b128 a[20:23],v4 offset:9216
mf v[212:215],a[36:39],a[80:83],v[212:215]
ds_read_b128 a[24:27],v4 offset:10240
ds_read_b128 a[28:31],v4 offset:11264
mf v[216:219],a[40:43],a[80:83],v[216:219]
mf v[216:219],a[56:59],a[88:91],v[216:219]
buffer_load_dwordx4 a[228:231],v2,s[24:27],s41 offen sc1
mf v[220:223],a[60:63],a[88:91],v[220:223]
mf v[220:223],a[44:47],a[80:83],v[220:223]
mf v[252:255],a[44:47],a[84:87],v[252:255]
mf v[252:255],a[60:63],a[92:95],v[252:255]
mf v[248:251],a[56:59],a[92:95],v[248:251]
mf v[248:251],a[40:43],a[84:87],v[248:251]
mf v[244:247],a[36:39],a[84:87],v[244:247]
mf v[244:247],a[52:55],a[92:95],v[244:247]
mf v[240:243],a[48:51],a[92:95],v[240:243]
mf v[240:243],a[32:35],a[84:87],v[240:243]
s_waitcnt lgkmcnt(0)
s_waitcnt vmcnt(14)
mf v[192:195],a[0:3],a[96:99],v[192:195]
ds_read_b128 a[32:35],v4 offset:4096
ds_read_b128 a[36:39],v4 offset:5120
s_waitcnt vmcnt(11)
mf v[192:195],a[16:19],a[104:107],v[192:195]
ds_read_b128 a[40:43],v4 offset:6144
ds_read_b128 a[44:47],v4 offset:7168
mf v[196:199],a[20:23],a[104:107],v[196:199]
ds_read_b128 a[48:51],v4 offset:12288
ds_read_b128 a[52:55],v4 offset:13312
mf v[196:199],a[4:7],a[96:99],v[196:199]
ds_read_b128 a[56:59],v4 offset:14336
ds_read_b128 a[60:63],v4 offset:15360
mf v[200:203],a[8:11],a[96:99],v[200:203]
mf v[200:203],a[24:27],a[104:107],v[200:203]
buffer_load_dwordx4 a[232:235],v2,s[24:27],s41 offen offset:1024 sc1
mf v[204:207],a[28:31],a[104:107],v[204:207]
mf v[204:207],a[12:15],a[96:99],v[204:207]
mf v[236:239],a[12:15],a[100:103],v[236:239]
s_waitcnt vmcnt(11)
mf v[236:239],a[28:31],a[108:111],v[236:239]
mf v[232:235],a[24:27],a[108:111],v[232:235]
s_waitcnt vmcnt(9)
buffer_store_dword v5,v6,s[8:11],s46 offen sc1
mf v[232:235],a[8:11],a[100:103],v[232:235]
mf v[228:231],a[4:7],a[100:103],v[228:231]
mf v[228:231],a[20:23],a[108:111],v[228:231]
mf v[224:227],a[16:19],a[108:111],v[224:227]
mf v[224:227],a[0:3],a[100:103],v[224:227]
s_waitcnt lgkmcnt(0)
mf v[208:211],a[32:35],a[96:99],v[208:211]
ds_read_b128 a[0:3],v4 offset:16384
ds_read_b128 a[4:7],v4 offset:17408
mf v[208:211],a[48:51],a[104:107],v[208:211]
ds_read_b128 a[8:11],v4 offset:18432
ds_read_b128 a[12:15],v4 offset:19456
mf v[212:215],a[52:55],a[104:107],v[212:215]
ds_read_b128 a[16:19],v4 offset:24576
ds_read_b128 a[20:23],v4 offset:25600
mf v[212:215],a[36:39],a[96:99],v[212:215]
ds_read_b128 a[24:27],v4 offset:26624
ds_read_b128 a[28:31],v4 offset:27648
mf v[216:219],a[40:43],a[96:99],v[216:219]
mf v[216:219],a[56:59],a[104:107],v[216:219]
buffer_load_dwordx4 a[236:239],v2,s[24:27],s41 offen offset:2048 sc1
mf v[220:223],a[60:63],a[104:107],v[220:223]
mf v[220:223],a[44:47],a[96:99],v[220:223]
mf v[252:255],a[44:47],a[100:103],v[252:255]
mf v[252:255],a[60:63],a[108:111],v[252:255]
mf v[248:251],a[56:59],a[108:111],v[248:251]
mf v[248:251],a[40:43],a[100:103],v[248:251]
mf v[244:247],a[36:39],a[100:103],v[244:247]
mf v[244:247],a[52:55],a[108:111],v[244:247]
mf v[240:243],a[48:51],a[108:111],v[240:243]
mf v[240:243],a[32:35],a[100:103],v[240:243]
s_waitcnt lgkmcnt(0)
s_waitcnt vmcnt(10)
mf v[192:195],a[0:3],a[112:115],v[192:195]
ds_read_b128 a[32:35],v4 offset:20480
ds_read_b128 a[36:39],v4 offset:21504
s_waitcnt vmcnt(7)
mf v[192:195],a[16:19],a[120:123],v[192:195]
ds_read_b128 a[40:43],v4 offset:22528
ds_read_b128 a[44:47],v4 offset:23552
mf v[196:199],a[20:23],a[120:123],v[196:199]
ds_read_b128 a[48:51],v4 offset:28672
ds_read_b128 a[52:55],v4 offset:29696
mf v[196:199],a[4:7],a[112:115],v[196:199]
ds_read_b128 a[56:59],v4 offset:30720
ds_read_b128 a[60:63],v4 offset:31744
mf v[200:203],a[8:11],a[112:115],v[200:203]
mf v[200:203],a[24:27],a[120:123],v[200:203]
buffer_load_dwordx4 a[240:243],v2,s[24:27],s41 offen offset:3072 sc1
mf v[204:207],a[28:31],a[120:123],v[204:207]
mf v[204:207],a[12:15],a[112:115],v[204:207]
mf v[236:239],a[12:15],a[116:119],v[236:239]
s_waitcnt vmcnt(7)
mf v[236:239],a[28:31],a[124:127],v[236:239]
mf v[232:235],a[24:27],a[124:127],v[232:235]
mf v[232:235],a[8:11],a[116:119],v[232:235]
mf v[228:231],a[4:7],a[116:119],v[228:231]
mf v[228:231],a[20:23],a[124:127],v[228:231]
mf v[224:227],a[16:19],a[124:127],v[224:227]
mf v[224:227],a[0:3],a[116:119],v[224:227]
s_waitcnt lgkmcnt(0)
mf v[208:211],a[32:35],a[112:115],v[208:211]
mf v[208:211],a[48:51],a[120:123],v[208:211]
mf v[212:215],a[52:55],a[120:123],v[212:215]
mf v[212:215],a[36:39],a[112:115],v[212:215]
mf v[216:219],a[40:43],a[112:115],v[216:219]
mf v[216:219],a[56:59],a[120:123],v[216:219]
buffer_load_dwordx4 a[244:247],v14,s[24:27],s41 offen sc1
s_add_u32 s41,s41,163840
mf v[220:223],a[60:63],a[120:123],v[220:223]
mf v[220:223],a[44:47],a[112:115],v[220:223]
mf v[252:255],a[44:47],a[116:119],v[252:255]
mf v[252:255],a[60:63],a[124:127],v[252:255]
mf v[248:251],a[56:59],a[124:127],v[248:251]
mf v[248:251],a[40:43],a[116:119],v[248:251]
mf v[244:247],a[36:39],a[116:119],v[244:247]
mf v[244:247],a[52:55],a[124:127],v[244:247]
mf v[240:243],a[48:51],a[124:127],v[240:243]
mf v[240:243],a[32:35],a[116:119],v[240:243]
s_add_u32 s44,s44,3538944
s_add_u32 s45,s45,3538944
buffer_load_dwordx4 a[248:251],v2,s[24:27],s41 offen sc1
v_pk_mul_f32 v[20:21],v[192:193],v[192:193]
v_pk_mul_f32 v[22:23],v[194:195],v[194:195]
v_pk_mul_f32 v[24:25],v[196:197],v[196:197]
v_pk_mul_f32 v[26:27],v[198:199],v[198:199]
v_pk_fma_f32 v[20:21],v[20:21],s[48:49],v[8:9]
v_pk_fma_f32 v[22:23],v[22:23],s[48:49],v[8:9]
v_pk_fma_f32 v[24:25],v[24:25],s[48:49],v[8:9]
v_pk_fma_f32 v[26:27],v[26:27],s[48:49],v[8:9]
v_pk_mul_f32 v[20:21],v[20:21],v[192:193]
v_pk_mul_f32 v[22:23],v[22:23],v[194:195]
v_pk_mul_f32 v[24:25],v[24:25],v[196:197]
v_pk_mul_f32 v[26:27],v[26:27],v[198:199]
v_pk_mul_f32 v[28:29],v[192:193],v[208:209]
v_pk_mul_f32 v[30:31],v[194:195],v[210:211]
v_pk_mul_f32 v[32:33],v[196:197],v[212:213]
v_pk_mul_f32 v[34:35],v[198:199],v[214:215]
v_exp_f32 v20,v20
v_exp_f32 v21,v21
v_pk_mul_f32 v[40:41],v[200:201],v[200:201]
v_exp_f32 v22,v22
v_exp_f32 v23,v23
v_pk_mul_f32 v[42:43],v[202:203],v[202:203]
v_exp_f32 v24,v24
v_exp_f32 v25,v25
v_pk_mul_f32 v[44:45],v[204:205],v[204:205]
v_exp_f32 v26,v26
v_exp_f32 v27,v27
v_pk_mul_f32 v[46:47],v[206:207],v[206:207]
buffer_load_dwordx4 a[252:255],v2,s[24:27],s41 offen offset:1024 sc1
buffer_load_dwordx4 v[96:99],v2,s[24:27],s41 offen offset:2048 sc1
v_pk_fma_f32 v[40:41],v[40:41],s[48:49],v[8:9]
v_pk_fma_f32 v[42:43],v[42:43],s[48:49],v[8:9]
v_pk_fma_f32 v[44:45],v[44:45],s[48:49],v[8:9]
v_pk_fma_f32 v[46:47],v[46:47],s[48:49],v[8:9]
v_pk_mul_f32 v[40:41],v[40:41],v[200:201]
v_pk_mul_f32 v[42:43],v[42:43],v[202:203]
v_pk_mul_f32 v[44:45],v[44:45],v[204:205]
v_pk_mul_f32 v[46:47],v[46:47],v[206:207]
v_pk_mul_f32 v[48:49],v[200:201],v[216:217]
v_pk_mul_f32 v[50:51],v[202:203],v[218:219]
v_pk_mul_f32 v[52:53],v[204:205],v[220:221]
v_pk_mul_f32 v[54:55],v[206:207],v[222:223]
v_pk_add_f32 v[20:21],v[20:21],v[10:11]
v_pk_add_f32 v[22:23],v[22:23],v[10:11]
v_pk_add_f32 v[24:25],v[24:25],v[10:11]
v_pk_add_f32 v[26:27],v[26:27],v[10:11]
buffer_load_dwordx4 v[100:103],v2,s[24:27],s41 offen offset:3072 sc1
buffer_load_dwordx4 v[104:107],v14,s[24:27],s41 offen sc1
s_add_u32 s41,s41,163840
v_exp_f32 v40,v40
v_exp_f32 v41,v41
v_pk_mul_f32 v[60:61],v[224:225],v[224:225]
v_exp_f32 v42,v42
v_exp_f32 v43,v43
v_pk_mul_f32 v[62:63],v[226:227],v[226:227]
v_exp_f32 v44,v44
v_exp_f32 v45,v45
v_pk_mul_f32 v[64:65],v[228:229],v[228:229]
v_exp_f32 v46,v46
v_exp_f32 v47,v47
v_pk_mul_f32 v[66:67],v[230:231],v[230:231]
buffer_load_dwordx4 v[108:111],v2,s[24:27],s41 offen sc1
v_rcp_f32 v20,v20
v_pk_fma_f32 v[60:61],v[60:61],s[48:49],v[8:9]
v_pk_fma_f32 v[62:63],v[62:63],s[48:49],v[8:9]
v_rcp_f32 v21,v21
v_pk_fma_f32 v[64:65],v[64:65],s[48:49],v[8:9]
v_pk_fma_f32 v[66:67],v[66:67],s[48:49],v[8:9]
v_rcp_f32 v22,v22
v_pk_mul_f32 v[60:61],v[60:61],v[224:225]
v_pk_mul_f32 v[62:63],v[62:63],v[226:227]
v_rcp_f32 v23,v23
v_pk_mul_f32 v[64:65],v[64:65],v[228:229]
v_pk_mul_f32 v[66:67],v[66:67],v[230:231]
v_rcp_f32 v24,v24
v_pk_mul_f32 v[68:69],v[224:225],v[240:241]
v_pk_mul_f32 v[70:71],v[226:227],v[242:243]
v_rcp_f32 v25,v25
v_pk_mul_f32 v[72:73],v[228:229],v[244:245]
v_pk_mul_f32 v[74:75],v[230:231],v[246:247]
v_rcp_f32 v26,v26
v_pk_add_f32 v[40:41],v[40:41],v[10:11]
v_pk_add_f32 v[42:43],v[42:43],v[10:11]
v_rcp_f32 v27,v27
v_pk_add_f32 v[44:45],v[44:45],v[10:11]
v_pk_add_f32 v[46:47],v[46:47],v[10:11]
buffer_load_dwordx4 v[112:115],v2,s[24:27],s41 offen offset:1024 sc1
buffer_load_dwordx4 v[116:119],v2,s[24:27],s41 offen offset:2048 sc1
v_exp_f32 v60,v60
v_pk_mul_f32 v[28:29],v[28:29],v[20:21]
v_exp_f32 v61,v61
v_pk_mul_f32 v[30:31],v[30:31],v[22:23]
v_pk_mul_f32 v[32:33],v[32:33],v[24:25]
v_exp_f32 v62,v62
v_pk_mul_f32 v[34:35],v[34:35],v[26:27]
v_exp_f32 v63,v63
cvt v16,v28,v29
cvt v17,v30,v31
v_exp_f32 v64,v64
cvt v18,v32,v33
cvt v19,v34,v35
v_exp_f32 v65,v65
buffer_store_dwordx4 v[16:19],v2,s[28:31],s44 offen sc1
v_exp_f32 v66,v66
v_pk_mul_f32 v[80:81],v[232:233],v[232:233]
v_pk_mul_f32 v[82:83],v[234:235],v[234:235]
v_exp_f32 v67,v67
v_pk_mul_f32 v[84:85],v[236:237],v[236:237]
v_pk_mul_f32 v[86:87],v[238:239],v[238:239]
buffer_load_dwordx4 a[0:3],v2,s[24:27],s41 offen offset:3072 sc1
buffer_load_dwordx4 a[4:7],v14,s[24:27],s41 offen sc1
s_add_u32 s41,s41,163840
v_rcp_f32 v40,v40
v_pk_fma_f32 v[80:81],v[80:81],s[48:49],v[8:9]
v_pk_fma_f32 v[82:83],v[82:83],s[48:49],v[8:9]
v_rcp_f32 v41,v41
v_pk_fma_f32 v[84:85],v[84:85],s[48:49],v[8:9]
v_pk_fma_f32 v[86:87],v[86:87],s[48:49],v[8:9]
v_rcp_f32 v42,v42
v_pk_mul_f32 v[80:81],v[80:81],v[232:233]
v_pk_mul_f32 v[82:83],v[82:83],v[234:235]
v_rcp_f32 v43,v43
v_pk_mul_f32 v[84:85],v[84:85],v[236:237]
v_pk_mul_f32 v[86:87],v[86:87],v[238:239]
v_rcp_f32 v44,v44
v_pk_mul_f32 v[88:89],v[232:233],v[248:249]
v_pk_mul_f32 v[90:91],v[234:235],v[250:251]
v_rcp_f32 v45,v45
v_pk_mul_f32 v[92:93],v[236:237],v[252:253]
v_pk_mul_f32 v[94:95],v[238:239],v[254:255]
v_rcp_f32 v46,v46
v_pk_add_f32 v[60:61],v[60:61],v[10:11]
v_pk_add_f32 v[62:63],v[62:63],v[10:11]
v_rcp_f32 v47,v47
v_pk_add_f32 v[64:65],v[64:65],v[10:11]
v_pk_add_f32 v[66:67],v[66:67],v[10:11]
buffer_load_dwordx4 a[8:11],v2,s[24:27],s41 offen sc1
buffer_load_dwordx4 a[12:15],v2,s[24:27],s41 offen offset:1024 sc1
v_exp_f32 v80,v80
v_pk_mul_f32 v[48:49],v[48:49],v[40:41]
v_exp_f32 v81,v81
v_pk_mul_f32 v[50:51],v[50:51],v[42:43]
v_exp_f32 v82,v82
v_pk_mul_f32 v[52:53],v[52:53],v[44:45]
v_exp_f32 v83,v83
v_pk_mul_f32 v[54:55],v[54:55],v[46:47]
v_exp_f32 v84,v84
cvt v36,v48,v49
v_exp_f32 v85,v85
cvt v37,v50,v51
v_exp_f32 v86,v86
cvt v38,v52,v53
v_exp_f32 v87,v87
cvt v39,v54,v55
buffer_store_dwordx4 v[36:39],v2,s[28:31],s45 offen sc1
v_rcp_f32 v60,v60
v_rcp_f32 v61,v61
v_pk_add_f32 v[80:81],v[80:81],v[10:11]
v_rcp_f32 v62,v62
v_rcp_f32 v63,v63
v_pk_add_f32 v[82:83],v[82:83],v[10:11]
v_rcp_f32 v64,v64
v_rcp_f32 v65,v65
v_pk_add_f32 v[84:85],v[84:85],v[10:11]
v_rcp_f32 v66,v66
v_rcp_f32 v67,v67
v_pk_add_f32 v[86:87],v[86:87],v[10:11]
v_pk_mul_f32 v[68:69],v[68:69],v[60:61]
v_pk_mul_f32 v[70:71],v[70:71],v[62:63]
v_pk_mul_f32 v[72:73],v[72:73],v[64:65]
v_pk_mul_f32 v[74:75],v[74:75],v[66:67]
cvt v56,v68,v69
cvt v57,v70,v71
cvt v58,v72,v73
cvt v59,v74,v75
buffer_load_dword v13,v7,s[8:11],s17 offen sc1
buffer_store_dwordx4 v[56:59],v2,s[28:31],s44 offen offset:1024 sc1
v_rcp_f32 v80,v80
v_rcp_f32 v81,v81
v_rcp_f32 v82,v82
v_rcp_f32 v83,v83
v_rcp_f32 v84,v84
v_rcp_f32 v85,v85
v_rcp_f32 v86,v86
v_rcp_f32 v87,v87
v_pk_mul_f32 v[88:89],v[88:89],v[80:81]
v_pk_mul_f32 v[90:91],v[90:91],v[82:83]
v_pk_mul_f32 v[92:93],v[92:93],v[84:85]
v_pk_mul_f32 v[94:95],v[94:95],v[86:87]
cvt v76,v88,v89
cvt v77,v90,v91
cvt v78,v92,v93
cvt v79,v94,v95
buffer_store_dwordx4 v[76:79],v2,s[28:31],s45 offen offset:1024 sc1
Ldn:
s_lshr_b32 s16,s14,1
s_mul_i32 s16,s16,221184
s_add_u32 s16,s16,70320128
s_and_b32 s18,s14,1
s_lshl_b32 s18,s18,11
s_lshl_b32 s40,s3,12
s_add_u32 s18,s18,s40
s_mov_b32 s40,s18
s_add_u32 s20,s4,s16
s_addc_u32 s21,s5,0
s_mov_b32 s22,221184
s_mov_b32 s23,0x20000
s_waitcnt vmcnt(2)
v_cmp_ne_u32 vcc,1,v13
s_nop 0
s_cbranch_vccnz Lwa_slow
Lwa_go:
buffer_load_dwordx4 v[128:131],v2,s[20:23],s40 offen sc1
buffer_load_dwordx4 v[132:135],v2,s[20:23],s40 offen offset:1024 sc1
s_add_u32 s40,s40,16384
buffer_load_dwordx4 v[136:139],v2,s[20:23],s40 offen sc1
buffer_load_dwordx4 v[140:143],v2,s[20:23],s40 offen offset:1024 sc1
s_add_u32 s40,s40,16384
buffer_load_dwordx4 v[144:147],v2,s[20:23],s40 offen sc1
buffer_load_dwordx4 v[148:151],v2,s[20:23],s40 offen offset:1024 sc1
s_add_u32 s40,s40,16384
buffer_load_dwordx4 v[152:155],v2,s[20:23],s40 offen sc1
buffer_load_dwordx4 v[156:159],v2,s[20:23],s40 offen offset:1024 sc1
s_add_u32 s40,s40,16384
s_add_u32 s28,s4,65536
s_addc_u32 s29,s5,0
s_mov_b32 s30,15360
s_mov_b32 s31,0x20000
s_add_u32 s32,s4,65077248
s_addc_u32 s33,s5,0
s_mov_b32 s34,2621440
s_mov_b32 s35,0x20000
s_mov_b32 s36,s12
s_mov_b32 s37,s13
s_mov_b32 s38,2621440
s_mov_b32 s39,0x20000
s_mul_i32 s42,s15,10
s_lshl_b32 s43,s14,5
v_mov_b32 v60,0x4000000
s_mov_b32 s45,12800
v_add_u32 v52,0,v0
v_mul_u32_u24 v53,104858,v52
v_lshrrev_b32 v53,20,v53
v_mul_u32_u24 v54,10,v53
v_sub_u32 v54,v52,v54
v_mul_u32_u24 v120,336,v53
v_lshl_add_u32 v120,v54,5,v120
v_add_u32 v54,s42,v54
v_lshlrev_b32 v123,5,v54
v_lshrrev_b32 v56,5,v53
v_mul_u32_u24 v56,992,v56
v_add3_u32 v55,v56,v53,s43
v_and_b32 v56,0x78f,v55
v_bfe_u32 v57,v55,5,2
v_lshl_add_u32 v56,v57,4,v56
v_bfe_u32 v57,v55,4,1
v_lshl_add_u32 v56,v57,6,v56
v_mul_u32_u24 v56,1280,v56
v_lshl_add_u32 v56,v54,4,v56
v_lshrrev_b32 v58,6,v55
v_mul_u32_u24 v58,80,v58
v_and_b32 v126,0xfc,v54
v_bfe_u32 v57,v55,4,2
v_add3_u32 v126,v126,v58,v57
v_lshlrev_b32 v126,10,v126
v_and_b32 v58,1,v54
v_lshl_add_u32 v126,v58,9,v126
v_bfe_u32 v58,v54,1,1
v_lshl_add_u32 v126,v58,3,v126
v_and_b32 v58,15,v53
v_lshl_add_u32 v126,v58,4,v126
v_mov_b32 v8,v56
v_add_u32 v52,256,v0
v_mul_u32_u24 v53,104858,v52
v_lshrrev_b32 v53,20,v53
v_mul_u32_u24 v54,10,v53
v_sub_u32 v54,v52,v54
v_mul_u32_u24 v121,336,v53
v_lshl_add_u32 v121,v54,5,v121
v_add_u32 v54,s42,v54
v_lshlrev_b32 v124,5,v54
v_lshrrev_b32 v56,5,v53
v_mul_u32_u24 v56,992,v56
v_add3_u32 v55,v56,v53,s43
v_and_b32 v56,0x78f,v55
v_bfe_u32 v57,v55,5,2
v_lshl_add_u32 v56,v57,4,v56
v_bfe_u32 v57,v55,4,1
v_lshl_add_u32 v56,v57,6,v56
v_mul_u32_u24 v56,1280,v56
v_lshl_add_u32 v56,v54,4,v56
v_lshrrev_b32 v58,6,v55
v_mul_u32_u24 v58,80,v58
v_and_b32 v127,0xfc,v54
v_bfe_u32 v57,v55,4,2
v_add3_u32 v127,v127,v58,v57
v_lshlrev_b32 v127,10,v127
v_and_b32 v58,1,v54
v_lshl_add_u32 v127,v58,9,v127
v_bfe_u32 v58,v54,1,1
v_lshl_add_u32 v127,v58,3,v127
v_and_b32 v58,15,v53
v_lshl_add_u32 v127,v58,4,v127
v_mov_b32 v9,v56
v_add_u32 v52,512,v0
v_mul_u32_u24 v53,104858,v52
v_lshrrev_b32 v53,20,v53
v_mul_u32_u24 v54,10,v53
v_sub_u32 v54,v52,v54
v_cmp_gt_u32 vcc,640,v52
s_nop 1
v_cndmask_b32 v53,0,v53,vcc
v_cndmask_b32 v54,0,v54,vcc
v_mul_u32_u24 v122,336,v53
v_lshl_add_u32 v122,v54,5,v122
v_add_u32 v54,s42,v54
v_lshlrev_b32 v125,5,v54
v_lshrrev_b32 v56,5,v53
v_mul_u32_u24 v56,992,v56
v_add3_u32 v55,v56,v53,s43
v_and_b32 v56,0x78f,v55
v_bfe_u32 v57,v55,5,2
v_lshl_add_u32 v56,v57,4,v56
v_bfe_u32 v57,v55,4,1
v_lshl_add_u32 v56,v57,6,v56
v_mul_u32_u24 v56,1280,v56
v_lshl_add_u32 v56,v54,4,v56
v_lshrrev_b32 v58,6,v55
v_mul_u32_u24 v58,80,v58
v_and_b32 v15,0xfc,v54
v_bfe_u32 v57,v55,4,2
v_add3_u32 v15,v15,v58,v57
v_lshlrev_b32 v15,10,v15
v_and_b32 v58,1,v54
v_lshl_add_u32 v15,v58,9,v15
v_bfe_u32 v58,v54,1,1
v_lshl_add_u32 v15,v58,3,v15
v_and_b32 v58,15,v53
v_lshl_add_u32 v15,v58,4,v15
v_cndmask_b32 v10,v60,v56,vcc
v_and_b32 v52,15,v1
v_mul_u32_u24 v12,336,v52
v_lshrrev_b32 v52,4,v1
v_lshl_add_u32 v12,v52,4,v12
s_mul_i32 s46,s3,21504
v_add_u32 v12,s46,v12
s_waitcnt vmcnt(7)
mf v[192:195],a[128:131],v[128:131],0
buffer_store_dword v5,v6,s[8:11],s47 offen sc1
s_waitcnt vmcnt(6)
mf v[192:195],a[148:151],v[136:139],v[192:195]
buffer_load_dwordx4 v[160:163],v2,s[20:23],s40 offen sc1
mf v[196:199],a[152:155],v[136:139],0
buffer_load_dwordx4 v[164:167],v2,s[20:23],s40 offen offset:1024 sc1
s_add_u32 s40,s40,16384
mf v[196:199],a[132:135],v[128:131],v[196:199]
buffer_load_dwordx4 v[168:171],v2,s[20:23],s40 offen sc1
mf v[200:203],a[136:139],v[128:131],0
buffer_load_dwordx4 v[172:175],v2,s[20:23],s40 offen offset:1024 sc1
s_add_u32 s40,s40,16384
mf v[200:203],a[156:159],v[136:139],v[200:203]
buffer_load_dwordx4 a[16:19],v2,s[24:27],s41 offen offset:2048 sc1
mf v[204:207],a[160:163],v[136:139],0
buffer_load_dwordx4 a[20:23],v2,s[24:27],s41 offen offset:3072 sc1
mf v[204:207],a[140:143],v[128:131],v[204:207]
buffer_load_dwordx4 a[24:27],v14,s[24:27],s41 offen sc1
s_add_u32 s41,s41,163840
mf v[208:211],a[144:147],v[128:131],0
buffer_load_dwordx4 a[28:31],v2,s[24:27],s41 offen sc1
mf v[208:211],a[164:167],v[136:139],v[208:211]
mf v[228:231],a[144:147],v[132:135],0
buffer_load_dwordx4 v[176:179],v2,s[20:23],s40 offen sc1
s_waitcnt vmcnt(14)
mf v[228:231],a[164:167],v[140:143],v[228:231]
buffer_load_dwordx4 v[180:183],v2,s[20:23],s40 offen offset:1024 sc1
s_add_u32 s40,s40,16384
mf v[224:227],a[160:163],v[140:143],0
buffer_load_dwordx4 v[184:187],v2,s[20:23],s40 offen sc1
mf v[224:227],a[140:143],v[132:135],v[224:227]
buffer_load_dwordx4 v[188:191],v2,s[20:23],s40 offen offset:1024 sc1
s_add_u32 s40,s40,16384
mf v[220:223],a[136:139],v[132:135],0
buffer_load_dwordx4 a[32:35],v2,s[24:27],s41 offen offset:1024 sc1
mf v[220:223],a[156:159],v[140:143],v[220:223]
buffer_load_dwordx4 a[36:39],v2,s[24:27],s41 offen offset:2048 sc1
mf v[216:219],a[152:155],v[140:143],0
buffer_load_dwordx4 a[40:43],v2,s[24:27],s41 offen offset:3072 sc1
mf v[216:219],a[132:135],v[132:135],v[216:219]
buffer_load_dwordx4 a[44:47],v14,s[24:27],s41 offen sc1
s_add_u32 s41,s41,163840
mf v[212:215],a[128:131],v[132:135],0
buffer_load_dwordx4 a[48:51],v2,s[24:27],s41 offen sc1
mf v[212:215],a[148:151],v[140:143],v[212:215]
s_waitcnt vmcnt(21)
mf v[192:195],a[168:171],v[144:147],v[192:195]
buffer_load_dwordx4 v[128:131],v2,s[20:23],s40 offen sc1
s_waitcnt vmcnt(20)
mf v[192:195],a[188:191],v[152:155],v[192:195]
buffer_load_dwordx4 v[132:135],v2,s[20:23],s40 offen offset:1024 sc1
s_add_u32 s40,s40,16384
mf v[196:199],a[192:195],v[152:155],v[196:199]
buffer_load_dwordx4 a[52:55],v2,s[24:27],s41 offen offset:1024 sc1
mf v[196:199],a[172:175],v[144:147],v[196:199]
mf v[200:203],a[176:179],v[144:147],v[200:203]
buffer_load_dwordx4 a[56:59],v2,s[24:27],s41 offen offset:2048 sc1
mf v[200:203],a[196:199],v[152:155],v[200:203]
buffer_load_dwordx4 a[60:63],v2,s[24:27],s41 offen offset:3072 sc1
mf v[204:207],a[200:203],v[152:155],v[204:207]
mf v[204:207],a[180:183],v[144:147],v[204:207]
buffer_load_dwordx4 a[64:67],v14,s[24:27],s41 offen sc1
s_add_u32 s41,s41,163840
mf v[208:211],a[184:187],v[144:147],v[208:211]
buffer_load_dwordx4 a[68:71],v2,s[24:27],s41 offen sc1
mf v[208:211],a[204:207],v[152:155],v[208:211]
mf v[228:231],a[184:187],v[148:151],v[228:231]
buffer_load_dwordx4 v[136:139],v2,s[20:23],s40 offen sc1
s_waitcnt vmcnt(26)
mf v[228:231],a[204:207],v[156:159],v[228:231]
buffer_load_dwordx4 v[140:143],v2,s[20:23],s40 offen offset:1024 sc1
s_add_u32 s40,s40,16384
mf v[224:227],a[200:203],v[156:159],v[224:227]
mf v[224:227],a[180:183],v[148:151],v[224:227]
buffer_load_dwordx4 a[72:75],v2,s[24:27],s41 offen offset:1024 sc1
mf v[220:223],a[176:179],v[148:151],v[220:223]
mf v[220:223],a[196:199],v[156:159],v[220:223]
buffer_load_dwordx4 a[76:79],v2,s[24:27],s41 offen offset:2048 sc1
mf v[216:219],a[192:195],v[156:159],v[216:219]
buffer_load_dwordx4 a[80:83],v2,s[24:27],s41 offen offset:3072 sc1
mf v[216:219],a[172:175],v[148:151],v[216:219]
mf v[212:215],a[168:171],v[148:151],v[212:215]
buffer_load_dwordx4 a[84:87],v14,s[24:27],s41 offen sc1
s_add_u32 s41,s41,163840
mf v[212:215],a[188:191],v[156:159],v[212:215]
s_waitcnt vmcnt(29)
mf v[192:195],a[208:211],v[160:163],v[192:195]
buffer_load_dwordx4 v[144:147],v2,s[20:23],s40 offen sc1
s_waitcnt vmcnt(28)
mf v[192:195],a[228:231],v[168:171],v[192:195]
buffer_load_dwordx4 v[148:151],v2,s[20:23],s40 offen offset:1024 sc1
s_add_u32 s40,s40,16384
mf v[196:199],a[232:235],v[168:171],v[196:199]
buffer_load_dwordx4 a[88:91],v2,s[24:27],s41 offen sc1
mf v[196:199],a[212:215],v[160:163],v[196:199]
mf v[200:203],a[216:219],v[160:163],v[200:203]
buffer_load_dwordx4 a[92:95],v2,s[24:27],s41 offen offset:1024 sc1
mf v[200:203],a[236:239],v[168:171],v[200:203]
buffer_load_dwordx4 a[96:99],v2,s[24:27],s41 offen offset:2048 sc1
mf v[204:207],a[240:243],v[168:171],v[204:207]
mf v[204:207],a[220:223],v[160:163],v[204:207]
buffer_load_dwordx4 a[100:103],v2,s[24:27],s41 offen offset:3072 sc1
mf v[208:211],a[224:227],v[160:163],v[208:211]
buffer_load_dwordx4 a[104:107],v14,s[24:27],s41 offen sc1
s_add_u32 s41,s41,163840
mf v[208:211],a[244:247],v[168:171],v[208:211]
mf v[228:231],a[224:227],v[164:167],v[228:231]
buffer_load_dwordx4 v[152:155],v2,s[20:23],s40 offen sc1
s_waitcnt vmcnt(34)
mf v[228:231],a[244:247],v[172:175],v[228:231]
buffer_load_dwordx4 v[156:159],v2,s[20:23],s40 offen offset:1024 sc1
s_add_u32 s40,s40,16384
mf v[224:227],a[240:243],v[172:175],v[224:227]
buffer_load_dwordx4 a[108:111],v2,s[24:27],s41 offen sc1
mf v[224:227],a[220:223],v[164:167],v[224:227]
mf v[220:223],a[216:219],v[164:167],v[220:223]
buffer_load_dwordx4 a[112:115],v2,s[24:27],s41 offen offset:1024 sc1
mf v[220:223],a[236:239],v[172:175],v[220:223]
buffer_load_dwordx4 a[116:119],v2,s[24:27],s41 offen offset:2048 sc1
mf v[216:219],a[232:235],v[172:175],v[216:219]
mf v[216:219],a[212:215],v[164:167],v[216:219]
buffer_load_dwordx4 a[120:123],v2,s[24:27],s41 offen offset:3072 sc1
mf v[212:215],a[208:211],v[164:167],v[212:215]
buffer_load_dwordx4 a[124:127],v14,s[24:27],s41 offen sc1
s_add_u32 s41,s41,163840
mf v[212:215],a[228:231],v[172:175],v[212:215]
s_waitcnt vmcnt(35)
mf v[192:195],a[248:251],v[176:179],v[192:195]
buffer_load_dwordx4 v[160:163],v2,s[20:23],s40 offen sc1
s_waitcnt vmcnt(34)
mf v[192:195],v[108:111],v[184:187],v[192:195]
mf v[196:199],v[112:115],v[184:187],v[196:199]
mf v[196:199],a[252:255],v[176:179],v[196:199]
mf v[200:203],v[96:99],v[176:179],v[200:203]
mf v[200:203],v[116:119],v[184:187],v[200:203]
buffer_load_dwordx4 v[164:167],v2,s[20:23],s40 offen offset:1024 sc1
s_add_u32 s40,s40,16384
mf v[204:207],a[0:3],v[184:187],v[204:207]
mf v[204:207],v[100:103],v[176:179],v[204:207]
mf v[208:211],v[104:107],v[176:179],v[208:211]
mf v[208:211],a[4:7],v[184:187],v[208:211]
mf v[228:231],v[104:107],v[180:183],v[228:231]
buffer_load_dwordx4 v[168:171],v2,s[20:23],s40 offen sc1
s_waitcnt vmcnt(35)
mf v[228:231],a[4:7],v[188:191],v[228:231]
mf v[224:227],a[0:3],v[188:191],v[224:227]
mf v[224:227],v[100:103],v[180:183],v[224:227]
mf v[220:223],v[96:99],v[180:183],v[220:223]
mf v[220:223],v[116:119],v[188:191],v[220:223]
buffer_load_dwordx4 v[172:175],v2,s[20:23],s40 offen offset:1024 sc1
s_add_u32 s20,s20,3538944
s_addc_u32 s21,s21,0
s_mov_b32 s40,s18
mf v[216:219],v[112:115],v[188:191],v[216:219]
mf v[216:219],a[252:255],v[180:183],v[216:219]
mf v[212:215],a[248:251],v[180:183],v[212:215]
mf v[212:215],v[108:111],v[188:191],v[212:215]
s_waitcnt vmcnt(30)
mf v[192:195],a[8:11],v[128:131],v[192:195]
s_add_u32 s17,s17,4
buffer_load_dword v13,v7,s[8:11],s17 offen sc1
s_waitcnt vmcnt(24)
mf v[192:195],a[28:31],v[136:139],v[192:195]
mf v[196:199],a[32:35],v[136:139],v[196:199]
mf v[196:199],a[12:15],v[128:131],v[196:199]
mf v[200:203],a[16:19],v[128:131],v[200:203]
mf v[200:203],a[36:39],v[136:139],v[200:203]
mf v[204:207],a[40:43],v[136:139],v[204:207]
mf v[204:207],a[20:23],v[128:131],v[204:207]
mf v[208:211],a[24:27],v[128:131],v[208:211]
mf v[208:211],a[44:47],v[136:139],v[208:211]
mf v[228:231],a[24:27],v[132:135],v[228:231]
s_waitcnt vmcnt(23)
mf v[228:231],a[44:47],v[140:143],v[228:231]
mf v[224:227],a[40:43],v[140:143],v[224:227]
mf v[224:227],a[20:23],v[132:135],v[224:227]
mf v[220:223],a[16:19],v[132:135],v[220:223]
mf v[220:223],a[36:39],v[140:143],v[220:223]
mf v[216:219],a[32:35],v[140:143],v[216:219]
mf v[216:219],a[12:15],v[132:135],v[216:219]
mf v[212:215],a[8:11],v[132:135],v[212:215]
mf v[212:215],a[28:31],v[140:143],v[212:215]
s_waitcnt vmcnt(18)
mf v[192:195],a[48:51],v[144:147],v[192:195]
s_waitcnt vmcnt(11)
mf v[192:195],a[68:71],v[152:155],v[192:195]
mf v[196:199],a[72:75],v[152:155],v[196:199]
mf v[196:199],a[52:55],v[144:147],v[196:199]
mf v[200:203],a[56:59],v[144:147],v[200:203]
mf v[200:203],a[76:79],v[152:155],v[200:203]
mf v[204:207],a[80:83],v[152:155],v[204:207]
mf v[204:207],a[60:63],v[144:147],v[204:207]
mf v[208:211],a[64:67],v[144:147],v[208:211]
mf v[208:211],a[84:87],v[152:155],v[208:211]
s_waitcnt vmcnt(0)
v_cmp_ne_u32 vcc,1,v13
s_nop 0
s_cbranch_vccnz Lwb_slow
Lwb_go:
mf v[228:231],a[64:67],v[148:151],v[228:231]
buffer_load_dwordx4 v[176:179],v2,s[20:23],s40 offen sc1
mf v[228:231],a[84:87],v[156:159],v[228:231]
mf v[224:227],a[80:83],v[156:159],v[224:227]
buffer_load_dwordx4 v[180:183],v2,s[20:23],s40 offen offset:1024 sc1
s_add_u32 s40,s40,16384
mf v[224:227],a[60:63],v[148:151],v[224:227]
mf v[220:223],a[56:59],v[148:151],v[220:223]
mf v[220:223],a[76:79],v[156:159],v[220:223]
buffer_load_dwordx4 v[184:187],v2,s[20:23],s40 offen sc1
mf v[216:219],a[72:75],v[156:159],v[216:219]
mf v[216:219],a[52:55],v[148:151],v[216:219]
buffer_load_dwordx4 v[188:191],v2,s[20:23],s40 offen offset:1024 sc1
s_add_u32 s40,s40,16384
mf v[212:215],a[48:51],v[148:151],v[212:215]
mf v[212:215],a[68:71],v[156:159],v[212:215]
mf v[192:195],a[88:91],v[160:163],v[192:195]
buffer_load_dwordx4 v[128:131],v2,s[20:23],s40 offen sc1
mf v[192:195],a[108:111],v[168:171],v[192:195]
mf v[196:199],a[112:115],v[168:171],v[196:199]
buffer_load_dwordx4 v[132:135],v2,s[20:23],s40 offen offset:1024 sc1
s_add_u32 s40,s40,16384
mf v[196:199],a[92:95],v[160:163],v[196:199]
mf v[200:203],a[96:99],v[160:163],v[200:203]
mf v[200:203],a[116:119],v[168:171],v[200:203]
buffer_load_dwordx4 v[136:139],v2,s[20:23],s40 offen sc1
mf v[204:207],a[120:123],v[168:171],v[204:207]
mf v[204:207],a[100:103],v[160:163],v[204:207]
buffer_load_dwordx4 v[140:143],v2,s[20:23],s40 offen offset:1024 sc1
s_add_u32 s40,s40,16384
mf v[208:211],a[104:107],v[160:163],v[208:211]
mf v[208:211],a[124:127],v[168:171],v[208:211]
mf v[228:231],a[104:107],v[164:167],v[228:231]
buffer_load_dwordx4 v[144:147],v2,s[20:23],s40 offen sc1
mf v[228:231],a[124:127],v[172:175],v[228:231]
mf v[224:227],a[120:123],v[172:175],v[224:227]
buffer_load_dwordx4 v[148:151],v2,s[20:23],s40 offen offset:1024 sc1
s_add_u32 s40,s40,16384
mf v[224:227],a[100:103],v[164:167],v[224:227]
mf v[220:223],a[96:99],v[164:167],v[220:223]
mf v[220:223],a[116:119],v[172:175],v[220:223]
buffer_load_dwordx4 v[152:155],v2,s[20:23],s40 offen sc1
mf v[216:219],a[112:115],v[172:175],v[216:219]
mf v[216:219],a[92:95],v[164:167],v[216:219]
buffer_load_dwordx4 v[156:159],v2,s[20:23],s40 offen offset:1024 sc1
s_add_u32 s40,s40,16384
mf v[212:215],a[88:91],v[164:167],v[212:215]
mf v[212:215],a[108:111],v[172:175],v[212:215]
s_waitcnt vmcnt(11)
mf v[232:235],a[128:131],v[176:179],0
buffer_load_dwordx4 v[160:163],v2,s[20:23],s40 offen sc1
s_waitcnt vmcnt(10)
mf v[232:235],a[148:151],v[184:187],v[232:235]
mf v[236:239],a[152:155],v[184:187],0
mf v[236:239],a[132:135],v[176:179],v[236:239]
mf v[240:243],a[136:139],v[176:179],0
mf v[240:243],a[156:159],v[184:187],v[240:243]
buffer_load_dwordx4 v[164:167],v2,s[20:23],s40 offen offset:1024 sc1
s_add_u32 s40,s40,16384
mf v[244:247],a[160:163],v[184:187],0
mf v[244:247],a[140:143],v[176:179],v[244:247]
mf v[248:251],a[144:147],v[176:179],0
mf v[248:251],a[164:167],v[184:187],v[248:251]
s_barrier
mf v[76:79],a[144:147],v[180:183],0
buffer_load_dwordx4 v[168:171],v2,s[20:23],s40 offen sc1
ds_write_b128 v12,v[192:195] offset:0
s_waitcnt vmcnt(11)
mf v[76:79],a[164:167],v[188:191],v[76:79]
mf v[72:75],a[160:163],v[188:191],0
buffer_load_dwordx4 v[172:175],v2,s[20:23],s40 offen offset:1024 sc1
s_add_u32 s40,s40,16384
mf v[72:75],a[140:143],v[180:183],v[72:75]
mf v[68:71],a[136:139],v[180:183],0
buffer_load_dwordx4 v[16:19],v123,s[28:31],s45 offen sc1
mf v[68:71],a[156:159],v[188:191],v[68:71]
ds_write_b128 v12,v[196:199] offset:64
mf v[64:67],a[152:155],v[188:191],0
buffer_load_dwordx4 v[20:23],v123,s[28:31],s45 offen offset:16 sc1
mf v[64:67],a[132:135],v[180:183],v[64:67]
mf v[252:255],a[128:131],v[180:183],0
buffer_load_dwordx2 v[40:41],v126,s[32:35],0 offen sc1
mf v[252:255],a[148:151],v[188:191],v[252:255]
s_waitcnt vmcnt(14)
mf v[232:235],a[168:171],v[128:131],v[232:235]
buffer_load_dwordx4 v[176:179],v2,s[20:23],s40 offen sc1
ds_write_b128 v12,v[200:203] offset:128
s_waitcnt vmcnt(13)
mf v[232:235],a[188:191],v[136:139],v[232:235]
mf v[236:239],a[192:195],v[136:139],v[236:239]
buffer_load_dwordx4 v[180:183],v2,s[20:23],s40 offen offset:1024 sc1
s_add_u32 s40,s40,16384
mf v[236:239],a[172:175],v[128:131],v[236:239]
mf v[240:243],a[176:179],v[128:131],v[240:243]
buffer_load_dwordx2 v[42:43],v126,s[32:35],0 offen offset:256 sc1
mf v[240:243],a[196:199],v[136:139],v[240:243]
ds_write_b128 v12,v[204:207] offset:192
mf v[244:247],a[200:203],v[136:139],v[244:247]
buffer_load_dwordx4 v[24:27],v124,s[28:31],s45 offen sc1
mf v[244:247],a[180:183],v[128:131],v[244:247]
mf v[248:251],a[184:187],v[128:131],v[248:251]
buffer_load_dwordx4 v[28:31],v124,s[28:31],s45 offen offset:16 sc1
mf v[248:251],a[204:207],v[136:139],v[248:251]
mf v[76:79],a[184:187],v[132:135],v[76:79]
buffer_load_dwordx4 v[184:187],v2,s[20:23],s40 offen sc1
ds_write_b128 v12,v[208:211] offset:256
s_waitcnt vmcnt(17)
mf v[76:79],a[204:207],v[140:143],v[76:79]
mf v[72:75],a[200:203],v[140:143],v[72:75]
buffer_load_dwordx4 v[188:191],v2,s[20:23],s40 offen offset:1024 sc1
s_add_u32 s40,s40,16384
mf v[72:75],a[180:183],v[132:135],v[72:75]
mf v[68:71],a[176:179],v[132:135],v[68:71]
buffer_load_dwordx2 v[44:45],v127,s[32:35],0 offen sc1
mf v[68:71],a[196:199],v[140:143],v[68:71]
ds_write_b128 v12,v[212:215] offset:5376
mf v[64:67],a[192:195],v[140:143],v[64:67]
buffer_load_dwordx2 v[46:47],v127,s[32:35],0 offen offset:256 sc1
mf v[64:67],a[172:175],v[132:135],v[64:67]
mf v[252:255],a[168:171],v[132:135],v[252:255]
buffer_load_dwordx4 v[32:35],v125,s[28:31],s45 offen sc1
mf v[252:255],a[188:191],v[140:143],v[252:255]
s_waitcnt vmcnt(20)
mf v[232:235],a[208:211],v[144:147],v[232:235]
buffer_load_dwordx4 v[128:131],v2,s[20:23],s40 offen sc1
ds_write_b128 v12,v[216:219] offset:5440
s_waitcnt vmcnt(19)
mf v[232:235],a[228:231],v[152:155],v[232:235]
mf v[236:239],a[232:235],v[152:155],v[236:239]
buffer_load_dwordx4 v[132:135],v2,s[20:23],s40 offen offset:1024 sc1
s_add_u32 s40,s40,16384
mf v[236:239],a[212:215],v[144:147],v[236:239]
mf v[240:243],a[216:219],v[144:147],v[240:243]
buffer_load_dwordx4 v[36:39],v125,s[28:31],s45 offen offset:16 sc1
mf v[240:243],a[236:239],v[152:155],v[240:243]
ds_write_b128 v12,v[220:223] offset:5504
mf v[244:247],a[240:243],v[152:155],v[244:247]
buffer_load_dwordx2 v[48:49],v15,s[32:35],0 offen sc1
mf v[244:247],a[220:223],v[144:147],v[244:247]
mf v[248:251],a[224:227],v[144:147],v[248:251]
buffer_load_dwordx2 v[50:51],v15,s[32:35],0 offen offset:256 sc1
mf v[248:251],a[244:247],v[152:155],v[248:251]
mf v[76:79],a[224:227],v[148:151],v[76:79]
buffer_load_dwordx4 v[136:139],v2,s[20:23],s40 offen sc1
ds_write_b128 v12,v[224:227] offset:5568
s_waitcnt vmcnt(23)
mf v[76:79],a[244:247],v[156:159],v[76:79]
mf v[72:75],a[240:243],v[156:159],v[72:75]
mf v[72:75],a[220:223],v[148:151],v[72:75]
mf v[68:71],a[216:219],v[148:151],v[68:71]
mf v[68:71],a[236:239],v[156:159],v[68:71]
buffer_load_dwordx4 v[140:143],v2,s[20:23],s40 offen offset:1024 sc1
s_add_u32 s40,s40,16384
mf v[64:67],a[232:235],v[156:159],v[64:67]
ds_write_b128 v12,v[228:231] offset:5632
mf v[64:67],a[212:215],v[148:151],v[64:67]
mf v[252:255],a[208:211],v[148:151],v[252:255]
mf v[252:255],a[228:231],v[156:159],v[252:255]
s_waitcnt vmcnt(23)
mf v[232:235],a[248:251],v[160:163],v[232:235]
buffer_load_dwordx4 v[144:147],v2,s[20:23],s40 offen sc1
s_waitcnt vmcnt(22)
mf v[232:235],v[108:111],v[168:171],v[232:235]
mf v[236:239],v[112:115],v[168:171],v[236:239]
mf v[236:239],a[252:255],v[160:163],v[236:239]
mf v[240:243],v[96:99],v[160:163],v[240:243]
mf v[240:243],v[116:119],v[168:171],v[240:243]
buffer_load_dwordx4 v[148:151],v2,s[20:23],s40 offen offset:1024 sc1
s_add_u32 s40,s40,16384
mf v[244:247],a[0:3],v[168:171],v[244:247]
mf v[244:247],v[100:103],v[160:163],v[244:247]
mf v[248:251],v[104:107],v[160:163],v[248:251]
s_waitcnt lgkmcnt(0)
s_barrier
mf v[248:251],a[4:7],v[168:171],v[248:251]
mf v[76:79],v[104:107],v[164:167],v[76:79]
buffer_load_dwordx4 v[152:155],v2,s[20:23],s40 offen sc1
s_waitcnt vmcnt(23)
mf v[76:79],a[4:7],v[172:175],v[76:79]
ds_read_b128 v[192:195],v120 offset:0
ds_read_b128 v[196:199],v120 offset:16
mf v[72:75],a[0:3],v[172:175],v[72:75]
ds_read_b128 v[200:203],v120 offset:21504
ds_read_b128 v[204:207],v120 offset:21520
mf v[72:75],v[100:103],v[164:167],v[72:75]
mf v[68:71],v[96:99],v[164:167],v[68:71]
mf v[68:71],v[116:119],v[172:175],v[68:71]
buffer_load_dwordx4 v[156:159],v2,s[20:23],s40 offen offset:1024 sc1
s_add_u32 s40,s40,16384
mf v[64:67],v[112:115],v[172:175],v[64:67]
ds_read_b128 v[208:211],v120 offset:43008
ds_read_b128 v[212:215],v120 offset:43024
mf v[64:67],a[252:255],v[164:167],v[64:67]
ds_read_b128 v[216:219],v120 offset:64512
ds_read_b128 v[220:223],v120 offset:64528
mf v[252:255],a[248:251],v[164:167],v[252:255]
mf v[252:255],v[108:111],v[172:175],v[252:255]
s_waitcnt vmcnt(20)
mf v[232:235],a[8:11],v[176:179],v[232:235]
s_waitcnt vmcnt(15)
mf v[232:235],a[28:31],v[184:187],v[232:235]
mf v[236:239],a[32:35],v[184:187],v[236:239]
mf v[236:239],a[12:15],v[176:179],v[236:239]
mf v[240:243],a[16:19],v[176:179],v[240:243]
mf v[240:243],a[36:39],v[184:187],v[240:243]
mf v[244:247],a[40:43],v[184:187],v[244:247]
mf v[244:247],a[20:23],v[176:179],v[244:247]
mf v[248:251],a[24:27],v[176:179],v[248:251]
mf v[248:251],a[44:47],v[184:187],v[248:251]
mf v[76:79],a[24:27],v[180:183],v[76:79]
s_waitcnt lgkmcnt(5)
v_add_f32 v192,v192,v200
v_add_f32 v193,v193,v201
s_waitcnt vmcnt(14)
mf v[76:79],a[44:47],v[188:191],v[76:79]
mf v[72:75],a[40:43],v[188:191],v[72:75]
v_add_f32 v194,v194,v202
v_add_f32 v195,v195,v203
mf v[72:75],a[20:23],v[180:183],v[72:75]
mf v[68:71],a[16:19],v[180:183],v[68:71]
s_waitcnt lgkmcnt(4)
v_add_f32 v196,v196,v204
v_add_f32 v197,v197,v205
mf v[68:71],a[36:39],v[188:191],v[68:71]
mf v[64:67],a[32:35],v[188:191],v[64:67]
v_add_f32 v198,v198,v206
v_add_f32 v199,v199,v207
mf v[64:67],a[12:15],v[180:183],v[64:67]
mf v[252:255],a[8:11],v[180:183],v[252:255]
s_waitcnt lgkmcnt(1)
v_add_f32 v208,v208,v216
mf v[252:255],a[28:31],v[188:191],v[252:255]
s_waitcnt vmcnt(10)
mf v[232:235],a[48:51],v[128:131],v[232:235]
v_add_f32 v209,v209,v217
v_add_f32 v210,v210,v218
s_waitcnt vmcnt(5)
mf v[232:235],a[68:71],v[136:139],v[232:235]
mf v[236:239],a[72:75],v[136:139],v[236:239]
v_add_f32 v211,v211,v219
s_waitcnt lgkmcnt(0)
v_add_f32 v212,v212,v220
mf v[236:239],a[52:55],v[128:131],v[236:239]
mf v[240:243],a[56:59],v[128:131],v[240:243]
v_add_f32 v213,v213,v221
v_add_f32 v214,v214,v222
mf v[240:243],a[76:79],v[136:139],v[240:243]
mf v[244:247],a[80:83],v[136:139],v[244:247]
v_add_f32 v215,v215,v223
v_lshlrev_b32 v200,16,v40
mf v[244:247],a[60:63],v[128:131],v[244:247]
mf v[248:251],a[64:67],v[128:131],v[248:251]
v_and_b32 v201,0xffff0000,v40
mf v[248:251],a[84:87],v[136:139],v[248:251]
mf v[76:79],a[64:67],v[132:135],v[76:79]
v_lshlrev_b32 v202,16,v41
v_and_b32 v203,0xffff0000,v41
s_waitcnt vmcnt(4)
mf v[76:79],a[84:87],v[140:143],v[76:79]
mf v[72:75],a[80:83],v[140:143],v[72:75]
v_lshlrev_b32 v204,16,v42
v_and_b32 v205,0xffff0000,v42
mf v[72:75],a[60:63],v[132:135],v[72:75]
mf v[68:71],a[56:59],v[132:135],v[68:71]
v_lshlrev_b32 v206,16,v43
v_and_b32 v207,0xffff0000,v43
mf v[68:71],a[76:79],v[140:143],v[68:71]
mf v[64:67],a[72:75],v[140:143],v[64:67]
v_add_f32 v192,v192,v208
v_add_f32 v193,v193,v209
mf v[64:67],a[52:55],v[132:135],v[64:67]
mf v[252:255],a[48:51],v[132:135],v[252:255]
v_add_f32 v194,v194,v210
mf v[252:255],a[68:71],v[140:143],v[252:255]
s_waitcnt vmcnt(3)
mf v[232:235],a[88:91],v[144:147],v[232:235]
v_add_f32 v195,v195,v211
v_add_f32 v196,v196,v212
s_waitcnt vmcnt(1)
mf v[232:235],a[108:111],v[152:155],v[232:235]
mf v[236:239],a[112:115],v[152:155],v[236:239]
v_add_f32 v197,v197,v213
v_add_f32 v198,v198,v214
mf v[236:239],a[92:95],v[144:147],v[236:239]
mf v[240:243],a[96:99],v[144:147],v[240:243]
v_add_f32 v199,v199,v215
v_fmac_f32 v200,v192,v16
mf v[240:243],a[116:119],v[152:155],v[240:243]
mf v[244:247],a[120:123],v[152:155],v[244:247]
v_fmac_f32 v201,v193,v17
v_fmac_f32 v202,v194,v18
mf v[244:247],a[100:103],v[144:147],v[244:247]
mf v[248:251],a[104:107],v[144:147],v[248:251]
v_fmac_f32 v203,v195,v19
mf v[248:251],a[124:127],v[152:155],v[248:251]
mf v[76:79],a[104:107],v[148:151],v[76:79]
v_fmac_f32 v204,v196,v20
v_fmac_f32 v205,v197,v21
s_waitcnt vmcnt(0)
mf v[76:79],a[124:127],v[156:159],v[76:79]
mf v[72:75],a[120:123],v[156:159],v[72:75]
v_fmac_f32 v206,v198,v22
v_fmac_f32 v207,v199,v23
mf v[72:75],a[100:103],v[148:151],v[72:75]
mf v[68:71],a[96:99],v[148:151],v[68:71]
cvt v208,v200,v201
cvt v209,v202,v203
mf v[68:71],a[116:119],v[156:159],v[68:71]
mf v[64:67],a[112:115],v[156:159],v[64:67]
cvt v210,v204,v205
cvt v211,v206,v207
mf v[64:67],a[92:95],v[148:151],v[64:67]
mf v[252:255],a[88:91],v[148:151],v[252:255]
buffer_store_dwordx4 v[208:211],v8,s[36:39],0 offen
mf v[252:255],a[108:111],v[156:159],v[252:255]
ds_write_b128 v12,v[232:235] offset:10752
ds_write_b128 v12,v[236:239] offset:10816
ds_write_b128 v12,v[240:243] offset:10880
ds_write_b128 v12,v[244:247] offset:10944
ds_write_b128 v12,v[248:251] offset:11008
s_nop 2
ds_write_b128 v12,v[252:255] offset:16128
ds_write_b128 v12,v[64:67] offset:16192
ds_write_b128 v12,v[68:71] offset:16256
ds_write_b128 v12,v[72:75] offset:16320
ds_write_b128 v12,v[76:79] offset:16384
s_waitcnt lgkmcnt(0)
s_barrier
ds_read_b128 v[128:131],v121 offset:0
ds_read_b128 v[132:135],v121 offset:16
ds_read_b128 v[136:139],v121 offset:21504
ds_read_b128 v[140:143],v121 offset:21520
ds_read_b128 v[144:147],v121 offset:43008
ds_read_b128 v[148:151],v121 offset:43024
ds_read_b128 v[152:155],v121 offset:64512
ds_read_b128 v[156:159],v121 offset:64528
s_waitcnt lgkmcnt(4)
ds_read_b128 v[160:163],v122 offset:0
ds_read_b128 v[164:167],v122 offset:16
ds_read_b128 v[168:171],v122 offset:21504
ds_read_b128 v[172:175],v122 offset:21520
ds_read_b128 v[176:179],v122 offset:43008
ds_read_b128 v[180:183],v122 offset:43024
ds_read_b128 v[184:187],v122 offset:64512
ds_read_b128 v[188:191],v122 offset:64528
v_pk_add_f32 v[128:129],v[128:129],v[136:137]
s_waitcnt lgkmcnt(9)
v_pk_add_f32 v[144:145],v[144:145],v[152:153]
v_pk_add_f32 v[130:131],v[130:131],v[138:139]
v_pk_add_f32 v[146:147],v[146:147],v[154:155]
v_pk_add_f32 v[132:133],v[132:133],v[140:141]
s_waitcnt lgkmcnt(8)
v_pk_add_f32 v[148:149],v[148:149],v[156:157]
v_pk_add_f32 v[134:135],v[134:135],v[142:143]
v_pk_add_f32 v[150:151],v[150:151],v[158:159]
v_lshlrev_b32 v136,16,v44
v_and_b32 v137,0xffff0000,v44
v_lshlrev_b32 v138,16,v45
v_and_b32 v139,0xffff0000,v45
v_lshlrev_b32 v140,16,v46
v_and_b32 v141,0xffff0000,v46
v_lshlrev_b32 v142,16,v47
v_and_b32 v143,0xffff0000,v47
v_pk_add_f32 v[128:129],v[128:129],v[144:145]
v_pk_add_f32 v[130:131],v[130:131],v[146:147]
v_pk_add_f32 v[132:133],v[132:133],v[148:149]
v_pk_add_f32 v[134:135],v[134:135],v[150:151]
v_pk_fma_f32 v[136:137],v[128:129],v[24:25],v[136:137]
v_pk_fma_f32 v[138:139],v[130:131],v[26:27],v[138:139]
v_pk_fma_f32 v[140:141],v[132:133],v[28:29],v[140:141]
v_pk_fma_f32 v[142:143],v[134:135],v[30:31],v[142:143]
cvt v144,v136,v137
cvt v145,v138,v139
cvt v146,v140,v141
cvt v147,v142,v143
buffer_store_dwordx4 v[144:147],v9,s[36:39],0 offen
s_waitcnt lgkmcnt(5)
v_pk_add_f32 v[160:161],v[160:161],v[168:169]
s_waitcnt lgkmcnt(1)
v_pk_add_f32 v[176:177],v[176:177],v[184:185]
v_pk_add_f32 v[162:163],v[162:163],v[170:171]
v_pk_add_f32 v[178:179],v[178:179],v[186:187]
v_pk_add_f32 v[164:165],v[164:165],v[172:173]
s_waitcnt lgkmcnt(0)
v_pk_add_f32 v[180:181],v[180:181],v[188:189]
v_pk_add_f32 v[166:167],v[166:167],v[174:175]
v_pk_add_f32 v[182:183],v[182:183],v[190:191]
v_lshlrev_b32 v168,16,v48
v_and_b32 v169,0xffff0000,v48
v_lshlrev_b32 v170,16,v49
v_and_b32 v171,0xffff0000,v49
v_lshlrev_b32 v172,16,v50
v_and_b32 v173,0xffff0000,v50
v_lshlrev_b32 v174,16,v51
v_and_b32 v175,0xffff0000,v51
v_pk_add_f32 v[160:161],v[160:161],v[176:177]
v_pk_add_f32 v[162:163],v[162:163],v[178:179]
v_pk_add_f32 v[164:165],v[164:165],v[180:181]
v_pk_add_f32 v[166:167],v[166:167],v[182:183]
v_pk_fma_f32 v[168:169],v[160:161],v[32:33],v[168:169]
v_pk_fma_f32 v[170:171],v[162:163],v[34:35],v[170:171]
v_pk_fma_f32 v[172:173],v[164:165],v[36:37],v[172:173]
v_pk_fma_f32 v[174:175],v[166:167],v[38:39],v[174:175]
cvt v176,v168,v169
cvt v177,v170,v171
cvt v178,v172,v173
cvt v179,v174,v175
buffer_store_dwordx4 v[176:179],v10,s[36:39],0 offen
s_endpgm
Lidle:
s_waitcnt vmcnt(0)
buffer_store_dword v5,v6,s[8:11],s54 offen sc1
s_add_u32 s55,s55,512
buffer_load_dword v15,v124,s[8:11],s55 offen sc1
Lhi_chk:
s_waitcnt vmcnt(0)
v_cmp_ne_u32 vcc,1,v15
s_nop 0
s_cbranch_vccnz Lhi_spin
s_lshr_b32 s40,s2,3
s_sub_u32 s40,s40,27
s_lshl_b32 s40,s40,2
s_add_u32 s40,s40,s3
s_mul_i32 s40,s40,40960
s_and_b32 s42,s2,1
s_mul_i32 s42,s42,16384
s_add_u32 s40,s40,s42
v_lshlrev_b32 v16,7,v1
buffer_load_dword v17,v16,s[24:27],s40 offen sc1
s_add_u32 s40,s40,8192
buffer_load_dword v18,v16,s[24:27],s40 offen sc1
s_add_u32 s40,s40,8192
buffer_load_dword v19,v16,s[24:27],s40 offen sc1
s_add_u32 s40,s40,802816
buffer_load_dword v20,v16,s[24:27],s40 offen sc1
s_add_u32 s40,s40,8192
buffer_load_dword v21,v16,s[24:27],s40 offen sc1
s_add_u32 s40,s40,8192
buffer_load_dword v22,v16,s[24:27],s40 offen sc1
s_add_u32 s40,s40,802816
buffer_load_dword v23,v16,s[24:27],s40 offen sc1
s_add_u32 s40,s40,8192
buffer_load_dword v24,v16,s[24:27],s40 offen sc1
s_add_u32 s40,s40,8192
buffer_load_dword v25,v16,s[24:27],s40 offen sc1
s_add_u32 s40,s40,802816
s_waitcnt vmcnt(0)
buffer_load_dwordx4 a[128:131],v2,s[24:27],s41 offen sc1
buffer_load_dwordx4 a[132:135],v2,s[24:27],s41 offen offset:1024 sc1
buffer_load_dwordx4 a[136:139],v2,s[24:27],s41 offen offset:2048 sc1
buffer_load_dwordx4 a[140:143],v2,s[24:27],s41 offen offset:3072 sc1
buffer_load_dwordx4 a[144:147],v14,s[24:27],s41 offen sc1
s_add_u32 s41,s41,163840
buffer_load_dwordx4 a[148:151],v2,s[24:27],s41 offen sc1
buffer_load_dwordx4 a[152:155],v2,s[24:27],s41 offen offset:1024 sc1
buffer_load_dwordx4 a[156:159],v2,s[24:27],s41 offen offset:2048 sc1
buffer_load_dwordx4 a[160:163],v2,s[24:27],s41 offen offset:3072 sc1
buffer_load_dwordx4 a[164:167],v14,s[24:27],s41 offen sc1
s_add_u32 s41,s41,163840
buffer_load_dwordx4 a[168:171],v2,s[24:27],s41 offen sc1
buffer_load_dwordx4 a[172:175],v2,s[24:27],s41 offen offset:1024 sc1
buffer_load_dwordx4 a[176:179],v2,s[24:27],s41 offen offset:2048 sc1
buffer_load_dwordx4 a[180:183],v2,s[24:27],s41 offen offset:3072 sc1
buffer_load_dwordx4 a[184:187],v14,s[24:27],s41 offen sc1
s_add_u32 s41,s41,163840
buffer_load_dwordx4 a[188:191],v2,s[24:27],s41 offen sc1
buffer_load_dwordx4 a[192:195],v2,s[24:27],s41 offen offset:1024 sc1
buffer_load_dwordx4 a[196:199],v2,s[24:27],s41 offen offset:2048 sc1
buffer_load_dwordx4 a[200:203],v2,s[24:27],s41 offen offset:3072 sc1
buffer_load_dwordx4 a[204:207],v14,s[24:27],s41 offen sc1
s_add_u32 s41,s41,163840
buffer_load_dwordx4 a[208:211],v2,s[24:27],s41 offen sc1
buffer_load_dwordx4 a[212:215],v2,s[24:27],s41 offen offset:1024 sc1
buffer_load_dwordx4 a[216:219],v2,s[24:27],s41 offen offset:2048 sc1
buffer_load_dwordx4 a[220:223],v2,s[24:27],s41 offen offset:3072 sc1
buffer_load_dwordx4 a[224:227],v14,s[24:27],s41 offen sc1
s_add_u32 s41,s41,163840
buffer_load_dwordx4 a[228:231],v2,s[24:27],s41 offen sc1
buffer_load_dwordx4 a[232:235],v2,s[24:27],s41 offen offset:1024 sc1
buffer_load_dwordx4 a[236:239],v2,s[24:27],s41 offen offset:2048 sc1
buffer_load_dwordx4 a[240:243],v2,s[24:27],s41 offen offset:3072 sc1
buffer_load_dwordx4 a[244:247],v14,s[24:27],s41 offen sc1
s_add_u32 s41,s41,163840
buffer_load_dwordx4 a[248:251],v2,s[24:27],s41 offen sc1
buffer_load_dwordx4 a[252:255],v2,s[24:27],s41 offen offset:1024 sc1
buffer_load_dwordx4 v[96:99],v2,s[24:27],s41 offen offset:2048 sc1
buffer_load_dwordx4 v[100:103],v2,s[24:27],s41 offen offset:3072 sc1
buffer_load_dwordx4 v[104:107],v14,s[24:27],s41 offen sc1
s_add_u32 s41,s41,163840
buffer_load_dwordx4 v[108:111],v2,s[24:27],s41 offen sc1
buffer_load_dwordx4 v[112:115],v2,s[24:27],s41 offen offset:1024 sc1
buffer_load_dwordx4 v[116:119],v2,s[24:27],s41 offen offset:2048 sc1
buffer_load_dwordx4 a[0:3],v2,s[24:27],s41 offen offset:3072 sc1
buffer_load_dwordx4 a[4:7],v14,s[24:27],s41 offen sc1
s_add_u32 s41,s41,163840
buffer_load_dwordx4 a[8:11],v2,s[24:27],s41 offen sc1
s_waitcnt vmcnt(20)
buffer_load_dwordx4 a[12:15],v2,s[24:27],s41 offen offset:1024 sc1
buffer_load_dword v13,v7,s[8:11],s17 offen sc1
s_waitcnt vmcnt(0)
s_branch Ldn
Lq0m:
v_cmp_le_i32 s[64:65],0,v5
v_cmp_le_i32 s[66:67],1,v5
v_cmp_le_i32 s[68:69],2,v5
v_cmp_le_i32 s[70:71],3,v5
v_cndmask_b32 v136,v7,v136,s[64:65]
v_cmp_le_i32 s[72:73],16,v5
v_cndmask_b32 v137,v7,v137,s[66:67]
v_cmp_le_i32 s[74:75],17,v5
v_cndmask_b32 v138,v7,v138,s[68:69]
v_cmp_le_i32 s[76:77],18,v5
v_cndmask_b32 v139,v7,v139,s[70:71]
v_cmp_le_i32 s[78:79],19,v5
v_cndmask_b32 v152,v7,v152,s[72:73]
v_cmp_le_i32 s[64:65],32,v5
v_cndmask_b32 v153,v7,v153,s[74:75]
v_cmp_le_i32 s[66:67],33,v5
v_cndmask_b32 v154,v7,v154,s[76:77]
v_cmp_le_i32 s[68:69],34,v5
v_cndmask_b32 v155,v7,v155,s[78:79]
v_cmp_le_i32 s[70:71],35,v5
v_cndmask_b32 v168,v7,v168,s[64:65]
v_cmp_le_i32 s[72:73],48,v5
v_cndmask_b32 v169,v7,v169,s[66:67]
v_cmp_le_i32 s[74:75],49,v5
v_cndmask_b32 v170,v7,v170,s[68:69]
v_cmp_le_i32 s[76:77],50,v5
v_cndmask_b32 v171,v7,v171,s[70:71]
v_cmp_le_i32 s[78:79],51,v5
v_cndmask_b32 v184,v7,v184,s[72:73]
v_cndmask_b32 v185,v7,v185,s[74:75]
v_cndmask_b32 v186,v7,v186,s[76:77]
v_cndmask_b32 v187,v7,v187,s[78:79]
s_branch Lq0c
Lt1m:
v_cmp_le_i32 s[64:65],0,v5
v_cmp_le_i32 s[66:67],1,v5
v_cmp_le_i32 s[68:69],2,v5
v_cmp_le_i32 s[70:71],3,v5
v_cndmask_b32 v128,v7,v128,s[64:65]
v_cmp_le_i32 s[72:73],16,v5
v_cndmask_b32 v129,v7,v129,s[66:67]
v_cmp_le_i32 s[74:75],17,v5
v_cndmask_b32 v130,v7,v130,s[68:69]
v_cmp_le_i32 s[76:77],18,v5
v_cndmask_b32 v131,v7,v131,s[70:71]
v_cmp_le_i32 s[78:79],19,v5
v_cndmask_b32 v144,v7,v144,s[72:73]
v_cmp_le_i32 s[64:65],32,v5
v_cndmask_b32 v145,v7,v145,s[74:75]
v_cmp_le_i32 s[66:67],33,v5
v_cndmask_b32 v146,v7,v146,s[76:77]
v_cmp_le_i32 s[68:69],34,v5
v_cndmask_b32 v147,v7,v147,s[78:79]
v_cmp_le_i32 s[70:71],35,v5
v_cndmask_b32 v160,v7,v160,s[64:65]
v_cmp_le_i32 s[72:73],48,v5
v_cndmask_b32 v161,v7,v161,s[66:67]
v_cmp_le_i32 s[74:75],49,v5
v_cndmask_b32 v162,v7,v162,s[68:69]
v_cmp_le_i32 s[76:77],50,v5
v_cndmask_b32 v163,v7,v163,s[70:71]
v_cmp_le_i32 s[78:79],51,v5
v_cndmask_b32 v176,v7,v176,s[72:73]
v_cndmask_b32 v177,v7,v177,s[74:75]
v_cndmask_b32 v178,v7,v178,s[76:77]
v_cndmask_b32 v179,v7,v179,s[78:79]
s_branch Lt1c
Lq1m:
v_cmp_le_i32 s[64:65],0,v5
v_cmp_le_i32 s[66:67],1,v5
v_cmp_le_i32 s[68:69],2,v5
v_cmp_le_i32 s[70:71],3,v5
v_cndmask_b32 v204,v7,v204,s[64:65]
v_cmp_le_i32 s[72:73],16,v5
v_cndmask_b32 v205,v7,v205,s[66:67]
v_cmp_le_i32 s[74:75],17,v5
v_cndmask_b32 v206,v7,v206,s[68:69]
v_cmp_le_i32 s[76:77],18,v5
v_cndmask_b32 v207,v7,v207,s[70:71]
v_cmp_le_i32 s[78:79],19,v5
v_cndmask_b32 v220,v7,v220,s[72:73]
v_cmp_le_i32 s[64:65],32,v5
v_cndmask_b32 v221,v7,v221,s[74:75]
v_cmp_le_i32 s[66:67],33,v5
v_cndmask_b32 v222,v7,v222,s[76:77]
v_cmp_le_i32 s[68:69],34,v5
v_cndmask_b32 v223,v7,v223,s[78:79]
v_cmp_le_i32 s[70:71],35,v5
v_cndmask_b32 v236,v7,v236,s[64:65]
v_cmp_le_i32 s[72:73],48,v5
v_cndmask_b32 v237,v7,v237,s[66:67]
v_cmp_le_i32 s[74:75],49,v5
v_cndmask_b32 v238,v7,v238,s[68:69]
v_cmp_le_i32 s[76:77],50,v5
v_cndmask_b32 v239,v7,v239,s[70:71]
v_cmp_le_i32 s[78:79],51,v5
v_cndmask_b32 v252,v7,v252,s[72:73]
v_cndmask_b32 v253,v7,v253,s[74:75]
v_cndmask_b32 v254,v7,v254,s[76:77]
v_cndmask_b32 v255,v7,v255,s[78:79]
s_branch LT1
Lt2m:
buffer_load_dword v223,v222,s[8:11],s47 offen sc1
s_getpc_b64 s[16:17]
ct4:
s_sub_u32 s16,s16,ct4-LE2
s_subb_u32 s17,s17,0
s_mov_b32 s18,code_end-LE2
s_mov_b32 s19,0x20000
s_bfe_u32 s20,s2,0x50003
s_lshl_b32 s20,s20,2
s_add_u32 s20,s20,s3
s_lshl_b32 s20,s20,7
v_lshlrev_b32 v46,14,v1
buffer_load_dword v46,v46,s[16:19],s20 offen
s_barrier
v_cmp_le_i32 s[64:65],0,v5
v_cmp_le_i32 s[66:67],1,v5
v_cmp_le_i32 s[68:69],2,v5
v_cmp_le_i32 s[70:71],3,v5
v_cndmask_b32 v196,v7,v196,s[64:65]
v_cmp_le_i32 s[72:73],16,v5
v_cndmask_b32 v197,v7,v197,s[66:67]
v_cmp_le_i32 s[74:75],17,v5
v_cndmask_b32 v198,v7,v198,s[68:69]
v_cmp_le_i32 s[76:77],18,v5
v_cndmask_b32 v199,v7,v199,s[70:71]
v_cmp_le_i32 s[78:79],19,v5
v_cndmask_b32 v212,v7,v212,s[72:73]
v_cmp_le_i32 s[64:65],32,v5
v_cndmask_b32 v213,v7,v213,s[74:75]
v_cmp_le_i32 s[66:67],33,v5
v_cndmask_b32 v214,v7,v214,s[76:77]
v_cmp_le_i32 s[68:69],34,v5
v_cndmask_b32 v215,v7,v215,s[78:79]
v_cmp_le_i32 s[70:71],35,v5
v_cndmask_b32 v228,v7,v228,s[64:65]
v_cmp_le_i32 s[72:73],48,v5
v_cndmask_b32 v229,v7,v229,s[66:67]
v_cmp_le_i32 s[74:75],49,v5
v_cndmask_b32 v230,v7,v230,s[68:69]
v_cmp_le_i32 s[76:77],50,v5
v_cndmask_b32 v231,v7,v231,s[70:71]
v_cmp_le_i32 s[78:79],51,v5
v_cndmask_b32 v244,v7,v244,s[72:73]
v_cndmask_b32 v245,v7,v245,s[74:75]
v_cndmask_b32 v246,v7,v246,s[76:77]
v_cndmask_b32 v247,v7,v247,s[78:79]
s_branch Lr_chk
LDF0_rare:
s_call_b64 s[98:99],LR04
s_branch LDF0_post
LDF1_rare:
s_call_b64 s[98:99],LR14
s_branch LDF1_post
LDM0_rare:
s_call_b64 s[98:99],LR04
s_branch LDM0_post
LDM1_rare:
s_call_b64 s[98:99],LR14
s_branch LDM1_post
LT1_rare:
s_call_b64 s[98:99],LR03
s_branch LT1_post
LT2_rare:
s_call_b64 s[98:99],LR12
s_branch LT2_post
LSA0_rare:
s_call_b64 s[98:99],LR02
s_branch LSA0_post
LSA1_rare:
s_call_b64 s[98:99],LR12
s_branch LSA1_post
LSF0_rare:
s_call_b64 s[98:99],LR02
s_branch LSF0_post
LSF1_rare:
s_call_b64 s[98:99],LR12
s_branch LSF1_post
LSM0_rare:
s_call_b64 s[98:99],LR02
s_branch LSM0_post
LSM1_rare:
s_call_b64 s[98:99],LR12
s_branch LSM1_post
LE1_rare:
s_call_b64 s[98:99],LR01
s_branch LE1_post
LR04:
v_max3_f32 v24,v192,v193,v194
v_max3_f32 v25,v196,v197,v198
v_max3_f32 v26,v200,v201,v202
v_max3_f32 v27,v204,v205,v206
v_max3_f32 v24,v24,v195,v208
v_max3_f32 v25,v25,v199,v212
v_max3_f32 v26,v26,v203,v216
v_max3_f32 v27,v27,v207,v220
v_max3_f32 v24,v24,v209,v210
v_max3_f32 v25,v25,v213,v214
v_max3_f32 v26,v26,v217,v218
v_max3_f32 v27,v27,v221,v222
v_max3_f32 v24,v24,v211,v224
v_max3_f32 v25,v25,v215,v228
v_max3_f32 v26,v26,v219,v232
v_max3_f32 v27,v27,v223,v236
v_max3_f32 v24,v24,v225,v226
v_max3_f32 v25,v25,v229,v230
v_max3_f32 v26,v26,v233,v234
v_max3_f32 v27,v27,v237,v238
v_max3_f32 v24,v24,v227,v240
v_max3_f32 v25,v25,v231,v244
v_max3_f32 v26,v26,v235,v248
v_max3_f32 v27,v27,v239,v252
v_max3_f32 v24,v24,v241,v242
v_max3_f32 v25,v25,v245,v246
v_max3_f32 v26,v26,v249,v250
v_max3_f32 v27,v27,v253,v254
v_max_f32 v24,v24,v243
v_max_f32 v25,v25,v247
v_max_f32 v26,v26,v251
v_max_f32 v27,v27,v255
v_mov_b32 v28,v24
v_mov_b32 v29,v25
v_mov_b32 v30,v26
v_mov_b32 v31,v27
v_permlane16_swap_b32 v24,v28
v_permlane16_swap_b32 v25,v29
v_permlane16_swap_b32 v26,v30
v_permlane16_swap_b32 v27,v31
v_max_f32 v24,v24,v28
v_max_f32 v25,v25,v29
v_max_f32 v26,v26,v30
v_max_f32 v27,v27,v31
v_mov_b32 v28,v24
v_mov_b32 v29,v25
v_mov_b32 v30,v26
v_mov_b32 v31,v27
v_permlane32_swap_b32 v24,v28
v_permlane32_swap_b32 v25,v29
v_permlane32_swap_b32 v26,v30
v_permlane32_swap_b32 v27,v31
v_max_f32 v24,v24,v28
v_max_f32 v25,v25,v29
v_max_f32 v26,v26,v30
v_max_f32 v27,v27,v31
v_max_f32 v24,0,v24
v_exp_f32 v28,-v24
v_max_f32 v25,0,v25
v_exp_f32 v29,-v25
v_max_f32 v26,0,v26
v_exp_f32 v30,-v26
v_max_f32 v27,0,v27
v_exp_f32 v31,-v27
v_mul_f32 v40,v40,v28
v_sub_f32 v48,v48,v24
v_sub_f32 v49,v49,v24
v_sub_f32 v50,v50,v24
v_sub_f32 v51,v51,v24
v_sub_f32 v192,v192,v24
v_sub_f32 v193,v193,v24
v_sub_f32 v194,v194,v24
v_sub_f32 v195,v195,v24
v_sub_f32 v208,v208,v24
v_sub_f32 v209,v209,v24
v_sub_f32 v210,v210,v24
v_sub_f32 v211,v211,v24
v_sub_f32 v224,v224,v24
v_sub_f32 v225,v225,v24
v_sub_f32 v226,v226,v24
v_sub_f32 v227,v227,v24
v_sub_f32 v240,v240,v24
v_sub_f32 v241,v241,v24
v_sub_f32 v242,v242,v24
v_sub_f32 v243,v243,v24
v_sub_f32 v128,v128,v24
v_sub_f32 v129,v129,v24
v_sub_f32 v130,v130,v24
v_sub_f32 v131,v131,v24
v_sub_f32 v144,v144,v24
v_sub_f32 v145,v145,v24
v_sub_f32 v146,v146,v24
v_sub_f32 v147,v147,v24
v_sub_f32 v160,v160,v24
v_sub_f32 v161,v161,v24
v_sub_f32 v162,v162,v24
v_sub_f32 v163,v163,v24
v_sub_f32 v176,v176,v24
v_sub_f32 v177,v177,v24
v_sub_f32 v178,v178,v24
v_sub_f32 v179,v179,v24
ard v32,a0
ard v33,a1
ard v34,a2
ard v35,a3
v_mul_f32 v32,v32,v28
v_mul_f32 v33,v33,v28
v_mul_f32 v34,v34,v28
v_mul_f32 v35,v35,v28
awr a0,v32
awr a1,v33
awr a2,v34
awr a3,v35
ard v32,a16
ard v33,a17
ard v34,a18
ard v35,a19
v_mul_f32 v32,v32,v28
v_mul_f32 v33,v33,v28
v_mul_f32 v34,v34,v28
v_mul_f32 v35,v35,v28
awr a16,v32
awr a17,v33
awr a18,v34
awr a19,v35
ard v32,a32
ard v33,a33
ard v34,a34
ard v35,a35
v_mul_f32 v32,v32,v28
v_mul_f32 v33,v33,v28
v_mul_f32 v34,v34,v28
v_mul_f32 v35,v35,v28
awr a32,v32
awr a33,v33
awr a34,v34
awr a35,v35
ard v32,a48
ard v33,a49
ard v34,a50
ard v35,a51
v_mul_f32 v32,v32,v28
v_mul_f32 v33,v33,v28
v_mul_f32 v34,v34,v28
v_mul_f32 v35,v35,v28
awr a48,v32
awr a49,v33
awr a50,v34
awr a51,v35
ard v32,a64
ard v33,a65
ard v34,a66
ard v35,a67
v_mul_f32 v32,v32,v28
v_mul_f32 v33,v33,v28
v_mul_f32 v34,v34,v28
v_mul_f32 v35,v35,v28
awr a64,v32
awr a65,v33
awr a66,v34
awr a67,v35
ard v32,a80
ard v33,a81
ard v34,a82
ard v35,a83
v_mul_f32 v32,v32,v28
v_mul_f32 v33,v33,v28
v_mul_f32 v34,v34,v28
v_mul_f32 v35,v35,v28
awr a80,v32
awr a81,v33
awr a82,v34
awr a83,v35
ard v32,a96
ard v33,a97
ard v34,a98
ard v35,a99
v_mul_f32 v32,v32,v28
v_mul_f32 v33,v33,v28
v_mul_f32 v34,v34,v28
v_mul_f32 v35,v35,v28
awr a96,v32
awr a97,v33
awr a98,v34
awr a99,v35
ard v32,a112
ard v33,a113
ard v34,a114
ard v35,a115
v_mul_f32 v32,v32,v28
v_mul_f32 v33,v33,v28
v_mul_f32 v34,v34,v28
v_mul_f32 v35,v35,v28
awr a112,v32
awr a113,v33
awr a114,v34
awr a115,v35
v_mul_f32 v41,v41,v29
v_sub_f32 v52,v52,v25
v_sub_f32 v53,v53,v25
v_sub_f32 v54,v54,v25
v_sub_f32 v55,v55,v25
v_sub_f32 v196,v196,v25
v_sub_f32 v197,v197,v25
v_sub_f32 v198,v198,v25
v_sub_f32 v199,v199,v25
v_sub_f32 v212,v212,v25
v_sub_f32 v213,v213,v25
v_sub_f32 v214,v214,v25
v_sub_f32 v215,v215,v25
v_sub_f32 v228,v228,v25
v_sub_f32 v229,v229,v25
v_sub_f32 v230,v230,v25
v_sub_f32 v231,v231,v25
v_sub_f32 v244,v244,v25
v_sub_f32 v245,v245,v25
v_sub_f32 v246,v246,v25
v_sub_f32 v247,v247,v25
v_sub_f32 v132,v132,v25
v_sub_f32 v133,v133,v25
v_sub_f32 v134,v134,v25
v_sub_f32 v135,v135,v25
v_sub_f32 v148,v148,v25
v_sub_f32 v149,v149,v25
v_sub_f32 v150,v150,v25
v_sub_f32 v151,v151,v25
v_sub_f32 v164,v164,v25
v_sub_f32 v165,v165,v25
v_sub_f32 v166,v166,v25
v_sub_f32 v167,v167,v25
v_sub_f32 v180,v180,v25
v_sub_f32 v181,v181,v25
v_sub_f32 v182,v182,v25
v_sub_f32 v183,v183,v25
ard v32,a4
ard v33,a5
ard v34,a6
ard v35,a7
v_mul_f32 v32,v32,v29
v_mul_f32 v33,v33,v29
v_mul_f32 v34,v34,v29
v_mul_f32 v35,v35,v29
awr a4,v32
awr a5,v33
awr a6,v34
awr a7,v35
ard v32,a20
ard v33,a21
ard v34,a22
ard v35,a23
v_mul_f32 v32,v32,v29
v_mul_f32 v33,v33,v29
v_mul_f32 v34,v34,v29
v_mul_f32 v35,v35,v29
awr a20,v32
awr a21,v33
awr a22,v34
awr a23,v35
ard v32,a36
ard v33,a37
ard v34,a38
ard v35,a39
v_mul_f32 v32,v32,v29
v_mul_f32 v33,v33,v29
v_mul_f32 v34,v34,v29
v_mul_f32 v35,v35,v29
awr a36,v32
awr a37,v33
awr a38,v34
awr a39,v35
ard v32,a52
ard v33,a53
ard v34,a54
ard v35,a55
v_mul_f32 v32,v32,v29
v_mul_f32 v33,v33,v29
v_mul_f32 v34,v34,v29
v_mul_f32 v35,v35,v29
awr a52,v32
awr a53,v33
awr a54,v34
awr a55,v35
ard v32,a68
ard v33,a69
ard v34,a70
ard v35,a71
v_mul_f32 v32,v32,v29
v_mul_f32 v33,v33,v29
v_mul_f32 v34,v34,v29
v_mul_f32 v35,v35,v29
awr a68,v32
awr a69,v33
awr a70,v34
awr a71,v35
ard v32,a84
ard v33,a85
ard v34,a86
ard v35,a87
v_mul_f32 v32,v32,v29
v_mul_f32 v33,v33,v29
v_mul_f32 v34,v34,v29
v_mul_f32 v35,v35,v29
awr a84,v32
awr a85,v33
awr a86,v34
awr a87,v35
ard v32,a100
ard v33,a101
ard v34,a102
ard v35,a103
v_mul_f32 v32,v32,v29
v_mul_f32 v33,v33,v29
v_mul_f32 v34,v34,v29
v_mul_f32 v35,v35,v29
awr a100,v32
awr a101,v33
awr a102,v34
awr a103,v35
ard v32,a116
ard v33,a117
ard v34,a118
ard v35,a119
v_mul_f32 v32,v32,v29
v_mul_f32 v33,v33,v29
v_mul_f32 v34,v34,v29
v_mul_f32 v35,v35,v29
awr a116,v32
awr a117,v33
awr a118,v34
awr a119,v35
v_mul_f32 v42,v42,v30
v_sub_f32 v56,v56,v26
v_sub_f32 v57,v57,v26
v_sub_f32 v58,v58,v26
v_sub_f32 v59,v59,v26
v_sub_f32 v200,v200,v26
v_sub_f32 v201,v201,v26
v_sub_f32 v202,v202,v26
v_sub_f32 v203,v203,v26
v_sub_f32 v216,v216,v26
v_sub_f32 v217,v217,v26
v_sub_f32 v218,v218,v26
v_sub_f32 v219,v219,v26
v_sub_f32 v232,v232,v26
v_sub_f32 v233,v233,v26
v_sub_f32 v234,v234,v26
v_sub_f32 v235,v235,v26
v_sub_f32 v248,v248,v26
v_sub_f32 v249,v249,v26
v_sub_f32 v250,v250,v26
v_sub_f32 v251,v251,v26
v_sub_f32 v136,v136,v26
v_sub_f32 v137,v137,v26
v_sub_f32 v138,v138,v26
v_sub_f32 v139,v139,v26
v_sub_f32 v152,v152,v26
v_sub_f32 v153,v153,v26
v_sub_f32 v154,v154,v26
v_sub_f32 v155,v155,v26
v_sub_f32 v168,v168,v26
v_sub_f32 v169,v169,v26
v_sub_f32 v170,v170,v26
v_sub_f32 v171,v171,v26
v_sub_f32 v184,v184,v26
v_sub_f32 v185,v185,v26
v_sub_f32 v186,v186,v26
v_sub_f32 v187,v187,v26
ard v32,a8
ard v33,a9
ard v34,a10
ard v35,a11
v_mul_f32 v32,v32,v30
v_mul_f32 v33,v33,v30
v_mul_f32 v34,v34,v30
v_mul_f32 v35,v35,v30
awr a8,v32
awr a9,v33
awr a10,v34
awr a11,v35
ard v32,a24
ard v33,a25
ard v34,a26
ard v35,a27
v_mul_f32 v32,v32,v30
v_mul_f32 v33,v33,v30
v_mul_f32 v34,v34,v30
v_mul_f32 v35,v35,v30
awr a24,v32
awr a25,v33
awr a26,v34
awr a27,v35
ard v32,a40
ard v33,a41
ard v34,a42
ard v35,a43
v_mul_f32 v32,v32,v30
v_mul_f32 v33,v33,v30
v_mul_f32 v34,v34,v30
v_mul_f32 v35,v35,v30
awr a40,v32
awr a41,v33
awr a42,v34
awr a43,v35
ard v32,a56
ard v33,a57
ard v34,a58
ard v35,a59
v_mul_f32 v32,v32,v30
v_mul_f32 v33,v33,v30
v_mul_f32 v34,v34,v30
v_mul_f32 v35,v35,v30
awr a56,v32
awr a57,v33
awr a58,v34
awr a59,v35
ard v32,a72
ard v33,a73
ard v34,a74
ard v35,a75
v_mul_f32 v32,v32,v30
v_mul_f32 v33,v33,v30
v_mul_f32 v34,v34,v30
v_mul_f32 v35,v35,v30
awr a72,v32
awr a73,v33
awr a74,v34
awr a75,v35
ard v32,a88
ard v33,a89
ard v34,a90
ard v35,a91
v_mul_f32 v32,v32,v30
v_mul_f32 v33,v33,v30
v_mul_f32 v34,v34,v30
v_mul_f32 v35,v35,v30
awr a88,v32
awr a89,v33
awr a90,v34
awr a91,v35
ard v32,a104
ard v33,a105
ard v34,a106
ard v35,a107
v_mul_f32 v32,v32,v30
v_mul_f32 v33,v33,v30
v_mul_f32 v34,v34,v30
v_mul_f32 v35,v35,v30
awr a104,v32
awr a105,v33
awr a106,v34
awr a107,v35
ard v32,a120
ard v33,a121
ard v34,a122
ard v35,a123
v_mul_f32 v32,v32,v30
v_mul_f32 v33,v33,v30
v_mul_f32 v34,v34,v30
v_mul_f32 v35,v35,v30
awr a120,v32
awr a121,v33
awr a122,v34
awr a123,v35
v_mul_f32 v43,v43,v31
v_sub_f32 v60,v60,v27
v_sub_f32 v61,v61,v27
v_sub_f32 v62,v62,v27
v_sub_f32 v63,v63,v27
v_sub_f32 v204,v204,v27
v_sub_f32 v205,v205,v27
v_sub_f32 v206,v206,v27
v_sub_f32 v207,v207,v27
v_sub_f32 v220,v220,v27
v_sub_f32 v221,v221,v27
v_sub_f32 v222,v222,v27
v_sub_f32 v223,v223,v27
v_sub_f32 v236,v236,v27
v_sub_f32 v237,v237,v27
v_sub_f32 v238,v238,v27
v_sub_f32 v239,v239,v27
v_sub_f32 v252,v252,v27
v_sub_f32 v253,v253,v27
v_sub_f32 v254,v254,v27
v_sub_f32 v255,v255,v27
v_sub_f32 v140,v140,v27
v_sub_f32 v141,v141,v27
v_sub_f32 v142,v142,v27
v_sub_f32 v143,v143,v27
v_sub_f32 v156,v156,v27
v_sub_f32 v157,v157,v27
v_sub_f32 v158,v158,v27
v_sub_f32 v159,v159,v27
v_sub_f32 v172,v172,v27
v_sub_f32 v173,v173,v27
v_sub_f32 v174,v174,v27
v_sub_f32 v175,v175,v27
v_sub_f32 v188,v188,v27
v_sub_f32 v189,v189,v27
v_sub_f32 v190,v190,v27
v_sub_f32 v191,v191,v27
ard v32,a12
ard v33,a13
ard v34,a14
ard v35,a15
v_mul_f32 v32,v32,v31
v_mul_f32 v33,v33,v31
v_mul_f32 v34,v34,v31
v_mul_f32 v35,v35,v31
awr a12,v32
awr a13,v33
awr a14,v34
awr a15,v35
ard v32,a28
ard v33,a29
ard v34,a30
ard v35,a31
v_mul_f32 v32,v32,v31
v_mul_f32 v33,v33,v31
v_mul_f32 v34,v34,v31
v_mul_f32 v35,v35,v31
awr a28,v32
awr a29,v33
awr a30,v34
awr a31,v35
ard v32,a44
ard v33,a45
ard v34,a46
ard v35,a47
v_mul_f32 v32,v32,v31
v_mul_f32 v33,v33,v31
v_mul_f32 v34,v34,v31
v_mul_f32 v35,v35,v31
awr a44,v32
awr a45,v33
awr a46,v34
awr a47,v35
ard v32,a60
ard v33,a61
ard v34,a62
ard v35,a63
v_mul_f32 v32,v32,v31
v_mul_f32 v33,v33,v31
v_mul_f32 v34,v34,v31
v_mul_f32 v35,v35,v31
awr a60,v32
awr a61,v33
awr a62,v34
awr a63,v35
ard v32,a76
ard v33,a77
ard v34,a78
ard v35,a79
v_mul_f32 v32,v32,v31
v_mul_f32 v33,v33,v31
v_mul_f32 v34,v34,v31
v_mul_f32 v35,v35,v31
awr a76,v32
awr a77,v33
awr a78,v34
awr a79,v35
ard v32,a92
ard v33,a93
ard v34,a94
ard v35,a95
v_mul_f32 v32,v32,v31
v_mul_f32 v33,v33,v31
v_mul_f32 v34,v34,v31
v_mul_f32 v35,v35,v31
awr a92,v32
awr a93,v33
awr a94,v34
awr a95,v35
ard v32,a108
ard v33,a109
ard v34,a110
ard v35,a111
v_mul_f32 v32,v32,v31
v_mul_f32 v33,v33,v31
v_mul_f32 v34,v34,v31
v_mul_f32 v35,v35,v31
awr a108,v32
awr a109,v33
awr a110,v34
awr a111,v35
ard v32,a124
ard v33,a125
ard v34,a126
ard v35,a127
v_mul_f32 v32,v32,v31
v_mul_f32 v33,v33,v31
v_mul_f32 v34,v34,v31
v_mul_f32 v35,v35,v31
awr a124,v32
awr a125,v33
awr a126,v34
awr a127,v35
v_exp_f32 v24,v192
v_exp_f32 v25,v193
v_exp_f32 v26,v194
v_exp_f32 v27,v195
cvt v96,v24,v25
v_exp_f32 v28,v208
v_exp_f32 v29,v209
cvt v97,v26,v27
v_exp_f32 v30,v210
v_exp_f32 v31,v211
cvt v98,v28,v29
v_exp_f32 v32,v224
v_exp_f32 v33,v225
cvt v99,v30,v31
v_exp_f32 v34,v226
v_exp_f32 v35,v227
cvt v112,v32,v33
mf v[8:11],v[36:39],v[96:99],0
v_exp_f32 v24,v240
v_exp_f32 v25,v241
cvt v113,v34,v35
v_exp_f32 v26,v242
v_exp_f32 v27,v243
cvt v114,v24,v25
v_exp_f32 v28,v196
v_exp_f32 v29,v197
cvt v115,v26,v27
v_exp_f32 v30,v198
v_exp_f32 v31,v199
cvt v100,v28,v29
mf v[8:11],v[36:39],v[112:115],v[8:11]
v_exp_f32 v32,v212
v_exp_f32 v33,v213
cvt v101,v30,v31
v_exp_f32 v34,v214
v_exp_f32 v35,v215
cvt v102,v32,v33
v_exp_f32 v24,v228
v_exp_f32 v25,v229
cvt v103,v34,v35
v_exp_f32 v26,v230
v_exp_f32 v27,v231
cvt v116,v24,v25
mf v[12:15],v[36:39],v[100:103],0
v_exp_f32 v28,v244
v_exp_f32 v29,v245
cvt v117,v26,v27
v_exp_f32 v30,v246
v_exp_f32 v31,v247
cvt v118,v28,v29
v_exp_f32 v32,v200
v_exp_f32 v33,v201
cvt v119,v30,v31
v_exp_f32 v34,v202
v_exp_f32 v35,v203
cvt v104,v32,v33
mf v[12:15],v[36:39],v[116:119],v[12:15]
v_exp_f32 v24,v216
v_exp_f32 v25,v217
cvt v105,v34,v35
v_exp_f32 v26,v218
v_exp_f32 v27,v219
cvt v106,v24,v25
v_exp_f32 v28,v232
v_exp_f32 v29,v233
cvt v107,v26,v27
v_exp_f32 v30,v234
v_exp_f32 v31,v235
cvt v120,v28,v29
mf v[16:19],v[36:39],v[104:107],0
v_exp_f32 v32,v248
v_exp_f32 v33,v249
cvt v121,v30,v31
v_exp_f32 v34,v250
v_exp_f32 v35,v251
cvt v122,v32,v33
v_exp_f32 v24,v204
v_exp_f32 v25,v205
cvt v123,v34,v35
v_exp_f32 v26,v206
v_exp_f32 v27,v207
cvt v108,v24,v25
mf v[16:19],v[36:39],v[120:123],v[16:19]
v_exp_f32 v28,v220
v_exp_f32 v29,v221
cvt v109,v26,v27
v_exp_f32 v30,v222
v_exp_f32 v31,v223
cvt v110,v28,v29
v_exp_f32 v32,v236
v_exp_f32 v33,v237
cvt v111,v30,v31
v_exp_f32 v34,v238
v_exp_f32 v35,v239
cvt v124,v32,v33
mf v[20:23],v[36:39],v[108:111],0
v_exp_f32 v24,v252
v_exp_f32 v25,v253
cvt v125,v34,v35
v_exp_f32 v26,v254
v_exp_f32 v27,v255
cvt v126,v24,v25
cvt v127,v26,v27
s_nop 1
mf v[20:23],v[36:39],v[124:127],v[20:23]
s_nop 7
s_setpc_b64 s[98:99]
LR14:
v_max3_f32 v24,v128,v129,v130
v_max3_f32 v25,v132,v133,v134
v_max3_f32 v26,v136,v137,v138
v_max3_f32 v27,v140,v141,v142
v_max3_f32 v24,v24,v131,v144
v_max3_f32 v25,v25,v135,v148
v_max3_f32 v26,v26,v139,v152
v_max3_f32 v27,v27,v143,v156
v_max3_f32 v24,v24,v145,v146
v_max3_f32 v25,v25,v149,v150
v_max3_f32 v26,v26,v153,v154
v_max3_f32 v27,v27,v157,v158
v_max3_f32 v24,v24,v147,v160
v_max3_f32 v25,v25,v151,v164
v_max3_f32 v26,v26,v155,v168
v_max3_f32 v27,v27,v159,v172
v_max3_f32 v24,v24,v161,v162
v_max3_f32 v25,v25,v165,v166
v_max3_f32 v26,v26,v169,v170
v_max3_f32 v27,v27,v173,v174
v_max3_f32 v24,v24,v163,v176
v_max3_f32 v25,v25,v167,v180
v_max3_f32 v26,v26,v171,v184
v_max3_f32 v27,v27,v175,v188
v_max3_f32 v24,v24,v177,v178
v_max3_f32 v25,v25,v181,v182
v_max3_f32 v26,v26,v185,v186
v_max3_f32 v27,v27,v189,v190
v_max_f32 v24,v24,v179
v_max_f32 v25,v25,v183
v_max_f32 v26,v26,v187
v_max_f32 v27,v27,v191
v_mov_b32 v28,v24
v_mov_b32 v29,v25
v_mov_b32 v30,v26
v_mov_b32 v31,v27
v_permlane16_swap_b32 v24,v28
v_permlane16_swap_b32 v25,v29
v_permlane16_swap_b32 v26,v30
v_permlane16_swap_b32 v27,v31
v_max_f32 v24,v24,v28
v_max_f32 v25,v25,v29
v_max_f32 v26,v26,v30
v_max_f32 v27,v27,v31
v_mov_b32 v28,v24
v_mov_b32 v29,v25
v_mov_b32 v30,v26
v_mov_b32 v31,v27
v_permlane32_swap_b32 v24,v28
v_permlane32_swap_b32 v25,v29
v_permlane32_swap_b32 v26,v30
v_permlane32_swap_b32 v27,v31
v_max_f32 v24,v24,v28
v_max_f32 v25,v25,v29
v_max_f32 v26,v26,v30
v_max_f32 v27,v27,v31
v_max_f32 v24,0,v24
v_exp_f32 v28,-v24
v_max_f32 v25,0,v25
v_exp_f32 v29,-v25
v_max_f32 v26,0,v26
v_exp_f32 v30,-v26
v_max_f32 v27,0,v27
v_exp_f32 v31,-v27
v_mul_f32 v40,v40,v28
v_sub_f32 v48,v48,v24
v_sub_f32 v49,v49,v24
v_sub_f32 v50,v50,v24
v_sub_f32 v51,v51,v24
v_sub_f32 v128,v128,v24
v_sub_f32 v129,v129,v24
v_sub_f32 v130,v130,v24
v_sub_f32 v131,v131,v24
v_sub_f32 v144,v144,v24
v_sub_f32 v145,v145,v24
v_sub_f32 v146,v146,v24
v_sub_f32 v147,v147,v24
v_sub_f32 v160,v160,v24
v_sub_f32 v161,v161,v24
v_sub_f32 v162,v162,v24
v_sub_f32 v163,v163,v24
v_sub_f32 v176,v176,v24
v_sub_f32 v177,v177,v24
v_sub_f32 v178,v178,v24
v_sub_f32 v179,v179,v24
v_sub_f32 v192,v192,v24
v_sub_f32 v193,v193,v24
v_sub_f32 v194,v194,v24
v_sub_f32 v195,v195,v24
v_sub_f32 v208,v208,v24
v_sub_f32 v209,v209,v24
v_sub_f32 v210,v210,v24
v_sub_f32 v211,v211,v24
v_sub_f32 v224,v224,v24
v_sub_f32 v225,v225,v24
v_sub_f32 v226,v226,v24
v_sub_f32 v227,v227,v24
v_sub_f32 v240,v240,v24
v_sub_f32 v241,v241,v24
v_sub_f32 v242,v242,v24
v_sub_f32 v243,v243,v24
ard v32,a0
ard v33,a1
ard v34,a2
ard v35,a3
v_mul_f32 v32,v32,v28
v_mul_f32 v33,v33,v28
v_mul_f32 v34,v34,v28
v_mul_f32 v35,v35,v28
awr a0,v32
awr a1,v33
awr a2,v34
awr a3,v35
ard v32,a16
ard v33,a17
ard v34,a18
ard v35,a19
v_mul_f32 v32,v32,v28
v_mul_f32 v33,v33,v28
v_mul_f32 v34,v34,v28
v_mul_f32 v35,v35,v28
awr a16,v32
awr a17,v33
awr a18,v34
awr a19,v35
ard v32,a32
ard v33,a33
ard v34,a34
ard v35,a35
v_mul_f32 v32,v32,v28
v_mul_f32 v33,v33,v28
v_mul_f32 v34,v34,v28
v_mul_f32 v35,v35,v28
awr a32,v32
awr a33,v33
awr a34,v34
awr a35,v35
ard v32,a48
ard v33,a49
ard v34,a50
ard v35,a51
v_mul_f32 v32,v32,v28
v_mul_f32 v33,v33,v28
v_mul_f32 v34,v34,v28
v_mul_f32 v35,v35,v28
awr a48,v32
awr a49,v33
awr a50,v34
awr a51,v35
ard v32,a64
ard v33,a65
ard v34,a66
ard v35,a67
v_mul_f32 v32,v32,v28
v_mul_f32 v33,v33,v28
v_mul_f32 v34,v34,v28
v_mul_f32 v35,v35,v28
awr a64,v32
awr a65,v33
awr a66,v34
awr a67,v35
ard v32,a80
ard v33,a81
ard v34,a82
ard v35,a83
v_mul_f32 v32,v32,v28
v_mul_f32 v33,v33,v28
v_mul_f32 v34,v34,v28
v_mul_f32 v35,v35,v28
awr a80,v32
awr a81,v33
awr a82,v34
awr a83,v35
ard v32,a96
ard v33,a97
ard v34,a98
ard v35,a99
v_mul_f32 v32,v32,v28
v_mul_f32 v33,v33,v28
v_mul_f32 v34,v34,v28
v_mul_f32 v35,v35,v28
awr a96,v32
awr a97,v33
awr a98,v34
awr a99,v35
ard v32,a112
ard v33,a113
ard v34,a114
ard v35,a115
v_mul_f32 v32,v32,v28
v_mul_f32 v33,v33,v28
v_mul_f32 v34,v34,v28
v_mul_f32 v35,v35,v28
awr a112,v32
awr a113,v33
awr a114,v34
awr a115,v35
v_mul_f32 v41,v41,v29
v_sub_f32 v52,v52,v25
v_sub_f32 v53,v53,v25
v_sub_f32 v54,v54,v25
v_sub_f32 v55,v55,v25
v_sub_f32 v132,v132,v25
v_sub_f32 v133,v133,v25
v_sub_f32 v134,v134,v25
v_sub_f32 v135,v135,v25
v_sub_f32 v148,v148,v25
v_sub_f32 v149,v149,v25
v_sub_f32 v150,v150,v25
v_sub_f32 v151,v151,v25
v_sub_f32 v164,v164,v25
v_sub_f32 v165,v165,v25
v_sub_f32 v166,v166,v25
v_sub_f32 v167,v167,v25
v_sub_f32 v180,v180,v25
v_sub_f32 v181,v181,v25
v_sub_f32 v182,v182,v25
v_sub_f32 v183,v183,v25
v_sub_f32 v196,v196,v25
v_sub_f32 v197,v197,v25
v_sub_f32 v198,v198,v25
v_sub_f32 v199,v199,v25
v_sub_f32 v212,v212,v25
v_sub_f32 v213,v213,v25
v_sub_f32 v214,v214,v25
v_sub_f32 v215,v215,v25
v_sub_f32 v228,v228,v25
v_sub_f32 v229,v229,v25
v_sub_f32 v230,v230,v25
v_sub_f32 v231,v231,v25
v_sub_f32 v244,v244,v25
v_sub_f32 v245,v245,v25
v_sub_f32 v246,v246,v25
v_sub_f32 v247,v247,v25
ard v32,a4
ard v33,a5
ard v34,a6
ard v35,a7
v_mul_f32 v32,v32,v29
v_mul_f32 v33,v33,v29
v_mul_f32 v34,v34,v29
v_mul_f32 v35,v35,v29
awr a4,v32
awr a5,v33
awr a6,v34
awr a7,v35
ard v32,a20
ard v33,a21
ard v34,a22
ard v35,a23
v_mul_f32 v32,v32,v29
v_mul_f32 v33,v33,v29
v_mul_f32 v34,v34,v29
v_mul_f32 v35,v35,v29
awr a20,v32
awr a21,v33
awr a22,v34
awr a23,v35
ard v32,a36
ard v33,a37
ard v34,a38
ard v35,a39
v_mul_f32 v32,v32,v29
v_mul_f32 v33,v33,v29
v_mul_f32 v34,v34,v29
v_mul_f32 v35,v35,v29
awr a36,v32
awr a37,v33
awr a38,v34
awr a39,v35
ard v32,a52
ard v33,a53
ard v34,a54
ard v35,a55
v_mul_f32 v32,v32,v29
v_mul_f32 v33,v33,v29
v_mul_f32 v34,v34,v29
v_mul_f32 v35,v35,v29
awr a52,v32
awr a53,v33
awr a54,v34
awr a55,v35
ard v32,a68
ard v33,a69
ard v34,a70
ard v35,a71
v_mul_f32 v32,v32,v29
v_mul_f32 v33,v33,v29
v_mul_f32 v34,v34,v29
v_mul_f32 v35,v35,v29
awr a68,v32
awr a69,v33
awr a70,v34
awr a71,v35
ard v32,a84
ard v33,a85
ard v34,a86
ard v35,a87
v_mul_f32 v32,v32,v29
v_mul_f32 v33,v33,v29
v_mul_f32 v34,v34,v29
v_mul_f32 v35,v35,v29
awr a84,v32
awr a85,v33
awr a86,v34
awr a87,v35
ard v32,a100
ard v33,a101
ard v34,a102
ard v35,a103
v_mul_f32 v32,v32,v29
v_mul_f32 v33,v33,v29
v_mul_f32 v34,v34,v29
v_mul_f32 v35,v35,v29
awr a100,v32
awr a101,v33
awr a102,v34
awr a103,v35
ard v32,a116
ard v33,a117
ard v34,a118
ard v35,a119
v_mul_f32 v32,v32,v29
v_mul_f32 v33,v33,v29
v_mul_f32 v34,v34,v29
v_mul_f32 v35,v35,v29
awr a116,v32
awr a117,v33
awr a118,v34
awr a119,v35
v_mul_f32 v42,v42,v30
v_sub_f32 v56,v56,v26
v_sub_f32 v57,v57,v26
v_sub_f32 v58,v58,v26
v_sub_f32 v59,v59,v26
v_sub_f32 v136,v136,v26
v_sub_f32 v137,v137,v26
v_sub_f32 v138,v138,v26
v_sub_f32 v139,v139,v26
v_sub_f32 v152,v152,v26
v_sub_f32 v153,v153,v26
v_sub_f32 v154,v154,v26
v_sub_f32 v155,v155,v26
v_sub_f32 v168,v168,v26
v_sub_f32 v169,v169,v26
v_sub_f32 v170,v170,v26
v_sub_f32 v171,v171,v26
v_sub_f32 v184,v184,v26
v_sub_f32 v185,v185,v26
v_sub_f32 v186,v186,v26
v_sub_f32 v187,v187,v26
v_sub_f32 v200,v200,v26
v_sub_f32 v201,v201,v26
v_sub_f32 v202,v202,v26
v_sub_f32 v203,v203,v26
v_sub_f32 v216,v216,v26
v_sub_f32 v217,v217,v26
v_sub_f32 v218,v218,v26
v_sub_f32 v219,v219,v26
v_sub_f32 v232,v232,v26
v_sub_f32 v233,v233,v26
v_sub_f32 v234,v234,v26
v_sub_f32 v235,v235,v26
v_sub_f32 v248,v248,v26
v_sub_f32 v249,v249,v26
v_sub_f32 v250,v250,v26
v_sub_f32 v251,v251,v26
ard v32,a8
ard v33,a9
ard v34,a10
ard v35,a11
v_mul_f32 v32,v32,v30
v_mul_f32 v33,v33,v30
v_mul_f32 v34,v34,v30
v_mul_f32 v35,v35,v30
awr a8,v32
awr a9,v33
awr a10,v34
awr a11,v35
ard v32,a24
ard v33,a25
ard v34,a26
ard v35,a27
v_mul_f32 v32,v32,v30
v_mul_f32 v33,v33,v30
v_mul_f32 v34,v34,v30
v_mul_f32 v35,v35,v30
awr a24,v32
awr a25,v33
awr a26,v34
awr a27,v35
ard v32,a40
ard v33,a41
ard v34,a42
ard v35,a43
v_mul_f32 v32,v32,v30
v_mul_f32 v33,v33,v30
v_mul_f32 v34,v34,v30
v_mul_f32 v35,v35,v30
awr a40,v32
awr a41,v33
awr a42,v34
awr a43,v35
ard v32,a56
ard v33,a57
ard v34,a58
ard v35,a59
v_mul_f32 v32,v32,v30
v_mul_f32 v33,v33,v30
v_mul_f32 v34,v34,v30
v_mul_f32 v35,v35,v30
awr a56,v32
awr a57,v33
awr a58,v34
awr a59,v35
ard v32,a72
ard v33,a73
ard v34,a74
ard v35,a75
v_mul_f32 v32,v32,v30
v_mul_f32 v33,v33,v30
v_mul_f32 v34,v34,v30
v_mul_f32 v35,v35,v30
awr a72,v32
awr a73,v33
awr a74,v34
awr a75,v35
ard v32,a88
ard v33,a89
ard v34,a90
ard v35,a91
v_mul_f32 v32,v32,v30
v_mul_f32 v33,v33,v30
v_mul_f32 v34,v34,v30
v_mul_f32 v35,v35,v30
awr a88,v32
awr a89,v33
awr a90,v34
awr a91,v35
ard v32,a104
ard v33,a105
ard v34,a106
ard v35,a107
v_mul_f32 v32,v32,v30
v_mul_f32 v33,v33,v30
v_mul_f32 v34,v34,v30
v_mul_f32 v35,v35,v30
awr a104,v32
awr a105,v33
awr a106,v34
awr a107,v35
ard v32,a120
ard v33,a121
ard v34,a122
ard v35,a123
v_mul_f32 v32,v32,v30
v_mul_f32 v33,v33,v30
v_mul_f32 v34,v34,v30
v_mul_f32 v35,v35,v30
awr a120,v32
awr a121,v33
awr a122,v34
awr a123,v35
v_mul_f32 v43,v43,v31
v_sub_f32 v60,v60,v27
v_sub_f32 v61,v61,v27
v_sub_f32 v62,v62,v27
v_sub_f32 v63,v63,v27
v_sub_f32 v140,v140,v27
v_sub_f32 v141,v141,v27
v_sub_f32 v142,v142,v27
v_sub_f32 v143,v143,v27
v_sub_f32 v156,v156,v27
v_sub_f32 v157,v157,v27
v_sub_f32 v158,v158,v27
v_sub_f32 v159,v159,v27
v_sub_f32 v172,v172,v27
v_sub_f32 v173,v173,v27
v_sub_f32 v174,v174,v27
v_sub_f32 v175,v175,v27
v_sub_f32 v188,v188,v27
v_sub_f32 v189,v189,v27
v_sub_f32 v190,v190,v27
v_sub_f32 v191,v191,v27
v_sub_f32 v204,v204,v27
v_sub_f32 v205,v205,v27
v_sub_f32 v206,v206,v27
v_sub_f32 v207,v207,v27
v_sub_f32 v220,v220,v27
v_sub_f32 v221,v221,v27
v_sub_f32 v222,v222,v27
v_sub_f32 v223,v223,v27
v_sub_f32 v236,v236,v27
v_sub_f32 v237,v237,v27
v_sub_f32 v238,v238,v27
v_sub_f32 v239,v239,v27
v_sub_f32 v252,v252,v27
v_sub_f32 v253,v253,v27
v_sub_f32 v254,v254,v27
v_sub_f32 v255,v255,v27
ard v32,a12
ard v33,a13
ard v34,a14
ard v35,a15
v_mul_f32 v32,v32,v31
v_mul_f32 v33,v33,v31
v_mul_f32 v34,v34,v31
v_mul_f32 v35,v35,v31
awr a12,v32
awr a13,v33
awr a14,v34
awr a15,v35
ard v32,a28
ard v33,a29
ard v34,a30
ard v35,a31
v_mul_f32 v32,v32,v31
v_mul_f32 v33,v33,v31
v_mul_f32 v34,v34,v31
v_mul_f32 v35,v35,v31
awr a28,v32
awr a29,v33
awr a30,v34
awr a31,v35
ard v32,a44
ard v33,a45
ard v34,a46
ard v35,a47
v_mul_f32 v32,v32,v31
v_mul_f32 v33,v33,v31
v_mul_f32 v34,v34,v31
v_mul_f32 v35,v35,v31
awr a44,v32
awr a45,v33
awr a46,v34
awr a47,v35
ard v32,a60
ard v33,a61
ard v34,a62
ard v35,a63
v_mul_f32 v32,v32,v31
v_mul_f32 v33,v33,v31
v_mul_f32 v34,v34,v31
v_mul_f32 v35,v35,v31
awr a60,v32
awr a61,v33
awr a62,v34
awr a63,v35
ard v32,a76
ard v33,a77
ard v34,a78
ard v35,a79
v_mul_f32 v32,v32,v31
v_mul_f32 v33,v33,v31
v_mul_f32 v34,v34,v31
v_mul_f32 v35,v35,v31
awr a76,v32
awr a77,v33
awr a78,v34
awr a79,v35
ard v32,a92
ard v33,a93
ard v34,a94
ard v35,a95
v_mul_f32 v32,v32,v31
v_mul_f32 v33,v33,v31
v_mul_f32 v34,v34,v31
v_mul_f32 v35,v35,v31
awr a92,v32
awr a93,v33
awr a94,v34
awr a95,v35
ard v32,a108
ard v33,a109
ard v34,a110
ard v35,a111
v_mul_f32 v32,v32,v31
v_mul_f32 v33,v33,v31
v_mul_f32 v34,v34,v31
v_mul_f32 v35,v35,v31
awr a108,v32
awr a109,v33
awr a110,v34
awr a111,v35
ard v32,a124
ard v33,a125
ard v34,a126
ard v35,a127
v_mul_f32 v32,v32,v31
v_mul_f32 v33,v33,v31
v_mul_f32 v34,v34,v31
v_mul_f32 v35,v35,v31
awr a124,v32
awr a125,v33
awr a126,v34
awr a127,v35
v_exp_f32 v24,v128
v_exp_f32 v25,v129
v_exp_f32 v26,v130
v_exp_f32 v27,v131
cvt v64,v24,v25
v_exp_f32 v28,v144
v_exp_f32 v29,v145
cvt v65,v26,v27
v_exp_f32 v30,v146
v_exp_f32 v31,v147
cvt v66,v28,v29
v_exp_f32 v32,v160
v_exp_f32 v33,v161
cvt v67,v30,v31
v_exp_f32 v34,v162
v_exp_f32 v35,v163
cvt v80,v32,v33
mf v[8:11],v[36:39],v[64:67],0
v_exp_f32 v24,v176
v_exp_f32 v25,v177
cvt v81,v34,v35
v_exp_f32 v26,v178
v_exp_f32 v27,v179
cvt v82,v24,v25
v_exp_f32 v28,v132
v_exp_f32 v29,v133
cvt v83,v26,v27
v_exp_f32 v30,v134
v_exp_f32 v31,v135
cvt v68,v28,v29
mf v[8:11],v[36:39],v[80:83],v[8:11]
v_exp_f32 v32,v148
v_exp_f32 v33,v149
cvt v69,v30,v31
v_exp_f32 v34,v150
v_exp_f32 v35,v151
cvt v70,v32,v33
v_exp_f32 v24,v164
v_exp_f32 v25,v165
cvt v71,v34,v35
v_exp_f32 v26,v166
v_exp_f32 v27,v167
cvt v84,v24,v25
mf v[12:15],v[36:39],v[68:71],0
v_exp_f32 v28,v180
v_exp_f32 v29,v181
cvt v85,v26,v27
v_exp_f32 v30,v182
v_exp_f32 v31,v183
cvt v86,v28,v29
v_exp_f32 v32,v136
v_exp_f32 v33,v137
cvt v87,v30,v31
v_exp_f32 v34,v138
v_exp_f32 v35,v139
cvt v72,v32,v33
mf v[12:15],v[36:39],v[84:87],v[12:15]
v_exp_f32 v24,v152
v_exp_f32 v25,v153
cvt v73,v34,v35
v_exp_f32 v26,v154
v_exp_f32 v27,v155
cvt v74,v24,v25
v_exp_f32 v28,v168
v_exp_f32 v29,v169
cvt v75,v26,v27
v_exp_f32 v30,v170
v_exp_f32 v31,v171
cvt v88,v28,v29
mf v[16:19],v[36:39],v[72:75],0
v_exp_f32 v32,v184
v_exp_f32 v33,v185
cvt v89,v30,v31
v_exp_f32 v34,v186
v_exp_f32 v35,v187
cvt v90,v32,v33
v_exp_f32 v24,v140
v_exp_f32 v25,v141
cvt v91,v34,v35
v_exp_f32 v26,v142
v_exp_f32 v27,v143
cvt v76,v24,v25
mf v[16:19],v[36:39],v[88:91],v[16:19]
v_exp_f32 v28,v156
v_exp_f32 v29,v157
cvt v77,v26,v27
v_exp_f32 v30,v158
v_exp_f32 v31,v159
cvt v78,v28,v29
v_exp_f32 v32,v172
v_exp_f32 v33,v173
cvt v79,v30,v31
v_exp_f32 v34,v174
v_exp_f32 v35,v175
cvt v92,v32,v33
mf v[20:23],v[36:39],v[76:79],0
v_exp_f32 v24,v188
v_exp_f32 v25,v189
cvt v93,v34,v35
v_exp_f32 v26,v190
v_exp_f32 v27,v191
cvt v94,v24,v25
cvt v95,v26,v27
s_nop 1
mf v[20:23],v[36:39],v[92:95],v[20:23]
s_nop 7
s_setpc_b64 s[98:99]
LR02:
v_max3_f32 v24,v192,v193,v194
v_max3_f32 v25,v196,v197,v198
v_max3_f32 v24,v24,v195,v208
v_max3_f32 v25,v25,v199,v212
v_max3_f32 v24,v24,v209,v210
v_max3_f32 v25,v25,v213,v214
v_max3_f32 v24,v24,v211,v224
v_max3_f32 v25,v25,v215,v228
v_max3_f32 v24,v24,v225,v226
v_max3_f32 v25,v25,v229,v230
v_max3_f32 v24,v24,v227,v240
v_max3_f32 v25,v25,v231,v244
v_max3_f32 v24,v24,v241,v242
v_max3_f32 v25,v25,v245,v246
v_max_f32 v24,v24,v243
v_max_f32 v25,v25,v247
v_mov_b32 v28,v24
v_mov_b32 v29,v25
s_nop 0
v_permlane16_swap_b32 v24,v28
v_permlane16_swap_b32 v25,v29
v_max_f32 v24,v24,v28
v_max_f32 v25,v25,v29
v_mov_b32 v28,v24
v_mov_b32 v29,v25
s_nop 0
v_permlane32_swap_b32 v24,v28
v_permlane32_swap_b32 v25,v29
v_max_f32 v24,v24,v28
v_max_f32 v25,v25,v29
v_max_f32 v24,0,v24
v_exp_f32 v28,-v24
v_max_f32 v25,0,v25
v_exp_f32 v29,-v25
v_mul_f32 v40,v40,v28
v_sub_f32 v48,v48,v24
v_sub_f32 v49,v49,v24
v_sub_f32 v50,v50,v24
v_sub_f32 v51,v51,v24
v_sub_f32 v192,v192,v24
v_sub_f32 v193,v193,v24
v_sub_f32 v194,v194,v24
v_sub_f32 v195,v195,v24
v_sub_f32 v208,v208,v24
v_sub_f32 v209,v209,v24
v_sub_f32 v210,v210,v24
v_sub_f32 v211,v211,v24
v_sub_f32 v224,v224,v24
v_sub_f32 v225,v225,v24
v_sub_f32 v226,v226,v24
v_sub_f32 v227,v227,v24
v_sub_f32 v240,v240,v24
v_sub_f32 v241,v241,v24
v_sub_f32 v242,v242,v24
v_sub_f32 v243,v243,v24
v_sub_f32 v128,v128,v24
v_sub_f32 v129,v129,v24
v_sub_f32 v130,v130,v24
v_sub_f32 v131,v131,v24
v_sub_f32 v144,v144,v24
v_sub_f32 v145,v145,v24
v_sub_f32 v146,v146,v24
v_sub_f32 v147,v147,v24
v_sub_f32 v160,v160,v24
v_sub_f32 v161,v161,v24
v_sub_f32 v162,v162,v24
v_sub_f32 v163,v163,v24
v_sub_f32 v176,v176,v24
v_sub_f32 v177,v177,v24
v_sub_f32 v178,v178,v24
v_sub_f32 v179,v179,v24
ard v32,a0
ard v33,a1
ard v34,a2
ard v35,a3
v_mul_f32 v32,v32,v28
v_mul_f32 v33,v33,v28
v_mul_f32 v34,v34,v28
v_mul_f32 v35,v35,v28
awr a0,v32
awr a1,v33
awr a2,v34
awr a3,v35
ard v32,a16
ard v33,a17
ard v34,a18
ard v35,a19
v_mul_f32 v32,v32,v28
v_mul_f32 v33,v33,v28
v_mul_f32 v34,v34,v28
v_mul_f32 v35,v35,v28
awr a16,v32
awr a17,v33
awr a18,v34
awr a19,v35
ard v32,a32
ard v33,a33
ard v34,a34
ard v35,a35
v_mul_f32 v32,v32,v28
v_mul_f32 v33,v33,v28
v_mul_f32 v34,v34,v28
v_mul_f32 v35,v35,v28
awr a32,v32
awr a33,v33
awr a34,v34
awr a35,v35
ard v32,a48
ard v33,a49
ard v34,a50
ard v35,a51
v_mul_f32 v32,v32,v28
v_mul_f32 v33,v33,v28
v_mul_f32 v34,v34,v28
v_mul_f32 v35,v35,v28
awr a48,v32
awr a49,v33
awr a50,v34
awr a51,v35
ard v32,a64
ard v33,a65
ard v34,a66
ard v35,a67
v_mul_f32 v32,v32,v28
v_mul_f32 v33,v33,v28
v_mul_f32 v34,v34,v28
v_mul_f32 v35,v35,v28
awr a64,v32
awr a65,v33
awr a66,v34
awr a67,v35
ard v32,a80
ard v33,a81
ard v34,a82
ard v35,a83
v_mul_f32 v32,v32,v28
v_mul_f32 v33,v33,v28
v_mul_f32 v34,v34,v28
v_mul_f32 v35,v35,v28
awr a80,v32
awr a81,v33
awr a82,v34
awr a83,v35
ard v32,a96
ard v33,a97
ard v34,a98
ard v35,a99
v_mul_f32 v32,v32,v28
v_mul_f32 v33,v33,v28
v_mul_f32 v34,v34,v28
v_mul_f32 v35,v35,v28
awr a96,v32
awr a97,v33
awr a98,v34
awr a99,v35
ard v32,a112
ard v33,a113
ard v34,a114
ard v35,a115
v_mul_f32 v32,v32,v28
v_mul_f32 v33,v33,v28
v_mul_f32 v34,v34,v28
v_mul_f32 v35,v35,v28
awr a112,v32
awr a113,v33
awr a114,v34
awr a115,v35
v_mul_f32 v41,v41,v29
v_sub_f32 v52,v52,v25
v_sub_f32 v53,v53,v25
v_sub_f32 v54,v54,v25
v_sub_f32 v55,v55,v25
v_sub_f32 v196,v196,v25
v_sub_f32 v197,v197,v25
v_sub_f32 v198,v198,v25
v_sub_f32 v199,v199,v25
v_sub_f32 v212,v212,v25
v_sub_f32 v213,v213,v25
v_sub_f32 v214,v214,v25
v_sub_f32 v215,v215,v25
v_sub_f32 v228,v228,v25
v_sub_f32 v229,v229,v25
v_sub_f32 v230,v230,v25
v_sub_f32 v231,v231,v25
v_sub_f32 v244,v244,v25
v_sub_f32 v245,v245,v25
v_sub_f32 v246,v246,v25
v_sub_f32 v247,v247,v25
v_sub_f32 v132,v132,v25
v_sub_f32 v133,v133,v25
v_sub_f32 v134,v134,v25
v_sub_f32 v135,v135,v25
v_sub_f32 v148,v148,v25
v_sub_f32 v149,v149,v25
v_sub_f32 v150,v150,v25
v_sub_f32 v151,v151,v25
v_sub_f32 v164,v164,v25
v_sub_f32 v165,v165,v25
v_sub_f32 v166,v166,v25
v_sub_f32 v167,v167,v25
v_sub_f32 v180,v180,v25
v_sub_f32 v181,v181,v25
v_sub_f32 v182,v182,v25
v_sub_f32 v183,v183,v25
ard v32,a4
ard v33,a5
ard v34,a6
ard v35,a7
v_mul_f32 v32,v32,v29
v_mul_f32 v33,v33,v29
v_mul_f32 v34,v34,v29
v_mul_f32 v35,v35,v29
awr a4,v32
awr a5,v33
awr a6,v34
awr a7,v35
ard v32,a20
ard v33,a21
ard v34,a22
ard v35,a23
v_mul_f32 v32,v32,v29
v_mul_f32 v33,v33,v29
v_mul_f32 v34,v34,v29
v_mul_f32 v35,v35,v29
awr a20,v32
awr a21,v33
awr a22,v34
awr a23,v35
ard v32,a36
ard v33,a37
ard v34,a38
ard v35,a39
v_mul_f32 v32,v32,v29
v_mul_f32 v33,v33,v29
v_mul_f32 v34,v34,v29
v_mul_f32 v35,v35,v29
awr a36,v32
awr a37,v33
awr a38,v34
awr a39,v35
ard v32,a52
ard v33,a53
ard v34,a54
ard v35,a55
v_mul_f32 v32,v32,v29
v_mul_f32 v33,v33,v29
v_mul_f32 v34,v34,v29
v_mul_f32 v35,v35,v29
awr a52,v32
awr a53,v33
awr a54,v34
awr a55,v35
ard v32,a68
ard v33,a69
ard v34,a70
ard v35,a71
v_mul_f32 v32,v32,v29
v_mul_f32 v33,v33,v29
v_mul_f32 v34,v34,v29
v_mul_f32 v35,v35,v29
awr a68,v32
awr a69,v33
awr a70,v34
awr a71,v35
ard v32,a84
ard v33,a85
ard v34,a86
ard v35,a87
v_mul_f32 v32,v32,v29
v_mul_f32 v33,v33,v29
v_mul_f32 v34,v34,v29
v_mul_f32 v35,v35,v29
awr a84,v32
awr a85,v33
awr a86,v34
awr a87,v35
ard v32,a100
ard v33,a101
ard v34,a102
ard v35,a103
v_mul_f32 v32,v32,v29
v_mul_f32 v33,v33,v29
v_mul_f32 v34,v34,v29
v_mul_f32 v35,v35,v29
awr a100,v32
awr a101,v33
awr a102,v34
awr a103,v35
ard v32,a116
ard v33,a117
ard v34,a118
ard v35,a119
v_mul_f32 v32,v32,v29
v_mul_f32 v33,v33,v29
v_mul_f32 v34,v34,v29
v_mul_f32 v35,v35,v29
awr a116,v32
awr a117,v33
awr a118,v34
awr a119,v35
v_exp_f32 v24,v192
v_exp_f32 v25,v193
v_exp_f32 v26,v194
v_exp_f32 v27,v195
cvt v96,v24,v25
v_exp_f32 v28,v208
v_exp_f32 v29,v209
cvt v97,v26,v27
v_exp_f32 v30,v210
v_exp_f32 v31,v211
cvt v98,v28,v29
v_exp_f32 v32,v224
v_exp_f32 v33,v225
cvt v99,v30,v31
v_exp_f32 v34,v226
v_exp_f32 v35,v227
cvt v112,v32,v33
mf v[8:11],v[36:39],v[96:99],0
v_exp_f32 v24,v240
v_exp_f32 v25,v241
cvt v113,v34,v35
v_exp_f32 v26,v242
v_exp_f32 v27,v243
cvt v114,v24,v25
v_exp_f32 v28,v196
v_exp_f32 v29,v197
cvt v115,v26,v27
v_exp_f32 v30,v198
v_exp_f32 v31,v199
cvt v100,v28,v29
mf v[8:11],v[36:39],v[112:115],v[8:11]
v_exp_f32 v32,v212
v_exp_f32 v33,v213
cvt v101,v30,v31
v_exp_f32 v34,v214
v_exp_f32 v35,v215
cvt v102,v32,v33
v_exp_f32 v24,v228
v_exp_f32 v25,v229
cvt v103,v34,v35
v_exp_f32 v26,v230
v_exp_f32 v27,v231
cvt v116,v24,v25
mf v[12:15],v[36:39],v[100:103],0
v_exp_f32 v28,v244
v_exp_f32 v29,v245
cvt v117,v26,v27
v_exp_f32 v30,v246
v_exp_f32 v31,v247
cvt v118,v28,v29
cvt v119,v30,v31
s_nop 1
mf v[12:15],v[36:39],v[116:119],v[12:15]
s_nop 7
s_setpc_b64 s[98:99]
LR12:
v_max3_f32 v24,v128,v129,v130
v_max3_f32 v25,v132,v133,v134
v_max3_f32 v24,v24,v131,v144
v_max3_f32 v25,v25,v135,v148
v_max3_f32 v24,v24,v145,v146
v_max3_f32 v25,v25,v149,v150
v_max3_f32 v24,v24,v147,v160
v_max3_f32 v25,v25,v151,v164
v_max3_f32 v24,v24,v161,v162
v_max3_f32 v25,v25,v165,v166
v_max3_f32 v24,v24,v163,v176
v_max3_f32 v25,v25,v167,v180
v_max3_f32 v24,v24,v177,v178
v_max3_f32 v25,v25,v181,v182
v_max_f32 v24,v24,v179
v_max_f32 v25,v25,v183
v_mov_b32 v28,v24
v_mov_b32 v29,v25
s_nop 0
v_permlane16_swap_b32 v24,v28
v_permlane16_swap_b32 v25,v29
v_max_f32 v24,v24,v28
v_max_f32 v25,v25,v29
v_mov_b32 v28,v24
v_mov_b32 v29,v25
s_nop 0
v_permlane32_swap_b32 v24,v28
v_permlane32_swap_b32 v25,v29
v_max_f32 v24,v24,v28
v_max_f32 v25,v25,v29
v_max_f32 v24,0,v24
v_exp_f32 v28,-v24
v_max_f32 v25,0,v25
v_exp_f32 v29,-v25
v_mul_f32 v40,v40,v28
v_sub_f32 v48,v48,v24
v_sub_f32 v49,v49,v24
v_sub_f32 v50,v50,v24
v_sub_f32 v51,v51,v24
v_sub_f32 v128,v128,v24
v_sub_f32 v129,v129,v24
v_sub_f32 v130,v130,v24
v_sub_f32 v131,v131,v24
v_sub_f32 v144,v144,v24
v_sub_f32 v145,v145,v24
v_sub_f32 v146,v146,v24
v_sub_f32 v147,v147,v24
v_sub_f32 v160,v160,v24
v_sub_f32 v161,v161,v24
v_sub_f32 v162,v162,v24
v_sub_f32 v163,v163,v24
v_sub_f32 v176,v176,v24
v_sub_f32 v177,v177,v24
v_sub_f32 v178,v178,v24
v_sub_f32 v179,v179,v24
v_sub_f32 v192,v192,v24
v_sub_f32 v193,v193,v24
v_sub_f32 v194,v194,v24
v_sub_f32 v195,v195,v24
v_sub_f32 v208,v208,v24
v_sub_f32 v209,v209,v24
v_sub_f32 v210,v210,v24
v_sub_f32 v211,v211,v24
v_sub_f32 v224,v224,v24
v_sub_f32 v225,v225,v24
v_sub_f32 v226,v226,v24
v_sub_f32 v227,v227,v24
v_sub_f32 v240,v240,v24
v_sub_f32 v241,v241,v24
v_sub_f32 v242,v242,v24
v_sub_f32 v243,v243,v24
ard v32,a0
ard v33,a1
ard v34,a2
ard v35,a3
v_mul_f32 v32,v32,v28
v_mul_f32 v33,v33,v28
v_mul_f32 v34,v34,v28
v_mul_f32 v35,v35,v28
awr a0,v32
awr a1,v33
awr a2,v34
awr a3,v35
ard v32,a16
ard v33,a17
ard v34,a18
ard v35,a19
v_mul_f32 v32,v32,v28
v_mul_f32 v33,v33,v28
v_mul_f32 v34,v34,v28
v_mul_f32 v35,v35,v28
awr a16,v32
awr a17,v33
awr a18,v34
awr a19,v35
ard v32,a32
ard v33,a33
ard v34,a34
ard v35,a35
v_mul_f32 v32,v32,v28
v_mul_f32 v33,v33,v28
v_mul_f32 v34,v34,v28
v_mul_f32 v35,v35,v28
awr a32,v32
awr a33,v33
awr a34,v34
awr a35,v35
ard v32,a48
ard v33,a49
ard v34,a50
ard v35,a51
v_mul_f32 v32,v32,v28
v_mul_f32 v33,v33,v28
v_mul_f32 v34,v34,v28
v_mul_f32 v35,v35,v28
awr a48,v32
awr a49,v33
awr a50,v34
awr a51,v35
ard v32,a64
ard v33,a65
ard v34,a66
ard v35,a67
v_mul_f32 v32,v32,v28
v_mul_f32 v33,v33,v28
v_mul_f32 v34,v34,v28
v_mul_f32 v35,v35,v28
awr a64,v32
awr a65,v33
awr a66,v34
awr a67,v35
ard v32,a80
ard v33,a81
ard v34,a82
ard v35,a83
v_mul_f32 v32,v32,v28
v_mul_f32 v33,v33,v28
v_mul_f32 v34,v34,v28
v_mul_f32 v35,v35,v28
awr a80,v32
awr a81,v33
awr a82,v34
awr a83,v35
ard v32,a96
ard v33,a97
ard v34,a98
ard v35,a99
v_mul_f32 v32,v32,v28
v_mul_f32 v33,v33,v28
v_mul_f32 v34,v34,v28
v_mul_f32 v35,v35,v28
awr a96,v32
awr a97,v33
awr a98,v34
awr a99,v35
ard v32,a112
ard v33,a113
ard v34,a114
ard v35,a115
v_mul_f32 v32,v32,v28
v_mul_f32 v33,v33,v28
v_mul_f32 v34,v34,v28
v_mul_f32 v35,v35,v28
awr a112,v32
awr a113,v33
awr a114,v34
awr a115,v35
v_mul_f32 v41,v41,v29
v_sub_f32 v52,v52,v25
v_sub_f32 v53,v53,v25
v_sub_f32 v54,v54,v25
v_sub_f32 v55,v55,v25
v_sub_f32 v132,v132,v25
v_sub_f32 v133,v133,v25
v_sub_f32 v134,v134,v25
v_sub_f32 v135,v135,v25
v_sub_f32 v148,v148,v25
v_sub_f32 v149,v149,v25
v_sub_f32 v150,v150,v25
v_sub_f32 v151,v151,v25
v_sub_f32 v164,v164,v25
v_sub_f32 v165,v165,v25
v_sub_f32 v166,v166,v25
v_sub_f32 v167,v167,v25
v_sub_f32 v180,v180,v25
v_sub_f32 v181,v181,v25
v_sub_f32 v182,v182,v25
v_sub_f32 v183,v183,v25
v_sub_f32 v196,v196,v25
v_sub_f32 v197,v197,v25
v_sub_f32 v198,v198,v25
v_sub_f32 v199,v199,v25
v_sub_f32 v212,v212,v25
v_sub_f32 v213,v213,v25
v_sub_f32 v214,v214,v25
v_sub_f32 v215,v215,v25
v_sub_f32 v228,v228,v25
v_sub_f32 v229,v229,v25
v_sub_f32 v230,v230,v25
v_sub_f32 v231,v231,v25
v_sub_f32 v244,v244,v25
v_sub_f32 v245,v245,v25
v_sub_f32 v246,v246,v25
v_sub_f32 v247,v247,v25
ard v32,a4
ard v33,a5
ard v34,a6
ard v35,a7
v_mul_f32 v32,v32,v29
v_mul_f32 v33,v33,v29
v_mul_f32 v34,v34,v29
v_mul_f32 v35,v35,v29
awr a4,v32
awr a5,v33
awr a6,v34
awr a7,v35
ard v32,a20
ard v33,a21
ard v34,a22
ard v35,a23
v_mul_f32 v32,v32,v29
v_mul_f32 v33,v33,v29
v_mul_f32 v34,v34,v29
v_mul_f32 v35,v35,v29
awr a20,v32
awr a21,v33
awr a22,v34
awr a23,v35
ard v32,a36
ard v33,a37
ard v34,a38
ard v35,a39
v_mul_f32 v32,v32,v29
v_mul_f32 v33,v33,v29
v_mul_f32 v34,v34,v29
v_mul_f32 v35,v35,v29
awr a36,v32
awr a37,v33
awr a38,v34
awr a39,v35
ard v32,a52
ard v33,a53
ard v34,a54
ard v35,a55
v_mul_f32 v32,v32,v29
v_mul_f32 v33,v33,v29
v_mul_f32 v34,v34,v29
v_mul_f32 v35,v35,v29
awr a52,v32
awr a53,v33
awr a54,v34
awr a55,v35
ard v32,a68
ard v33,a69
ard v34,a70
ard v35,a71
v_mul_f32 v32,v32,v29
v_mul_f32 v33,v33,v29
v_mul_f32 v34,v34,v29
v_mul_f32 v35,v35,v29
awr a68,v32
awr a69,v33
awr a70,v34
awr a71,v35
ard v32,a84
ard v33,a85
ard v34,a86
ard v35,a87
v_mul_f32 v32,v32,v29
v_mul_f32 v33,v33,v29
v_mul_f32 v34,v34,v29
v_mul_f32 v35,v35,v29
awr a84,v32
awr a85,v33
awr a86,v34
awr a87,v35
ard v32,a100
ard v33,a101
ard v34,a102
ard v35,a103
v_mul_f32 v32,v32,v29
v_mul_f32 v33,v33,v29
v_mul_f32 v34,v34,v29
v_mul_f32 v35,v35,v29
awr a100,v32
awr a101,v33
awr a102,v34
awr a103,v35
ard v32,a116
ard v33,a117
ard v34,a118
ard v35,a119
v_mul_f32 v32,v32,v29
v_mul_f32 v33,v33,v29
v_mul_f32 v34,v34,v29
v_mul_f32 v35,v35,v29
awr a116,v32
awr a117,v33
awr a118,v34
awr a119,v35
v_exp_f32 v24,v128
v_exp_f32 v25,v129
v_exp_f32 v26,v130
v_exp_f32 v27,v131
cvt v64,v24,v25
v_exp_f32 v28,v144
v_exp_f32 v29,v145
cvt v65,v26,v27
v_exp_f32 v30,v146
v_exp_f32 v31,v147
cvt v66,v28,v29
v_exp_f32 v32,v160
v_exp_f32 v33,v161
cvt v67,v30,v31
v_exp_f32 v34,v162
v_exp_f32 v35,v163
cvt v80,v32,v33
mf v[8:11],v[36:39],v[64:67],0
v_exp_f32 v24,v176
v_exp_f32 v25,v177
cvt v81,v34,v35
v_exp_f32 v26,v178
v_exp_f32 v27,v179
cvt v82,v24,v25
v_exp_f32 v28,v132
v_exp_f32 v29,v133
cvt v83,v26,v27
v_exp_f32 v30,v134
v_exp_f32 v31,v135
cvt v68,v28,v29
mf v[8:11],v[36:39],v[80:83],v[8:11]
v_exp_f32 v32,v148
v_exp_f32 v33,v149
cvt v69,v30,v31
v_exp_f32 v34,v150
v_exp_f32 v35,v151
cvt v70,v32,v33
v_exp_f32 v24,v164
v_exp_f32 v25,v165
cvt v71,v34,v35
v_exp_f32 v26,v166
v_exp_f32 v27,v167
cvt v84,v24,v25
mf v[12:15],v[36:39],v[68:71],0
v_exp_f32 v28,v180
v_exp_f32 v29,v181
cvt v85,v26,v27
v_exp_f32 v30,v182
v_exp_f32 v31,v183
cvt v86,v28,v29
cvt v87,v30,v31
s_nop 1
mf v[12:15],v[36:39],v[84:87],v[12:15]
s_nop 7
s_setpc_b64 s[98:99]
LR03:
v_max3_f32 v24,v192,v193,v194
v_max3_f32 v25,v196,v197,v198
v_max3_f32 v27,v204,v205,v206
v_max3_f32 v24,v24,v195,v208
v_max3_f32 v25,v25,v199,v212
v_max3_f32 v27,v27,v207,v220
v_max3_f32 v24,v24,v209,v210
v_max3_f32 v25,v25,v213,v214
v_max3_f32 v27,v27,v221,v222
v_max3_f32 v24,v24,v211,v224
v_max3_f32 v25,v25,v215,v228
v_max3_f32 v27,v27,v223,v236
v_max3_f32 v24,v24,v225,v226
v_max3_f32 v25,v25,v229,v230
v_max3_f32 v27,v27,v237,v238
v_max3_f32 v24,v24,v227,v240
v_max3_f32 v25,v25,v231,v244
v_max3_f32 v27,v27,v239,v252
v_max3_f32 v24,v24,v241,v242
v_max3_f32 v25,v25,v245,v246
v_max3_f32 v27,v27,v253,v254
v_max_f32 v24,v24,v243
v_max_f32 v25,v25,v247
v_max_f32 v27,v27,v255
v_mov_b32 v28,v24
v_mov_b32 v29,v25
v_mov_b32 v31,v27
v_permlane16_swap_b32 v24,v28
v_permlane16_swap_b32 v25,v29
v_permlane16_swap_b32 v27,v31
v_max_f32 v24,v24,v28
v_max_f32 v25,v25,v29
v_max_f32 v27,v27,v31
v_mov_b32 v28,v24
v_mov_b32 v29,v25
v_mov_b32 v31,v27
v_permlane32_swap_b32 v24,v28
v_permlane32_swap_b32 v25,v29
v_permlane32_swap_b32 v27,v31
v_max_f32 v24,v24,v28
v_max_f32 v25,v25,v29
v_max_f32 v27,v27,v31
v_max_f32 v24,0,v24
v_exp_f32 v28,-v24
v_max_f32 v25,0,v25
v_exp_f32 v29,-v25
v_max_f32 v27,0,v27
v_exp_f32 v31,-v27
v_mul_f32 v40,v40,v28
v_sub_f32 v48,v48,v24
v_sub_f32 v49,v49,v24
v_sub_f32 v50,v50,v24
v_sub_f32 v51,v51,v24
v_sub_f32 v192,v192,v24
v_sub_f32 v193,v193,v24
v_sub_f32 v194,v194,v24
v_sub_f32 v195,v195,v24
v_sub_f32 v208,v208,v24
v_sub_f32 v209,v209,v24
v_sub_f32 v210,v210,v24
v_sub_f32 v211,v211,v24
v_sub_f32 v224,v224,v24
v_sub_f32 v225,v225,v24
v_sub_f32 v226,v226,v24
v_sub_f32 v227,v227,v24
v_sub_f32 v240,v240,v24
v_sub_f32 v241,v241,v24
v_sub_f32 v242,v242,v24
v_sub_f32 v243,v243,v24
v_sub_f32 v128,v128,v24
v_sub_f32 v129,v129,v24
v_sub_f32 v130,v130,v24
v_sub_f32 v131,v131,v24
v_sub_f32 v144,v144,v24
v_sub_f32 v145,v145,v24
v_sub_f32 v146,v146,v24
v_sub_f32 v147,v147,v24
v_sub_f32 v160,v160,v24
v_sub_f32 v161,v161,v24
v_sub_f32 v162,v162,v24
v_sub_f32 v163,v163,v24
v_sub_f32 v176,v176,v24
v_sub_f32 v177,v177,v24
v_sub_f32 v178,v178,v24
v_sub_f32 v179,v179,v24
ard v32,a0
ard v33,a1
ard v34,a2
ard v35,a3
v_mul_f32 v32,v32,v28
v_mul_f32 v33,v33,v28
v_mul_f32 v34,v34,v28
v_mul_f32 v35,v35,v28
awr a0,v32
awr a1,v33
awr a2,v34
awr a3,v35
ard v32,a16
ard v33,a17
ard v34,a18
ard v35,a19
v_mul_f32 v32,v32,v28
v_mul_f32 v33,v33,v28
v_mul_f32 v34,v34,v28
v_mul_f32 v35,v35,v28
awr a16,v32
awr a17,v33
awr a18,v34
awr a19,v35
ard v32,a32
ard v33,a33
ard v34,a34
ard v35,a35
v_mul_f32 v32,v32,v28
v_mul_f32 v33,v33,v28
v_mul_f32 v34,v34,v28
v_mul_f32 v35,v35,v28
awr a32,v32
awr a33,v33
awr a34,v34
awr a35,v35
ard v32,a48
ard v33,a49
ard v34,a50
ard v35,a51
v_mul_f32 v32,v32,v28
v_mul_f32 v33,v33,v28
v_mul_f32 v34,v34,v28
v_mul_f32 v35,v35,v28
awr a48,v32
awr a49,v33
awr a50,v34
awr a51,v35
ard v32,a64
ard v33,a65
ard v34,a66
ard v35,a67
v_mul_f32 v32,v32,v28
v_mul_f32 v33,v33,v28
v_mul_f32 v34,v34,v28
v_mul_f32 v35,v35,v28
awr a64,v32
awr a65,v33
awr a66,v34
awr a67,v35
ard v32,a80
ard v33,a81
ard v34,a82
ard v35,a83
v_mul_f32 v32,v32,v28
v_mul_f32 v33,v33,v28
v_mul_f32 v34,v34,v28
v_mul_f32 v35,v35,v28
awr a80,v32
awr a81,v33
awr a82,v34
awr a83,v35
ard v32,a96
ard v33,a97
ard v34,a98
ard v35,a99
v_mul_f32 v32,v32,v28
v_mul_f32 v33,v33,v28
v_mul_f32 v34,v34,v28
v_mul_f32 v35,v35,v28
awr a96,v32
awr a97,v33
awr a98,v34
awr a99,v35
ard v32,a112
ard v33,a113
ard v34,a114
ard v35,a115
v_mul_f32 v32,v32,v28
v_mul_f32 v33,v33,v28
v_mul_f32 v34,v34,v28
v_mul_f32 v35,v35,v28
awr a112,v32
awr a113,v33
awr a114,v34
awr a115,v35
v_mul_f32 v41,v41,v29
v_sub_f32 v52,v52,v25
v_sub_f32 v53,v53,v25
v_sub_f32 v54,v54,v25
v_sub_f32 v55,v55,v25
v_sub_f32 v196,v196,v25
v_sub_f32 v197,v197,v25
v_sub_f32 v198,v198,v25
v_sub_f32 v199,v199,v25
v_sub_f32 v212,v212,v25
v_sub_f32 v213,v213,v25
v_sub_f32 v214,v214,v25
v_sub_f32 v215,v215,v25
v_sub_f32 v228,v228,v25
v_sub_f32 v229,v229,v25
v_sub_f32 v230,v230,v25
v_sub_f32 v231,v231,v25
v_sub_f32 v244,v244,v25
v_sub_f32 v245,v245,v25
v_sub_f32 v246,v246,v25
v_sub_f32 v247,v247,v25
v_sub_f32 v132,v132,v25
v_sub_f32 v133,v133,v25
v_sub_f32 v134,v134,v25
v_sub_f32 v135,v135,v25
v_sub_f32 v148,v148,v25
v_sub_f32 v149,v149,v25
v_sub_f32 v150,v150,v25
v_sub_f32 v151,v151,v25
v_sub_f32 v164,v164,v25
v_sub_f32 v165,v165,v25
v_sub_f32 v166,v166,v25
v_sub_f32 v167,v167,v25
v_sub_f32 v180,v180,v25
v_sub_f32 v181,v181,v25
v_sub_f32 v182,v182,v25
v_sub_f32 v183,v183,v25
ard v32,a4
ard v33,a5
ard v34,a6
ard v35,a7
v_mul_f32 v32,v32,v29
v_mul_f32 v33,v33,v29
v_mul_f32 v34,v34,v29
v_mul_f32 v35,v35,v29
awr a4,v32
awr a5,v33
awr a6,v34
awr a7,v35
ard v32,a20
ard v33,a21
ard v34,a22
ard v35,a23
v_mul_f32 v32,v32,v29
v_mul_f32 v33,v33,v29
v_mul_f32 v34,v34,v29
v_mul_f32 v35,v35,v29
awr a20,v32
awr a21,v33
awr a22,v34
awr a23,v35
ard v32,a36
ard v33,a37
ard v34,a38
ard v35,a39
v_mul_f32 v32,v32,v29
v_mul_f32 v33,v33,v29
v_mul_f32 v34,v34,v29
v_mul_f32 v35,v35,v29
awr a36,v32
awr a37,v33
awr a38,v34
awr a39,v35
ard v32,a52
ard v33,a53
ard v34,a54
ard v35,a55
v_mul_f32 v32,v32,v29
v_mul_f32 v33,v33,v29
v_mul_f32 v34,v34,v29
v_mul_f32 v35,v35,v29
awr a52,v32
awr a53,v33
awr a54,v34
awr a55,v35
ard v32,a68
ard v33,a69
ard v34,a70
ard v35,a71
v_mul_f32 v32,v32,v29
v_mul_f32 v33,v33,v29
v_mul_f32 v34,v34,v29
v_mul_f32 v35,v35,v29
awr a68,v32
awr a69,v33
awr a70,v34
awr a71,v35
ard v32,a84
ard v33,a85
ard v34,a86
ard v35,a87
v_mul_f32 v32,v32,v29
v_mul_f32 v33,v33,v29
v_mul_f32 v34,v34,v29
v_mul_f32 v35,v35,v29
awr a84,v32
awr a85,v33
awr a86,v34
awr a87,v35
ard v32,a100
ard v33,a101
ard v34,a102
ard v35,a103
v_mul_f32 v32,v32,v29
v_mul_f32 v33,v33,v29
v_mul_f32 v34,v34,v29
v_mul_f32 v35,v35,v29
awr a100,v32
awr a101,v33
awr a102,v34
awr a103,v35
ard v32,a116
ard v33,a117
ard v34,a118
ard v35,a119
v_mul_f32 v32,v32,v29
v_mul_f32 v33,v33,v29
v_mul_f32 v34,v34,v29
v_mul_f32 v35,v35,v29
awr a116,v32
awr a117,v33
awr a118,v34
awr a119,v35
v_mul_f32 v43,v43,v31
v_sub_f32 v60,v60,v27
v_sub_f32 v61,v61,v27
v_sub_f32 v62,v62,v27
v_sub_f32 v63,v63,v27
v_sub_f32 v204,v204,v27
v_sub_f32 v205,v205,v27
v_sub_f32 v206,v206,v27
v_sub_f32 v207,v207,v27
v_sub_f32 v220,v220,v27
v_sub_f32 v221,v221,v27
v_sub_f32 v222,v222,v27
v_sub_f32 v223,v223,v27
v_sub_f32 v236,v236,v27
v_sub_f32 v237,v237,v27
v_sub_f32 v238,v238,v27
v_sub_f32 v239,v239,v27
v_sub_f32 v252,v252,v27
v_sub_f32 v253,v253,v27
v_sub_f32 v254,v254,v27
v_sub_f32 v255,v255,v27
v_sub_f32 v140,v140,v27
v_sub_f32 v141,v141,v27
v_sub_f32 v142,v142,v27
v_sub_f32 v143,v143,v27
v_sub_f32 v156,v156,v27
v_sub_f32 v157,v157,v27
v_sub_f32 v158,v158,v27
v_sub_f32 v159,v159,v27
v_sub_f32 v172,v172,v27
v_sub_f32 v173,v173,v27
v_sub_f32 v174,v174,v27
v_sub_f32 v175,v175,v27
v_sub_f32 v188,v188,v27
v_sub_f32 v189,v189,v27
v_sub_f32 v190,v190,v27
v_sub_f32 v191,v191,v27
ard v32,a12
ard v33,a13
ard v34,a14
ard v35,a15
v_mul_f32 v32,v32,v31
v_mul_f32 v33,v33,v31
v_mul_f32 v34,v34,v31
v_mul_f32 v35,v35,v31
awr a12,v32
awr a13,v33
awr a14,v34
awr a15,v35
ard v32,a28
ard v33,a29
ard v34,a30
ard v35,a31
v_mul_f32 v32,v32,v31
v_mul_f32 v33,v33,v31
v_mul_f32 v34,v34,v31
v_mul_f32 v35,v35,v31
awr a28,v32
awr a29,v33
awr a30,v34
awr a31,v35
ard v32,a44
ard v33,a45
ard v34,a46
ard v35,a47
v_mul_f32 v32,v32,v31
v_mul_f32 v33,v33,v31
v_mul_f32 v34,v34,v31
v_mul_f32 v35,v35,v31
awr a44,v32
awr a45,v33
awr a46,v34
awr a47,v35
ard v32,a60
ard v33,a61
ard v34,a62
ard v35,a63
v_mul_f32 v32,v32,v31
v_mul_f32 v33,v33,v31
v_mul_f32 v34,v34,v31
v_mul_f32 v35,v35,v31
awr a60,v32
awr a61,v33
awr a62,v34
awr a63,v35
ard v32,a76
ard v33,a77
ard v34,a78
ard v35,a79
v_mul_f32 v32,v32,v31
v_mul_f32 v33,v33,v31
v_mul_f32 v34,v34,v31
v_mul_f32 v35,v35,v31
awr a76,v32
awr a77,v33
awr a78,v34
awr a79,v35
ard v32,a92
ard v33,a93
ard v34,a94
ard v35,a95
v_mul_f32 v32,v32,v31
v_mul_f32 v33,v33,v31
v_mul_f32 v34,v34,v31
v_mul_f32 v35,v35,v31
awr a92,v32
awr a93,v33
awr a94,v34
awr a95,v35
ard v32,a108
ard v33,a109
ard v34,a110
ard v35,a111
v_mul_f32 v32,v32,v31
v_mul_f32 v33,v33,v31
v_mul_f32 v34,v34,v31
v_mul_f32 v35,v35,v31
awr a108,v32
awr a109,v33
awr a110,v34
awr a111,v35
ard v32,a124
ard v33,a125
ard v34,a126
ard v35,a127
v_mul_f32 v32,v32,v31
v_mul_f32 v33,v33,v31
v_mul_f32 v34,v34,v31
v_mul_f32 v35,v35,v31
awr a124,v32
awr a125,v33
awr a126,v34
awr a127,v35
v_exp_f32 v24,v192
v_exp_f32 v25,v193
v_exp_f32 v26,v194
v_exp_f32 v27,v195
cvt v96,v24,v25
v_exp_f32 v28,v208
v_exp_f32 v29,v209
cvt v97,v26,v27
v_exp_f32 v30,v210
v_exp_f32 v31,v211
cvt v98,v28,v29
v_exp_f32 v32,v224
v_exp_f32 v33,v225
cvt v99,v30,v31
v_exp_f32 v34,v226
v_exp_f32 v35,v227
cvt v112,v32,v33
mf v[8:11],v[36:39],v[96:99],0
v_exp_f32 v24,v240
v_exp_f32 v25,v241
cvt v113,v34,v35
v_exp_f32 v26,v242
v_exp_f32 v27,v243
cvt v114,v24,v25
v_exp_f32 v28,v196
v_exp_f32 v29,v197
cvt v115,v26,v27
v_exp_f32 v30,v198
v_exp_f32 v31,v199
cvt v100,v28,v29
mf v[8:11],v[36:39],v[112:115],v[8:11]
v_exp_f32 v32,v212
v_exp_f32 v33,v213
cvt v101,v30,v31
v_exp_f32 v34,v214
v_exp_f32 v35,v215
cvt v102,v32,v33
v_exp_f32 v24,v228
v_exp_f32 v25,v229
cvt v103,v34,v35
v_exp_f32 v26,v230
v_exp_f32 v27,v231
cvt v116,v24,v25
mf v[12:15],v[36:39],v[100:103],0
v_exp_f32 v28,v244
v_exp_f32 v29,v245
cvt v117,v26,v27
v_exp_f32 v30,v246
v_exp_f32 v31,v247
cvt v118,v28,v29
v_exp_f32 v32,v204
v_exp_f32 v33,v205
cvt v119,v30,v31
v_exp_f32 v34,v206
v_exp_f32 v35,v207
cvt v108,v32,v33
mf v[12:15],v[36:39],v[116:119],v[12:15]
v_exp_f32 v24,v220
v_exp_f32 v25,v221
cvt v109,v34,v35
v_exp_f32 v26,v222
v_exp_f32 v27,v223
cvt v110,v24,v25
v_exp_f32 v28,v236
v_exp_f32 v29,v237
cvt v111,v26,v27
v_exp_f32 v30,v238
v_exp_f32 v31,v239
cvt v124,v28,v29
mf v[20:23],v[36:39],v[108:111],0
v_exp_f32 v32,v252
v_exp_f32 v33,v253
cvt v125,v30,v31
v_exp_f32 v34,v254
v_exp_f32 v35,v255
cvt v126,v32,v33
cvt v127,v34,v35
s_nop 1
mf v[20:23],v[36:39],v[124:127],v[20:23]
s_nop 7
s_setpc_b64 s[98:99]
LR01:
v_max3_f32 v25,v196,v197,v198
v_max3_f32 v25,v25,v199,v212
v_max3_f32 v25,v25,v213,v214
v_max3_f32 v25,v25,v215,v228
v_max3_f32 v25,v25,v229,v230
v_max3_f32 v25,v25,v231,v244
v_max3_f32 v25,v25,v245,v246
v_max_f32 v25,v25,v247
v_mov_b32 v29,v25
s_nop 1
v_permlane16_swap_b32 v25,v29
v_max_f32 v25,v25,v29
v_mov_b32 v29,v25
s_nop 1
v_permlane32_swap_b32 v25,v29
v_max_f32 v25,v25,v29
v_max_f32 v25,0,v25
v_exp_f32 v29,-v25
s_nop 0
v_mul_f32 v41,v41,v29
v_sub_f32 v52,v52,v25
v_sub_f32 v53,v53,v25
v_sub_f32 v54,v54,v25
v_sub_f32 v55,v55,v25
v_sub_f32 v196,v196,v25
v_sub_f32 v197,v197,v25
v_sub_f32 v198,v198,v25
v_sub_f32 v199,v199,v25
v_sub_f32 v212,v212,v25
v_sub_f32 v213,v213,v25
v_sub_f32 v214,v214,v25
v_sub_f32 v215,v215,v25
v_sub_f32 v228,v228,v25
v_sub_f32 v229,v229,v25
v_sub_f32 v230,v230,v25
v_sub_f32 v231,v231,v25
v_sub_f32 v244,v244,v25
v_sub_f32 v245,v245,v25
v_sub_f32 v246,v246,v25
v_sub_f32 v247,v247,v25
v_sub_f32 v132,v132,v25
v_sub_f32 v133,v133,v25
v_sub_f32 v134,v134,v25
v_sub_f32 v135,v135,v25
v_sub_f32 v148,v148,v25
v_sub_f32 v149,v149,v25
v_sub_f32 v150,v150,v25
v_sub_f32 v151,v151,v25
v_sub_f32 v164,v164,v25
v_sub_f32 v165,v165,v25
v_sub_f32 v166,v166,v25
v_sub_f32 v167,v167,v25
v_sub_f32 v180,v180,v25
v_sub_f32 v181,v181,v25
v_sub_f32 v182,v182,v25
v_sub_f32 v183,v183,v25
ard v32,a4
ard v33,a5
ard v34,a6
ard v35,a7
v_mul_f32 v32,v32,v29
v_mul_f32 v33,v33,v29
v_mul_f32 v34,v34,v29
v_mul_f32 v35,v35,v29
awr a4,v32
awr a5,v33
awr a6,v34
awr a7,v35
ard v32,a20
ard v33,a21
ard v34,a22
ard v35,a23
v_mul_f32 v32,v32,v29
v_mul_f32 v33,v33,v29
v_mul_f32 v34,v34,v29
v_mul_f32 v35,v35,v29
awr a20,v32
awr a21,v33
awr a22,v34
awr a23,v35
ard v32,a36
ard v33,a37
ard v34,a38
ard v35,a39
v_mul_f32 v32,v32,v29
v_mul_f32 v33,v33,v29
v_mul_f32 v34,v34,v29
v_mul_f32 v35,v35,v29
awr a36,v32
awr a37,v33
awr a38,v34
awr a39,v35
ard v32,a52
ard v33,a53
ard v34,a54
ard v35,a55
v_mul_f32 v32,v32,v29
v_mul_f32 v33,v33,v29
v_mul_f32 v34,v34,v29
v_mul_f32 v35,v35,v29
awr a52,v32
awr a53,v33
awr a54,v34
awr a55,v35
ard v32,a68
ard v33,a69
ard v34,a70
ard v35,a71
v_mul_f32 v32,v32,v29
v_mul_f32 v33,v33,v29
v_mul_f32 v34,v34,v29
v_mul_f32 v35,v35,v29
awr a68,v32
awr a69,v33
awr a70,v34
awr a71,v35
ard v32,a84
ard v33,a85
ard v34,a86
ard v35,a87
v_mul_f32 v32,v32,v29
v_mul_f32 v33,v33,v29
v_mul_f32 v34,v34,v29
v_mul_f32 v35,v35,v29
awr a84,v32
awr a85,v33
awr a86,v34
awr a87,v35
ard v32,a100
ard v33,a101
ard v34,a102
ard v35,a103
v_mul_f32 v32,v32,v29
v_mul_f32 v33,v33,v29
v_mul_f32 v34,v34,v29
v_mul_f32 v35,v35,v29
awr a100,v32
awr a101,v33
awr a102,v34
awr a103,v35
ard v32,a116
ard v33,a117
ard v34,a118
ard v35,a119
v_mul_f32 v32,v32,v29
v_mul_f32 v33,v33,v29
v_mul_f32 v34,v34,v29
v_mul_f32 v35,v35,v29
awr a116,v32
awr a117,v33
awr a118,v34
awr a119,v35
v_exp_f32 v24,v196
v_exp_f32 v25,v197
v_exp_f32 v26,v198
v_exp_f32 v27,v199
cvt v100,v24,v25
v_exp_f32 v28,v212
v_exp_f32 v29,v213
cvt v101,v26,v27
v_exp_f32 v30,v214
v_exp_f32 v31,v215
cvt v102,v28,v29
v_exp_f32 v32,v228
v_exp_f32 v33,v229
cvt v103,v30,v31
v_exp_f32 v34,v230
v_exp_f32 v35,v231
cvt v116,v32,v33
mf v[12:15],v[36:39],v[100:103],0
v_exp_f32 v24,v244
v_exp_f32 v25,v245
cvt v117,v34,v35
v_exp_f32 v26,v246
v_exp_f32 v27,v247
cvt v118,v24,v25
cvt v119,v26,v27
s_nop 1
mf v[12:15],v[36:39],v[116:119],v[12:15]
s_nop 7
s_setpc_b64 s[98:99]
LKm_spin:
s_sleep 4
buffer_load_dword v188,v37,s[36:39],0 offen sc1
s_waitcnt vmcnt(0)
s_branch LKm_chk
LKh_spin:
s_sleep 4
buffer_load_dword v188,v37,s[8:11],s52 offen sc1
s_waitcnt vmcnt(0)
s_branch LKh_chk
LVm_spin:
s_sleep 4
buffer_load_dword v188,v37,s[36:39],0 offen sc1
s_waitcnt vmcnt(0)
s_branch LVm_chk
LVh_spin:
s_sleep 4
buffer_load_dword v188,v37,s[8:11],s52 offen sc1
s_waitcnt vmcnt(0)
s_branch LVh_chk
Lkv_spin:
s_sleep 4
buffer_load_dword v18,v19,s[8:11],s46 offen sc1
s_waitcnt vmcnt(0)
s_branch Lkv_chk
Lr_spin:
s_sleep 4
buffer_load_dword v223,v222,s[8:11],s47 offen sc1
s_waitcnt vmcnt(0)
s_branch Lr_chk
Le_spin:
s_sleep 4
buffer_load_dword v121,v120,s[8:11],s54 offen sc1
s_waitcnt vmcnt(0)
s_branch Le_chk
Lwp_spin:
s_sleep 4
buffer_load_dword v16,v120,s[8:11],s45 offen sc1
s_waitcnt vmcnt(0)
s_branch Lwp_chk
Lhi_spin:
s_sleep 4
buffer_load_dword v15,v124,s[8:11],s55 offen sc1
s_waitcnt vmcnt(0)
s_branch Lhi_chk
Lwc_slow:
buffer_load_dword v204,v205,s[8:11],s63 offen sc1
s_waitcnt vmcnt(1)
buffer_store_dword v220,v221,s[8:11],s49 offen sc1
s_mov_b32 s49,0x100000
s_mov_b32 s40,s62
s_waitcnt vmcnt(1)
v_cmp_ne_u32 vcc,1,v204
s_nop 0
s_cbranch_vccz Lwc_bk
Lwc_lp:
buffer_load_dword v204,v205,s[8:11],s63 offen sc1
s_waitcnt vmcnt(0)
v_cmp_ne_u32 vcc,1,v204
s_nop 0
s_cbranch_vccz Lwc_bk
s_sleep 4
s_branch Lwc_lp
Lwc_bk:
buffer_load_dwordx4 a[128:131],v2,s[20:23],s40 offen sc1
buffer_load_dwordx4 a[132:135],v2,s[20:23],s40 offen offset:1024 sc1
s_add_u32 s40,s40,4096
buffer_load_dwordx4 a[136:139],v2,s[20:23],s40 offen sc1
buffer_load_dwordx4 a[140:143],v2,s[20:23],s40 offen offset:1024 sc1
s_add_u32 s40,s40,4096
buffer_load_dwordx4 a[144:147],v2,s[20:23],s40 offen sc1
buffer_load_dwordx4 a[148:151],v2,s[20:23],s40 offen offset:1024 sc1
s_add_u32 s40,s40,4096
buffer_load_dword v208,v6,s[8:11],s49 offen
buffer_load_dword v209,v6,s[8:11],s49 offen
buffer_load_dword v210,v6,s[8:11],s49 offen
buffer_load_dword v211,v6,s[8:11],s49 offen
buffer_load_dword v212,v6,s[8:11],s49 offen
buffer_load_dword v213,v6,s[8:11],s49 offen
buffer_load_dword v214,v6,s[8:11],s49 offen
buffer_load_dword v215,v6,s[8:11],s49 offen
s_branch Lwc_go
Lwd_slow:
Lwd_lp:
buffer_load_dword v204,v205,s[8:11],s63 offen sc1
s_waitcnt vmcnt(0)
v_cmp_ne_u32 vcc,1,v204
s_nop 0
s_cbranch_vccz Lwd_bk
s_sleep 4
s_branch Lwd_lp
Lwd_bk:
s_branch Lwd_go
Lha_slow:
buffer_load_dword v15,v124,s[8:11],s55 offen sc1
s_waitcnt vmcnt(1)
buffer_store_dword v5,v6,s[8:11],s54 offen sc1
s_mov_b32 s54,0x100000
s_mov_b32 s40,s62
s_waitcnt vmcnt(1)
v_cmp_ne_u32 vcc,1,v15
s_nop 0
s_cbranch_vccz Lha_bk
Lha_lp:
buffer_load_dword v15,v124,s[8:11],s55 offen sc1
s_waitcnt vmcnt(0)
v_cmp_ne_u32 vcc,1,v15
s_nop 0
s_cbranch_vccz Lha_bk
s_sleep 4
s_branch Lha_lp
Lha_bk:
buffer_load_dwordx4 a[64:67],v2,s[32:35],s40 offen sc1
buffer_load_dwordx4 a[68:71],v2,s[32:35],s40 offen offset:1024 sc1
s_add_u32 s40,s40,4096
buffer_load_dwordx4 a[72:75],v2,s[32:35],s40 offen sc1
buffer_load_dwordx4 a[76:79],v2,s[32:35],s40 offen offset:1024 sc1
s_add_u32 s40,s40,4096
buffer_load_dwordx4 a[80:83],v2,s[32:35],s40 offen sc1
buffer_load_dwordx4 a[84:87],v2,s[32:35],s40 offen offset:1024 sc1
s_add_u32 s40,s40,4096
buffer_load_dwordx4 a[88:91],v2,s[32:35],s40 offen sc1
buffer_load_dwordx4 a[92:95],v2,s[32:35],s40 offen offset:1024 sc1
s_add_u32 s40,s40,4096
buffer_load_dword v16,v6,s[8:11],s54 offen
buffer_load_dword v17,v6,s[8:11],s54 offen
buffer_load_dword v18,v6,s[8:11],s54 offen
buffer_load_dword v19,v6,s[8:11],s54 offen
buffer_load_dword v20,v6,s[8:11],s54 offen
s_branch Lha_go
Lhb_slow:
Lhb_lp:
buffer_load_dword v15,v124,s[8:11],s55 offen sc1
s_waitcnt vmcnt(0)
v_cmp_ne_u32 vcc,1,v15
s_nop 0
s_cbranch_vccz Lhb_bk
s_sleep 4
s_branch Lhb_lp
Lhb_bk:
s_branch Lhb_go
Lwa_slow:
buffer_load_dword v13,v7,s[8:11],s17 offen sc1
s_waitcnt vmcnt(1)
buffer_store_dword v5,v6,s[8:11],s47 offen sc1
s_mov_b32 s47,0x100000
s_waitcnt vmcnt(1)
v_cmp_ne_u32 vcc,1,v13
s_nop 0
s_cbranch_vccz Lwa_bk
Lwa_lp:
buffer_load_dword v13,v7,s[8:11],s17 offen sc1
s_waitcnt vmcnt(0)
v_cmp_ne_u32 vcc,1,v13
s_nop 0
s_cbranch_vccz Lwa_bk
s_sleep 4
s_branch Lwa_lp
Lwa_bk:
s_branch Lwa_go
Lwb_slow:
Lwb_lp:
buffer_load_dword v13,v7,s[8:11],s17 offen sc1
s_waitcnt vmcnt(0)
v_cmp_ne_u32 vcc,1,v13
s_nop 0
s_cbranch_vccz Lwb_bk
s_sleep 4
s_branch Lwb_lp
Lwb_bk:
s_branch Lwb_go
adaLN_cond__compressed_kv_cla__glu_gated_geglu__prompt_kernel_end:
code_end:
.section .rodata,"a"
.p2align 6
.amdhsa_kernel adaLN_cond__compressed_kv_cla__glu_gated_geglu__prompt_kernel
  .amdhsa_next_free_vgpr 512
  .amdhsa_next_free_sgpr 100
  .amdhsa_accum_offset 256
  .amdhsa_group_segment_fixed_size 0
  .amdhsa_kernarg_size 120
  .amdhsa_user_sgpr_count 2
  .amdhsa_user_sgpr_kernarg_segment_ptr 1
  .amdhsa_system_sgpr_workgroup_id_x 1
  .amdhsa_float_denorm_mode_32 3
.end_amdhsa_kernel
```
